```python
import torch

def _softmax(x, axis=-1):
    return torch.softmax(x, dim=axis)
def _gelu(x):
    return torch.nn.functional.gelu(x, approximate="tanh")
def _silu(x):
    return torch.nn.functional.silu(x)
def _sigmoid(x):
    return torch.sigmoid(x)
def _layernorm(x, axis=-1, eps=1e-5):
    m = x.mean(dim=axis, keepdim=True)
    v = x.var(dim=axis, keepdim=True, unbiased=False)
    return (x - m) / torch.sqrt(v + eps)
def _scatter_add(tgt, idx, src, axis=0):
    return tgt.clone().index_add_(axis, idx, src)
def _segment_sum(src, seg, n):
    out = torch.zeros((n,) + src.shape[1:], dtype=src.dtype)
    return out.index_add_(0, seg, src)
def _pad(x, pw):
    flat = tuple(v for pair in reversed(pw) for v in pair)
    return torch.nn.functional.pad(x, flat)

kernel_name = 'gated_mix__linear_kernel_hedgehog__swiglu_ffn__prompt'

def setup_inputs():

    _w = (lambda a: (lambda t: t.to(torch.bfloat16) if t.is_floating_point() else t)(torch.as_tensor(a)))
    def _A_setup():
        B, S, D, H = 1, 2048, 640, 32
        Dh = D // H
        return {
            "x": _w((lambda *s: torch.randn(*s, dtype=torch.bfloat16) * 0.05)(B, S, D)),
            "wqkv": _w((lambda *s: torch.randn(*s, dtype=torch.bfloat16) * 0.8)(D, 3 * D)),
            "w_phi": _w((lambda *s: torch.randn(*s, dtype=torch.bfloat16) * 0.8)(H, Dh, Dh) * (Dh ** -0.5)),
            "wo": _w((lambda *s: torch.randn(*s, dtype=torch.bfloat16) * 0.05)(D, D)),
        }
    _A_in = _A_setup()

    def _B_setup():
        B, S, D, F = 1, 2048, 640, 1728
        return {
            "x": _w((lambda *s: torch.randn(*s, dtype=torch.bfloat16) * 0.05)(B, S, D)),
            "w_gate": _w((lambda *s: torch.randn(*s, dtype=torch.bfloat16) * 0.05)(D, F)),
            "w_up": _w((lambda *s: torch.randn(*s, dtype=torch.bfloat16) * 0.05)(D, F)),
            "w_down": _w((lambda *s: torch.randn(*s, dtype=torch.bfloat16) * 0.05)(F, D)),
        }
    _B_in = _B_setup()

    return {
        "A_x": _A_in["x"],
        "A_wqkv": _A_in["wqkv"],
        "A_w_phi": _A_in["w_phi"],
        "A_wo": _A_in["wo"],
        "B_x": _B_in["x"],
        "B_w_gate": _B_in["w_gate"],
        "B_w_up": _B_in["w_up"],
        "B_w_down": _B_in["w_down"],
        "gate_w": _w((lambda *s: torch.randn(*s, dtype=torch.bfloat16) * 0.05)(640) * 16.0),
    }

def reference(A_x, A_wqkv, A_w_phi, A_wo, B_x, B_w_gate, B_w_up, B_w_down, gate_w):
    def _A_ref(x, wqkv, w_phi, wo):
        B, S, D = x.shape
        H = 32; Dh = D // H
        qkv = (lambda x, *d: x.permute(*d))((x @ wqkv).reshape(B, S, 3, H, Dh), 2, 0, 3, 1, 4)
        q, k, v = qkv[0], qkv[1], qkv[2]
        pq = torch.einsum("bhsd,hdf->bhsf", q, w_phi)
        pk = torch.einsum("bhsd,hdf->bhsf", k, w_phi)
        phi_q = torch.concatenate([_softmax(pq, axis=-1), _softmax(-pq, axis=-1)], axis=-1)
        phi_k = torch.concatenate([_softmax(pk, axis=-1), _softmax(-pk, axis=-1)], axis=-1)
        kv = torch.einsum("bhsf,bhsd->bhfd", phi_k, v)
        z  = torch.einsum("bhsf->bhf", phi_k)
        num = torch.einsum("bhqf,bhfd->bhqd", phi_q, kv)
        den = torch.einsum("bhqf,bhf->bhq", phi_q, z)[..., None] + 1e-6
        o = num / den
        return (lambda x, *d: x.permute(*d))(o, 0, 2, 1, 3).reshape(B, S, D) @ wo

    def _B_ref(x, w_gate, w_up, w_down):
        g = _silu(x @ w_gate)
        u = x @ w_up
        return (g * u) @ w_down

    x = A_x
    g = _sigmoid((x * gate_w).sum(-1, keepdims=True))
    a = _A_ref(x, A_wqkv, A_w_phi, A_wo)
    b = _B_ref(x, B_w_gate, B_w_up, B_w_down)
    return g * a + (1 - g) * b
```

```asm
; @launch kernel=gated_mix__linear_kernel_hedgehog__swiglu_ffn__prompt_kernel grid=(256,1,1) block=(256,1,1) lds=163840
.amdgcn_target "amdgcn-amd-amdhsa--gfx950"
.text
.globl gated_mix__linear_kernel_hedgehog__swiglu_ffn__prompt_kernel
.p2align 8
.type gated_mix__linear_kernel_hedgehog__swiglu_ffn__prompt_kernel,@function
gated_mix__linear_kernel_hedgehog__swiglu_ffn__prompt_kernel:
  s_load_dwordx16 s[8:23], s[0:1], 0
  s_load_dwordx8 s[24:31], s[0:1], 64
  s_cmp_ge_u32 s2, 256
  s_cbranch_scc1 L_end
  s_getpc_b64 s[72:73]
Lpc_1:
  s_lshr_b32 s74, s2, 3
  s_lshl_b32 s74, s74, 7
  v_and_b32 v63, 31, v0
  v_lshlrev_b32 v63, 12, v63
  v_add_u32_e64 v63, s74, v63
  v_min_u32 v63, L_end-Lpc_1-4, v63
  global_load_dword v63, v63, s[72:73]
  v_lshrrev_b32 v2, 6, v0
  v_and_b32 v0, 63, v0
  v_readfirstlane_b32 s32, v2
  s_and_b32 s64, s2, 7
  s_lshr_b32 s65, s2, 3
  s_lshl_b32 s74, s64, 3
  s_add_u32 s74, s74, s65
  s_add_u32 s74, s74, 126
  s_lshl_b32 s75, s64, 1
  s_add_u32 s75, s75, s65
  s_add_u32 s76, s75, 112
  s_cmp_lt_u32 s65, 18
  s_cselect_b32 s74, s76, s74
  s_lshl_b32 s76, s64, 4
  s_add_u32 s76, s76, s65
  s_cmp_lt_u32 s65, 16
  s_cselect_b32 s74, s76, s74
  s_and_b32 s35, s74, 15
  s_lshr_b32 s36, s74, 4
  s_and_b32 s33, s32, 1
  s_lshr_b32 s34, s32, 1
  v_lshlrev_b32 v2, 4, v0
  s_cmp_ge_u32 s65, 26
  s_cbranch_scc1 L_qa
  s_mov_b32 s75, 1280
  s_mov_b32 s76, 1280
  s_sub_u32 s79, s36, 9
  s_mul_i32 s65, s79, 320
  s_and_b32 s68, s65, 127
  s_sub_u32 s65, s65, s68
  s_add_u32 s75, s75, s65
  s_add_u32 s76, s76, s75
  s_mul_i32 s65, s36, 384
  s_mov_b32 s60, 3840
  s_cmp_lt_u32 s36, 9
  s_cselect_b32 s75, s65, s75
  s_cselect_b32 s76, s65, s76
  s_cselect_b32 s60, 3456, s60
  s_mul_i32 s65, s60, 640
  s_sub_u32 s77, s65, s75
  s_sub_u32 s78, s65, s76
  v_lshrrev_b32 v28, 3, v0
  v_and_b32 v29, 7, v0
  v_bfe_u32 v26, v28, 1, 1
  s_lshl_b32 s64, s33, 1
  v_or_b32 v26, s64, v26
  v_lshlrev_b32 v26, 1, v26
  v_xor_b32 v26, v26, v29
  s_lshl_b32 s64, s32, 3
  v_add_u32_e64 v27, s64, v28
  v_mul_lo_u32 v27, v27, s60
  v_lshl_add_u32 v5, v26, 4, v27
  s_lshl_b32 s64, s32, 5
  v_lshrrev_b32 v26, 1, v28
  v_xor_b32 v27, v26, v29
  v_add_u32 v26, s64, v28
  v_mul_u32_u24 v26, 1280, v26
  v_lshl_add_u32 v6, v27, 4, v26
  v_xor_b32_e64 v7, 64, v6
  v_add_u32 v7, 10240, v7
  v_add_u32 v8, 20480, v6
  v_add_u32 v9, 20480, v7
  s_mul_i32 s62, s32, 6144
  s_lshl_b32 s63, s32, 12
  s_add_u32 s63, s63, 98304
  s_mov_b32 s61, 0
  s_lshl_b32 s67, s60, 5
  s_mul_i32 s64, s35, 163840
  s_waitcnt lgkmcnt(0)
  s_cmp_lt_u32 s36, 9
  s_cselect_b64 s[16:17], s[18:19], s[10:11]
  s_cselect_b64 s[20:21], s[20:21], s[10:11]
  s_add_u32 s40, s8, s64
  s_addc_u32 s41, s9, 0
  s_and_b32 s41, s41, 0xffff
  s_mov_b32 s42, 0x28000
  s_mov_b32 s43, 0x20000
  s_add_u32 m0, s63, 0
  s_nop 0
  buffer_load_dwordx4 v6, s[40:43], 0 offen offset:0 lds
  s_add_u32 m0, s63, 1024
  s_nop 0
  buffer_load_dwordx4 v7, s[40:43], 0 offen offset:0 lds
  s_add_u32 m0, s63, 2048
  s_nop 0
  buffer_load_dwordx4 v8, s[40:43], 0 offen offset:0 lds
  s_add_u32 m0, s63, 3072
  s_nop 0
  buffer_load_dwordx4 v9, s[40:43], 0 offen offset:0 lds
  s_add_u32 s44, s16, s75
  s_addc_u32 s45, s17, 0
  s_and_b32 s45, s45, 0xffff
  s_mov_b32 s46, s77
  s_mov_b32 s47, 0x20000
  s_add_u32 s48, s20, s76
  s_addc_u32 s49, s21, 0
  s_and_b32 s49, s49, 0xffff
  s_mov_b32 s50, s78
  s_mov_b32 s51, 0x20000
  s_add_u32 m0, s62, 0
  s_nop 0
  buffer_load_dwordx4 v5, s[44:47], s61 offen offset:0 lds
  s_add_u32 m0, s62, 896
  s_nop 0
  buffer_load_dwordx4 v5, s[44:47], s61 offen offset:128 lds
  s_add_u32 m0, s62, 1792
  s_nop 0
  buffer_load_dwordx4 v5, s[44:47], s61 offen offset:256 lds
  s_add_u32 m0, s62, 3072
  s_nop 0
  buffer_load_dwordx4 v5, s[48:51], s61 offen offset:0 lds
  s_add_u32 m0, s62, 3968
  s_nop 0
  buffer_load_dwordx4 v5, s[48:51], s61 offen offset:128 lds
  s_add_u32 m0, s62, 4864
  s_nop 0
  buffer_load_dwordx4 v5, s[48:51], s61 offen offset:256 lds
  s_add_u32 s61, s61, s67
  v_lshrrev_b32 v26, 2, v0
  v_and_b32 v27, 3, v0
  s_lshl_b32 s64, s35, 1
  s_add_u32 s64, s64, s34
  v_lshlrev_b32 v28, 5, v26
  v_add_u32 v28, s64, v28
  v_mul_lo_u32 v28, v28, s60
  v_min_u32 v29, 2, v27
  v_lshl_add_u32 v24, v29, 7, v28
  s_lshl_b32 s64, s36, 4
  s_lshl_b32 s65, s32, 2
  s_add_u32 s64, s64, s65
  v_add_u32_e64 v27, s64, v27
  v_mul_u32_u24 v27, 1280, v27
  v_lshl_add_u32 v25, v26, 7, v27
  s_cmp_eq_u32 s33, 0
  s_cselect_b32 s96, s44, s48
  s_cselect_b32 s97, s45, s49
  s_cselect_b32 s98, s46, s50
  s_mov_b32 s99, 0x20000
  s_mul_i32 s101, s60, 32
  s_bfm_b64 exec, 28, 0
  buffer_load_dword v63, v24, s[96:99], s101 offen
  s_mov_b64 exec, -1
  s_bfm_b64 exec, 12, 0
  buffer_load_dword v63, v25, s[40:43], 0 offen offset:128
  s_mov_b64 exec, -1
  s_cmp_ge_u32 s36, 9
  s_cbranch_scc1 L_att
  v_and_b32 v54, 15, v0
  v_lshrrev_b32 v55, 4, v0
  v_bfe_u32 v26, v54, 1, 3
  v_xor_b32 v26, v26, v55
  s_lshl_b32 s64, s33, 13
  s_add_u32 s64, s64, 98304
  v_lshlrev_b32 v27, 7, v54
  v_add_u32 v27, s64, v27
  v_lshl_add_u32 v10, v26, 4, v27
  v_xor_b32 v11, 64, v10
  v_bfe_u32 v26, v0, 2, 2
  v_and_b32 v27, 3, v0
  v_lshrrev_b32 v28, 1, v26
  v_and_b32 v29, 1, v55
  v_lshl_or_b32 v28, v29, 1, v28
  v_lshlrev_b32 v28, 5, v28
  v_mul_u32_u24 v29, 6144, v55
  v_lshl_add_u32 v29, v26, 7, v29
  s_mul_i32 s64, s34, 192
  v_lshlrev_b32 v27, 3, v27
  v_add_u32 v27, s64, v27
  v_add_u32 v30, 0, v27
  v_lshrrev_b32 v31, 7, v30
  v_and_b32 v30, 127, v30
  v_xor_b32 v30, v30, v28
  v_lshl_add_u32 v31, v31, 10, v29
  v_add_u32 v12, v30, v31
  v_add_u32 v18, 49152, v12
  v_add_u32 v30, 32, v27
  v_lshrrev_b32 v31, 7, v30
  v_and_b32 v30, 127, v30
  v_xor_b32 v30, v30, v28
  v_lshl_add_u32 v31, v31, 10, v29
  v_add_u32 v13, v30, v31
  v_add_u32 v19, 49152, v13
  v_add_u32 v30, 64, v27
  v_lshrrev_b32 v31, 7, v30
  v_and_b32 v30, 127, v30
  v_xor_b32 v30, v30, v28
  v_lshl_add_u32 v31, v31, 10, v29
  v_add_u32 v14, v30, v31
  v_add_u32 v20, 49152, v14
  v_add_u32 v30, 96, v27
  v_lshrrev_b32 v31, 7, v30
  v_and_b32 v30, 127, v30
  v_xor_b32 v30, v30, v28
  v_lshl_add_u32 v31, v31, 10, v29
  v_add_u32_e64 v15, v30, v31
  v_add_u32 v21, 49152, v15
  v_add_u32 v30, 128, v27
  v_lshrrev_b32 v31, 7, v30
  v_and_b32 v30, 127, v30
  v_xor_b32 v30, v30, v28
  v_lshl_add_u32 v31, v31, 10, v29
  v_add_u32_e64 v16, v30, v31
  v_add_u32 v22, 49152, v16
  v_add_u32 v30, 160, v27
  v_lshrrev_b32 v31, 7, v30
  v_and_b32 v30, 127, v30
  v_xor_b32 v30, v30, v28
  v_lshl_add_u32 v31, v31, 10, v29
  v_add_u32_e64 v17, v30, v31
  v_add_u32 v23, 49152, v17
  s_add_u32 m0, s62, 24576
  s_nop 0
  buffer_load_dwordx4 v5, s[44:47], s61 offen offset:0 lds
  s_add_u32 m0, s62, 25472
  s_nop 0
  buffer_load_dwordx4 v5, s[44:47], s61 offen offset:128 lds
  s_add_u32 m0, s62, 26368
  s_nop 0
  buffer_load_dwordx4 v5, s[44:47], s61 offen offset:256 lds
  s_add_u32 m0, s62, 27648
  s_nop 0
  buffer_load_dwordx4 v5, s[48:51], s61 offen offset:0 lds
  s_add_u32 m0, s62, 28544
  s_nop 0
  buffer_load_dwordx4 v5, s[48:51], s61 offen offset:128 lds
  s_add_u32 m0, s62, 29440
  s_nop 0
  buffer_load_dwordx4 v5, s[48:51], s61 offen offset:256 lds
  s_add_u32 s61, s61, s67
  s_waitcnt vmcnt(8)
  s_barrier
  s_nop 0
  ds_read_b128 a[96:99], v10 offset:0
  ds_read_b128 a[100:103], v10 offset:2048
  ds_read_b128 a[104:107], v10 offset:4096
  ds_read_b128 a[108:111], v10 offset:6144
  ds_read_b64_tr_b16 a[0:1], v12 offset:0
  ds_read_b64_tr_b16 a[2:3], v12 offset:512
  ds_read_b64_tr_b16 a[4:5], v12 offset:3072
  ds_read_b64_tr_b16 a[6:7], v12 offset:3584
  ds_read_b64_tr_b16 a[8:9], v13 offset:0
  ds_read_b64_tr_b16 a[10:11], v13 offset:512
  ds_read_b64_tr_b16 a[12:13], v13 offset:3072
  ds_read_b64_tr_b16 a[14:15], v13 offset:3584
  ds_read_b64_tr_b16 a[16:17], v14 offset:0
  ds_read_b64_tr_b16 a[18:19], v14 offset:512
  ds_read_b64_tr_b16 a[20:21], v14 offset:3072
  ds_read_b64_tr_b16 a[22:23], v14 offset:3584
  ds_read_b64_tr_b16 a[24:25], v15 offset:0
  ds_read_b64_tr_b16 a[26:27], v15 offset:512
  ds_read_b64_tr_b16 a[28:29], v15 offset:3072
  ds_read_b64_tr_b16 a[30:31], v15 offset:3584
  ds_read_b64_tr_b16 a[32:33], v16 offset:0
  ds_read_b64_tr_b16 a[34:35], v16 offset:512
  ds_read_b64_tr_b16 a[36:37], v16 offset:3072
  ds_read_b64_tr_b16 a[38:39], v16 offset:3584
  ds_read_b64_tr_b16 a[40:41], v17 offset:0
  ds_read_b64_tr_b16 a[42:43], v17 offset:512
  ds_read_b64_tr_b16 a[44:45], v17 offset:3072
  ds_read_b64_tr_b16 a[46:47], v17 offset:3584
  s_waitcnt lgkmcnt(14)
  s_nop 0
  v_mfma_f32_16x16x32_bf16 v[64:67], a[0:3], a[96:99], 0
  s_add_u32 m0, s63, 16256
  v_mfma_f32_16x16x32_bf16 v[68:71], a[0:3], a[100:103], 0
  buffer_load_dwordx4 v6, s[40:43], 0 offen offset:128 lds
  v_mfma_f32_16x16x32_bf16 v[72:75], a[0:3], a[104:107], 0
  s_add_u32 m0, s63, 17280
  v_mfma_f32_16x16x32_bf16 v[76:79], a[0:3], a[108:111], 0
  buffer_load_dwordx4 v7, s[40:43], 0 offen offset:128 lds
  v_mfma_f32_16x16x32_bf16 v[80:83], a[4:7], a[96:99], 0
  v_mfma_f32_16x16x32_bf16 v[84:87], a[4:7], a[100:103], 0
  s_add_u32 m0, s63, 18304
  v_mfma_f32_16x16x32_bf16 v[88:91], a[4:7], a[104:107], 0
  buffer_load_dwordx4 v8, s[40:43], 0 offen offset:128 lds
  v_mfma_f32_16x16x32_bf16 v[92:95], a[4:7], a[108:111], 0
  v_mfma_f32_16x16x32_bf16 v[96:99], a[8:11], a[96:99], 0
  s_add_u32 m0, s63, 19328
  v_mfma_f32_16x16x32_bf16 v[100:103], a[8:11], a[100:103], 0
  buffer_load_dwordx4 v9, s[40:43], 0 offen offset:128 lds
  v_mfma_f32_16x16x32_bf16 v[104:107], a[8:11], a[104:107], 0
  v_mfma_f32_16x16x32_bf16 v[108:111], a[8:11], a[108:111], 0
  s_add_u32 m0, s62, 49152
  v_mfma_f32_16x16x32_bf16 v[112:115], a[12:15], a[96:99], 0
  buffer_load_dwordx4 v5, s[44:47], s61 offen offset:0 lds
  v_mfma_f32_16x16x32_bf16 v[116:119], a[12:15], a[100:103], 0
  v_mfma_f32_16x16x32_bf16 v[120:123], a[12:15], a[104:107], 0
  s_add_u32 m0, s62, 50048
  v_mfma_f32_16x16x32_bf16 v[124:127], a[12:15], a[108:111], 0
  buffer_load_dwordx4 v5, s[44:47], s61 offen offset:128 lds
  v_mfma_f32_16x16x32_bf16 v[128:131], a[16:19], a[96:99], 0
  s_add_u32 m0, s62, 50944
  v_mfma_f32_16x16x32_bf16 v[132:135], a[16:19], a[100:103], 0
  buffer_load_dwordx4 v5, s[44:47], s61 offen offset:256 lds
  v_mfma_f32_16x16x32_bf16 v[136:139], a[16:19], a[104:107], 0
  v_mfma_f32_16x16x32_bf16 v[140:143], a[16:19], a[108:111], 0
  s_add_u32 m0, s62, 52224
  s_waitcnt lgkmcnt(12)
  v_mfma_f32_16x16x32_bf16 v[144:147], a[20:23], a[96:99], 0
  buffer_load_dwordx4 v5, s[48:51], s61 offen offset:0 lds
  v_mfma_f32_16x16x32_bf16 v[148:151], a[20:23], a[100:103], 0
  v_mfma_f32_16x16x32_bf16 v[152:155], a[20:23], a[104:107], 0
  s_add_u32 m0, s62, 53120
  v_mfma_f32_16x16x32_bf16 v[156:159], a[20:23], a[108:111], 0
  buffer_load_dwordx4 v5, s[48:51], s61 offen offset:128 lds
  s_waitcnt lgkmcnt(10)
  v_mfma_f32_16x16x32_bf16 v[160:163], a[24:27], a[96:99], 0
  v_mfma_f32_16x16x32_bf16 v[164:167], a[24:27], a[100:103], 0
  s_add_u32 m0, s62, 54016
  v_mfma_f32_16x16x32_bf16 v[168:171], a[24:27], a[104:107], 0
  buffer_load_dwordx4 v5, s[48:51], s61 offen offset:256 lds
  s_add_u32 s61, s61, s67
  v_mfma_f32_16x16x32_bf16 v[172:175], a[24:27], a[108:111], 0
  s_waitcnt lgkmcnt(8)
  v_mfma_f32_16x16x32_bf16 v[176:179], a[28:31], a[96:99], 0
  s_add_u32 m0, s62, 73728
  v_mfma_f32_16x16x32_bf16 v[180:183], a[28:31], a[100:103], 0
  buffer_load_dwordx4 v5, s[44:47], s61 offen offset:0 lds
  s_waitcnt vmcnt(11) lgkmcnt(0)
  s_barrier
  v_mfma_f32_16x16x32_bf16 v[184:187], a[28:31], a[104:107], 0
  ds_read_b128 a[112:115], v11 offset:0
  ds_read_b128 a[116:119], v11 offset:2048
  s_add_u32 m0, s62, 74624
  v_mfma_f32_16x16x32_bf16 v[188:191], a[28:31], a[108:111], 0
  ds_read_b128 a[120:123], v11 offset:4096
  ds_read_b128 a[124:127], v11 offset:6144
  buffer_load_dwordx4 v5, s[44:47], s61 offen offset:128 lds
  v_mfma_f32_16x16x32_bf16 v[192:195], a[32:35], a[96:99], 0
  ds_read_b64_tr_b16 a[48:49], v12 offset:24576
  ds_read_b64_tr_b16 a[50:51], v12 offset:25088
  v_mfma_f32_16x16x32_bf16 v[196:199], a[32:35], a[100:103], 0
  ds_read_b64_tr_b16 a[52:53], v12 offset:27648
  ds_read_b64_tr_b16 a[54:55], v12 offset:28160
  s_add_u32 m0, s62, 75520
  v_mfma_f32_16x16x32_bf16 v[200:203], a[32:35], a[104:107], 0
  ds_read_b64_tr_b16 a[56:57], v13 offset:24576
  ds_read_b64_tr_b16 a[58:59], v13 offset:25088
  buffer_load_dwordx4 v5, s[44:47], s61 offen offset:256 lds
  v_mfma_f32_16x16x32_bf16 v[204:207], a[32:35], a[108:111], 0
  ds_read_b64_tr_b16 a[60:61], v13 offset:27648
  ds_read_b64_tr_b16 a[62:63], v13 offset:28160
  v_mfma_f32_16x16x32_bf16 v[208:211], a[36:39], a[96:99], 0
  ds_read_b64_tr_b16 a[64:65], v14 offset:24576
  ds_read_b64_tr_b16 a[66:67], v14 offset:25088
  s_add_u32 m0, s62, 76800
  v_mfma_f32_16x16x32_bf16 v[212:215], a[36:39], a[100:103], 0
  ds_read_b64_tr_b16 a[68:69], v14 offset:27648
  ds_read_b64_tr_b16 a[70:71], v14 offset:28160
  buffer_load_dwordx4 v5, s[48:51], s61 offen offset:0 lds
  v_mfma_f32_16x16x32_bf16 v[216:219], a[36:39], a[104:107], 0
  ds_read_b64_tr_b16 a[72:73], v15 offset:24576
  ds_read_b64_tr_b16 a[74:75], v15 offset:25088
  v_mfma_f32_16x16x32_bf16 v[220:223], a[36:39], a[108:111], 0
  ds_read_b64_tr_b16 a[76:77], v15 offset:27648
  ds_read_b64_tr_b16 a[78:79], v15 offset:28160
  s_add_u32 m0, s62, 77696
  v_mfma_f32_16x16x32_bf16 v[224:227], a[40:43], a[96:99], 0
  ds_read_b64_tr_b16 a[80:81], v16 offset:24576
  ds_read_b64_tr_b16 a[82:83], v16 offset:25088
  buffer_load_dwordx4 v5, s[48:51], s61 offen offset:128 lds
  v_mfma_f32_16x16x32_bf16 v[228:231], a[40:43], a[100:103], 0
  ds_read_b64_tr_b16 a[84:85], v16 offset:27648
  ds_read_b64_tr_b16 a[86:87], v16 offset:28160
  v_mfma_f32_16x16x32_bf16 v[232:235], a[40:43], a[104:107], 0
  ds_read_b64_tr_b16 a[88:89], v17 offset:24576
  ds_read_b64_tr_b16 a[90:91], v17 offset:25088
  s_add_u32 m0, s62, 78592
  v_mfma_f32_16x16x32_bf16 v[236:239], a[40:43], a[108:111], 0
  ds_read_b64_tr_b16 a[92:93], v17 offset:27648
  ds_read_b64_tr_b16 a[94:95], v17 offset:28160
  buffer_load_dwordx4 v5, s[48:51], s61 offen offset:256 lds
  s_add_u32 s61, s61, s67
  v_mfma_f32_16x16x32_bf16 v[240:243], a[44:47], a[96:99], 0
  v_mfma_f32_16x16x32_bf16 v[244:247], a[44:47], a[100:103], 0
  v_mfma_f32_16x16x32_bf16 v[248:251], a[44:47], a[104:107], 0
  v_mfma_f32_16x16x32_bf16 v[252:255], a[44:47], a[108:111], 0
  s_waitcnt vmcnt(6) lgkmcnt(0)
  s_barrier
  v_mfma_f32_16x16x32_bf16 v[64:67], a[48:51], a[112:115], v[64:67]
  ds_read_b128 a[96:99], v10 offset:16384
  s_add_u32 m0, s63, 32512
  v_mfma_f32_16x16x32_bf16 v[68:71], a[48:51], a[116:119], v[68:71]
  ds_read_b128 a[100:103], v10 offset:18432
  buffer_load_dwordx4 v6, s[40:43], 0 offen offset:256 lds
  v_mfma_f32_16x16x32_bf16 v[72:75], a[48:51], a[120:123], v[72:75]
  ds_read_b128 a[104:107], v10 offset:20480
  s_and_b32 s65, s2, 7
  v_mfma_f32_16x16x32_bf16 v[76:79], a[48:51], a[124:127], v[76:79]
  ds_read_b128 a[108:111], v10 offset:22528
  s_add_u32 m0, s63, 33536
  v_mfma_f32_16x16x32_bf16 v[80:83], a[52:55], a[112:115], v[80:83]
  ds_read_b64_tr_b16 a[0:1], v18 offset:0
  buffer_load_dwordx4 v7, s[40:43], 0 offen offset:256 lds
  v_mfma_f32_16x16x32_bf16 v[84:87], a[52:55], a[116:119], v[84:87]
  ds_read_b64_tr_b16 a[2:3], v18 offset:512
  s_lshr_b32 s39, s2, 3
  v_mfma_f32_16x16x32_bf16 v[88:91], a[52:55], a[120:123], v[88:91]
  ds_read_b64_tr_b16 a[4:5], v18 offset:3072
  s_add_u32 m0, s63, 34560
  v_mfma_f32_16x16x32_bf16 v[92:95], a[52:55], a[124:127], v[92:95]
  ds_read_b64_tr_b16 a[6:7], v18 offset:3584
  buffer_load_dwordx4 v8, s[40:43], 0 offen offset:256 lds
  v_mfma_f32_16x16x32_bf16 v[96:99], a[56:59], a[112:115], v[96:99]
  ds_read_b64_tr_b16 a[8:9], v19 offset:0
  s_lshl_b32 s37, s65, 2
  v_mfma_f32_16x16x32_bf16 v[100:103], a[56:59], a[116:119], v[100:103]
  ds_read_b64_tr_b16 a[10:11], v19 offset:512
  s_and_b32 s64, s39, 3
  v_mfma_f32_16x16x32_bf16 v[104:107], a[56:59], a[120:123], v[104:107]
  ds_read_b64_tr_b16 a[12:13], v19 offset:3072
  s_add_u32 m0, s63, 35584
  v_mfma_f32_16x16x32_bf16 v[108:111], a[56:59], a[124:127], v[108:111]
  ds_read_b64_tr_b16 a[14:15], v19 offset:3584
  buffer_load_dwordx4 v9, s[40:43], 0 offen offset:256 lds
  v_mfma_f32_16x16x32_bf16 v[112:115], a[60:63], a[112:115], v[112:115]
  ds_read_b64_tr_b16 a[16:17], v20 offset:0
  s_add_u32 s37, s37, s64
  v_mfma_f32_16x16x32_bf16 v[116:119], a[60:63], a[116:119], v[116:119]
  ds_read_b64_tr_b16 a[18:19], v20 offset:512
  s_add_u32 m0, s62, 0
  v_mfma_f32_16x16x32_bf16 v[120:123], a[60:63], a[120:123], v[120:123]
  ds_read_b64_tr_b16 a[20:21], v20 offset:3072
  buffer_load_dwordx4 v5, s[44:47], s61 offen offset:0 lds
  v_mfma_f32_16x16x32_bf16 v[124:127], a[60:63], a[124:127], v[124:127]
  ds_read_b64_tr_b16 a[22:23], v20 offset:3584
  s_lshr_b32 s38, s39, 2
  v_mfma_f32_16x16x32_bf16 v[128:131], a[64:67], a[112:115], v[128:131]
  ds_read_b64_tr_b16 a[24:25], v21 offset:0
  s_lshr_b32 s83, s39, 1
  v_mfma_f32_16x16x32_bf16 v[132:135], a[64:67], a[116:119], v[132:135]
  ds_read_b64_tr_b16 a[26:27], v21 offset:512
  s_add_u32 m0, s62, 896
  v_mfma_f32_16x16x32_bf16 v[136:139], a[64:67], a[120:123], v[136:139]
  ds_read_b64_tr_b16 a[28:29], v21 offset:3072
  buffer_load_dwordx4 v5, s[44:47], s61 offen offset:128 lds
  v_mfma_f32_16x16x32_bf16 v[140:143], a[64:67], a[124:127], v[140:143]
  ds_read_b64_tr_b16 a[30:31], v21 offset:3584
  s_lshl_b32 s83, s83, 1
  v_mfma_f32_16x16x32_bf16 v[144:147], a[68:71], a[112:115], v[144:147]
  ds_read_b64_tr_b16 a[32:33], v22 offset:0
  s_add_u32 m0, s62, 1792
  v_mfma_f32_16x16x32_bf16 v[148:151], a[68:71], a[116:119], v[148:151]
  ds_read_b64_tr_b16 a[34:35], v22 offset:512
  buffer_load_dwordx4 v5, s[44:47], s61 offen offset:256 lds
  v_mfma_f32_16x16x32_bf16 v[152:155], a[68:71], a[120:123], v[152:155]
  ds_read_b64_tr_b16 a[36:37], v22 offset:3072
  s_and_b32 s39, s39, 1
  v_mfma_f32_16x16x32_bf16 v[156:159], a[68:71], a[124:127], v[156:159]
  ds_read_b64_tr_b16 a[38:39], v22 offset:3584
  s_lshl_b32 s64, s65, 1
  v_mfma_f32_16x16x32_bf16 v[160:163], a[72:75], a[112:115], v[160:163]
  ds_read_b64_tr_b16 a[40:41], v23 offset:0
  s_add_u32 m0, s62, 3072
  v_mfma_f32_16x16x32_bf16 v[164:167], a[72:75], a[116:119], v[164:167]
  ds_read_b64_tr_b16 a[42:43], v23 offset:512
  buffer_load_dwordx4 v5, s[48:51], s61 offen offset:0 lds
  v_mfma_f32_16x16x32_bf16 v[168:171], a[72:75], a[120:123], v[168:171]
  ds_read_b64_tr_b16 a[44:45], v23 offset:3072
  s_add_u32 s39, s39, s64
  v_mfma_f32_16x16x32_bf16 v[172:175], a[72:75], a[124:127], v[172:175]
  ds_read_b64_tr_b16 a[46:47], v23 offset:3584
  s_add_u32 m0, s62, 3968
  v_mfma_f32_16x16x32_bf16 v[176:179], a[76:79], a[112:115], v[176:179]
  buffer_load_dwordx4 v5, s[48:51], s61 offen offset:128 lds
  s_mul_i32 s64, s38, 378880
  v_mfma_f32_16x16x32_bf16 v[180:183], a[76:79], a[116:119], v[180:183]
  s_add_u32 s84, s30, s64
  s_addc_u32 s85, s31, 0
  s_add_u32 s84, s84, 0xa00000
  s_addc_u32 s85, s85, 0
  v_mfma_f32_16x16x32_bf16 v[184:187], a[76:79], a[120:123], v[184:187]
  s_and_b32 s85, s85, 0xffff
  s_mov_b32 s86, 0x5c800
  v_mfma_f32_16x16x32_bf16 v[188:191], a[76:79], a[124:127], v[188:191]
  s_add_u32 m0, s62, 4864
  s_mov_b32 s87, 0x20000
  v_mfma_f32_16x16x32_bf16 v[192:195], a[80:83], a[112:115], v[192:195]
  buffer_load_dwordx4 v5, s[48:51], s61 offen offset:256 lds
  s_add_u32 s61, s61, s67
  s_mul_i32 s89, s32, 5120
  v_mfma_f32_16x16x32_bf16 v[196:199], a[80:83], a[116:119], v[196:199]
  s_add_u32 s90, s30, 0x1300000
  s_addc_u32 s91, s31, 0
  v_add_u32 v3, 4096, v2
  v_mfma_f32_16x16x32_bf16 v[200:203], a[80:83], a[120:123], v[200:203]
  s_add_u32 m0, s62, 24576
  s_mov_b32 s70, 0x3fb8aa3b
  v_mfma_f32_16x16x32_bf16 v[204:207], a[80:83], a[124:127], v[204:207]
  buffer_load_dwordx4 v5, s[44:47], s61 offen offset:0 lds
  s_mov_b32 s71, 0x3fb8aa3b
  v_mfma_f32_16x16x32_bf16 v[208:211], a[84:87], a[112:115], v[208:211]
  s_lshl_b32 s75, s35, 1
  s_add_u32 s75, s75, s33
  v_mfma_f32_16x16x32_bf16 v[212:215], a[84:87], a[116:119], v[212:215]
  s_mul_i32 s75, s75, 74
  s_mul_i32 s76, s36, 6
  v_mfma_f32_16x16x32_bf16 v[216:219], a[84:87], a[120:123], v[216:219]
  s_mul_i32 s101, s60, 256
  s_add_u32 s75, s75, s76
  v_mfma_f32_16x16x32_bf16 v[220:223], a[84:87], a[124:127], v[220:223]
  s_bfm_b64 exec, 24, 0
  buffer_load_dword v63, v24, s[96:99], s101 offen
  s_mov_b64 exec, -1
  s_mul_i32 s76, s34, 3
  v_mfma_f32_16x16x32_bf16 v[224:227], a[88:91], a[112:115], v[224:227]
  s_add_u32 s75, s75, s76
  s_add_u32 s75, s75, 20
  v_mfma_f32_16x16x32_bf16 v[228:231], a[88:91], a[116:119], v[228:231]
  s_lshl_b32 s75, s75, 12
  s_mul_i32 s69, s35, 4352
  v_mfma_f32_16x16x32_bf16 v[232:235], a[88:91], a[120:123], v[232:235]
  s_bfm_b64 exec, 12, 0
  buffer_load_dword v63, v25, s[40:43], 0 offen offset:512
  s_mov_b64 exec, -1
  s_mov_b32 s52, s30
  v_mfma_f32_16x16x32_bf16 v[236:239], a[88:91], a[124:127], v[236:239]
  s_and_b32 s53, s31, 0xffff
  s_mov_b32 s54, 0x940000
  v_mfma_f32_16x16x32_bf16 v[240:243], a[92:95], a[112:115], v[240:243]
  s_mov_b32 s55, 0x20000
  s_mul_i32 s77, s35, 163840
  v_mfma_f32_16x16x32_bf16 v[244:247], a[92:95], a[116:119], v[244:247]
  s_add_u32 s56, s26, s77
  s_addc_u32 s57, s27, 0
  s_and_b32 s57, s57, 0xffff
  v_mfma_f32_16x16x32_bf16 v[248:251], a[92:95], a[120:123], v[248:251]
  s_mov_b32 s58, 0x28000
  s_mov_b32 s59, 0x20000
  v_mfma_f32_16x16x32_bf16 v[252:255], a[92:95], a[124:127], v[252:255]
  s_lshl_b32 s76, s36, 2
  s_add_u32 s76, s76, s32
  s_waitcnt vmcnt(13) lgkmcnt(0)
  s_barrier
  s_nop 0
  v_mfma_f32_16x16x32_bf16 v[64:67], a[0:3], a[96:99], v[64:67]
  ds_read_b128 a[112:115], v11 offset:16384
  s_add_u32 m0, s62, 25472
  v_mfma_f32_16x16x32_bf16 v[68:71], a[0:3], a[100:103], v[68:71]
  ds_read_b128 a[116:119], v11 offset:18432
  buffer_load_dwordx4 v5, s[44:47], s61 offen offset:128 lds
  v_mfma_f32_16x16x32_bf16 v[72:75], a[0:3], a[104:107], v[72:75]
  ds_read_b128 a[120:123], v11 offset:20480
  s_mul_i32 s76, s76, 5120
  v_mfma_f32_16x16x32_bf16 v[76:79], a[0:3], a[108:111], v[76:79]
  ds_read_b128 a[124:127], v11 offset:22528
  v_mov_b32_e64 v26, 0
  v_mfma_f32_16x16x32_bf16 v[80:83], a[4:7], a[96:99], v[80:83]
  ds_read_b64_tr_b16 a[48:49], v18 offset:24576
  s_add_u32 m0, s62, 26368
  v_mfma_f32_16x16x32_bf16 v[84:87], a[4:7], a[100:103], v[84:87]
  ds_read_b64_tr_b16 a[50:51], v18 offset:25088
  buffer_load_dwordx4 v5, s[44:47], s61 offen offset:256 lds
  v_mfma_f32_16x16x32_bf16 v[88:91], a[4:7], a[104:107], v[88:91]
  ds_read_b64_tr_b16 a[52:53], v18 offset:27648
  v_mov_b32_e64 v27, 0
  v_mfma_f32_16x16x32_bf16 v[92:95], a[4:7], a[108:111], v[92:95]
  ds_read_b64_tr_b16 a[54:55], v18 offset:28160
  v_mov_b32_e64 v28, 0
  v_mfma_f32_16x16x32_bf16 v[96:99], a[8:11], a[96:99], v[96:99]
  ds_read_b64_tr_b16 a[56:57], v19 offset:24576
  s_add_u32 m0, s62, 27648
  v_mfma_f32_16x16x32_bf16 v[100:103], a[8:11], a[100:103], v[100:103]
  ds_read_b64_tr_b16 a[58:59], v19 offset:25088
  buffer_load_dwordx4 v5, s[48:51], s61 offen offset:0 lds
  v_mfma_f32_16x16x32_bf16 v[104:107], a[8:11], a[104:107], v[104:107]
  ds_read_b64_tr_b16 a[60:61], v19 offset:27648
  v_mov_b32_e64 v29, 0
  v_mfma_f32_16x16x32_bf16 v[108:111], a[8:11], a[108:111], v[108:111]
  ds_read_b64_tr_b16 a[62:63], v19 offset:28160
  v_mfma_f32_16x16x32_bf16 v[112:115], a[12:15], a[96:99], v[112:115]
  ds_read_b64_tr_b16 a[64:65], v20 offset:24576
  s_add_u32 m0, s62, 28544
  v_mfma_f32_16x16x32_bf16 v[116:119], a[12:15], a[100:103], v[116:119]
  ds_read_b64_tr_b16 a[66:67], v20 offset:25088
  buffer_load_dwordx4 v5, s[48:51], s61 offen offset:128 lds
  v_mfma_f32_16x16x32_bf16 v[120:123], a[12:15], a[104:107], v[120:123]
  ds_read_b64_tr_b16 a[68:69], v20 offset:27648
  v_mfma_f32_16x16x32_bf16 v[124:127], a[12:15], a[108:111], v[124:127]
  ds_read_b64_tr_b16 a[70:71], v20 offset:28160
  v_mfma_f32_16x16x32_bf16 v[128:131], a[16:19], a[96:99], v[128:131]
  ds_read_b64_tr_b16 a[72:73], v21 offset:24576
  s_add_u32 m0, s62, 29440
  v_mfma_f32_16x16x32_bf16 v[132:135], a[16:19], a[100:103], v[132:135]
  ds_read_b64_tr_b16 a[74:75], v21 offset:25088
  buffer_load_dwordx4 v5, s[48:51], s61 offen offset:256 lds
  s_add_u32 s61, s61, s67
  s_nop 0
  v_mfma_f32_16x16x32_bf16 v[136:139], a[16:19], a[104:107], v[136:139]
  ds_read_b64_tr_b16 a[76:77], v21 offset:27648
  v_mfma_f32_16x16x32_bf16 v[140:143], a[16:19], a[108:111], v[140:143]
  ds_read_b64_tr_b16 a[78:79], v21 offset:28160
  v_mfma_f32_16x16x32_bf16 v[144:147], a[20:23], a[96:99], v[144:147]
  ds_read_b64_tr_b16 a[80:81], v22 offset:24576
  s_add_u32 m0, s63, -384
  v_mfma_f32_16x16x32_bf16 v[148:151], a[20:23], a[100:103], v[148:151]
  ds_read_b64_tr_b16 a[82:83], v22 offset:25088
  buffer_load_dwordx4 v6, s[40:43], 0 offen offset:384 lds
  v_mfma_f32_16x16x32_bf16 v[152:155], a[20:23], a[104:107], v[152:155]
  ds_read_b64_tr_b16 a[84:85], v22 offset:27648
  v_mfma_f32_16x16x32_bf16 v[156:159], a[20:23], a[108:111], v[156:159]
  ds_read_b64_tr_b16 a[86:87], v22 offset:28160
  v_mfma_f32_16x16x32_bf16 v[160:163], a[24:27], a[96:99], v[160:163]
  ds_read_b64_tr_b16 a[88:89], v23 offset:24576
  s_add_u32 m0, s63, 640
  v_mfma_f32_16x16x32_bf16 v[164:167], a[24:27], a[100:103], v[164:167]
  ds_read_b64_tr_b16 a[90:91], v23 offset:25088
  buffer_load_dwordx4 v7, s[40:43], 0 offen offset:384 lds
  v_mfma_f32_16x16x32_bf16 v[168:171], a[24:27], a[104:107], v[168:171]
  ds_read_b64_tr_b16 a[92:93], v23 offset:27648
  v_mfma_f32_16x16x32_bf16 v[172:175], a[24:27], a[108:111], v[172:175]
  ds_read_b64_tr_b16 a[94:95], v23 offset:28160
  v_mfma_f32_16x16x32_bf16 v[176:179], a[28:31], a[96:99], v[176:179]
  s_add_u32 m0, s63, 1664
  v_mfma_f32_16x16x32_bf16 v[180:183], a[28:31], a[100:103], v[180:183]
  buffer_load_dwordx4 v8, s[40:43], 0 offen offset:384 lds
  v_mfma_f32_16x16x32_bf16 v[184:187], a[28:31], a[104:107], v[184:187]
  v_mfma_f32_16x16x32_bf16 v[188:191], a[28:31], a[108:111], v[188:191]
  v_mfma_f32_16x16x32_bf16 v[192:195], a[32:35], a[96:99], v[192:195]
  s_add_u32 m0, s63, 2688
  v_mfma_f32_16x16x32_bf16 v[196:199], a[32:35], a[100:103], v[196:199]
  buffer_load_dwordx4 v9, s[40:43], 0 offen offset:384 lds
  v_mfma_f32_16x16x32_bf16 v[200:203], a[32:35], a[104:107], v[200:203]
  v_mfma_f32_16x16x32_bf16 v[204:207], a[32:35], a[108:111], v[204:207]
  v_mfma_f32_16x16x32_bf16 v[208:211], a[36:39], a[96:99], v[208:211]
  s_add_u32 m0, s62, 49152
  v_mfma_f32_16x16x32_bf16 v[212:215], a[36:39], a[100:103], v[212:215]
  buffer_load_dwordx4 v5, s[44:47], s61 offen offset:0 lds
  v_mfma_f32_16x16x32_bf16 v[216:219], a[36:39], a[104:107], v[216:219]
  v_mfma_f32_16x16x32_bf16 v[220:223], a[36:39], a[108:111], v[220:223]
  v_mfma_f32_16x16x32_bf16 v[224:227], a[40:43], a[96:99], v[224:227]
  s_add_u32 m0, s62, 50048
  v_mfma_f32_16x16x32_bf16 v[228:231], a[40:43], a[100:103], v[228:231]
  buffer_load_dwordx4 v5, s[44:47], s61 offen offset:128 lds
  v_mfma_f32_16x16x32_bf16 v[232:235], a[40:43], a[104:107], v[232:235]
  v_mfma_f32_16x16x32_bf16 v[236:239], a[40:43], a[108:111], v[236:239]
  v_mfma_f32_16x16x32_bf16 v[240:243], a[44:47], a[96:99], v[240:243]
  v_mfma_f32_16x16x32_bf16 v[244:247], a[44:47], a[100:103], v[244:247]
  v_mfma_f32_16x16x32_bf16 v[248:251], a[44:47], a[104:107], v[248:251]
  v_mfma_f32_16x16x32_bf16 v[252:255], a[44:47], a[108:111], v[252:255]
  s_waitcnt vmcnt(14) lgkmcnt(0)
  s_barrier
  v_mfma_f32_16x16x32_bf16 v[64:67], a[48:51], a[112:115], v[64:67]
  ds_read_b128 a[96:99], v10 offset:32768
  s_add_u32 m0, s62, 50944
  v_mfma_f32_16x16x32_bf16 v[68:71], a[48:51], a[116:119], v[68:71]
  ds_read_b128 a[100:103], v10 offset:34816
  buffer_load_dwordx4 v5, s[44:47], s61 offen offset:256 lds
  v_mfma_f32_16x16x32_bf16 v[72:75], a[48:51], a[120:123], v[72:75]
  ds_read_b128 a[104:107], v10 offset:36864
  v_mfma_f32_16x16x32_bf16 v[76:79], a[48:51], a[124:127], v[76:79]
  ds_read_b128 a[108:111], v10 offset:38912
  v_mfma_f32_16x16x32_bf16 v[80:83], a[52:55], a[112:115], v[80:83]
  ds_read_b64_tr_b16 a[0:1], v12 offset:0
  s_add_u32 m0, s62, 52224
  v_mfma_f32_16x16x32_bf16 v[84:87], a[52:55], a[116:119], v[84:87]
  ds_read_b64_tr_b16 a[2:3], v12 offset:512
  buffer_load_dwordx4 v5, s[48:51], s61 offen offset:0 lds
  v_mfma_f32_16x16x32_bf16 v[88:91], a[52:55], a[120:123], v[88:91]
  ds_read_b64_tr_b16 a[4:5], v12 offset:3072
  v_mfma_f32_16x16x32_bf16 v[92:95], a[52:55], a[124:127], v[92:95]
  ds_read_b64_tr_b16 a[6:7], v12 offset:3584
  v_mfma_f32_16x16x32_bf16 v[96:99], a[56:59], a[112:115], v[96:99]
  ds_read_b64_tr_b16 a[8:9], v13 offset:0
  s_add_u32 m0, s62, 53120
  v_mfma_f32_16x16x32_bf16 v[100:103], a[56:59], a[116:119], v[100:103]
  ds_read_b64_tr_b16 a[10:11], v13 offset:512
  buffer_load_dwordx4 v5, s[48:51], s61 offen offset:128 lds
  v_mfma_f32_16x16x32_bf16 v[104:107], a[56:59], a[120:123], v[104:107]
  ds_read_b64_tr_b16 a[12:13], v13 offset:3072
  v_mfma_f32_16x16x32_bf16 v[108:111], a[56:59], a[124:127], v[108:111]
  ds_read_b64_tr_b16 a[14:15], v13 offset:3584
  v_mfma_f32_16x16x32_bf16 v[112:115], a[60:63], a[112:115], v[112:115]
  ds_read_b64_tr_b16 a[16:17], v14 offset:0
  s_add_u32 m0, s62, 54016
  v_mfma_f32_16x16x32_bf16 v[116:119], a[60:63], a[116:119], v[116:119]
  ds_read_b64_tr_b16 a[18:19], v14 offset:512
  buffer_load_dwordx4 v5, s[48:51], s61 offen offset:256 lds
  s_add_u32 s61, s61, s67
  s_nop 0
  v_mfma_f32_16x16x32_bf16 v[120:123], a[60:63], a[120:123], v[120:123]
  ds_read_b64_tr_b16 a[20:21], v14 offset:3072
  v_mfma_f32_16x16x32_bf16 v[124:127], a[60:63], a[124:127], v[124:127]
  ds_read_b64_tr_b16 a[22:23], v14 offset:3584
  v_mfma_f32_16x16x32_bf16 v[128:131], a[64:67], a[112:115], v[128:131]
  ds_read_b64_tr_b16 a[24:25], v15 offset:0
  s_add_u32 m0, s62, 73728
  v_mfma_f32_16x16x32_bf16 v[132:135], a[64:67], a[116:119], v[132:135]
  ds_read_b64_tr_b16 a[26:27], v15 offset:512
  buffer_load_dwordx4 v5, s[44:47], s61 offen offset:0 lds
  v_mfma_f32_16x16x32_bf16 v[136:139], a[64:67], a[120:123], v[136:139]
  ds_read_b64_tr_b16 a[28:29], v15 offset:3072
  v_mfma_f32_16x16x32_bf16 v[140:143], a[64:67], a[124:127], v[140:143]
  ds_read_b64_tr_b16 a[30:31], v15 offset:3584
  v_mfma_f32_16x16x32_bf16 v[144:147], a[68:71], a[112:115], v[144:147]
  ds_read_b64_tr_b16 a[32:33], v16 offset:0
  s_add_u32 m0, s62, 74624
  v_mfma_f32_16x16x32_bf16 v[148:151], a[68:71], a[116:119], v[148:151]
  ds_read_b64_tr_b16 a[34:35], v16 offset:512
  buffer_load_dwordx4 v5, s[44:47], s61 offen offset:128 lds
  v_mfma_f32_16x16x32_bf16 v[152:155], a[68:71], a[120:123], v[152:155]
  ds_read_b64_tr_b16 a[36:37], v16 offset:3072
  v_mfma_f32_16x16x32_bf16 v[156:159], a[68:71], a[124:127], v[156:159]
  ds_read_b64_tr_b16 a[38:39], v16 offset:3584
  v_mfma_f32_16x16x32_bf16 v[160:163], a[72:75], a[112:115], v[160:163]
  ds_read_b64_tr_b16 a[40:41], v17 offset:0
  s_add_u32 m0, s62, 75520
  v_mfma_f32_16x16x32_bf16 v[164:167], a[72:75], a[116:119], v[164:167]
  ds_read_b64_tr_b16 a[42:43], v17 offset:512
  buffer_load_dwordx4 v5, s[44:47], s61 offen offset:256 lds
  v_mfma_f32_16x16x32_bf16 v[168:171], a[72:75], a[120:123], v[168:171]
  ds_read_b64_tr_b16 a[44:45], v17 offset:3072
  v_mfma_f32_16x16x32_bf16 v[172:175], a[72:75], a[124:127], v[172:175]
  ds_read_b64_tr_b16 a[46:47], v17 offset:3584
  v_mfma_f32_16x16x32_bf16 v[176:179], a[76:79], a[112:115], v[176:179]
  s_add_u32 m0, s62, 76800
  v_mfma_f32_16x16x32_bf16 v[180:183], a[76:79], a[116:119], v[180:183]
  buffer_load_dwordx4 v5, s[48:51], s61 offen offset:0 lds
  v_mfma_f32_16x16x32_bf16 v[184:187], a[76:79], a[120:123], v[184:187]
  v_mfma_f32_16x16x32_bf16 v[188:191], a[76:79], a[124:127], v[188:191]
  v_mfma_f32_16x16x32_bf16 v[192:195], a[80:83], a[112:115], v[192:195]
  s_add_u32 m0, s62, 77696
  v_mfma_f32_16x16x32_bf16 v[196:199], a[80:83], a[116:119], v[196:199]
  buffer_load_dwordx4 v5, s[48:51], s61 offen offset:128 lds
  v_mfma_f32_16x16x32_bf16 v[200:203], a[80:83], a[120:123], v[200:203]
  v_mfma_f32_16x16x32_bf16 v[204:207], a[80:83], a[124:127], v[204:207]
  v_mfma_f32_16x16x32_bf16 v[208:211], a[84:87], a[112:115], v[208:211]
  s_add_u32 m0, s62, 78592
  v_mfma_f32_16x16x32_bf16 v[212:215], a[84:87], a[116:119], v[212:215]
  buffer_load_dwordx4 v5, s[48:51], s61 offen offset:256 lds
  s_add_u32 s61, s61, s67
  s_nop 0
  v_mfma_f32_16x16x32_bf16 v[216:219], a[84:87], a[120:123], v[216:219]
  v_mfma_f32_16x16x32_bf16 v[220:223], a[84:87], a[124:127], v[220:223]
  v_mfma_f32_16x16x32_bf16 v[224:227], a[88:91], a[112:115], v[224:227]
  s_add_u32 m0, s63, 15872
  v_mfma_f32_16x16x32_bf16 v[228:231], a[88:91], a[116:119], v[228:231]
  buffer_load_dwordx4 v6, s[40:43], 0 offen offset:512 lds
  v_mfma_f32_16x16x32_bf16 v[232:235], a[88:91], a[120:123], v[232:235]
  v_mfma_f32_16x16x32_bf16 v[236:239], a[88:91], a[124:127], v[236:239]
  v_mfma_f32_16x16x32_bf16 v[240:243], a[92:95], a[112:115], v[240:243]
  v_mfma_f32_16x16x32_bf16 v[244:247], a[92:95], a[116:119], v[244:247]
  v_mfma_f32_16x16x32_bf16 v[248:251], a[92:95], a[120:123], v[248:251]
  v_mfma_f32_16x16x32_bf16 v[252:255], a[92:95], a[124:127], v[252:255]
  s_waitcnt vmcnt(17) lgkmcnt(0)
  s_barrier
  v_mfma_f32_16x16x32_bf16 v[64:67], a[0:3], a[96:99], v[64:67]
  ds_read_b128 a[112:115], v11 offset:32768
  s_add_u32 m0, s63, 16896
  v_mfma_f32_16x16x32_bf16 v[68:71], a[0:3], a[100:103], v[68:71]
  ds_read_b128 a[116:119], v11 offset:34816
  buffer_load_dwordx4 v7, s[40:43], 0 offen offset:512 lds
  v_mfma_f32_16x16x32_bf16 v[72:75], a[0:3], a[104:107], v[72:75]
  ds_read_b128 a[120:123], v11 offset:36864
  v_mfma_f32_16x16x32_bf16 v[76:79], a[0:3], a[108:111], v[76:79]
  ds_read_b128 a[124:127], v11 offset:38912
  v_mfma_f32_16x16x32_bf16 v[80:83], a[4:7], a[96:99], v[80:83]
  ds_read_b64_tr_b16 a[48:49], v12 offset:24576
  s_add_u32 m0, s63, 17920
  v_mfma_f32_16x16x32_bf16 v[84:87], a[4:7], a[100:103], v[84:87]
  ds_read_b64_tr_b16 a[50:51], v12 offset:25088
  buffer_load_dwordx4 v8, s[40:43], 0 offen offset:512 lds
  v_mfma_f32_16x16x32_bf16 v[88:91], a[4:7], a[104:107], v[88:91]
  ds_read_b64_tr_b16 a[52:53], v12 offset:27648
  v_mfma_f32_16x16x32_bf16 v[92:95], a[4:7], a[108:111], v[92:95]
  ds_read_b64_tr_b16 a[54:55], v12 offset:28160
  v_mfma_f32_16x16x32_bf16 v[96:99], a[8:11], a[96:99], v[96:99]
  ds_read_b64_tr_b16 a[56:57], v13 offset:24576
  s_add_u32 m0, s63, 18944
  v_mfma_f32_16x16x32_bf16 v[100:103], a[8:11], a[100:103], v[100:103]
  ds_read_b64_tr_b16 a[58:59], v13 offset:25088
  buffer_load_dwordx4 v9, s[40:43], 0 offen offset:512 lds
  v_mfma_f32_16x16x32_bf16 v[104:107], a[8:11], a[104:107], v[104:107]
  ds_read_b64_tr_b16 a[60:61], v13 offset:27648
  v_mfma_f32_16x16x32_bf16 v[108:111], a[8:11], a[108:111], v[108:111]
  ds_read_b64_tr_b16 a[62:63], v13 offset:28160
  v_mfma_f32_16x16x32_bf16 v[112:115], a[12:15], a[96:99], v[112:115]
  ds_read_b64_tr_b16 a[64:65], v14 offset:24576
  s_add_u32 m0, s62, 0
  s_nop 0
  v_mfma_f32_16x16x32_bf16 v[116:119], a[12:15], a[100:103], v[116:119]
  ds_read_b64_tr_b16 a[66:67], v14 offset:25088
  buffer_load_dwordx4 v5, s[44:47], s61 offen offset:0 lds
  v_mfma_f32_16x16x32_bf16 v[120:123], a[12:15], a[104:107], v[120:123]
  ds_read_b64_tr_b16 a[68:69], v14 offset:27648
  v_mfma_f32_16x16x32_bf16 v[124:127], a[12:15], a[108:111], v[124:127]
  ds_read_b64_tr_b16 a[70:71], v14 offset:28160
  v_mfma_f32_16x16x32_bf16 v[128:131], a[16:19], a[96:99], v[128:131]
  ds_read_b64_tr_b16 a[72:73], v15 offset:24576
  s_add_u32 m0, s62, 896
  v_mfma_f32_16x16x32_bf16 v[132:135], a[16:19], a[100:103], v[132:135]
  ds_read_b64_tr_b16 a[74:75], v15 offset:25088
  buffer_load_dwordx4 v5, s[44:47], s61 offen offset:128 lds
  v_mfma_f32_16x16x32_bf16 v[136:139], a[16:19], a[104:107], v[136:139]
  ds_read_b64_tr_b16 a[76:77], v15 offset:27648
  v_mfma_f32_16x16x32_bf16 v[140:143], a[16:19], a[108:111], v[140:143]
  ds_read_b64_tr_b16 a[78:79], v15 offset:28160
  v_mfma_f32_16x16x32_bf16 v[144:147], a[20:23], a[96:99], v[144:147]
  ds_read_b64_tr_b16 a[80:81], v16 offset:24576
  s_add_u32 m0, s62, 1792
  v_mfma_f32_16x16x32_bf16 v[148:151], a[20:23], a[100:103], v[148:151]
  ds_read_b64_tr_b16 a[82:83], v16 offset:25088
  buffer_load_dwordx4 v5, s[44:47], s61 offen offset:256 lds
  v_mfma_f32_16x16x32_bf16 v[152:155], a[20:23], a[104:107], v[152:155]
  ds_read_b64_tr_b16 a[84:85], v16 offset:27648
  v_mfma_f32_16x16x32_bf16 v[156:159], a[20:23], a[108:111], v[156:159]
  ds_read_b64_tr_b16 a[86:87], v16 offset:28160
  v_mfma_f32_16x16x32_bf16 v[160:163], a[24:27], a[96:99], v[160:163]
  ds_read_b64_tr_b16 a[88:89], v17 offset:24576
  s_add_u32 m0, s62, 3072
  v_mfma_f32_16x16x32_bf16 v[164:167], a[24:27], a[100:103], v[164:167]
  ds_read_b64_tr_b16 a[90:91], v17 offset:25088
  buffer_load_dwordx4 v5, s[48:51], s61 offen offset:0 lds
  v_mfma_f32_16x16x32_bf16 v[168:171], a[24:27], a[104:107], v[168:171]
  ds_read_b64_tr_b16 a[92:93], v17 offset:27648
  v_mfma_f32_16x16x32_bf16 v[172:175], a[24:27], a[108:111], v[172:175]
  ds_read_b64_tr_b16 a[94:95], v17 offset:28160
  v_mfma_f32_16x16x32_bf16 v[176:179], a[28:31], a[96:99], v[176:179]
  s_add_u32 m0, s62, 3968
  v_mfma_f32_16x16x32_bf16 v[180:183], a[28:31], a[100:103], v[180:183]
  buffer_load_dwordx4 v5, s[48:51], s61 offen offset:128 lds
  v_mfma_f32_16x16x32_bf16 v[184:187], a[28:31], a[104:107], v[184:187]
  v_mfma_f32_16x16x32_bf16 v[188:191], a[28:31], a[108:111], v[188:191]
  v_mfma_f32_16x16x32_bf16 v[192:195], a[32:35], a[96:99], v[192:195]
  s_add_u32 m0, s62, 4864
  v_mfma_f32_16x16x32_bf16 v[196:199], a[32:35], a[100:103], v[196:199]
  buffer_load_dwordx4 v5, s[48:51], s61 offen offset:256 lds
  s_add_u32 s61, s61, s67
  v_mfma_f32_16x16x32_bf16 v[200:203], a[32:35], a[104:107], v[200:203]
  v_mfma_f32_16x16x32_bf16 v[204:207], a[32:35], a[108:111], v[204:207]
  v_mfma_f32_16x16x32_bf16 v[208:211], a[36:39], a[96:99], v[208:211]
  s_mul_i32 s101, s60, 448
  v_mfma_f32_16x16x32_bf16 v[212:215], a[36:39], a[100:103], v[212:215]
  s_bfm_b64 exec, 24, 0
  buffer_load_dword v63, v24, s[96:99], s101 offen
  s_mov_b64 exec, -1
  v_mfma_f32_16x16x32_bf16 v[216:219], a[36:39], a[104:107], v[216:219]
  v_mfma_f32_16x16x32_bf16 v[220:223], a[36:39], a[108:111], v[220:223]
  v_mfma_f32_16x16x32_bf16 v[224:227], a[40:43], a[96:99], v[224:227]
  v_mfma_f32_16x16x32_bf16 v[228:231], a[40:43], a[100:103], v[228:231]
  s_bfm_b64 exec, 12, 0
  buffer_load_dword v63, v25, s[40:43], 0 offen offset:896
  s_mov_b64 exec, -1
  v_mfma_f32_16x16x32_bf16 v[232:235], a[40:43], a[104:107], v[232:235]
  v_mfma_f32_16x16x32_bf16 v[236:239], a[40:43], a[108:111], v[236:239]
  v_mfma_f32_16x16x32_bf16 v[240:243], a[44:47], a[96:99], v[240:243]
  v_mfma_f32_16x16x32_bf16 v[244:247], a[44:47], a[100:103], v[244:247]
  v_mfma_f32_16x16x32_bf16 v[248:251], a[44:47], a[104:107], v[248:251]
  v_mfma_f32_16x16x32_bf16 v[252:255], a[44:47], a[108:111], v[252:255]
  s_waitcnt vmcnt(18) lgkmcnt(0)
  s_barrier
  s_nop 0
  v_mfma_f32_16x16x32_bf16 v[64:67], a[48:51], a[112:115], v[64:67]
  ds_read_b128 a[96:99], v10 offset:0
  s_add_u32 m0, s62, 24576
  v_mfma_f32_16x16x32_bf16 v[68:71], a[48:51], a[116:119], v[68:71]
  ds_read_b128 a[100:103], v10 offset:2048
  buffer_load_dwordx4 v5, s[44:47], s61 offen offset:0 lds
  v_mfma_f32_16x16x32_bf16 v[72:75], a[48:51], a[120:123], v[72:75]
  ds_read_b128 a[104:107], v10 offset:4096
  v_mfma_f32_16x16x32_bf16 v[76:79], a[48:51], a[124:127], v[76:79]
  ds_read_b128 a[108:111], v10 offset:6144
  v_mfma_f32_16x16x32_bf16 v[80:83], a[52:55], a[112:115], v[80:83]
  ds_read_b64_tr_b16 a[0:1], v18 offset:0
  s_add_u32 m0, s62, 25472
  v_mfma_f32_16x16x32_bf16 v[84:87], a[52:55], a[116:119], v[84:87]
  ds_read_b64_tr_b16 a[2:3], v18 offset:512
  buffer_load_dwordx4 v5, s[44:47], s61 offen offset:128 lds
  v_mfma_f32_16x16x32_bf16 v[88:91], a[52:55], a[120:123], v[88:91]
  ds_read_b64_tr_b16 a[4:5], v18 offset:3072
  v_mfma_f32_16x16x32_bf16 v[92:95], a[52:55], a[124:127], v[92:95]
  ds_read_b64_tr_b16 a[6:7], v18 offset:3584
  v_mfma_f32_16x16x32_bf16 v[96:99], a[56:59], a[112:115], v[96:99]
  ds_read_b64_tr_b16 a[8:9], v19 offset:0
  v_mfma_f32_16x16x32_bf16 v[100:103], a[56:59], a[116:119], v[100:103]
  ds_read_b64_tr_b16 a[10:11], v19 offset:512
  s_add_u32 m0, s62, 26368
  v_mfma_f32_16x16x32_bf16 v[104:107], a[56:59], a[120:123], v[104:107]
  ds_read_b64_tr_b16 a[12:13], v19 offset:3072
  buffer_load_dwordx4 v5, s[44:47], s61 offen offset:256 lds
  v_mfma_f32_16x16x32_bf16 v[108:111], a[56:59], a[124:127], v[108:111]
  ds_read_b64_tr_b16 a[14:15], v19 offset:3584
  v_mfma_f32_16x16x32_bf16 v[112:115], a[60:63], a[112:115], v[112:115]
  ds_read_b64_tr_b16 a[16:17], v20 offset:0
  v_mfma_f32_16x16x32_bf16 v[116:119], a[60:63], a[116:119], v[116:119]
  ds_read_b64_tr_b16 a[18:19], v20 offset:512
  s_add_u32 m0, s62, 27648
  v_mfma_f32_16x16x32_bf16 v[120:123], a[60:63], a[120:123], v[120:123]
  ds_read_b64_tr_b16 a[20:21], v20 offset:3072
  buffer_load_dwordx4 v5, s[48:51], s61 offen offset:0 lds
  v_mfma_f32_16x16x32_bf16 v[124:127], a[60:63], a[124:127], v[124:127]
  ds_read_b64_tr_b16 a[22:23], v20 offset:3584
  v_mfma_f32_16x16x32_bf16 v[128:131], a[64:67], a[112:115], v[128:131]
  ds_read_b64_tr_b16 a[24:25], v21 offset:0
  v_mfma_f32_16x16x32_bf16 v[132:135], a[64:67], a[116:119], v[132:135]
  ds_read_b64_tr_b16 a[26:27], v21 offset:512
  v_mfma_f32_16x16x32_bf16 v[136:139], a[64:67], a[120:123], v[136:139]
  ds_read_b64_tr_b16 a[28:29], v21 offset:3072
  s_add_u32 m0, s62, 28544
  v_mfma_f32_16x16x32_bf16 v[140:143], a[64:67], a[124:127], v[140:143]
  ds_read_b64_tr_b16 a[30:31], v21 offset:3584
  buffer_load_dwordx4 v5, s[48:51], s61 offen offset:128 lds
  v_mfma_f32_16x16x32_bf16 v[144:147], a[68:71], a[112:115], v[144:147]
  ds_read_b64_tr_b16 a[32:33], v22 offset:0
  v_mfma_f32_16x16x32_bf16 v[148:151], a[68:71], a[116:119], v[148:151]
  ds_read_b64_tr_b16 a[34:35], v22 offset:512
  v_mfma_f32_16x16x32_bf16 v[152:155], a[68:71], a[120:123], v[152:155]
  ds_read_b64_tr_b16 a[36:37], v22 offset:3072
  s_add_u32 m0, s62, 29440
  v_mfma_f32_16x16x32_bf16 v[156:159], a[68:71], a[124:127], v[156:159]
  ds_read_b64_tr_b16 a[38:39], v22 offset:3584
  buffer_load_dwordx4 v5, s[48:51], s61 offen offset:256 lds
  s_add_u32 s61, s61, s67
  s_nop 0
  v_mfma_f32_16x16x32_bf16 v[160:163], a[72:75], a[112:115], v[160:163]
  ds_read_b64_tr_b16 a[40:41], v23 offset:0
  v_mfma_f32_16x16x32_bf16 v[164:167], a[72:75], a[116:119], v[164:167]
  ds_read_b64_tr_b16 a[42:43], v23 offset:512
  v_mfma_f32_16x16x32_bf16 v[168:171], a[72:75], a[120:123], v[168:171]
  ds_read_b64_tr_b16 a[44:45], v23 offset:3072
  v_mfma_f32_16x16x32_bf16 v[172:175], a[72:75], a[124:127], v[172:175]
  ds_read_b64_tr_b16 a[46:47], v23 offset:3584
  s_add_u32 m0, s63, 32128
  v_mfma_f32_16x16x32_bf16 v[176:179], a[76:79], a[112:115], v[176:179]
  buffer_load_dwordx4 v6, s[40:43], 0 offen offset:640 lds
  v_mfma_f32_16x16x32_bf16 v[180:183], a[76:79], a[116:119], v[180:183]
  v_mfma_f32_16x16x32_bf16 v[184:187], a[76:79], a[120:123], v[184:187]
  v_mfma_f32_16x16x32_bf16 v[188:191], a[76:79], a[124:127], v[188:191]
  s_add_u32 m0, s63, 33152
  v_mfma_f32_16x16x32_bf16 v[192:195], a[80:83], a[112:115], v[192:195]
  buffer_load_dwordx4 v7, s[40:43], 0 offen offset:640 lds
  v_mfma_f32_16x16x32_bf16 v[196:199], a[80:83], a[116:119], v[196:199]
  v_mfma_f32_16x16x32_bf16 v[200:203], a[80:83], a[120:123], v[200:203]
  v_mfma_f32_16x16x32_bf16 v[204:207], a[80:83], a[124:127], v[204:207]
  v_mfma_f32_16x16x32_bf16 v[208:211], a[84:87], a[112:115], v[208:211]
  s_add_u32 m0, s63, 34176
  v_mfma_f32_16x16x32_bf16 v[212:215], a[84:87], a[116:119], v[212:215]
  buffer_load_dwordx4 v8, s[40:43], 0 offen offset:640 lds
  v_mfma_f32_16x16x32_bf16 v[216:219], a[84:87], a[120:123], v[216:219]
  v_mfma_f32_16x16x32_bf16 v[220:223], a[84:87], a[124:127], v[220:223]
  v_mfma_f32_16x16x32_bf16 v[224:227], a[88:91], a[112:115], v[224:227]
  s_add_u32 m0, s63, 35200
  v_mfma_f32_16x16x32_bf16 v[228:231], a[88:91], a[116:119], v[228:231]
  buffer_load_dwordx4 v9, s[40:43], 0 offen offset:640 lds
  v_mfma_f32_16x16x32_bf16 v[232:235], a[88:91], a[120:123], v[232:235]
  v_mfma_f32_16x16x32_bf16 v[236:239], a[88:91], a[124:127], v[236:239]
  v_mfma_f32_16x16x32_bf16 v[240:243], a[92:95], a[112:115], v[240:243]
  v_mfma_f32_16x16x32_bf16 v[244:247], a[92:95], a[116:119], v[244:247]
  v_mfma_f32_16x16x32_bf16 v[248:251], a[92:95], a[120:123], v[248:251]
  v_mfma_f32_16x16x32_bf16 v[252:255], a[92:95], a[124:127], v[252:255]
  s_waitcnt vmcnt(22) lgkmcnt(0)
  s_barrier
  v_mfma_f32_16x16x32_bf16 v[64:67], a[0:3], a[96:99], v[64:67]
  ds_read_b128 a[112:115], v11 offset:0
  s_add_u32 m0, s62, 49152
  v_mfma_f32_16x16x32_bf16 v[68:71], a[0:3], a[100:103], v[68:71]
  ds_read_b128 a[116:119], v11 offset:2048
  buffer_load_dwordx4 v5, s[44:47], s61 offen offset:0 lds
  v_mfma_f32_16x16x32_bf16 v[72:75], a[0:3], a[104:107], v[72:75]
  ds_read_b128 a[120:123], v11 offset:4096
  v_mfma_f32_16x16x32_bf16 v[76:79], a[0:3], a[108:111], v[76:79]
  ds_read_b128 a[124:127], v11 offset:6144
  v_mfma_f32_16x16x32_bf16 v[80:83], a[4:7], a[96:99], v[80:83]
  ds_read_b64_tr_b16 a[48:49], v18 offset:24576
  v_mfma_f32_16x16x32_bf16 v[84:87], a[4:7], a[100:103], v[84:87]
  ds_read_b64_tr_b16 a[50:51], v18 offset:25088
  v_mfma_f32_16x16x32_bf16 v[88:91], a[4:7], a[104:107], v[88:91]
  ds_read_b64_tr_b16 a[52:53], v18 offset:27648
  s_add_u32 m0, s62, 50048
  v_mfma_f32_16x16x32_bf16 v[92:95], a[4:7], a[108:111], v[92:95]
  ds_read_b64_tr_b16 a[54:55], v18 offset:28160
  buffer_load_dwordx4 v5, s[44:47], s61 offen offset:128 lds
  v_mfma_f32_16x16x32_bf16 v[96:99], a[8:11], a[96:99], v[96:99]
  ds_read_b64_tr_b16 a[56:57], v19 offset:24576
  v_mfma_f32_16x16x32_bf16 v[100:103], a[8:11], a[100:103], v[100:103]
  ds_read_b64_tr_b16 a[58:59], v19 offset:25088
  v_mfma_f32_16x16x32_bf16 v[104:107], a[8:11], a[104:107], v[104:107]
  ds_read_b64_tr_b16 a[60:61], v19 offset:27648
  v_mfma_f32_16x16x32_bf16 v[108:111], a[8:11], a[108:111], v[108:111]
  ds_read_b64_tr_b16 a[62:63], v19 offset:28160
  v_mfma_f32_16x16x32_bf16 v[112:115], a[12:15], a[96:99], v[112:115]
  ds_read_b64_tr_b16 a[64:65], v20 offset:24576
  s_add_u32 m0, s62, 50944
  v_mfma_f32_16x16x32_bf16 v[116:119], a[12:15], a[100:103], v[116:119]
  ds_read_b64_tr_b16 a[66:67], v20 offset:25088
  buffer_load_dwordx4 v5, s[44:47], s61 offen offset:256 lds
  v_mfma_f32_16x16x32_bf16 v[120:123], a[12:15], a[104:107], v[120:123]
  ds_read_b64_tr_b16 a[68:69], v20 offset:27648
  v_mfma_f32_16x16x32_bf16 v[124:127], a[12:15], a[108:111], v[124:127]
  ds_read_b64_tr_b16 a[70:71], v20 offset:28160
  v_mfma_f32_16x16x32_bf16 v[128:131], a[16:19], a[96:99], v[128:131]
  ds_read_b64_tr_b16 a[72:73], v21 offset:24576
  v_mfma_f32_16x16x32_bf16 v[132:135], a[16:19], a[100:103], v[132:135]
  ds_read_b64_tr_b16 a[74:75], v21 offset:25088
  v_mfma_f32_16x16x32_bf16 v[136:139], a[16:19], a[104:107], v[136:139]
  ds_read_b64_tr_b16 a[76:77], v21 offset:27648
  v_mfma_f32_16x16x32_bf16 v[140:143], a[16:19], a[108:111], v[140:143]
  ds_read_b64_tr_b16 a[78:79], v21 offset:28160
  s_add_u32 m0, s62, 52224
  v_mfma_f32_16x16x32_bf16 v[144:147], a[20:23], a[96:99], v[144:147]
  ds_read_b64_tr_b16 a[80:81], v22 offset:24576
  buffer_load_dwordx4 v5, s[48:51], s61 offen offset:0 lds
  v_mfma_f32_16x16x32_bf16 v[148:151], a[20:23], a[100:103], v[148:151]
  ds_read_b64_tr_b16 a[82:83], v22 offset:25088
  v_mfma_f32_16x16x32_bf16 v[152:155], a[20:23], a[104:107], v[152:155]
  ds_read_b64_tr_b16 a[84:85], v22 offset:27648
  v_mfma_f32_16x16x32_bf16 v[156:159], a[20:23], a[108:111], v[156:159]
  ds_read_b64_tr_b16 a[86:87], v22 offset:28160
  v_mfma_f32_16x16x32_bf16 v[160:163], a[24:27], a[96:99], v[160:163]
  ds_read_b64_tr_b16 a[88:89], v23 offset:24576
  v_mfma_f32_16x16x32_bf16 v[164:167], a[24:27], a[100:103], v[164:167]
  ds_read_b64_tr_b16 a[90:91], v23 offset:25088
  s_add_u32 m0, s62, 53120
  v_mfma_f32_16x16x32_bf16 v[168:171], a[24:27], a[104:107], v[168:171]
  ds_read_b64_tr_b16 a[92:93], v23 offset:27648
  buffer_load_dwordx4 v5, s[48:51], s61 offen offset:128 lds
  v_mfma_f32_16x16x32_bf16 v[172:175], a[24:27], a[108:111], v[172:175]
  ds_read_b64_tr_b16 a[94:95], v23 offset:28160
  v_mfma_f32_16x16x32_bf16 v[176:179], a[28:31], a[96:99], v[176:179]
  v_mfma_f32_16x16x32_bf16 v[180:183], a[28:31], a[100:103], v[180:183]
  v_mfma_f32_16x16x32_bf16 v[184:187], a[28:31], a[104:107], v[184:187]
  v_mfma_f32_16x16x32_bf16 v[188:191], a[28:31], a[108:111], v[188:191]
  v_mfma_f32_16x16x32_bf16 v[192:195], a[32:35], a[96:99], v[192:195]
  v_mfma_f32_16x16x32_bf16 v[196:199], a[32:35], a[100:103], v[196:199]
  buffer_store_dwordx4 v[26:29], v2, s[56:59], s76 offen offset:0 sc1
  v_mfma_f32_16x16x32_bf16 v[200:203], a[32:35], a[104:107], v[200:203]
  v_mfma_f32_16x16x32_bf16 v[204:207], a[32:35], a[108:111], v[204:207]
  v_mfma_f32_16x16x32_bf16 v[208:211], a[36:39], a[96:99], v[208:211]
  v_mfma_f32_16x16x32_bf16 v[212:215], a[36:39], a[100:103], v[212:215]
  v_mfma_f32_16x16x32_bf16 v[216:219], a[36:39], a[104:107], v[216:219]
  s_add_u32 m0, s62, 54016
  v_mfma_f32_16x16x32_bf16 v[220:223], a[36:39], a[108:111], v[220:223]
  buffer_load_dwordx4 v5, s[48:51], s61 offen offset:256 lds
  s_add_u32 s61, s61, s67
  v_mfma_f32_16x16x32_bf16 v[224:227], a[40:43], a[96:99], v[224:227]
  v_mfma_f32_16x16x32_bf16 v[228:231], a[40:43], a[100:103], v[228:231]
  v_mfma_f32_16x16x32_bf16 v[232:235], a[40:43], a[104:107], v[232:235]
  v_mfma_f32_16x16x32_bf16 v[236:239], a[40:43], a[108:111], v[236:239]
  v_mfma_f32_16x16x32_bf16 v[240:243], a[44:47], a[96:99], v[240:243]
  v_mfma_f32_16x16x32_bf16 v[244:247], a[44:47], a[100:103], v[244:247]
  v_mfma_f32_16x16x32_bf16 v[248:251], a[44:47], a[104:107], v[248:251]
  v_mfma_f32_16x16x32_bf16 v[252:255], a[44:47], a[108:111], v[252:255]
  s_waitcnt vmcnt(19) lgkmcnt(0)
  s_barrier
  s_nop 0
  v_mfma_f32_16x16x32_bf16 v[64:67], a[48:51], a[112:115], v[64:67]
  ds_read_b128 a[96:99], v10 offset:16384
  s_add_u32 m0, s62, 73728
  v_mfma_f32_16x16x32_bf16 v[68:71], a[48:51], a[116:119], v[68:71]
  ds_read_b128 a[100:103], v10 offset:18432
  buffer_load_dwordx4 v5, s[44:47], s61 offen offset:0 lds
  v_mfma_f32_16x16x32_bf16 v[72:75], a[48:51], a[120:123], v[72:75]
  ds_read_b128 a[104:107], v10 offset:20480
  v_mfma_f32_16x16x32_bf16 v[76:79], a[48:51], a[124:127], v[76:79]
  ds_read_b128 a[108:111], v10 offset:22528
  v_mfma_f32_16x16x32_bf16 v[80:83], a[52:55], a[112:115], v[80:83]
  ds_read_b64_tr_b16 a[0:1], v12 offset:0
  s_add_u32 m0, s62, 74624
  v_mfma_f32_16x16x32_bf16 v[84:87], a[52:55], a[116:119], v[84:87]
  ds_read_b64_tr_b16 a[2:3], v12 offset:512
  buffer_load_dwordx4 v5, s[44:47], s61 offen offset:128 lds
  v_mfma_f32_16x16x32_bf16 v[88:91], a[52:55], a[120:123], v[88:91]
  ds_read_b64_tr_b16 a[4:5], v12 offset:3072
  v_mfma_f32_16x16x32_bf16 v[92:95], a[52:55], a[124:127], v[92:95]
  ds_read_b64_tr_b16 a[6:7], v12 offset:3584
  v_mfma_f32_16x16x32_bf16 v[96:99], a[56:59], a[112:115], v[96:99]
  ds_read_b64_tr_b16 a[8:9], v13 offset:0
  s_add_u32 m0, s62, 75520
  v_mfma_f32_16x16x32_bf16 v[100:103], a[56:59], a[116:119], v[100:103]
  ds_read_b64_tr_b16 a[10:11], v13 offset:512
  buffer_load_dwordx4 v5, s[44:47], s61 offen offset:256 lds
  v_mfma_f32_16x16x32_bf16 v[104:107], a[56:59], a[120:123], v[104:107]
  ds_read_b64_tr_b16 a[12:13], v13 offset:3072
  v_mfma_f32_16x16x32_bf16 v[108:111], a[56:59], a[124:127], v[108:111]
  ds_read_b64_tr_b16 a[14:15], v13 offset:3584
  v_mfma_f32_16x16x32_bf16 v[112:115], a[60:63], a[112:115], v[112:115]
  ds_read_b64_tr_b16 a[16:17], v14 offset:0
  s_add_u32 m0, s62, 76800
  v_mfma_f32_16x16x32_bf16 v[116:119], a[60:63], a[116:119], v[116:119]
  ds_read_b64_tr_b16 a[18:19], v14 offset:512
  buffer_load_dwordx4 v5, s[48:51], s61 offen offset:0 lds
  v_mfma_f32_16x16x32_bf16 v[120:123], a[60:63], a[120:123], v[120:123]
  ds_read_b64_tr_b16 a[20:21], v14 offset:3072
  v_mfma_f32_16x16x32_bf16 v[124:127], a[60:63], a[124:127], v[124:127]
  ds_read_b64_tr_b16 a[22:23], v14 offset:3584
  v_mfma_f32_16x16x32_bf16 v[128:131], a[64:67], a[112:115], v[128:131]
  ds_read_b64_tr_b16 a[24:25], v15 offset:0
  s_add_u32 m0, s62, 77696
  v_mfma_f32_16x16x32_bf16 v[132:135], a[64:67], a[116:119], v[132:135]
  ds_read_b64_tr_b16 a[26:27], v15 offset:512
  buffer_load_dwordx4 v5, s[48:51], s61 offen offset:128 lds
  v_mfma_f32_16x16x32_bf16 v[136:139], a[64:67], a[120:123], v[136:139]
  ds_read_b64_tr_b16 a[28:29], v15 offset:3072
  v_mfma_f32_16x16x32_bf16 v[140:143], a[64:67], a[124:127], v[140:143]
  ds_read_b64_tr_b16 a[30:31], v15 offset:3584
  v_mfma_f32_16x16x32_bf16 v[144:147], a[68:71], a[112:115], v[144:147]
  ds_read_b64_tr_b16 a[32:33], v16 offset:0
  s_add_u32 m0, s62, 78592
  v_mfma_f32_16x16x32_bf16 v[148:151], a[68:71], a[116:119], v[148:151]
  ds_read_b64_tr_b16 a[34:35], v16 offset:512
  buffer_load_dwordx4 v5, s[48:51], s61 offen offset:256 lds
  s_add_u32 s61, s61, s67
  s_nop 0
  v_mfma_f32_16x16x32_bf16 v[152:155], a[68:71], a[120:123], v[152:155]
  ds_read_b64_tr_b16 a[36:37], v16 offset:3072
  v_mfma_f32_16x16x32_bf16 v[156:159], a[68:71], a[124:127], v[156:159]
  ds_read_b64_tr_b16 a[38:39], v16 offset:3584
  v_mfma_f32_16x16x32_bf16 v[160:163], a[72:75], a[112:115], v[160:163]
  ds_read_b64_tr_b16 a[40:41], v17 offset:0
  s_add_u32 m0, s63, -768
  v_mfma_f32_16x16x32_bf16 v[164:167], a[72:75], a[116:119], v[164:167]
  ds_read_b64_tr_b16 a[42:43], v17 offset:512
  buffer_load_dwordx4 v6, s[40:43], 0 offen offset:768 lds
  v_mfma_f32_16x16x32_bf16 v[168:171], a[72:75], a[120:123], v[168:171]
  ds_read_b64_tr_b16 a[44:45], v17 offset:3072
  v_mfma_f32_16x16x32_bf16 v[172:175], a[72:75], a[124:127], v[172:175]
  ds_read_b64_tr_b16 a[46:47], v17 offset:3584
  v_mfma_f32_16x16x32_bf16 v[176:179], a[76:79], a[112:115], v[176:179]
  s_add_u32 m0, s63, 256
  v_mfma_f32_16x16x32_bf16 v[180:183], a[76:79], a[116:119], v[180:183]
  buffer_load_dwordx4 v7, s[40:43], 0 offen offset:768 lds
  v_mfma_f32_16x16x32_bf16 v[184:187], a[76:79], a[120:123], v[184:187]
  v_mfma_f32_16x16x32_bf16 v[188:191], a[76:79], a[124:127], v[188:191]
  v_mfma_f32_16x16x32_bf16 v[192:195], a[80:83], a[112:115], v[192:195]
  s_add_u32 m0, s63, 1280
  v_mfma_f32_16x16x32_bf16 v[196:199], a[80:83], a[116:119], v[196:199]
  buffer_load_dwordx4 v8, s[40:43], 0 offen offset:768 lds
  v_mfma_f32_16x16x32_bf16 v[200:203], a[80:83], a[120:123], v[200:203]
  v_mfma_f32_16x16x32_bf16 v[204:207], a[80:83], a[124:127], v[204:207]
  v_mfma_f32_16x16x32_bf16 v[208:211], a[84:87], a[112:115], v[208:211]
  v_mfma_f32_16x16x32_bf16 v[212:215], a[84:87], a[116:119], v[212:215]
  buffer_store_dwordx4 v[26:29], v2, s[56:59], s76 offen offset:1024 sc1
  v_mfma_f32_16x16x32_bf16 v[216:219], a[84:87], a[120:123], v[216:219]
  v_mfma_f32_16x16x32_bf16 v[220:223], a[84:87], a[124:127], v[220:223]
  v_mfma_f32_16x16x32_bf16 v[224:227], a[88:91], a[112:115], v[224:227]
  s_add_u32 m0, s63, 2304
  v_mfma_f32_16x16x32_bf16 v[228:231], a[88:91], a[116:119], v[228:231]
  buffer_load_dwordx4 v9, s[40:43], 0 offen offset:768 lds
  v_mfma_f32_16x16x32_bf16 v[232:235], a[88:91], a[120:123], v[232:235]
  v_mfma_f32_16x16x32_bf16 v[236:239], a[88:91], a[124:127], v[236:239]
  v_mfma_f32_16x16x32_bf16 v[240:243], a[92:95], a[112:115], v[240:243]
  v_mfma_f32_16x16x32_bf16 v[244:247], a[92:95], a[116:119], v[244:247]
  v_mfma_f32_16x16x32_bf16 v[248:251], a[92:95], a[120:123], v[248:251]
  v_mfma_f32_16x16x32_bf16 v[252:255], a[92:95], a[124:127], v[252:255]
  s_waitcnt vmcnt(22) lgkmcnt(0)
  s_barrier
  v_mfma_f32_16x16x32_bf16 v[64:67], a[0:3], a[96:99], v[64:67]
  ds_read_b128 a[112:115], v11 offset:16384
  s_add_u32 m0, s62, 0
  s_nop 0
  v_mfma_f32_16x16x32_bf16 v[68:71], a[0:3], a[100:103], v[68:71]
  ds_read_b128 a[116:119], v11 offset:18432
  buffer_load_dwordx4 v5, s[44:47], s61 offen offset:0 lds
  v_mfma_f32_16x16x32_bf16 v[72:75], a[0:3], a[104:107], v[72:75]
  ds_read_b128 a[120:123], v11 offset:20480
  v_mfma_f32_16x16x32_bf16 v[76:79], a[0:3], a[108:111], v[76:79]
  ds_read_b128 a[124:127], v11 offset:22528
  v_mfma_f32_16x16x32_bf16 v[80:83], a[4:7], a[96:99], v[80:83]
  ds_read_b64_tr_b16 a[48:49], v12 offset:24576
  v_mfma_f32_16x16x32_bf16 v[84:87], a[4:7], a[100:103], v[84:87]
  ds_read_b64_tr_b16 a[50:51], v12 offset:25088
  v_mfma_f32_16x16x32_bf16 v[88:91], a[4:7], a[104:107], v[88:91]
  ds_read_b64_tr_b16 a[52:53], v12 offset:27648
  s_add_u32 m0, s62, 896
  v_mfma_f32_16x16x32_bf16 v[92:95], a[4:7], a[108:111], v[92:95]
  ds_read_b64_tr_b16 a[54:55], v12 offset:28160
  buffer_load_dwordx4 v5, s[44:47], s61 offen offset:128 lds
  v_mfma_f32_16x16x32_bf16 v[96:99], a[8:11], a[96:99], v[96:99]
  ds_read_b64_tr_b16 a[56:57], v13 offset:24576
  v_mfma_f32_16x16x32_bf16 v[100:103], a[8:11], a[100:103], v[100:103]
  ds_read_b64_tr_b16 a[58:59], v13 offset:25088
  v_mfma_f32_16x16x32_bf16 v[104:107], a[8:11], a[104:107], v[104:107]
  ds_read_b64_tr_b16 a[60:61], v13 offset:27648
  v_mfma_f32_16x16x32_bf16 v[108:111], a[8:11], a[108:111], v[108:111]
  ds_read_b64_tr_b16 a[62:63], v13 offset:28160
  v_mfma_f32_16x16x32_bf16 v[112:115], a[12:15], a[96:99], v[112:115]
  ds_read_b64_tr_b16 a[64:65], v14 offset:24576
  s_add_u32 m0, s62, 1792
  v_mfma_f32_16x16x32_bf16 v[116:119], a[12:15], a[100:103], v[116:119]
  ds_read_b64_tr_b16 a[66:67], v14 offset:25088
  buffer_load_dwordx4 v5, s[44:47], s61 offen offset:256 lds
  v_mfma_f32_16x16x32_bf16 v[120:123], a[12:15], a[104:107], v[120:123]
  ds_read_b64_tr_b16 a[68:69], v14 offset:27648
  v_mfma_f32_16x16x32_bf16 v[124:127], a[12:15], a[108:111], v[124:127]
  ds_read_b64_tr_b16 a[70:71], v14 offset:28160
  v_mfma_f32_16x16x32_bf16 v[128:131], a[16:19], a[96:99], v[128:131]
  ds_read_b64_tr_b16 a[72:73], v15 offset:24576
  v_mfma_f32_16x16x32_bf16 v[132:135], a[16:19], a[100:103], v[132:135]
  ds_read_b64_tr_b16 a[74:75], v15 offset:25088
  v_mfma_f32_16x16x32_bf16 v[136:139], a[16:19], a[104:107], v[136:139]
  ds_read_b64_tr_b16 a[76:77], v15 offset:27648
  v_mfma_f32_16x16x32_bf16 v[140:143], a[16:19], a[108:111], v[140:143]
  ds_read_b64_tr_b16 a[78:79], v15 offset:28160
  s_add_u32 m0, s62, 3072
  v_mfma_f32_16x16x32_bf16 v[144:147], a[20:23], a[96:99], v[144:147]
  ds_read_b64_tr_b16 a[80:81], v16 offset:24576
  buffer_load_dwordx4 v5, s[48:51], s61 offen offset:0 lds
  v_mfma_f32_16x16x32_bf16 v[148:151], a[20:23], a[100:103], v[148:151]
  ds_read_b64_tr_b16 a[82:83], v16 offset:25088
  v_mfma_f32_16x16x32_bf16 v[152:155], a[20:23], a[104:107], v[152:155]
  ds_read_b64_tr_b16 a[84:85], v16 offset:27648
  v_mfma_f32_16x16x32_bf16 v[156:159], a[20:23], a[108:111], v[156:159]
  ds_read_b64_tr_b16 a[86:87], v16 offset:28160
  v_mfma_f32_16x16x32_bf16 v[160:163], a[24:27], a[96:99], v[160:163]
  ds_read_b64_tr_b16 a[88:89], v17 offset:24576
  v_mfma_f32_16x16x32_bf16 v[164:167], a[24:27], a[100:103], v[164:167]
  ds_read_b64_tr_b16 a[90:91], v17 offset:25088
  s_add_u32 m0, s62, 3968
  v_mfma_f32_16x16x32_bf16 v[168:171], a[24:27], a[104:107], v[168:171]
  ds_read_b64_tr_b16 a[92:93], v17 offset:27648
  buffer_load_dwordx4 v5, s[48:51], s61 offen offset:128 lds
  v_mfma_f32_16x16x32_bf16 v[172:175], a[24:27], a[108:111], v[172:175]
  ds_read_b64_tr_b16 a[94:95], v17 offset:28160
  v_mfma_f32_16x16x32_bf16 v[176:179], a[28:31], a[96:99], v[176:179]
  v_mfma_f32_16x16x32_bf16 v[180:183], a[28:31], a[100:103], v[180:183]
  v_mfma_f32_16x16x32_bf16 v[184:187], a[28:31], a[104:107], v[184:187]
  v_mfma_f32_16x16x32_bf16 v[188:191], a[28:31], a[108:111], v[188:191]
  v_mfma_f32_16x16x32_bf16 v[192:195], a[32:35], a[96:99], v[192:195]
  v_mfma_f32_16x16x32_bf16 v[196:199], a[32:35], a[100:103], v[196:199]
  buffer_store_dwordx4 v[26:29], v2, s[56:59], s76 offen offset:2048 sc1
  v_mfma_f32_16x16x32_bf16 v[200:203], a[32:35], a[104:107], v[200:203]
  v_mfma_f32_16x16x32_bf16 v[204:207], a[32:35], a[108:111], v[204:207]
  v_mfma_f32_16x16x32_bf16 v[208:211], a[36:39], a[96:99], v[208:211]
  v_mfma_f32_16x16x32_bf16 v[212:215], a[36:39], a[100:103], v[212:215]
  v_mfma_f32_16x16x32_bf16 v[216:219], a[36:39], a[104:107], v[216:219]
  s_add_u32 m0, s62, 4864
  v_mfma_f32_16x16x32_bf16 v[220:223], a[36:39], a[108:111], v[220:223]
  buffer_load_dwordx4 v5, s[48:51], s61 offen offset:256 lds
  s_add_u32 s61, s61, s67
  v_mfma_f32_16x16x32_bf16 v[224:227], a[40:43], a[96:99], v[224:227]
  v_mfma_f32_16x16x32_bf16 v[228:231], a[40:43], a[100:103], v[228:231]
  v_mfma_f32_16x16x32_bf16 v[232:235], a[40:43], a[104:107], v[232:235]
  v_mfma_f32_16x16x32_bf16 v[236:239], a[40:43], a[108:111], v[236:239]
  v_mfma_f32_16x16x32_bf16 v[240:243], a[44:47], a[96:99], v[240:243]
  v_mfma_f32_16x16x32_bf16 v[244:247], a[44:47], a[100:103], v[244:247]
  v_mfma_f32_16x16x32_bf16 v[248:251], a[44:47], a[104:107], v[248:251]
  v_mfma_f32_16x16x32_bf16 v[252:255], a[44:47], a[108:111], v[252:255]
  v_mov_b32 v4, 0
  s_cmp_lg_u32 s32, 0
  s_cbranch_scc1 Lp0_2
  global_load_dword v31, v4, s[28:29] sc1
  s_branch Lp1_3
Lp0_2:
  v_mov_b32 v4, 0
  global_load_dword v31, v4, s[8:9]
Lp1_3:
  s_waitcnt vmcnt(19) lgkmcnt(0)
  s_barrier
  v_mfma_f32_16x16x32_bf16 v[64:67], a[48:51], a[112:115], v[64:67]
  ds_read_b128 a[96:99], v10 offset:32768
  s_add_u32 m0, s62, 24576
  v_mfma_f32_16x16x32_bf16 v[68:71], a[48:51], a[116:119], v[68:71]
  ds_read_b128 a[100:103], v10 offset:34816
  buffer_load_dwordx4 v5, s[44:47], s61 offen offset:0 lds
  v_mfma_f32_16x16x32_bf16 v[72:75], a[48:51], a[120:123], v[72:75]
  ds_read_b128 a[104:107], v10 offset:36864
  v_mfma_f32_16x16x32_bf16 v[76:79], a[48:51], a[124:127], v[76:79]
  ds_read_b128 a[108:111], v10 offset:38912
  v_mfma_f32_16x16x32_bf16 v[80:83], a[52:55], a[112:115], v[80:83]
  ds_read_b64_tr_b16 a[0:1], v18 offset:0
  s_add_u32 m0, s62, 25472
  v_mfma_f32_16x16x32_bf16 v[84:87], a[52:55], a[116:119], v[84:87]
  ds_read_b64_tr_b16 a[2:3], v18 offset:512
  buffer_load_dwordx4 v5, s[44:47], s61 offen offset:128 lds
  v_mfma_f32_16x16x32_bf16 v[88:91], a[52:55], a[120:123], v[88:91]
  ds_read_b64_tr_b16 a[4:5], v18 offset:3072
  v_mfma_f32_16x16x32_bf16 v[92:95], a[52:55], a[124:127], v[92:95]
  ds_read_b64_tr_b16 a[6:7], v18 offset:3584
  v_mfma_f32_16x16x32_bf16 v[96:99], a[56:59], a[112:115], v[96:99]
  ds_read_b64_tr_b16 a[8:9], v19 offset:0
  s_add_u32 m0, s62, 26368
  v_mfma_f32_16x16x32_bf16 v[100:103], a[56:59], a[116:119], v[100:103]
  ds_read_b64_tr_b16 a[10:11], v19 offset:512
  buffer_load_dwordx4 v5, s[44:47], s61 offen offset:256 lds
  v_mfma_f32_16x16x32_bf16 v[104:107], a[56:59], a[120:123], v[104:107]
  ds_read_b64_tr_b16 a[12:13], v19 offset:3072
  v_mfma_f32_16x16x32_bf16 v[108:111], a[56:59], a[124:127], v[108:111]
  ds_read_b64_tr_b16 a[14:15], v19 offset:3584
  v_mfma_f32_16x16x32_bf16 v[112:115], a[60:63], a[112:115], v[112:115]
  ds_read_b64_tr_b16 a[16:17], v20 offset:0
  s_add_u32 m0, s62, 27648
  v_mfma_f32_16x16x32_bf16 v[116:119], a[60:63], a[116:119], v[116:119]
  ds_read_b64_tr_b16 a[18:19], v20 offset:512
  buffer_load_dwordx4 v5, s[48:51], s61 offen offset:0 lds
  v_mfma_f32_16x16x32_bf16 v[120:123], a[60:63], a[120:123], v[120:123]
  ds_read_b64_tr_b16 a[20:21], v20 offset:3072
  v_mfma_f32_16x16x32_bf16 v[124:127], a[60:63], a[124:127], v[124:127]
  ds_read_b64_tr_b16 a[22:23], v20 offset:3584
  v_mfma_f32_16x16x32_bf16 v[128:131], a[64:67], a[112:115], v[128:131]
  ds_read_b64_tr_b16 a[24:25], v21 offset:0
  s_add_u32 m0, s62, 28544
  v_mfma_f32_16x16x32_bf16 v[132:135], a[64:67], a[116:119], v[132:135]
  ds_read_b64_tr_b16 a[26:27], v21 offset:512
  buffer_load_dwordx4 v5, s[48:51], s61 offen offset:128 lds
  v_mfma_f32_16x16x32_bf16 v[136:139], a[64:67], a[120:123], v[136:139]
  ds_read_b64_tr_b16 a[28:29], v21 offset:3072
  v_mfma_f32_16x16x32_bf16 v[140:143], a[64:67], a[124:127], v[140:143]
  ds_read_b64_tr_b16 a[30:31], v21 offset:3584
  v_mfma_f32_16x16x32_bf16 v[144:147], a[68:71], a[112:115], v[144:147]
  ds_read_b64_tr_b16 a[32:33], v22 offset:0
  s_add_u32 m0, s62, 29440
  v_mfma_f32_16x16x32_bf16 v[148:151], a[68:71], a[116:119], v[148:151]
  ds_read_b64_tr_b16 a[34:35], v22 offset:512
  buffer_load_dwordx4 v5, s[48:51], s61 offen offset:256 lds
  s_add_u32 s61, s61, s67
  s_nop 0
  v_mfma_f32_16x16x32_bf16 v[152:155], a[68:71], a[120:123], v[152:155]
  ds_read_b64_tr_b16 a[36:37], v22 offset:3072
  v_mfma_f32_16x16x32_bf16 v[156:159], a[68:71], a[124:127], v[156:159]
  ds_read_b64_tr_b16 a[38:39], v22 offset:3584
  v_mfma_f32_16x16x32_bf16 v[160:163], a[72:75], a[112:115], v[160:163]
  ds_read_b64_tr_b16 a[40:41], v23 offset:0
  s_add_u32 m0, s63, 15488
  v_mfma_f32_16x16x32_bf16 v[164:167], a[72:75], a[116:119], v[164:167]
  ds_read_b64_tr_b16 a[42:43], v23 offset:512
  buffer_load_dwordx4 v6, s[40:43], 0 offen offset:896 lds
  v_mfma_f32_16x16x32_bf16 v[168:171], a[72:75], a[120:123], v[168:171]
  ds_read_b64_tr_b16 a[44:45], v23 offset:3072
  v_mfma_f32_16x16x32_bf16 v[172:175], a[72:75], a[124:127], v[172:175]
  ds_read_b64_tr_b16 a[46:47], v23 offset:3584
  v_mfma_f32_16x16x32_bf16 v[176:179], a[76:79], a[112:115], v[176:179]
  s_add_u32 m0, s63, 16512
  v_mfma_f32_16x16x32_bf16 v[180:183], a[76:79], a[116:119], v[180:183]
  buffer_load_dwordx4 v7, s[40:43], 0 offen offset:896 lds
  v_mfma_f32_16x16x32_bf16 v[184:187], a[76:79], a[120:123], v[184:187]
  v_mfma_f32_16x16x32_bf16 v[188:191], a[76:79], a[124:127], v[188:191]
  v_mfma_f32_16x16x32_bf16 v[192:195], a[80:83], a[112:115], v[192:195]
  s_add_u32 m0, s63, 17536
  v_mfma_f32_16x16x32_bf16 v[196:199], a[80:83], a[116:119], v[196:199]
  buffer_load_dwordx4 v8, s[40:43], 0 offen offset:896 lds
  v_mfma_f32_16x16x32_bf16 v[200:203], a[80:83], a[120:123], v[200:203]
  v_mfma_f32_16x16x32_bf16 v[204:207], a[80:83], a[124:127], v[204:207]
  v_mfma_f32_16x16x32_bf16 v[208:211], a[84:87], a[112:115], v[208:211]
  v_mfma_f32_16x16x32_bf16 v[212:215], a[84:87], a[116:119], v[212:215]
  buffer_store_dwordx4 v[26:29], v2, s[56:59], s76 offen offset:3072 sc1
  v_mfma_f32_16x16x32_bf16 v[216:219], a[84:87], a[120:123], v[216:219]
  v_mfma_f32_16x16x32_bf16 v[220:223], a[84:87], a[124:127], v[220:223]
  v_mfma_f32_16x16x32_bf16 v[224:227], a[88:91], a[112:115], v[224:227]
  s_add_u32 m0, s63, 18560
  v_mfma_f32_16x16x32_bf16 v[228:231], a[88:91], a[116:119], v[228:231]
  buffer_load_dwordx4 v9, s[40:43], 0 offen offset:896 lds
  v_mfma_f32_16x16x32_bf16 v[232:235], a[88:91], a[120:123], v[232:235]
  v_mfma_f32_16x16x32_bf16 v[236:239], a[88:91], a[124:127], v[236:239]
  v_mfma_f32_16x16x32_bf16 v[240:243], a[92:95], a[112:115], v[240:243]
  v_mfma_f32_16x16x32_bf16 v[244:247], a[92:95], a[116:119], v[244:247]
  v_mfma_f32_16x16x32_bf16 v[248:251], a[92:95], a[120:123], v[248:251]
  v_mfma_f32_16x16x32_bf16 v[252:255], a[92:95], a[124:127], v[252:255]
  s_waitcnt vmcnt(24) lgkmcnt(0)
  s_waitcnt vmcnt(11)
  s_cmp_lg_u32 s32, 0
  s_cbranch_scc1 Lpd_5
  v_cmp_gt_u32 vcc, 48, v31
  s_mov_b32 s95, 0x8000
  s_cmp_eq_u64 vcc, 0
  s_cbranch_scc1 Lpd_5
Lpoll_4:
  s_sleep 8
  global_load_dword v31, v4, s[28:29] sc1
  s_waitcnt vmcnt(0)
  v_cmp_gt_u32 vcc, 48, v31
  s_sub_u32 s95, s95, 1
  s_cmp_eq_u64 vcc, 0
  s_cbranch_scc1 Lpd_5
  s_cmp_lg_u32 s95, 0
  s_cbranch_scc1 Lpoll_4
Lpd_5:
  s_barrier
  v_mfma_f32_16x16x32_bf16 v[64:67], a[0:3], a[96:99], v[64:67]
  ds_read_b128 a[112:115], v11 offset:32768
  s_add_u32 m0, s62, 49152
  v_mfma_f32_16x16x32_bf16 v[68:71], a[0:3], a[100:103], v[68:71]
  ds_read_b128 a[116:119], v11 offset:34816
  buffer_load_dwordx4 v5, s[44:47], s61 offen offset:0 lds
  v_mfma_f32_16x16x32_bf16 v[72:75], a[0:3], a[104:107], v[72:75]
  ds_read_b128 a[120:123], v11 offset:36864
  v_mfma_f32_16x16x32_bf16 v[76:79], a[0:3], a[108:111], v[76:79]
  ds_read_b128 a[124:127], v11 offset:38912
  v_mfma_f32_16x16x32_bf16 v[80:83], a[4:7], a[96:99], v[80:83]
  ds_read_b64_tr_b16 a[48:49], v18 offset:24576
  s_add_u32 s88, s89, 102400
  v_mfma_f32_16x16x32_bf16 v[84:87], a[4:7], a[100:103], v[84:87]
  ds_read_b64_tr_b16 a[50:51], v18 offset:25088
  buffer_load_dwordx4 a[128:131], v2, s[84:87], s88 offen offset:0 sc1
  v_mfma_f32_16x16x32_bf16 v[88:91], a[4:7], a[104:107], v[88:91]
  ds_read_b64_tr_b16 a[52:53], v18 offset:27648
  v_mfma_f32_16x16x32_bf16 v[92:95], a[4:7], a[108:111], v[92:95]
  ds_read_b64_tr_b16 a[54:55], v18 offset:28160
  v_mfma_f32_16x16x32_bf16 v[96:99], a[8:11], a[96:99], v[96:99]
  ds_read_b64_tr_b16 a[56:57], v19 offset:24576
  s_add_u32 m0, s62, 50048
  v_mfma_f32_16x16x32_bf16 v[100:103], a[8:11], a[100:103], v[100:103]
  ds_read_b64_tr_b16 a[58:59], v19 offset:25088
  buffer_load_dwordx4 v5, s[44:47], s61 offen offset:128 lds
  v_mfma_f32_16x16x32_bf16 v[104:107], a[8:11], a[104:107], v[104:107]
  ds_read_b64_tr_b16 a[60:61], v19 offset:27648
  v_mfma_f32_16x16x32_bf16 v[108:111], a[8:11], a[108:111], v[108:111]
  ds_read_b64_tr_b16 a[62:63], v19 offset:28160
  v_mfma_f32_16x16x32_bf16 v[112:115], a[12:15], a[96:99], v[112:115]
  ds_read_b64_tr_b16 a[64:65], v20 offset:24576
  v_mfma_f32_16x16x32_bf16 v[116:119], a[12:15], a[100:103], v[116:119]
  ds_read_b64_tr_b16 a[66:67], v20 offset:25088
  buffer_load_dwordx4 a[132:135], v2, s[84:87], s88 offen offset:1024 sc1
  v_mfma_f32_16x16x32_bf16 v[120:123], a[12:15], a[104:107], v[120:123]
  ds_read_b64_tr_b16 a[68:69], v20 offset:27648
  v_mfma_f32_16x16x32_bf16 v[124:127], a[12:15], a[108:111], v[124:127]
  ds_read_b64_tr_b16 a[70:71], v20 offset:28160
  v_mfma_f32_16x16x32_bf16 v[128:131], a[16:19], a[96:99], v[128:131]
  ds_read_b64_tr_b16 a[72:73], v21 offset:24576
  s_add_u32 m0, s62, 50944
  v_mfma_f32_16x16x32_bf16 v[132:135], a[16:19], a[100:103], v[132:135]
  ds_read_b64_tr_b16 a[74:75], v21 offset:25088
  buffer_load_dwordx4 v5, s[44:47], s61 offen offset:256 lds
  v_mfma_f32_16x16x32_bf16 v[136:139], a[16:19], a[104:107], v[136:139]
  ds_read_b64_tr_b16 a[76:77], v21 offset:27648
  v_mfma_f32_16x16x32_bf16 v[140:143], a[16:19], a[108:111], v[140:143]
  ds_read_b64_tr_b16 a[78:79], v21 offset:28160
  v_mfma_f32_16x16x32_bf16 v[144:147], a[20:23], a[96:99], v[144:147]
  ds_read_b64_tr_b16 a[80:81], v22 offset:24576
  v_mfma_f32_16x16x32_bf16 v[148:151], a[20:23], a[100:103], v[148:151]
  ds_read_b64_tr_b16 a[82:83], v22 offset:25088
  buffer_load_dwordx4 a[136:139], v2, s[84:87], s88 offen offset:2048 sc1
  v_mfma_f32_16x16x32_bf16 v[152:155], a[20:23], a[104:107], v[152:155]
  ds_read_b64_tr_b16 a[84:85], v22 offset:27648
  v_mfma_f32_16x16x32_bf16 v[156:159], a[20:23], a[108:111], v[156:159]
  ds_read_b64_tr_b16 a[86:87], v22 offset:28160
  v_mfma_f32_16x16x32_bf16 v[160:163], a[24:27], a[96:99], v[160:163]
  ds_read_b64_tr_b16 a[88:89], v23 offset:24576
  s_add_u32 m0, s62, 52224
  v_mfma_f32_16x16x32_bf16 v[164:167], a[24:27], a[100:103], v[164:167]
  ds_read_b64_tr_b16 a[90:91], v23 offset:25088
  buffer_load_dwordx4 v5, s[48:51], s61 offen offset:0 lds
  v_mfma_f32_16x16x32_bf16 v[168:171], a[24:27], a[104:107], v[168:171]
  ds_read_b64_tr_b16 a[92:93], v23 offset:27648
  v_mfma_f32_16x16x32_bf16 v[172:175], a[24:27], a[108:111], v[172:175]
  ds_read_b64_tr_b16 a[94:95], v23 offset:28160
  v_mfma_f32_16x16x32_bf16 v[176:179], a[28:31], a[96:99], v[176:179]
  v_mfma_f32_16x16x32_bf16 v[180:183], a[28:31], a[100:103], v[180:183]
  buffer_load_dwordx4 a[140:143], v2, s[84:87], s88 offen offset:3072 sc1
  v_mfma_f32_16x16x32_bf16 v[184:187], a[28:31], a[104:107], v[184:187]
  v_mfma_f32_16x16x32_bf16 v[188:191], a[28:31], a[108:111], v[188:191]
  v_mfma_f32_16x16x32_bf16 v[192:195], a[32:35], a[96:99], v[192:195]
  s_add_u32 m0, s62, 53120
  v_mfma_f32_16x16x32_bf16 v[196:199], a[32:35], a[100:103], v[196:199]
  buffer_load_dwordx4 v5, s[48:51], s61 offen offset:128 lds
  v_mfma_f32_16x16x32_bf16 v[200:203], a[32:35], a[104:107], v[200:203]
  v_mfma_f32_16x16x32_bf16 v[204:207], a[32:35], a[108:111], v[204:207]
  v_mfma_f32_16x16x32_bf16 v[208:211], a[36:39], a[96:99], v[208:211]
  v_mfma_f32_16x16x32_bf16 v[212:215], a[36:39], a[100:103], v[212:215]
  buffer_store_dwordx4 v[26:29], v3, s[56:59], s76 offen offset:0 sc1
  v_mfma_f32_16x16x32_bf16 v[216:219], a[36:39], a[104:107], v[216:219]
  v_mfma_f32_16x16x32_bf16 v[220:223], a[36:39], a[108:111], v[220:223]
  v_mfma_f32_16x16x32_bf16 v[224:227], a[40:43], a[96:99], v[224:227]
  s_add_u32 m0, s62, 54016
  v_mfma_f32_16x16x32_bf16 v[228:231], a[40:43], a[100:103], v[228:231]
  buffer_load_dwordx4 v5, s[48:51], s61 offen offset:256 lds
  s_add_u32 s61, s61, s67
  v_mfma_f32_16x16x32_bf16 v[232:235], a[40:43], a[104:107], v[232:235]
  v_mfma_f32_16x16x32_bf16 v[236:239], a[40:43], a[108:111], v[236:239]
  v_mfma_f32_16x16x32_bf16 v[240:243], a[44:47], a[96:99], v[240:243]
  v_mfma_f32_16x16x32_bf16 v[244:247], a[44:47], a[100:103], v[244:247]
  v_mfma_f32_16x16x32_bf16 v[248:251], a[44:47], a[104:107], v[248:251]
  v_mfma_f32_16x16x32_bf16 v[252:255], a[44:47], a[108:111], v[252:255]
  s_waitcnt lgkmcnt(0)
  s_barrier
  s_nop 0
  v_mfma_f32_16x16x32_bf16 v[64:67], a[48:51], a[112:115], v[64:67]
  ds_read_b128 a[96:99], v10 offset:0
  s_add_u32 m0, s62, 73728
  v_mfma_f32_16x16x32_bf16 v[68:71], a[48:51], a[116:119], v[68:71]
  ds_read_b128 a[100:103], v10 offset:2048
  buffer_load_dwordx4 v5, s[44:47], s61 offen offset:0 lds
  v_mfma_f32_16x16x32_bf16 v[72:75], a[48:51], a[120:123], v[72:75]
  ds_read_b128 a[104:107], v10 offset:4096
  v_mfma_f32_16x16x32_bf16 v[76:79], a[48:51], a[124:127], v[76:79]
  ds_read_b128 a[108:111], v10 offset:6144
  s_add_u32 m0, s62, 74624
  v_mfma_f32_16x16x32_bf16 v[80:83], a[52:55], a[112:115], v[80:83]
  ds_read_b64_tr_b16 a[0:1], v12 offset:0
  buffer_load_dwordx4 v5, s[44:47], s61 offen offset:128 lds
  v_mfma_f32_16x16x32_bf16 v[84:87], a[52:55], a[116:119], v[84:87]
  ds_read_b64_tr_b16 a[2:3], v12 offset:512
  v_mfma_f32_16x16x32_bf16 v[88:91], a[52:55], a[120:123], v[88:91]
  ds_read_b64_tr_b16 a[4:5], v12 offset:3072
  s_add_u32 m0, s62, 75520
  v_mfma_f32_16x16x32_bf16 v[92:95], a[52:55], a[124:127], v[92:95]
  ds_read_b64_tr_b16 a[6:7], v12 offset:3584
  buffer_load_dwordx4 v5, s[44:47], s61 offen offset:256 lds
  v_mfma_f32_16x16x32_bf16 v[96:99], a[56:59], a[112:115], v[96:99]
  ds_read_b64_tr_b16 a[8:9], v13 offset:0
  v_mfma_f32_16x16x32_bf16 v[100:103], a[56:59], a[116:119], v[100:103]
  ds_read_b64_tr_b16 a[10:11], v13 offset:512
  s_add_u32 m0, s62, 76800
  v_mfma_f32_16x16x32_bf16 v[104:107], a[56:59], a[120:123], v[104:107]
  ds_read_b64_tr_b16 a[12:13], v13 offset:3072
  buffer_load_dwordx4 v5, s[48:51], s61 offen offset:0 lds
  v_mfma_f32_16x16x32_bf16 v[108:111], a[56:59], a[124:127], v[108:111]
  ds_read_b64_tr_b16 a[14:15], v13 offset:3584
  v_mfma_f32_16x16x32_bf16 v[112:115], a[60:63], a[112:115], v[112:115]
  ds_read_b64_tr_b16 a[16:17], v14 offset:0
  s_add_u32 m0, s62, 77696
  v_mfma_f32_16x16x32_bf16 v[116:119], a[60:63], a[116:119], v[116:119]
  ds_read_b64_tr_b16 a[18:19], v14 offset:512
  buffer_load_dwordx4 v5, s[48:51], s61 offen offset:128 lds
  v_mfma_f32_16x16x32_bf16 v[120:123], a[60:63], a[120:123], v[120:123]
  ds_read_b64_tr_b16 a[20:21], v14 offset:3072
  v_mfma_f32_16x16x32_bf16 v[124:127], a[60:63], a[124:127], v[124:127]
  ds_read_b64_tr_b16 a[22:23], v14 offset:3584
  v_mfma_f32_16x16x32_bf16 v[128:131], a[64:67], a[112:115], v[128:131]
  ds_read_b64_tr_b16 a[24:25], v15 offset:0
  s_add_u32 m0, s62, 78592
  v_mfma_f32_16x16x32_bf16 v[132:135], a[64:67], a[116:119], v[132:135]
  ds_read_b64_tr_b16 a[26:27], v15 offset:512
  buffer_load_dwordx4 v5, s[48:51], s61 offen offset:256 lds
  s_add_u32 s61, s61, s67
  s_nop 0
  v_mfma_f32_16x16x32_bf16 v[136:139], a[64:67], a[120:123], v[136:139]
  ds_read_b64_tr_b16 a[28:29], v15 offset:3072
  v_mfma_f32_16x16x32_bf16 v[140:143], a[64:67], a[124:127], v[140:143]
  ds_read_b64_tr_b16 a[30:31], v15 offset:3584
  v_mfma_f32_16x16x32_bf16 v[144:147], a[68:71], a[112:115], v[144:147]
  ds_read_b64_tr_b16 a[32:33], v16 offset:0
  buffer_load_dwordx4 a[144:147], v3, s[84:87], s88 offen sc1
  v_mfma_f32_16x16x32_bf16 v[148:151], a[68:71], a[116:119], v[148:151]
  ds_read_b64_tr_b16 a[34:35], v16 offset:512
  v_mfma_f32_16x16x32_bf16 v[152:155], a[68:71], a[120:123], v[152:155]
  ds_read_b64_tr_b16 a[36:37], v16 offset:3072
  s_add_u32 m0, s63, 31744
  v_mfma_f32_16x16x32_bf16 v[156:159], a[68:71], a[124:127], v[156:159]
  ds_read_b64_tr_b16 a[38:39], v16 offset:3584
  buffer_load_dwordx4 v6, s[40:43], 0 offen offset:1024 lds
  v_mfma_f32_16x16x32_bf16 v[160:163], a[72:75], a[112:115], v[160:163]
  ds_read_b64_tr_b16 a[40:41], v17 offset:0
  v_mfma_f32_16x16x32_bf16 v[164:167], a[72:75], a[116:119], v[164:167]
  ds_read_b64_tr_b16 a[42:43], v17 offset:512
  s_add_u32 s88, s89, 122880
  v_mfma_f32_16x16x32_bf16 v[168:171], a[72:75], a[120:123], v[168:171]
  ds_read_b64_tr_b16 a[44:45], v17 offset:3072
  buffer_load_dwordx4 a[148:151], v2, s[84:87], s88 offen offset:0 sc1
  v_mfma_f32_16x16x32_bf16 v[172:175], a[72:75], a[124:127], v[172:175]
  ds_read_b64_tr_b16 a[46:47], v17 offset:3584
  v_mfma_f32_16x16x32_bf16 v[176:179], a[76:79], a[112:115], v[176:179]
  s_add_u32 m0, s63, 32768
  v_mfma_f32_16x16x32_bf16 v[180:183], a[76:79], a[116:119], v[180:183]
  buffer_load_dwordx4 v7, s[40:43], 0 offen offset:1024 lds
  v_mfma_f32_16x16x32_bf16 v[184:187], a[76:79], a[120:123], v[184:187]
  v_mfma_f32_16x16x32_bf16 v[188:191], a[76:79], a[124:127], v[188:191]
  v_mfma_f32_16x16x32_bf16 v[192:195], a[80:83], a[112:115], v[192:195]
  v_mfma_f32_16x16x32_bf16 v[196:199], a[80:83], a[116:119], v[196:199]
  buffer_load_dwordx4 a[152:155], v2, s[84:87], s88 offen offset:1024 sc1
  v_mfma_f32_16x16x32_bf16 v[200:203], a[80:83], a[120:123], v[200:203]
  v_mfma_f32_16x16x32_bf16 v[204:207], a[80:83], a[124:127], v[204:207]
  s_add_u32 m0, s63, 33792
  v_mfma_f32_16x16x32_bf16 v[208:211], a[84:87], a[112:115], v[208:211]
  buffer_load_dwordx4 v8, s[40:43], 0 offen offset:1024 lds
  v_mfma_f32_16x16x32_bf16 v[212:215], a[84:87], a[116:119], v[212:215]
  v_mfma_f32_16x16x32_bf16 v[216:219], a[84:87], a[120:123], v[216:219]
  v_mfma_f32_16x16x32_bf16 v[220:223], a[84:87], a[124:127], v[220:223]
  buffer_load_dwordx4 a[156:159], v2, s[84:87], s88 offen offset:2048 sc1
  v_mfma_f32_16x16x32_bf16 v[224:227], a[88:91], a[112:115], v[224:227]
  v_mfma_f32_16x16x32_bf16 v[228:231], a[88:91], a[116:119], v[228:231]
  s_add_u32 m0, s63, 34816
  v_mfma_f32_16x16x32_bf16 v[232:235], a[88:91], a[120:123], v[232:235]
  buffer_load_dwordx4 v9, s[40:43], 0 offen offset:1024 lds
  v_mfma_f32_16x16x32_bf16 v[236:239], a[88:91], a[124:127], v[236:239]
  v_mfma_f32_16x16x32_bf16 v[240:243], a[92:95], a[112:115], v[240:243]
  v_mfma_f32_16x16x32_bf16 v[244:247], a[92:95], a[116:119], v[244:247]
  v_mfma_f32_16x16x32_bf16 v[248:251], a[92:95], a[120:123], v[248:251]
  v_mfma_f32_16x16x32_bf16 v[252:255], a[92:95], a[124:127], v[252:255]
  s_waitcnt vmcnt(30) lgkmcnt(0)
  s_barrier
  v_mfma_f32_16x16x32_bf16 v[64:67], a[0:3], a[96:99], v[64:67]
  ds_read_b128 a[112:115], v11 offset:0
  s_add_u32 m0, s62, 0
  s_nop 0
  v_mfma_f32_16x16x32_bf16 v[68:71], a[0:3], a[100:103], v[68:71]
  ds_read_b128 a[116:119], v11 offset:2048
  buffer_load_dwordx4 v5, s[44:47], s61 offen offset:0 lds
  v_mfma_f32_16x16x32_bf16 v[72:75], a[0:3], a[104:107], v[72:75]
  ds_read_b128 a[120:123], v11 offset:4096
  v_mfma_f32_16x16x32_bf16 v[76:79], a[0:3], a[108:111], v[76:79]
  ds_read_b128 a[124:127], v11 offset:6144
  v_mfma_f32_16x16x32_bf16 v[80:83], a[4:7], a[96:99], v[80:83]
  ds_read_b64_tr_b16 a[48:49], v12 offset:24576
  s_add_u32 m0, s62, 896
  v_mfma_f32_16x16x32_bf16 v[84:87], a[4:7], a[100:103], v[84:87]
  ds_read_b64_tr_b16 a[50:51], v12 offset:25088
  buffer_load_dwordx4 v5, s[44:47], s61 offen offset:128 lds
  v_mfma_f32_16x16x32_bf16 v[88:91], a[4:7], a[104:107], v[88:91]
  ds_read_b64_tr_b16 a[52:53], v12 offset:27648
  v_mfma_f32_16x16x32_bf16 v[92:95], a[4:7], a[108:111], v[92:95]
  ds_read_b64_tr_b16 a[54:55], v12 offset:28160
  v_mfma_f32_16x16x32_bf16 v[96:99], a[8:11], a[96:99], v[96:99]
  ds_read_b64_tr_b16 a[56:57], v13 offset:24576
  v_mfma_f32_16x16x32_bf16 v[100:103], a[8:11], a[100:103], v[100:103]
  ds_read_b64_tr_b16 a[58:59], v13 offset:25088
  v_mfma_f32_16x16x32_bf16 v[104:107], a[8:11], a[104:107], v[104:107]
  ds_read_b64_tr_b16 a[60:61], v13 offset:27648
  buffer_load_dwordx4 a[160:163], v2, s[84:87], s88 offen offset:3072 sc1
  v_mfma_f32_16x16x32_bf16 v[108:111], a[8:11], a[108:111], v[108:111]
  ds_read_b64_tr_b16 a[62:63], v13 offset:28160
  v_mfma_f32_16x16x32_bf16 v[112:115], a[12:15], a[96:99], v[112:115]
  ds_read_b64_tr_b16 a[64:65], v14 offset:24576
  v_mfma_f32_16x16x32_bf16 v[116:119], a[12:15], a[100:103], v[116:119]
  ds_read_b64_tr_b16 a[66:67], v14 offset:25088
  s_add_u32 m0, s62, 1792
  v_mfma_f32_16x16x32_bf16 v[120:123], a[12:15], a[104:107], v[120:123]
  ds_read_b64_tr_b16 a[68:69], v14 offset:27648
  buffer_load_dwordx4 v5, s[44:47], s61 offen offset:256 lds
  v_mfma_f32_16x16x32_bf16 v[124:127], a[12:15], a[108:111], v[124:127]
  ds_read_b64_tr_b16 a[70:71], v14 offset:28160
  v_mfma_f32_16x16x32_bf16 v[128:131], a[16:19], a[96:99], v[128:131]
  ds_read_b64_tr_b16 a[72:73], v15 offset:24576
  v_mfma_f32_16x16x32_bf16 v[132:135], a[16:19], a[100:103], v[132:135]
  ds_read_b64_tr_b16 a[74:75], v15 offset:25088
  v_mfma_f32_16x16x32_bf16 v[136:139], a[16:19], a[104:107], v[136:139]
  ds_read_b64_tr_b16 a[76:77], v15 offset:27648
  v_mfma_f32_16x16x32_bf16 v[140:143], a[16:19], a[108:111], v[140:143]
  ds_read_b64_tr_b16 a[78:79], v15 offset:28160
  buffer_load_dwordx4 a[164:167], v3, s[84:87], s88 offen sc1
  v_mfma_f32_16x16x32_bf16 v[144:147], a[20:23], a[96:99], v[144:147]
  ds_read_b64_tr_b16 a[80:81], v16 offset:24576
  v_mfma_f32_16x16x32_bf16 v[148:151], a[20:23], a[100:103], v[148:151]
  ds_read_b64_tr_b16 a[82:83], v16 offset:25088
  v_mfma_f32_16x16x32_bf16 v[152:155], a[20:23], a[104:107], v[152:155]
  ds_read_b64_tr_b16 a[84:85], v16 offset:27648
  s_add_u32 m0, s62, 3072
  v_mfma_f32_16x16x32_bf16 v[156:159], a[20:23], a[108:111], v[156:159]
  ds_read_b64_tr_b16 a[86:87], v16 offset:28160
  buffer_load_dwordx4 v5, s[48:51], s61 offen offset:0 lds
  v_mfma_f32_16x16x32_bf16 v[160:163], a[24:27], a[96:99], v[160:163]
  ds_read_b64_tr_b16 a[88:89], v17 offset:24576
  v_mfma_f32_16x16x32_bf16 v[164:167], a[24:27], a[100:103], v[164:167]
  ds_read_b64_tr_b16 a[90:91], v17 offset:25088
  v_mfma_f32_16x16x32_bf16 v[168:171], a[24:27], a[104:107], v[168:171]
  ds_read_b64_tr_b16 a[92:93], v17 offset:27648
  v_mfma_f32_16x16x32_bf16 v[172:175], a[24:27], a[108:111], v[172:175]
  ds_read_b64_tr_b16 a[94:95], v17 offset:28160
  s_add_u32 s88, s89, 143360
  v_mfma_f32_16x16x32_bf16 v[176:179], a[28:31], a[96:99], v[176:179]
  buffer_load_dwordx4 a[168:171], v2, s[84:87], s88 offen offset:0 sc1
  v_mfma_f32_16x16x32_bf16 v[180:183], a[28:31], a[100:103], v[180:183]
  v_mfma_f32_16x16x32_bf16 v[184:187], a[28:31], a[104:107], v[184:187]
  v_mfma_f32_16x16x32_bf16 v[188:191], a[28:31], a[108:111], v[188:191]
  s_add_u32 m0, s62, 3968
  v_mfma_f32_16x16x32_bf16 v[192:195], a[32:35], a[96:99], v[192:195]
  buffer_load_dwordx4 v5, s[48:51], s61 offen offset:128 lds
  v_mfma_f32_16x16x32_bf16 v[196:199], a[32:35], a[100:103], v[196:199]
  v_mfma_f32_16x16x32_bf16 v[200:203], a[32:35], a[104:107], v[200:203]
  v_mfma_f32_16x16x32_bf16 v[204:207], a[32:35], a[108:111], v[204:207]
  v_mfma_f32_16x16x32_bf16 v[208:211], a[36:39], a[96:99], v[208:211]
  v_mfma_f32_16x16x32_bf16 v[212:215], a[36:39], a[100:103], v[212:215]
  buffer_load_dwordx4 a[172:175], v2, s[84:87], s88 offen offset:1024 sc1
  v_mfma_f32_16x16x32_bf16 v[216:219], a[36:39], a[104:107], v[216:219]
  v_mfma_f32_16x16x32_bf16 v[220:223], a[36:39], a[108:111], v[220:223]
  v_mfma_f32_16x16x32_bf16 v[224:227], a[40:43], a[96:99], v[224:227]
  s_add_u32 m0, s62, 4864
  v_mfma_f32_16x16x32_bf16 v[228:231], a[40:43], a[100:103], v[228:231]
  buffer_load_dwordx4 v5, s[48:51], s61 offen offset:256 lds
  s_add_u32 s61, s61, s67
  v_mfma_f32_16x16x32_bf16 v[232:235], a[40:43], a[104:107], v[232:235]
  v_mfma_f32_16x16x32_bf16 v[236:239], a[40:43], a[108:111], v[236:239]
  v_mfma_f32_16x16x32_bf16 v[240:243], a[44:47], a[96:99], v[240:243]
  v_mfma_f32_16x16x32_bf16 v[244:247], a[44:47], a[100:103], v[244:247]
  v_mfma_f32_16x16x32_bf16 v[248:251], a[44:47], a[104:107], v[248:251]
  v_mfma_f32_16x16x32_bf16 v[252:255], a[44:47], a[108:111], v[252:255]
  s_waitcnt vmcnt(24) lgkmcnt(0)
  s_barrier
  s_nop 0
  v_mfma_f32_16x16x32_bf16 v[64:67], a[48:51], a[112:115], v[64:67]
  ds_read_b128 a[96:99], v10 offset:16384
  s_add_u32 m0, s62, 24576
  v_mfma_f32_16x16x32_bf16 v[68:71], a[48:51], a[116:119], v[68:71]
  ds_read_b128 a[100:103], v10 offset:18432
  buffer_load_dwordx4 v5, s[44:47], s61 offen offset:0 lds
  v_mfma_f32_16x16x32_bf16 v[72:75], a[48:51], a[120:123], v[72:75]
  ds_read_b128 a[104:107], v10 offset:20480
  v_mfma_f32_16x16x32_bf16 v[76:79], a[48:51], a[124:127], v[76:79]
  ds_read_b128 a[108:111], v10 offset:22528
  s_add_u32 m0, s62, 25472
  v_mfma_f32_16x16x32_bf16 v[80:83], a[52:55], a[112:115], v[80:83]
  ds_read_b64_tr_b16 a[0:1], v18 offset:0
  buffer_load_dwordx4 v5, s[44:47], s61 offen offset:128 lds
  v_mfma_f32_16x16x32_bf16 v[84:87], a[52:55], a[116:119], v[84:87]
  ds_read_b64_tr_b16 a[2:3], v18 offset:512
  v_mfma_f32_16x16x32_bf16 v[88:91], a[52:55], a[120:123], v[88:91]
  ds_read_b64_tr_b16 a[4:5], v18 offset:3072
  s_add_u32 m0, s62, 26368
  v_mfma_f32_16x16x32_bf16 v[92:95], a[52:55], a[124:127], v[92:95]
  ds_read_b64_tr_b16 a[6:7], v18 offset:3584
  buffer_load_dwordx4 v5, s[44:47], s61 offen offset:256 lds
  v_mfma_f32_16x16x32_bf16 v[96:99], a[56:59], a[112:115], v[96:99]
  ds_read_b64_tr_b16 a[8:9], v19 offset:0
  v_mfma_f32_16x16x32_bf16 v[100:103], a[56:59], a[116:119], v[100:103]
  ds_read_b64_tr_b16 a[10:11], v19 offset:512
  s_add_u32 m0, s62, 27648
  v_mfma_f32_16x16x32_bf16 v[104:107], a[56:59], a[120:123], v[104:107]
  ds_read_b64_tr_b16 a[12:13], v19 offset:3072
  buffer_load_dwordx4 v5, s[48:51], s61 offen offset:0 lds
  v_mfma_f32_16x16x32_bf16 v[108:111], a[56:59], a[124:127], v[108:111]
  ds_read_b64_tr_b16 a[14:15], v19 offset:3584
  v_mfma_f32_16x16x32_bf16 v[112:115], a[60:63], a[112:115], v[112:115]
  ds_read_b64_tr_b16 a[16:17], v20 offset:0
  s_add_u32 m0, s62, 28544
  v_mfma_f32_16x16x32_bf16 v[116:119], a[60:63], a[116:119], v[116:119]
  ds_read_b64_tr_b16 a[18:19], v20 offset:512
  buffer_load_dwordx4 v5, s[48:51], s61 offen offset:128 lds
  v_mfma_f32_16x16x32_bf16 v[120:123], a[60:63], a[120:123], v[120:123]
  ds_read_b64_tr_b16 a[20:21], v20 offset:3072
  v_mfma_f32_16x16x32_bf16 v[124:127], a[60:63], a[124:127], v[124:127]
  ds_read_b64_tr_b16 a[22:23], v20 offset:3584
  v_mfma_f32_16x16x32_bf16 v[128:131], a[64:67], a[112:115], v[128:131]
  ds_read_b64_tr_b16 a[24:25], v21 offset:0
  s_add_u32 m0, s62, 29440
  v_mfma_f32_16x16x32_bf16 v[132:135], a[64:67], a[116:119], v[132:135]
  ds_read_b64_tr_b16 a[26:27], v21 offset:512
  buffer_load_dwordx4 v5, s[48:51], s61 offen offset:256 lds
  s_add_u32 s61, s61, s67
  s_nop 0
  v_mfma_f32_16x16x32_bf16 v[136:139], a[64:67], a[120:123], v[136:139]
  ds_read_b64_tr_b16 a[28:29], v21 offset:3072
  v_mfma_f32_16x16x32_bf16 v[140:143], a[64:67], a[124:127], v[140:143]
  ds_read_b64_tr_b16 a[30:31], v21 offset:3584
  v_mfma_f32_16x16x32_bf16 v[144:147], a[68:71], a[112:115], v[144:147]
  ds_read_b64_tr_b16 a[32:33], v22 offset:0
  buffer_load_dwordx4 a[176:179], v2, s[84:87], s88 offen offset:2048 sc1
  v_mfma_f32_16x16x32_bf16 v[148:151], a[68:71], a[116:119], v[148:151]
  ds_read_b64_tr_b16 a[34:35], v22 offset:512
  v_mfma_f32_16x16x32_bf16 v[152:155], a[68:71], a[120:123], v[152:155]
  ds_read_b64_tr_b16 a[36:37], v22 offset:3072
  s_add_u32 m0, s63, -1152
  v_mfma_f32_16x16x32_bf16 v[156:159], a[68:71], a[124:127], v[156:159]
  ds_read_b64_tr_b16 a[38:39], v22 offset:3584
  buffer_load_dwordx4 v6, s[40:43], 0 offen offset:1152 lds
  v_mfma_f32_16x16x32_bf16 v[160:163], a[72:75], a[112:115], v[160:163]
  ds_read_b64_tr_b16 a[40:41], v23 offset:0
  v_mfma_f32_16x16x32_bf16 v[164:167], a[72:75], a[116:119], v[164:167]
  ds_read_b64_tr_b16 a[42:43], v23 offset:512
  v_mfma_f32_16x16x32_bf16 v[168:171], a[72:75], a[120:123], v[168:171]
  ds_read_b64_tr_b16 a[44:45], v23 offset:3072
  buffer_load_dwordx4 a[180:183], v2, s[84:87], s88 offen offset:3072 sc1
  v_mfma_f32_16x16x32_bf16 v[172:175], a[72:75], a[124:127], v[172:175]
  ds_read_b64_tr_b16 a[46:47], v23 offset:3584
  v_mfma_f32_16x16x32_bf16 v[176:179], a[76:79], a[112:115], v[176:179]
  s_add_u32 m0, s63, -128
  v_mfma_f32_16x16x32_bf16 v[180:183], a[76:79], a[116:119], v[180:183]
  buffer_load_dwordx4 v7, s[40:43], 0 offen offset:1152 lds
  v_mfma_f32_16x16x32_bf16 v[184:187], a[76:79], a[120:123], v[184:187]
  v_mfma_f32_16x16x32_bf16 v[188:191], a[76:79], a[124:127], v[188:191]
  v_mfma_f32_16x16x32_bf16 v[192:195], a[80:83], a[112:115], v[192:195]
  v_mfma_f32_16x16x32_bf16 v[196:199], a[80:83], a[116:119], v[196:199]
  buffer_load_dwordx4 a[184:187], v3, s[84:87], s88 offen sc1
  v_mfma_f32_16x16x32_bf16 v[200:203], a[80:83], a[120:123], v[200:203]
  v_mfma_f32_16x16x32_bf16 v[204:207], a[80:83], a[124:127], v[204:207]
  s_add_u32 m0, s63, 896
  v_mfma_f32_16x16x32_bf16 v[208:211], a[84:87], a[112:115], v[208:211]
  buffer_load_dwordx4 v8, s[40:43], 0 offen offset:1152 lds
  v_mfma_f32_16x16x32_bf16 v[212:215], a[84:87], a[116:119], v[212:215]
  v_mfma_f32_16x16x32_bf16 v[216:219], a[84:87], a[120:123], v[216:219]
  s_add_u32 s88, s89, 163840
  v_mfma_f32_16x16x32_bf16 v[220:223], a[84:87], a[124:127], v[220:223]
  buffer_load_dwordx4 a[188:191], v2, s[84:87], s88 offen offset:0 sc1
  v_mfma_f32_16x16x32_bf16 v[224:227], a[88:91], a[112:115], v[224:227]
  v_mfma_f32_16x16x32_bf16 v[228:231], a[88:91], a[116:119], v[228:231]
  s_add_u32 m0, s63, 1920
  v_mfma_f32_16x16x32_bf16 v[232:235], a[88:91], a[120:123], v[232:235]
  buffer_load_dwordx4 v9, s[40:43], 0 offen offset:1152 lds
  v_mfma_f32_16x16x32_bf16 v[236:239], a[88:91], a[124:127], v[236:239]
  v_mfma_f32_16x16x32_bf16 v[240:243], a[92:95], a[112:115], v[240:243]
  v_mfma_f32_16x16x32_bf16 v[244:247], a[92:95], a[116:119], v[244:247]
  v_mfma_f32_16x16x32_bf16 v[248:251], a[92:95], a[120:123], v[248:251]
  v_mfma_f32_16x16x32_bf16 v[252:255], a[92:95], a[124:127], v[252:255]
  s_waitcnt vmcnt(32) lgkmcnt(0)
  s_barrier
  v_mfma_f32_16x16x32_bf16 v[64:67], a[0:3], a[96:99], v[64:67]
  ds_read_b128 a[112:115], v11 offset:16384
  s_add_u32 m0, s62, 49152
  v_mfma_f32_16x16x32_bf16 v[68:71], a[0:3], a[100:103], v[68:71]
  ds_read_b128 a[116:119], v11 offset:18432
  buffer_load_dwordx4 v5, s[44:47], s61 offen offset:0 lds
  v_mfma_f32_16x16x32_bf16 v[72:75], a[0:3], a[104:107], v[72:75]
  ds_read_b128 a[120:123], v11 offset:20480
  v_mfma_f32_16x16x32_bf16 v[76:79], a[0:3], a[108:111], v[76:79]
  ds_read_b128 a[124:127], v11 offset:22528
  v_mfma_f32_16x16x32_bf16 v[80:83], a[4:7], a[96:99], v[80:83]
  ds_read_b64_tr_b16 a[48:49], v18 offset:24576
  s_add_u32 m0, s62, 50048
  v_mfma_f32_16x16x32_bf16 v[84:87], a[4:7], a[100:103], v[84:87]
  ds_read_b64_tr_b16 a[50:51], v18 offset:25088
  buffer_load_dwordx4 v5, s[44:47], s61 offen offset:128 lds
  v_mfma_f32_16x16x32_bf16 v[88:91], a[4:7], a[104:107], v[88:91]
  ds_read_b64_tr_b16 a[52:53], v18 offset:27648
  v_mfma_f32_16x16x32_bf16 v[92:95], a[4:7], a[108:111], v[92:95]
  ds_read_b64_tr_b16 a[54:55], v18 offset:28160
  v_mfma_f32_16x16x32_bf16 v[96:99], a[8:11], a[96:99], v[96:99]
  ds_read_b64_tr_b16 a[56:57], v19 offset:24576
  v_mfma_f32_16x16x32_bf16 v[100:103], a[8:11], a[100:103], v[100:103]
  ds_read_b64_tr_b16 a[58:59], v19 offset:25088
  v_mfma_f32_16x16x32_bf16 v[104:107], a[8:11], a[104:107], v[104:107]
  ds_read_b64_tr_b16 a[60:61], v19 offset:27648
  buffer_load_dwordx4 a[192:195], v2, s[84:87], s88 offen offset:1024 sc1
  v_mfma_f32_16x16x32_bf16 v[108:111], a[8:11], a[108:111], v[108:111]
  ds_read_b64_tr_b16 a[62:63], v19 offset:28160
  v_mfma_f32_16x16x32_bf16 v[112:115], a[12:15], a[96:99], v[112:115]
  ds_read_b64_tr_b16 a[64:65], v20 offset:24576
  v_mfma_f32_16x16x32_bf16 v[116:119], a[12:15], a[100:103], v[116:119]
  ds_read_b64_tr_b16 a[66:67], v20 offset:25088
  s_add_u32 m0, s62, 50944
  v_mfma_f32_16x16x32_bf16 v[120:123], a[12:15], a[104:107], v[120:123]
  ds_read_b64_tr_b16 a[68:69], v20 offset:27648
  buffer_load_dwordx4 v5, s[44:47], s61 offen offset:256 lds
  v_mfma_f32_16x16x32_bf16 v[124:127], a[12:15], a[108:111], v[124:127]
  ds_read_b64_tr_b16 a[70:71], v20 offset:28160
  v_mfma_f32_16x16x32_bf16 v[128:131], a[16:19], a[96:99], v[128:131]
  ds_read_b64_tr_b16 a[72:73], v21 offset:24576
  v_mfma_f32_16x16x32_bf16 v[132:135], a[16:19], a[100:103], v[132:135]
  ds_read_b64_tr_b16 a[74:75], v21 offset:25088
  v_mfma_f32_16x16x32_bf16 v[136:139], a[16:19], a[104:107], v[136:139]
  ds_read_b64_tr_b16 a[76:77], v21 offset:27648
  v_mfma_f32_16x16x32_bf16 v[140:143], a[16:19], a[108:111], v[140:143]
  ds_read_b64_tr_b16 a[78:79], v21 offset:28160
  buffer_load_dwordx4 a[196:199], v2, s[84:87], s88 offen offset:2048 sc1
  v_mfma_f32_16x16x32_bf16 v[144:147], a[20:23], a[96:99], v[144:147]
  ds_read_b64_tr_b16 a[80:81], v22 offset:24576
  v_mfma_f32_16x16x32_bf16 v[148:151], a[20:23], a[100:103], v[148:151]
  ds_read_b64_tr_b16 a[82:83], v22 offset:25088
  v_mfma_f32_16x16x32_bf16 v[152:155], a[20:23], a[104:107], v[152:155]
  ds_read_b64_tr_b16 a[84:85], v22 offset:27648
  s_add_u32 m0, s62, 52224
  v_mfma_f32_16x16x32_bf16 v[156:159], a[20:23], a[108:111], v[156:159]
  ds_read_b64_tr_b16 a[86:87], v22 offset:28160
  buffer_load_dwordx4 v5, s[48:51], s61 offen offset:0 lds
  v_mfma_f32_16x16x32_bf16 v[160:163], a[24:27], a[96:99], v[160:163]
  ds_read_b64_tr_b16 a[88:89], v23 offset:24576
  v_mfma_f32_16x16x32_bf16 v[164:167], a[24:27], a[100:103], v[164:167]
  ds_read_b64_tr_b16 a[90:91], v23 offset:25088
  v_mfma_f32_16x16x32_bf16 v[168:171], a[24:27], a[104:107], v[168:171]
  ds_read_b64_tr_b16 a[92:93], v23 offset:27648
  v_mfma_f32_16x16x32_bf16 v[172:175], a[24:27], a[108:111], v[172:175]
  ds_read_b64_tr_b16 a[94:95], v23 offset:28160
  v_mfma_f32_16x16x32_bf16 v[176:179], a[28:31], a[96:99], v[176:179]
  buffer_load_dwordx4 a[200:203], v2, s[84:87], s88 offen offset:3072 sc1
  v_mfma_f32_16x16x32_bf16 v[180:183], a[28:31], a[100:103], v[180:183]
  v_mfma_f32_16x16x32_bf16 v[184:187], a[28:31], a[104:107], v[184:187]
  v_mfma_f32_16x16x32_bf16 v[188:191], a[28:31], a[108:111], v[188:191]
  s_add_u32 m0, s62, 53120
  v_mfma_f32_16x16x32_bf16 v[192:195], a[32:35], a[96:99], v[192:195]
  buffer_load_dwordx4 v5, s[48:51], s61 offen offset:128 lds
  v_mfma_f32_16x16x32_bf16 v[196:199], a[32:35], a[100:103], v[196:199]
  v_mfma_f32_16x16x32_bf16 v[200:203], a[32:35], a[104:107], v[200:203]
  v_mfma_f32_16x16x32_bf16 v[204:207], a[32:35], a[108:111], v[204:207]
  v_mfma_f32_16x16x32_bf16 v[208:211], a[36:39], a[96:99], v[208:211]
  v_mfma_f32_16x16x32_bf16 v[212:215], a[36:39], a[100:103], v[212:215]
  buffer_load_dwordx4 a[204:207], v3, s[84:87], s88 offen sc1
  v_mfma_f32_16x16x32_bf16 v[216:219], a[36:39], a[104:107], v[216:219]
  v_mfma_f32_16x16x32_bf16 v[220:223], a[36:39], a[108:111], v[220:223]
  v_mfma_f32_16x16x32_bf16 v[224:227], a[40:43], a[96:99], v[224:227]
  s_add_u32 m0, s62, 54016
  v_mfma_f32_16x16x32_bf16 v[228:231], a[40:43], a[100:103], v[228:231]
  buffer_load_dwordx4 v5, s[48:51], s61 offen offset:256 lds
  s_add_u32 s61, s61, s67
  v_mfma_f32_16x16x32_bf16 v[232:235], a[40:43], a[104:107], v[232:235]
  v_mfma_f32_16x16x32_bf16 v[236:239], a[40:43], a[108:111], v[236:239]
  v_mfma_f32_16x16x32_bf16 v[240:243], a[44:47], a[96:99], v[240:243]
  v_mfma_f32_16x16x32_bf16 v[244:247], a[44:47], a[100:103], v[244:247]
  v_mfma_f32_16x16x32_bf16 v[248:251], a[44:47], a[104:107], v[248:251]
  v_mfma_f32_16x16x32_bf16 v[252:255], a[44:47], a[108:111], v[252:255]
  s_waitcnt vmcnt(24) lgkmcnt(0)
  s_barrier
  s_nop 0
  v_mfma_f32_16x16x32_bf16 v[64:67], a[48:51], a[112:115], v[64:67]
  ds_read_b128 a[96:99], v10 offset:32768
  s_add_u32 m0, s62, 73728
  v_mfma_f32_16x16x32_bf16 v[68:71], a[48:51], a[116:119], v[68:71]
  ds_read_b128 a[100:103], v10 offset:34816
  buffer_load_dwordx4 v5, s[44:47], s61 offen offset:0 lds
  v_mfma_f32_16x16x32_bf16 v[72:75], a[48:51], a[120:123], v[72:75]
  ds_read_b128 a[104:107], v10 offset:36864
  v_mfma_f32_16x16x32_bf16 v[76:79], a[48:51], a[124:127], v[76:79]
  ds_read_b128 a[108:111], v10 offset:38912
  v_mfma_f32_16x16x32_bf16 v[80:83], a[52:55], a[112:115], v[80:83]
  ds_read_b64_tr_b16 a[0:1], v12 offset:0
  s_add_u32 m0, s62, 74624
  v_mfma_f32_16x16x32_bf16 v[84:87], a[52:55], a[116:119], v[84:87]
  ds_read_b64_tr_b16 a[2:3], v12 offset:512
  buffer_load_dwordx4 v5, s[44:47], s61 offen offset:128 lds
  v_mfma_f32_16x16x32_bf16 v[88:91], a[52:55], a[120:123], v[88:91]
  ds_read_b64_tr_b16 a[4:5], v12 offset:3072
  v_mfma_f32_16x16x32_bf16 v[92:95], a[52:55], a[124:127], v[92:95]
  ds_read_b64_tr_b16 a[6:7], v12 offset:3584
  v_mfma_f32_16x16x32_bf16 v[96:99], a[56:59], a[112:115], v[96:99]
  ds_read_b64_tr_b16 a[8:9], v13 offset:0
  v_mfma_f32_16x16x32_bf16 v[100:103], a[56:59], a[116:119], v[100:103]
  ds_read_b64_tr_b16 a[10:11], v13 offset:512
  s_add_u32 s88, s89, 184320
  v_mfma_f32_16x16x32_bf16 v[104:107], a[56:59], a[120:123], v[104:107]
  ds_read_b64_tr_b16 a[12:13], v13 offset:3072
  buffer_load_dwordx4 a[208:211], v2, s[84:87], s88 offen offset:0 sc1
  v_mfma_f32_16x16x32_bf16 v[108:111], a[56:59], a[124:127], v[108:111]
  ds_read_b64_tr_b16 a[14:15], v13 offset:3584
  v_mfma_f32_16x16x32_bf16 v[112:115], a[60:63], a[112:115], v[112:115]
  ds_read_b64_tr_b16 a[16:17], v14 offset:0
  v_mfma_f32_16x16x32_bf16 v[116:119], a[60:63], a[116:119], v[116:119]
  ds_read_b64_tr_b16 a[18:19], v14 offset:512
  s_add_u32 m0, s62, 75520
  v_mfma_f32_16x16x32_bf16 v[120:123], a[60:63], a[120:123], v[120:123]
  ds_read_b64_tr_b16 a[20:21], v14 offset:3072
  buffer_load_dwordx4 v5, s[44:47], s61 offen offset:256 lds
  v_mfma_f32_16x16x32_bf16 v[124:127], a[60:63], a[124:127], v[124:127]
  ds_read_b64_tr_b16 a[22:23], v14 offset:3584
  v_mfma_f32_16x16x32_bf16 v[128:131], a[64:67], a[112:115], v[128:131]
  ds_read_b64_tr_b16 a[24:25], v15 offset:0
  v_mfma_f32_16x16x32_bf16 v[132:135], a[64:67], a[116:119], v[132:135]
  ds_read_b64_tr_b16 a[26:27], v15 offset:512
  v_mfma_f32_16x16x32_bf16 v[136:139], a[64:67], a[120:123], v[136:139]
  ds_read_b64_tr_b16 a[28:29], v15 offset:3072
  v_mfma_f32_16x16x32_bf16 v[140:143], a[64:67], a[124:127], v[140:143]
  ds_read_b64_tr_b16 a[30:31], v15 offset:3584
  buffer_load_dwordx4 a[212:215], v2, s[84:87], s88 offen offset:1024 sc1
  v_mfma_f32_16x16x32_bf16 v[144:147], a[68:71], a[112:115], v[144:147]
  ds_read_b64_tr_b16 a[32:33], v16 offset:0
  v_mfma_f32_16x16x32_bf16 v[148:151], a[68:71], a[116:119], v[148:151]
  ds_read_b64_tr_b16 a[34:35], v16 offset:512
  v_mfma_f32_16x16x32_bf16 v[152:155], a[68:71], a[120:123], v[152:155]
  ds_read_b64_tr_b16 a[36:37], v16 offset:3072
  s_add_u32 m0, s62, 76800
  v_mfma_f32_16x16x32_bf16 v[156:159], a[68:71], a[124:127], v[156:159]
  ds_read_b64_tr_b16 a[38:39], v16 offset:3584
  buffer_load_dwordx4 v5, s[48:51], s61 offen offset:0 lds
  v_mfma_f32_16x16x32_bf16 v[160:163], a[72:75], a[112:115], v[160:163]
  ds_read_b64_tr_b16 a[40:41], v17 offset:0
  v_mfma_f32_16x16x32_bf16 v[164:167], a[72:75], a[116:119], v[164:167]
  ds_read_b64_tr_b16 a[42:43], v17 offset:512
  v_mfma_f32_16x16x32_bf16 v[168:171], a[72:75], a[120:123], v[168:171]
  ds_read_b64_tr_b16 a[44:45], v17 offset:3072
  v_mfma_f32_16x16x32_bf16 v[172:175], a[72:75], a[124:127], v[172:175]
  ds_read_b64_tr_b16 a[46:47], v17 offset:3584
  v_mfma_f32_16x16x32_bf16 v[176:179], a[76:79], a[112:115], v[176:179]
  buffer_load_dwordx4 a[216:219], v2, s[84:87], s88 offen offset:2048 sc1
  v_mfma_f32_16x16x32_bf16 v[180:183], a[76:79], a[116:119], v[180:183]
  v_mfma_f32_16x16x32_bf16 v[184:187], a[76:79], a[120:123], v[184:187]
  v_mfma_f32_16x16x32_bf16 v[188:191], a[76:79], a[124:127], v[188:191]
  s_add_u32 m0, s62, 77696
  v_mfma_f32_16x16x32_bf16 v[192:195], a[80:83], a[112:115], v[192:195]
  buffer_load_dwordx4 v5, s[48:51], s61 offen offset:128 lds
  v_mfma_f32_16x16x32_bf16 v[196:199], a[80:83], a[116:119], v[196:199]
  v_mfma_f32_16x16x32_bf16 v[200:203], a[80:83], a[120:123], v[200:203]
  v_mfma_f32_16x16x32_bf16 v[204:207], a[80:83], a[124:127], v[204:207]
  v_mfma_f32_16x16x32_bf16 v[208:211], a[84:87], a[112:115], v[208:211]
  v_mfma_f32_16x16x32_bf16 v[212:215], a[84:87], a[116:119], v[212:215]
  buffer_load_dwordx4 a[220:223], v2, s[84:87], s88 offen offset:3072 sc1
  v_mfma_f32_16x16x32_bf16 v[216:219], a[84:87], a[120:123], v[216:219]
  v_mfma_f32_16x16x32_bf16 v[220:223], a[84:87], a[124:127], v[220:223]
  v_mfma_f32_16x16x32_bf16 v[224:227], a[88:91], a[112:115], v[224:227]
  s_add_u32 m0, s62, 78592
  v_mfma_f32_16x16x32_bf16 v[228:231], a[88:91], a[116:119], v[228:231]
  buffer_load_dwordx4 v5, s[48:51], s61 offen offset:256 lds
  s_add_u32 s61, s61, s67
  v_mfma_f32_16x16x32_bf16 v[232:235], a[88:91], a[120:123], v[232:235]
  v_mfma_f32_16x16x32_bf16 v[236:239], a[88:91], a[124:127], v[236:239]
  v_mfma_f32_16x16x32_bf16 v[240:243], a[92:95], a[112:115], v[240:243]
  v_mfma_f32_16x16x32_bf16 v[244:247], a[92:95], a[116:119], v[244:247]
  v_mfma_f32_16x16x32_bf16 v[248:251], a[92:95], a[120:123], v[248:251]
  v_mfma_f32_16x16x32_bf16 v[252:255], a[92:95], a[124:127], v[252:255]
  s_waitcnt vmcnt(28) lgkmcnt(0)
  s_barrier
  s_nop 0
  v_mfma_f32_16x16x32_bf16 v[64:67], a[0:3], a[96:99], v[64:67]
  ds_read_b128 a[112:115], v11 offset:32768
  v_mfma_f32_16x16x32_bf16 v[68:71], a[0:3], a[100:103], v[68:71]
  ds_read_b128 a[116:119], v11 offset:34816
  buffer_load_dwordx4 a[224:227], v3, s[84:87], s88 offen sc1
  v_mfma_f32_16x16x32_bf16 v[72:75], a[0:3], a[104:107], v[72:75]
  ds_read_b128 a[120:123], v11 offset:36864
  v_mfma_f32_16x16x32_bf16 v[76:79], a[0:3], a[108:111], v[76:79]
  ds_read_b128 a[124:127], v11 offset:38912
  v_mfma_f32_16x16x32_bf16 v[80:83], a[4:7], a[96:99], v[80:83]
  ds_read_b64_tr_b16 a[48:49], v12 offset:24576
  v_mfma_f32_16x16x32_bf16 v[84:87], a[4:7], a[100:103], v[84:87]
  ds_read_b64_tr_b16 a[50:51], v12 offset:25088
  v_mfma_f32_16x16x32_bf16 v[88:91], a[4:7], a[104:107], v[88:91]
  ds_read_b64_tr_b16 a[52:53], v12 offset:27648
  v_mfma_f32_16x16x32_bf16 v[92:95], a[4:7], a[108:111], v[92:95]
  ds_read_b64_tr_b16 a[54:55], v12 offset:28160
  v_mfma_f32_16x16x32_bf16 v[96:99], a[8:11], a[96:99], v[96:99]
  ds_read_b64_tr_b16 a[56:57], v13 offset:24576
  v_mfma_f32_16x16x32_bf16 v[100:103], a[8:11], a[100:103], v[100:103]
  ds_read_b64_tr_b16 a[58:59], v13 offset:25088
  v_mfma_f32_16x16x32_bf16 v[104:107], a[8:11], a[104:107], v[104:107]
  ds_read_b64_tr_b16 a[60:61], v13 offset:27648
  v_mfma_f32_16x16x32_bf16 v[108:111], a[8:11], a[108:111], v[108:111]
  ds_read_b64_tr_b16 a[62:63], v13 offset:28160
  s_add_u32 s88, s89, 204800
  v_mfma_f32_16x16x32_bf16 v[112:115], a[12:15], a[96:99], v[112:115]
  ds_read_b64_tr_b16 a[64:65], v14 offset:24576
  buffer_load_dwordx4 a[228:231], v2, s[84:87], s88 offen offset:0 sc1
  v_mfma_f32_16x16x32_bf16 v[116:119], a[12:15], a[100:103], v[116:119]
  ds_read_b64_tr_b16 a[66:67], v14 offset:25088
  v_mfma_f32_16x16x32_bf16 v[120:123], a[12:15], a[104:107], v[120:123]
  ds_read_b64_tr_b16 a[68:69], v14 offset:27648
  v_mfma_f32_16x16x32_bf16 v[124:127], a[12:15], a[108:111], v[124:127]
  ds_read_b64_tr_b16 a[70:71], v14 offset:28160
  v_mfma_f32_16x16x32_bf16 v[128:131], a[16:19], a[96:99], v[128:131]
  ds_read_b64_tr_b16 a[72:73], v15 offset:24576
  v_mfma_f32_16x16x32_bf16 v[132:135], a[16:19], a[100:103], v[132:135]
  ds_read_b64_tr_b16 a[74:75], v15 offset:25088
  v_mfma_f32_16x16x32_bf16 v[136:139], a[16:19], a[104:107], v[136:139]
  ds_read_b64_tr_b16 a[76:77], v15 offset:27648
  v_mfma_f32_16x16x32_bf16 v[140:143], a[16:19], a[108:111], v[140:143]
  ds_read_b64_tr_b16 a[78:79], v15 offset:28160
  v_mfma_f32_16x16x32_bf16 v[144:147], a[20:23], a[96:99], v[144:147]
  ds_read_b64_tr_b16 a[80:81], v16 offset:24576
  v_mfma_f32_16x16x32_bf16 v[148:151], a[20:23], a[100:103], v[148:151]
  ds_read_b64_tr_b16 a[82:83], v16 offset:25088
  v_mfma_f32_16x16x32_bf16 v[152:155], a[20:23], a[104:107], v[152:155]
  ds_read_b64_tr_b16 a[84:85], v16 offset:27648
  v_mfma_f32_16x16x32_bf16 v[156:159], a[20:23], a[108:111], v[156:159]
  ds_read_b64_tr_b16 a[86:87], v16 offset:28160
  buffer_load_dwordx4 a[232:235], v2, s[84:87], s88 offen offset:1024 sc1
  v_mfma_f32_16x16x32_bf16 v[160:163], a[24:27], a[96:99], v[160:163]
  ds_read_b64_tr_b16 a[88:89], v17 offset:24576
  v_mfma_f32_16x16x32_bf16 v[164:167], a[24:27], a[100:103], v[164:167]
  ds_read_b64_tr_b16 a[90:91], v17 offset:25088
  v_mfma_f32_16x16x32_bf16 v[168:171], a[24:27], a[104:107], v[168:171]
  ds_read_b64_tr_b16 a[92:93], v17 offset:27648
  v_mfma_f32_16x16x32_bf16 v[172:175], a[24:27], a[108:111], v[172:175]
  ds_read_b64_tr_b16 a[94:95], v17 offset:28160
  v_mfma_f32_16x16x32_bf16 v[176:179], a[28:31], a[96:99], v[176:179]
  v_mfma_f32_16x16x32_bf16 v[180:183], a[28:31], a[100:103], v[180:183]
  v_mfma_f32_16x16x32_bf16 v[184:187], a[28:31], a[104:107], v[184:187]
  v_mfma_f32_16x16x32_bf16 v[188:191], a[28:31], a[108:111], v[188:191]
  v_mfma_f32_16x16x32_bf16 v[192:195], a[32:35], a[96:99], v[192:195]
  v_mfma_f32_16x16x32_bf16 v[196:199], a[32:35], a[100:103], v[196:199]
  v_mfma_f32_16x16x32_bf16 v[200:203], a[32:35], a[104:107], v[200:203]
  buffer_load_dwordx4 a[236:239], v2, s[84:87], s88 offen offset:2048 sc1
  v_mfma_f32_16x16x32_bf16 v[204:207], a[32:35], a[108:111], v[204:207]
  v_mfma_f32_16x16x32_bf16 v[208:211], a[36:39], a[96:99], v[208:211]
  v_mfma_f32_16x16x32_bf16 v[212:215], a[36:39], a[100:103], v[212:215]
  v_mfma_f32_16x16x32_bf16 v[216:219], a[36:39], a[104:107], v[216:219]
  v_mfma_f32_16x16x32_bf16 v[220:223], a[36:39], a[108:111], v[220:223]
  v_mfma_f32_16x16x32_bf16 v[224:227], a[40:43], a[96:99], v[224:227]
  v_mfma_f32_16x16x32_bf16 v[228:231], a[40:43], a[100:103], v[228:231]
  v_mfma_f32_16x16x32_bf16 v[232:235], a[40:43], a[104:107], v[232:235]
  v_mfma_f32_16x16x32_bf16 v[236:239], a[40:43], a[108:111], v[236:239]
  v_mfma_f32_16x16x32_bf16 v[240:243], a[44:47], a[96:99], v[240:243]
  v_mfma_f32_16x16x32_bf16 v[244:247], a[44:47], a[100:103], v[244:247]
  v_mfma_f32_16x16x32_bf16 v[248:251], a[44:47], a[104:107], v[248:251]
  v_mfma_f32_16x16x32_bf16 v[252:255], a[44:47], a[108:111], v[252:255]
  s_waitcnt vmcnt(14) lgkmcnt(0)
  s_barrier
  v_mfma_f32_16x16x32_bf16 v[64:67], a[48:51], a[112:115], v[64:67]
  ds_read_b128 a[96:99], v10 offset:0
  v_mfma_f32_16x16x32_bf16 v[68:71], a[48:51], a[116:119], v[68:71]
  ds_read_b128 a[100:103], v10 offset:2048
  buffer_load_dwordx4 a[240:243], v2, s[84:87], s88 offen offset:3072 sc1
  v_mfma_f32_16x16x32_bf16 v[72:75], a[48:51], a[120:123], v[72:75]
  ds_read_b128 a[104:107], v10 offset:4096
  v_mfma_f32_16x16x32_bf16 v[76:79], a[48:51], a[124:127], v[76:79]
  ds_read_b128 a[108:111], v10 offset:6144
  v_mfma_f32_16x16x32_bf16 v[80:83], a[52:55], a[112:115], v[80:83]
  ds_read_b64_tr_b16 a[0:1], v18 offset:0
  v_mfma_f32_16x16x32_bf16 v[84:87], a[52:55], a[116:119], v[84:87]
  ds_read_b64_tr_b16 a[2:3], v18 offset:512
  v_mfma_f32_16x16x32_bf16 v[88:91], a[52:55], a[120:123], v[88:91]
  ds_read_b64_tr_b16 a[4:5], v18 offset:3072
  buffer_load_dwordx4 a[244:247], v3, s[84:87], s88 offen sc1
  v_mfma_f32_16x16x32_bf16 v[92:95], a[52:55], a[124:127], v[92:95]
  ds_read_b64_tr_b16 a[6:7], v18 offset:3584
  v_mfma_f32_16x16x32_bf16 v[96:99], a[56:59], a[112:115], v[96:99]
  ds_read_b64_tr_b16 a[8:9], v19 offset:0
  v_mfma_f32_16x16x32_bf16 v[100:103], a[56:59], a[116:119], v[100:103]
  ds_read_b64_tr_b16 a[10:11], v19 offset:512
  v_mfma_f32_16x16x32_bf16 v[104:107], a[56:59], a[120:123], v[104:107]
  ds_read_b64_tr_b16 a[12:13], v19 offset:3072
  s_add_u32 s88, s89, 225280
  v_mfma_f32_16x16x32_bf16 v[108:111], a[56:59], a[124:127], v[108:111]
  ds_read_b64_tr_b16 a[14:15], v19 offset:3584
  buffer_load_dwordx4 a[248:251], v2, s[84:87], s88 offen offset:0 sc1
  v_mfma_f32_16x16x32_bf16 v[112:115], a[60:63], a[112:115], v[112:115]
  ds_read_b64_tr_b16 a[16:17], v20 offset:0
  v_mfma_f32_16x16x32_bf16 v[116:119], a[60:63], a[116:119], v[116:119]
  ds_read_b64_tr_b16 a[18:19], v20 offset:512
  v_mfma_f32_16x16x32_bf16 v[120:123], a[60:63], a[120:123], v[120:123]
  ds_read_b64_tr_b16 a[20:21], v20 offset:3072
  v_mfma_f32_16x16x32_bf16 v[124:127], a[60:63], a[124:127], v[124:127]
  ds_read_b64_tr_b16 a[22:23], v20 offset:3584
  v_mfma_f32_16x16x32_bf16 v[128:131], a[64:67], a[112:115], v[128:131]
  ds_read_b64_tr_b16 a[24:25], v21 offset:0
  buffer_load_dwordx4 a[252:255], v2, s[84:87], s88 offen offset:1024 sc1
  v_mfma_f32_16x16x32_bf16 v[132:135], a[64:67], a[116:119], v[132:135]
  ds_read_b64_tr_b16 a[26:27], v21 offset:512
  v_mfma_f32_16x16x32_bf16 v[136:139], a[64:67], a[120:123], v[136:139]
  ds_read_b64_tr_b16 a[28:29], v21 offset:3072
  v_mfma_f32_16x16x32_bf16 v[140:143], a[64:67], a[124:127], v[140:143]
  ds_read_b64_tr_b16 a[30:31], v21 offset:3584
  v_mfma_f32_16x16x32_bf16 v[144:147], a[68:71], a[112:115], v[144:147]
  ds_read_b64_tr_b16 a[32:33], v22 offset:0
  s_add_u32 s100, s89, 0
  s_add_u32 m0, s89, 0
  v_mfma_f32_16x16x32_bf16 v[148:151], a[68:71], a[116:119], v[148:151]
  ds_read_b64_tr_b16 a[34:35], v22 offset:512
  buffer_load_dwordx4 v2, s[84:87], s100 offen offset:0 sc1 lds
  v_mfma_f32_16x16x32_bf16 v[152:155], a[68:71], a[120:123], v[152:155]
  ds_read_b64_tr_b16 a[36:37], v22 offset:3072
  v_mfma_f32_16x16x32_bf16 v[156:159], a[68:71], a[124:127], v[156:159]
  ds_read_b64_tr_b16 a[38:39], v22 offset:3584
  v_mfma_f32_16x16x32_bf16 v[160:163], a[72:75], a[112:115], v[160:163]
  ds_read_b64_tr_b16 a[40:41], v23 offset:0
  v_mfma_f32_16x16x32_bf16 v[164:167], a[72:75], a[116:119], v[164:167]
  ds_read_b64_tr_b16 a[42:43], v23 offset:512
  s_add_u32 m0, s89, 0
  v_mfma_f32_16x16x32_bf16 v[168:171], a[72:75], a[120:123], v[168:171]
  ds_read_b64_tr_b16 a[44:45], v23 offset:3072
  buffer_load_dwordx4 v2, s[84:87], s100 offen offset:1024 sc1 lds
  v_mfma_f32_16x16x32_bf16 v[172:175], a[72:75], a[124:127], v[172:175]
  ds_read_b64_tr_b16 a[46:47], v23 offset:3584
  v_mfma_f32_16x16x32_bf16 v[176:179], a[76:79], a[112:115], v[176:179]
  v_mfma_f32_16x16x32_bf16 v[180:183], a[76:79], a[116:119], v[180:183]
  v_mfma_f32_16x16x32_bf16 v[184:187], a[76:79], a[120:123], v[184:187]
  s_add_u32 m0, s89, 0
  v_mfma_f32_16x16x32_bf16 v[188:191], a[76:79], a[124:127], v[188:191]
  buffer_load_dwordx4 v2, s[84:87], s100 offen offset:2048 sc1 lds
  v_mfma_f32_16x16x32_bf16 v[192:195], a[80:83], a[112:115], v[192:195]
  v_mfma_f32_16x16x32_bf16 v[196:199], a[80:83], a[116:119], v[196:199]
  v_mfma_f32_16x16x32_bf16 v[200:203], a[80:83], a[120:123], v[200:203]
  v_mfma_f32_16x16x32_bf16 v[204:207], a[80:83], a[124:127], v[204:207]
  s_add_u32 m0, s89, 0
  s_nop 0
  v_mfma_f32_16x16x32_bf16 v[208:211], a[84:87], a[112:115], v[208:211]
  buffer_load_dwordx4 v2, s[84:87], s100 offen offset:3072 sc1 lds
  v_mfma_f32_16x16x32_bf16 v[212:215], a[84:87], a[116:119], v[212:215]
  v_mfma_f32_16x16x32_bf16 v[216:219], a[84:87], a[120:123], v[216:219]
  v_mfma_f32_16x16x32_bf16 v[220:223], a[84:87], a[124:127], v[220:223]
  v_mfma_f32_16x16x32_bf16 v[224:227], a[88:91], a[112:115], v[224:227]
  s_add_u32 m0, s89, 4096
  v_mfma_f32_16x16x32_bf16 v[228:231], a[88:91], a[116:119], v[228:231]
  buffer_load_dwordx4 v3, s[84:87], s100 offen sc1 lds
  v_mfma_f32_16x16x32_bf16 v[232:235], a[88:91], a[120:123], v[232:235]
  v_mfma_f32_16x16x32_bf16 v[236:239], a[88:91], a[124:127], v[236:239]
  v_mfma_f32_16x16x32_bf16 v[240:243], a[92:95], a[112:115], v[240:243]
  v_mfma_f32_16x16x32_bf16 v[244:247], a[92:95], a[116:119], v[244:247]
  v_mfma_f32_16x16x32_bf16 v[248:251], a[92:95], a[120:123], v[248:251]
  v_mfma_f32_16x16x32_bf16 v[252:255], a[92:95], a[124:127], v[252:255]
  s_waitcnt vmcnt(13) lgkmcnt(0)
  s_barrier
  v_mfma_f32_16x16x32_bf16 v[64:67], a[0:3], a[96:99], v[64:67]
  ds_read_b128 a[112:115], v11 offset:0
  s_add_u32 s88, s89, 348160
  v_mfma_f32_16x16x32_bf16 v[68:71], a[0:3], a[100:103], v[68:71]
  ds_read_b128 a[116:119], v11 offset:2048
  buffer_load_dwordx4 v[32:35], v2, s[84:87], s88 offen offset:2048 sc1
  v_mfma_f32_16x16x32_bf16 v[72:75], a[0:3], a[104:107], v[72:75]
  ds_read_b128 a[120:123], v11 offset:4096
  v_mfma_f32_16x16x32_bf16 v[76:79], a[0:3], a[108:111], v[76:79]
  ds_read_b128 a[124:127], v11 offset:6144
  v_mfma_f32_16x16x32_bf16 v[80:83], a[4:7], a[96:99], v[80:83]
  ds_read_b64_tr_b16 a[48:49], v18 offset:24576
  v_mfma_f32_16x16x32_bf16 v[84:87], a[4:7], a[100:103], v[84:87]
  ds_read_b64_tr_b16 a[50:51], v18 offset:25088
  v_mfma_f32_16x16x32_bf16 v[88:91], a[4:7], a[104:107], v[88:91]
  ds_read_b64_tr_b16 a[52:53], v18 offset:27648
  buffer_load_dwordx4 v[36:39], v2, s[84:87], s88 offen offset:3072 sc1
  v_mfma_f32_16x16x32_bf16 v[92:95], a[4:7], a[108:111], v[92:95]
  ds_read_b64_tr_b16 a[54:55], v18 offset:28160
  v_mfma_f32_16x16x32_bf16 v[96:99], a[8:11], a[96:99], v[96:99]
  ds_read_b64_tr_b16 a[56:57], v19 offset:24576
  v_mfma_f32_16x16x32_bf16 v[100:103], a[8:11], a[100:103], v[100:103]
  ds_read_b64_tr_b16 a[58:59], v19 offset:25088
  v_mfma_f32_16x16x32_bf16 v[104:107], a[8:11], a[104:107], v[104:107]
  ds_read_b64_tr_b16 a[60:61], v19 offset:27648
  v_mfma_f32_16x16x32_bf16 v[108:111], a[8:11], a[108:111], v[108:111]
  ds_read_b64_tr_b16 a[62:63], v19 offset:28160
  buffer_load_dwordx4 v[40:43], v3, s[84:87], s88 offen sc1
  v_mfma_f32_16x16x32_bf16 v[112:115], a[12:15], a[96:99], v[112:115]
  ds_read_b64_tr_b16 a[64:65], v20 offset:24576
  v_mfma_f32_16x16x32_bf16 v[116:119], a[12:15], a[100:103], v[116:119]
  ds_read_b64_tr_b16 a[66:67], v20 offset:25088
  v_mfma_f32_16x16x32_bf16 v[120:123], a[12:15], a[104:107], v[120:123]
  ds_read_b64_tr_b16 a[68:69], v20 offset:27648
  v_mfma_f32_16x16x32_bf16 v[124:127], a[12:15], a[108:111], v[124:127]
  ds_read_b64_tr_b16 a[70:71], v20 offset:28160
  s_add_u32 s88, s89, 368640
  v_mfma_f32_16x16x32_bf16 v[128:131], a[16:19], a[96:99], v[128:131]
  ds_read_b64_tr_b16 a[72:73], v21 offset:24576
  buffer_load_dwordx4 v[44:47], v2, s[84:87], s88 offen offset:0 sc1
  v_mfma_f32_16x16x32_bf16 v[132:135], a[16:19], a[100:103], v[132:135]
  ds_read_b64_tr_b16 a[74:75], v21 offset:25088
  v_mfma_f32_16x16x32_bf16 v[136:139], a[16:19], a[104:107], v[136:139]
  ds_read_b64_tr_b16 a[76:77], v21 offset:27648
  v_mfma_f32_16x16x32_bf16 v[140:143], a[16:19], a[108:111], v[140:143]
  ds_read_b64_tr_b16 a[78:79], v21 offset:28160
  v_mfma_f32_16x16x32_bf16 v[144:147], a[20:23], a[96:99], v[144:147]
  ds_read_b64_tr_b16 a[80:81], v22 offset:24576
  s_add_u32 s100, s89, 20480
  s_add_u32 m0, s89, 20480
  v_mfma_f32_16x16x32_bf16 v[148:151], a[20:23], a[100:103], v[148:151]
  ds_read_b64_tr_b16 a[82:83], v22 offset:25088
  buffer_load_dwordx4 v2, s[84:87], s100 offen offset:0 sc1 lds
  v_mfma_f32_16x16x32_bf16 v[152:155], a[20:23], a[104:107], v[152:155]
  ds_read_b64_tr_b16 a[84:85], v22 offset:27648
  v_mfma_f32_16x16x32_bf16 v[156:159], a[20:23], a[108:111], v[156:159]
  ds_read_b64_tr_b16 a[86:87], v22 offset:28160
  v_mfma_f32_16x16x32_bf16 v[160:163], a[24:27], a[96:99], v[160:163]
  ds_read_b64_tr_b16 a[88:89], v23 offset:24576
  v_mfma_f32_16x16x32_bf16 v[164:167], a[24:27], a[100:103], v[164:167]
  ds_read_b64_tr_b16 a[90:91], v23 offset:25088
  s_add_u32 m0, s89, 20480
  v_mfma_f32_16x16x32_bf16 v[168:171], a[24:27], a[104:107], v[168:171]
  ds_read_b64_tr_b16 a[92:93], v23 offset:27648
  buffer_load_dwordx4 v2, s[84:87], s100 offen offset:1024 sc1 lds
  v_mfma_f32_16x16x32_bf16 v[172:175], a[24:27], a[108:111], v[172:175]
  ds_read_b64_tr_b16 a[94:95], v23 offset:28160
  v_mfma_f32_16x16x32_bf16 v[176:179], a[28:31], a[96:99], v[176:179]
  v_mfma_f32_16x16x32_bf16 v[180:183], a[28:31], a[100:103], v[180:183]
  v_mfma_f32_16x16x32_bf16 v[184:187], a[28:31], a[104:107], v[184:187]
  s_add_u32 m0, s89, 20480
  v_mfma_f32_16x16x32_bf16 v[188:191], a[28:31], a[108:111], v[188:191]
  buffer_load_dwordx4 v2, s[84:87], s100 offen offset:2048 sc1 lds
  v_mfma_f32_16x16x32_bf16 v[192:195], a[32:35], a[96:99], v[192:195]
  v_mfma_f32_16x16x32_bf16 v[196:199], a[32:35], a[100:103], v[196:199]
  v_mfma_f32_16x16x32_bf16 v[200:203], a[32:35], a[104:107], v[200:203]
  v_mfma_f32_16x16x32_bf16 v[204:207], a[32:35], a[108:111], v[204:207]
  s_add_u32 m0, s89, 20480
  v_mfma_f32_16x16x32_bf16 v[208:211], a[36:39], a[96:99], v[208:211]
  buffer_load_dwordx4 v2, s[84:87], s100 offen offset:3072 sc1 lds
  v_mfma_f32_16x16x32_bf16 v[212:215], a[36:39], a[100:103], v[212:215]
  v_mfma_f32_16x16x32_bf16 v[216:219], a[36:39], a[104:107], v[216:219]
  v_mfma_f32_16x16x32_bf16 v[220:223], a[36:39], a[108:111], v[220:223]
  v_mfma_f32_16x16x32_bf16 v[224:227], a[40:43], a[96:99], v[224:227]
  s_add_u32 m0, s89, 24576
  v_mfma_f32_16x16x32_bf16 v[228:231], a[40:43], a[100:103], v[228:231]
  buffer_load_dwordx4 v3, s[84:87], s100 offen sc1 lds
  v_mfma_f32_16x16x32_bf16 v[232:235], a[40:43], a[104:107], v[232:235]
  v_mfma_f32_16x16x32_bf16 v[236:239], a[40:43], a[108:111], v[236:239]
  v_mfma_f32_16x16x32_bf16 v[240:243], a[44:47], a[96:99], v[240:243]
  v_mfma_f32_16x16x32_bf16 v[244:247], a[44:47], a[100:103], v[244:247]
  v_mfma_f32_16x16x32_bf16 v[248:251], a[44:47], a[104:107], v[248:251]
  v_mfma_f32_16x16x32_bf16 v[252:255], a[44:47], a[108:111], v[252:255]
  s_waitcnt lgkmcnt(0)
  s_barrier
  v_mfma_f32_16x16x32_bf16 v[64:67], a[48:51], a[112:115], v[64:67]
  v_mfma_f32_16x16x32_bf16 v[68:71], a[48:51], a[116:119], v[68:71]
  buffer_load_dwordx4 v[48:51], v2, s[84:87], s88 offen offset:1024 sc1
  v_mfma_f32_16x16x32_bf16 v[72:75], a[48:51], a[120:123], v[72:75]
  v_mfma_f32_16x16x32_bf16 v[76:79], a[48:51], a[124:127], v[76:79]
  v_mfma_f32_16x16x32_bf16 v[80:83], a[52:55], a[112:115], v[80:83]
  v_mfma_f32_16x16x32_bf16 v[84:87], a[52:55], a[116:119], v[84:87]
  v_mfma_f32_16x16x32_bf16 v[88:91], a[52:55], a[120:123], v[88:91]
  buffer_load_dwordx4 v[52:55], v2, s[84:87], s88 offen offset:2048 sc1
  v_mfma_f32_16x16x32_bf16 v[92:95], a[52:55], a[124:127], v[92:95]
  v_mfma_f32_16x16x32_bf16 v[96:99], a[56:59], a[112:115], v[96:99]
  v_mfma_f32_16x16x32_bf16 v[100:103], a[56:59], a[116:119], v[100:103]
  v_mfma_f32_16x16x32_bf16 v[104:107], a[56:59], a[120:123], v[104:107]
  v_mfma_f32_16x16x32_bf16 v[108:111], a[56:59], a[124:127], v[108:111]
  buffer_load_dwordx4 v[56:59], v2, s[84:87], s88 offen offset:3072 sc1
  v_mfma_f32_16x16x32_bf16 v[112:115], a[60:63], a[112:115], v[112:115]
  v_mfma_f32_16x16x32_bf16 v[116:119], a[60:63], a[116:119], v[116:119]
  v_mfma_f32_16x16x32_bf16 v[120:123], a[60:63], a[120:123], v[120:123]
  v_mfma_f32_16x16x32_bf16 v[124:127], a[60:63], a[124:127], v[124:127]
  v_mfma_f32_16x16x32_bf16 v[128:131], a[64:67], a[112:115], v[128:131]
  buffer_load_dwordx4 v[60:63], v3, s[84:87], s88 offen sc1
  v_mfma_f32_16x16x32_bf16 v[132:135], a[64:67], a[116:119], v[132:135]
  v_mfma_f32_16x16x32_bf16 v[136:139], a[64:67], a[120:123], v[136:139]
  v_mfma_f32_16x16x32_bf16 v[140:143], a[64:67], a[124:127], v[140:143]
  v_mfma_f32_16x16x32_bf16 v[144:147], a[68:71], a[112:115], v[144:147]
  s_add_u32 s100, s89, 40960
  s_add_u32 m0, s89, 40960
  v_mfma_f32_16x16x32_bf16 v[148:151], a[68:71], a[116:119], v[148:151]
  buffer_load_dwordx4 v2, s[84:87], s100 offen offset:0 sc1 lds
  v_mfma_f32_16x16x32_bf16 v[152:155], a[68:71], a[120:123], v[152:155]
  v_mfma_f32_16x16x32_bf16 v[156:159], a[68:71], a[124:127], v[156:159]
  v_mfma_f32_16x16x32_bf16 v[160:163], a[72:75], a[112:115], v[160:163]
  v_mfma_f32_16x16x32_bf16 v[164:167], a[72:75], a[116:119], v[164:167]
  s_add_u32 m0, s89, 40960
  v_mfma_f32_16x16x32_bf16 v[168:171], a[72:75], a[120:123], v[168:171]
  buffer_load_dwordx4 v2, s[84:87], s100 offen offset:1024 sc1 lds
  v_mfma_f32_16x16x32_bf16 v[172:175], a[72:75], a[124:127], v[172:175]
  v_mfma_f32_16x16x32_bf16 v[176:179], a[76:79], a[112:115], v[176:179]
  v_mfma_f32_16x16x32_bf16 v[180:183], a[76:79], a[116:119], v[180:183]
  v_mfma_f32_16x16x32_bf16 v[184:187], a[76:79], a[120:123], v[184:187]
  s_add_u32 m0, s89, 40960
  v_mfma_f32_16x16x32_bf16 v[188:191], a[76:79], a[124:127], v[188:191]
  buffer_load_dwordx4 v2, s[84:87], s100 offen offset:2048 sc1 lds
  v_mfma_f32_16x16x32_bf16 v[192:195], a[80:83], a[112:115], v[192:195]
  v_mfma_f32_16x16x32_bf16 v[196:199], a[80:83], a[116:119], v[196:199]
  v_mfma_f32_16x16x32_bf16 v[200:203], a[80:83], a[120:123], v[200:203]
  v_mfma_f32_16x16x32_bf16 v[204:207], a[80:83], a[124:127], v[204:207]
  s_add_u32 m0, s89, 40960
  v_mfma_f32_16x16x32_bf16 v[208:211], a[84:87], a[112:115], v[208:211]
  buffer_load_dwordx4 v2, s[84:87], s100 offen offset:3072 sc1 lds
  v_mfma_f32_16x16x32_bf16 v[212:215], a[84:87], a[116:119], v[212:215]
  v_mfma_f32_16x16x32_bf16 v[216:219], a[84:87], a[120:123], v[216:219]
  v_mfma_f32_16x16x32_bf16 v[220:223], a[84:87], a[124:127], v[220:223]
  v_mfma_f32_16x16x32_bf16 v[224:227], a[88:91], a[112:115], v[224:227]
  s_add_u32 m0, s89, 45056
  v_mfma_f32_16x16x32_bf16 v[228:231], a[88:91], a[116:119], v[228:231]
  buffer_load_dwordx4 v3, s[84:87], s100 offen sc1 lds
  v_mfma_f32_16x16x32_bf16 v[232:235], a[88:91], a[120:123], v[232:235]
  v_mfma_f32_16x16x32_bf16 v[236:239], a[88:91], a[124:127], v[236:239]
  v_mfma_f32_16x16x32_bf16 v[240:243], a[92:95], a[112:115], v[240:243]
  v_mfma_f32_16x16x32_bf16 v[244:247], a[92:95], a[116:119], v[244:247]
  v_mfma_f32_16x16x32_bf16 v[248:251], a[92:95], a[120:123], v[248:251]
  v_mfma_f32_16x16x32_bf16 v[252:255], a[92:95], a[124:127], v[252:255]
  v_pk_mul_f32 v[6:7], v[64:65], s[70:71] neg_lo:[0,1] neg_hi:[0,1]
  v_pk_mul_f32 v[8:9], v[66:67], s[70:71] neg_lo:[0,1] neg_hi:[0,1]
  v_pk_mul_f32 v[10:11], v[96:97], s[70:71] neg_lo:[0,1] neg_hi:[0,1]
  v_pk_mul_f32 v[12:13], v[98:99], s[70:71] neg_lo:[0,1] neg_hi:[0,1]
  s_add_u32 s88, s89, 225280
  buffer_load_dwordx4 a[48:51], v2, s[84:87], s88 offen offset:2048 sc1
  v_exp_f32 v6, v6
  v_exp_f32 v7, v7
  v_exp_f32 v8, v8
  v_exp_f32 v9, v9
  v_exp_f32 v10, v10
  v_exp_f32 v11, v11
  v_exp_f32 v12, v12
  v_exp_f32 v13, v13
  v_pk_mul_f32 v[64:65], v[64:65], v[80:81]
  v_pk_mul_f32 v[66:67], v[66:67], v[82:83]
  v_pk_mul_f32 v[96:97], v[96:97], v[112:113]
  v_pk_mul_f32 v[98:99], v[98:99], v[114:115]
  v_pk_add_f32 v[6:7], v[6:7], 1.0 op_sel_hi:[1,0]
  v_pk_add_f32 v[8:9], v[8:9], 1.0 op_sel_hi:[1,0]
  v_pk_add_f32 v[10:11], v[10:11], 1.0 op_sel_hi:[1,0]
  v_pk_add_f32 v[12:13], v[12:13], 1.0 op_sel_hi:[1,0]
  buffer_load_dwordx4 a[52:55], v2, s[84:87], s88 offen offset:3072 sc1
  v_rcp_f32 v6, v6
  v_rcp_f32 v7, v7
  v_rcp_f32 v8, v8
  v_rcp_f32 v9, v9
  v_rcp_f32 v10, v10
  v_rcp_f32 v11, v11
  v_rcp_f32 v12, v12
  v_rcp_f32 v13, v13
  v_pk_mul_f32 v[6:7], v[64:65], v[6:7]
  v_pk_mul_f32 v[8:9], v[66:67], v[8:9]
  v_pk_mul_f32 v[10:11], v[96:97], v[10:11]
  v_pk_mul_f32 v[12:13], v[98:99], v[12:13]
  v_cvt_pk_bf16_f32 v80, v6, v7
  v_cvt_pk_bf16_f32 v81, v8, v9
  v_cvt_pk_bf16_f32 v82, v10, v11
  v_cvt_pk_bf16_f32 v83, v12, v13
  buffer_store_dwordx4 v[80:83], v2, s[52:55], s75 offen offset:0 sc1
  v_pk_mul_f32 v[14:15], v[68:69], s[70:71] neg_lo:[0,1] neg_hi:[0,1]
  v_pk_mul_f32 v[16:17], v[70:71], s[70:71] neg_lo:[0,1] neg_hi:[0,1]
  v_pk_mul_f32 v[18:19], v[100:101], s[70:71] neg_lo:[0,1] neg_hi:[0,1]
  v_pk_mul_f32 v[20:21], v[102:103], s[70:71] neg_lo:[0,1] neg_hi:[0,1]
  buffer_load_dwordx4 a[56:59], v3, s[84:87], s88 offen sc1
  v_exp_f32 v14, v14
  v_exp_f32 v15, v15
  v_exp_f32 v16, v16
  v_exp_f32 v17, v17
  v_exp_f32 v18, v18
  v_exp_f32 v19, v19
  v_exp_f32 v20, v20
  v_exp_f32 v21, v21
  v_pk_mul_f32 v[68:69], v[68:69], v[84:85]
  v_pk_mul_f32 v[70:71], v[70:71], v[86:87]
  v_pk_mul_f32 v[100:101], v[100:101], v[116:117]
  v_pk_mul_f32 v[102:103], v[102:103], v[118:119]
  v_pk_add_f32 v[14:15], v[14:15], 1.0 op_sel_hi:[1,0]
  v_pk_add_f32 v[16:17], v[16:17], 1.0 op_sel_hi:[1,0]
  v_pk_add_f32 v[18:19], v[18:19], 1.0 op_sel_hi:[1,0]
  v_pk_add_f32 v[20:21], v[20:21], 1.0 op_sel_hi:[1,0]
  s_add_u32 s88, s89, 245760
  buffer_load_dwordx4 a[60:63], v2, s[84:87], s88 offen offset:0 sc1
  v_rcp_f32 v14, v14
  v_rcp_f32 v15, v15
  v_rcp_f32 v16, v16
  v_rcp_f32 v17, v17
  v_rcp_f32 v18, v18
  v_rcp_f32 v19, v19
  v_rcp_f32 v20, v20
  v_rcp_f32 v21, v21
  v_pk_mul_f32 v[14:15], v[68:69], v[14:15]
  v_pk_mul_f32 v[16:17], v[70:71], v[16:17]
  v_pk_mul_f32 v[18:19], v[100:101], v[18:19]
  v_pk_mul_f32 v[20:21], v[102:103], v[20:21]
  v_cvt_pk_bf16_f32 v84, v14, v15
  v_cvt_pk_bf16_f32 v85, v16, v17
  v_cvt_pk_bf16_f32 v86, v18, v19
  v_cvt_pk_bf16_f32 v87, v20, v21
  buffer_store_dwordx4 v[84:87], v2, s[52:55], s75 offen offset:1024 sc1
  v_pk_mul_f32 v[6:7], v[72:73], s[70:71] neg_lo:[0,1] neg_hi:[0,1]
  v_pk_mul_f32 v[8:9], v[74:75], s[70:71] neg_lo:[0,1] neg_hi:[0,1]
  v_pk_mul_f32 v[10:11], v[104:105], s[70:71] neg_lo:[0,1] neg_hi:[0,1]
  v_pk_mul_f32 v[12:13], v[106:107], s[70:71] neg_lo:[0,1] neg_hi:[0,1]
  buffer_load_dwordx4 a[64:67], v2, s[84:87], s88 offen offset:1024 sc1
  v_exp_f32 v6, v6
  v_exp_f32 v7, v7
  v_exp_f32 v8, v8
  v_exp_f32 v9, v9
  v_exp_f32 v10, v10
  v_exp_f32 v11, v11
  v_exp_f32 v12, v12
  v_exp_f32 v13, v13
  v_pk_mul_f32 v[72:73], v[72:73], v[88:89]
  v_pk_mul_f32 v[74:75], v[74:75], v[90:91]
  v_pk_mul_f32 v[104:105], v[104:105], v[120:121]
  v_pk_mul_f32 v[106:107], v[106:107], v[122:123]
  v_pk_add_f32 v[6:7], v[6:7], 1.0 op_sel_hi:[1,0]
  v_pk_add_f32 v[8:9], v[8:9], 1.0 op_sel_hi:[1,0]
  v_pk_add_f32 v[10:11], v[10:11], 1.0 op_sel_hi:[1,0]
  v_pk_add_f32 v[12:13], v[12:13], 1.0 op_sel_hi:[1,0]
  buffer_load_dwordx4 a[68:71], v2, s[84:87], s88 offen offset:2048 sc1
  v_rcp_f32 v6, v6
  v_rcp_f32 v7, v7
  v_rcp_f32 v8, v8
  v_rcp_f32 v9, v9
  v_rcp_f32 v10, v10
  v_rcp_f32 v11, v11
  v_rcp_f32 v12, v12
  v_rcp_f32 v13, v13
  v_pk_mul_f32 v[6:7], v[72:73], v[6:7]
  v_pk_mul_f32 v[8:9], v[74:75], v[8:9]
  v_pk_mul_f32 v[10:11], v[104:105], v[10:11]
  v_pk_mul_f32 v[12:13], v[106:107], v[12:13]
  v_cvt_pk_bf16_f32 v88, v6, v7
  v_cvt_pk_bf16_f32 v89, v8, v9
  v_cvt_pk_bf16_f32 v90, v10, v11
  v_cvt_pk_bf16_f32 v91, v12, v13
  buffer_store_dwordx4 v[88:91], v2, s[52:55], s75 offen offset:2048 sc1
  v_pk_mul_f32 v[14:15], v[76:77], s[70:71] neg_lo:[0,1] neg_hi:[0,1]
  v_pk_mul_f32 v[16:17], v[78:79], s[70:71] neg_lo:[0,1] neg_hi:[0,1]
  v_pk_mul_f32 v[18:19], v[108:109], s[70:71] neg_lo:[0,1] neg_hi:[0,1]
  v_pk_mul_f32 v[20:21], v[110:111], s[70:71] neg_lo:[0,1] neg_hi:[0,1]
  buffer_load_dwordx4 a[72:75], v2, s[84:87], s88 offen offset:3072 sc1
  v_exp_f32 v14, v14
  v_exp_f32 v15, v15
  v_exp_f32 v16, v16
  v_exp_f32 v17, v17
  v_exp_f32 v18, v18
  v_exp_f32 v19, v19
  v_exp_f32 v20, v20
  v_exp_f32 v21, v21
  v_pk_mul_f32 v[76:77], v[76:77], v[92:93]
  v_pk_mul_f32 v[78:79], v[78:79], v[94:95]
  v_pk_mul_f32 v[108:109], v[108:109], v[124:125]
  v_pk_mul_f32 v[110:111], v[110:111], v[126:127]
  v_pk_add_f32 v[14:15], v[14:15], 1.0 op_sel_hi:[1,0]
  v_pk_add_f32 v[16:17], v[16:17], 1.0 op_sel_hi:[1,0]
  v_pk_add_f32 v[18:19], v[18:19], 1.0 op_sel_hi:[1,0]
  v_pk_add_f32 v[20:21], v[20:21], 1.0 op_sel_hi:[1,0]
  buffer_load_dwordx4 a[76:79], v3, s[84:87], s88 offen sc1
  v_rcp_f32 v14, v14
  v_rcp_f32 v15, v15
  v_rcp_f32 v16, v16
  v_rcp_f32 v17, v17
  v_rcp_f32 v18, v18
  v_rcp_f32 v19, v19
  v_rcp_f32 v20, v20
  v_rcp_f32 v21, v21
  v_pk_mul_f32 v[14:15], v[76:77], v[14:15]
  v_pk_mul_f32 v[16:17], v[78:79], v[16:17]
  v_pk_mul_f32 v[18:19], v[108:109], v[18:19]
  v_pk_mul_f32 v[20:21], v[110:111], v[20:21]
  v_cvt_pk_bf16_f32 v92, v14, v15
  v_cvt_pk_bf16_f32 v93, v16, v17
  v_cvt_pk_bf16_f32 v94, v18, v19
  v_cvt_pk_bf16_f32 v95, v20, v21
  buffer_store_dwordx4 v[92:95], v2, s[52:55], s75 offen offset:3072 sc1
  s_add_u32 s75, s75, 4096
  v_pk_mul_f32 v[6:7], v[128:129], s[70:71] neg_lo:[0,1] neg_hi:[0,1]
  v_pk_mul_f32 v[8:9], v[130:131], s[70:71] neg_lo:[0,1] neg_hi:[0,1]
  v_pk_mul_f32 v[10:11], v[160:161], s[70:71] neg_lo:[0,1] neg_hi:[0,1]
  v_pk_mul_f32 v[12:13], v[162:163], s[70:71] neg_lo:[0,1] neg_hi:[0,1]
  s_add_u32 s88, s89, 266240
  buffer_load_dwordx4 a[80:83], v2, s[84:87], s88 offen offset:0 sc1
  v_exp_f32 v6, v6
  v_exp_f32 v7, v7
  v_exp_f32 v8, v8
  v_exp_f32 v9, v9
  v_exp_f32 v10, v10
  v_exp_f32 v11, v11
  v_exp_f32 v12, v12
  v_exp_f32 v13, v13
  v_pk_mul_f32 v[128:129], v[128:129], v[144:145]
  v_pk_mul_f32 v[130:131], v[130:131], v[146:147]
  v_pk_mul_f32 v[160:161], v[160:161], v[176:177]
  v_pk_mul_f32 v[162:163], v[162:163], v[178:179]
  v_pk_add_f32 v[6:7], v[6:7], 1.0 op_sel_hi:[1,0]
  v_pk_add_f32 v[8:9], v[8:9], 1.0 op_sel_hi:[1,0]
  v_pk_add_f32 v[10:11], v[10:11], 1.0 op_sel_hi:[1,0]
  v_pk_add_f32 v[12:13], v[12:13], 1.0 op_sel_hi:[1,0]
  buffer_load_dwordx4 a[84:87], v2, s[84:87], s88 offen offset:1024 sc1
  v_rcp_f32 v6, v6
  v_rcp_f32 v7, v7
  v_rcp_f32 v8, v8
  v_rcp_f32 v9, v9
  v_rcp_f32 v10, v10
  v_rcp_f32 v11, v11
  v_rcp_f32 v12, v12
  v_rcp_f32 v13, v13
  v_pk_mul_f32 v[6:7], v[128:129], v[6:7]
  v_pk_mul_f32 v[8:9], v[130:131], v[8:9]
  v_pk_mul_f32 v[10:11], v[160:161], v[10:11]
  v_pk_mul_f32 v[12:13], v[162:163], v[12:13]
  v_cvt_pk_bf16_f32 v144, v6, v7
  v_cvt_pk_bf16_f32 v145, v8, v9
  v_cvt_pk_bf16_f32 v146, v10, v11
  v_cvt_pk_bf16_f32 v147, v12, v13
  buffer_store_dwordx4 v[144:147], v2, s[52:55], s75 offen offset:0 sc1
  v_pk_mul_f32 v[14:15], v[132:133], s[70:71] neg_lo:[0,1] neg_hi:[0,1]
  v_pk_mul_f32 v[16:17], v[134:135], s[70:71] neg_lo:[0,1] neg_hi:[0,1]
  v_pk_mul_f32 v[18:19], v[164:165], s[70:71] neg_lo:[0,1] neg_hi:[0,1]
  v_pk_mul_f32 v[20:21], v[166:167], s[70:71] neg_lo:[0,1] neg_hi:[0,1]
  buffer_load_dwordx4 a[88:91], v2, s[84:87], s88 offen offset:2048 sc1
  v_exp_f32 v14, v14
  v_exp_f32 v15, v15
  v_exp_f32 v16, v16
  v_exp_f32 v17, v17
  v_exp_f32 v18, v18
  v_exp_f32 v19, v19
  v_exp_f32 v20, v20
  v_exp_f32 v21, v21
  v_pk_mul_f32 v[132:133], v[132:133], v[148:149]
  v_pk_mul_f32 v[134:135], v[134:135], v[150:151]
  v_pk_mul_f32 v[164:165], v[164:165], v[180:181]
  v_pk_mul_f32 v[166:167], v[166:167], v[182:183]
  v_pk_add_f32 v[14:15], v[14:15], 1.0 op_sel_hi:[1,0]
  v_pk_add_f32 v[16:17], v[16:17], 1.0 op_sel_hi:[1,0]
  v_pk_add_f32 v[18:19], v[18:19], 1.0 op_sel_hi:[1,0]
  v_pk_add_f32 v[20:21], v[20:21], 1.0 op_sel_hi:[1,0]
  buffer_load_dwordx4 a[92:95], v2, s[84:87], s88 offen offset:3072 sc1
  v_rcp_f32 v14, v14
  v_rcp_f32 v15, v15
  v_rcp_f32 v16, v16
  v_rcp_f32 v17, v17
  v_rcp_f32 v18, v18
  v_rcp_f32 v19, v19
  v_rcp_f32 v20, v20
  v_rcp_f32 v21, v21
  v_pk_mul_f32 v[14:15], v[132:133], v[14:15]
  v_pk_mul_f32 v[16:17], v[134:135], v[16:17]
  v_pk_mul_f32 v[18:19], v[164:165], v[18:19]
  v_pk_mul_f32 v[20:21], v[166:167], v[20:21]
  v_cvt_pk_bf16_f32 v148, v14, v15
  v_cvt_pk_bf16_f32 v149, v16, v17
  v_cvt_pk_bf16_f32 v150, v18, v19
  v_cvt_pk_bf16_f32 v151, v20, v21
  buffer_store_dwordx4 v[148:151], v2, s[52:55], s75 offen offset:1024 sc1
  v_pk_mul_f32 v[6:7], v[136:137], s[70:71] neg_lo:[0,1] neg_hi:[0,1]
  v_pk_mul_f32 v[8:9], v[138:139], s[70:71] neg_lo:[0,1] neg_hi:[0,1]
  v_pk_mul_f32 v[10:11], v[168:169], s[70:71] neg_lo:[0,1] neg_hi:[0,1]
  v_pk_mul_f32 v[12:13], v[170:171], s[70:71] neg_lo:[0,1] neg_hi:[0,1]
  buffer_load_dwordx4 a[108:111], v3, s[84:87], s88 offen sc1
  v_exp_f32 v6, v6
  v_exp_f32 v7, v7
  v_exp_f32 v8, v8
  v_exp_f32 v9, v9
  v_exp_f32 v10, v10
  v_exp_f32 v11, v11
  v_exp_f32 v12, v12
  v_exp_f32 v13, v13
  v_pk_mul_f32 v[136:137], v[136:137], v[152:153]
  v_pk_mul_f32 v[138:139], v[138:139], v[154:155]
  v_pk_mul_f32 v[168:169], v[168:169], v[184:185]
  v_pk_mul_f32 v[170:171], v[170:171], v[186:187]
  v_pk_add_f32 v[6:7], v[6:7], 1.0 op_sel_hi:[1,0]
  v_pk_add_f32 v[8:9], v[8:9], 1.0 op_sel_hi:[1,0]
  v_pk_add_f32 v[10:11], v[10:11], 1.0 op_sel_hi:[1,0]
  v_pk_add_f32 v[12:13], v[12:13], 1.0 op_sel_hi:[1,0]
  s_add_u32 s88, s89, 286720
  buffer_load_dwordx4 a[112:115], v2, s[84:87], s88 offen offset:0 sc1
  v_rcp_f32 v6, v6
  v_rcp_f32 v7, v7
  v_rcp_f32 v8, v8
  v_rcp_f32 v9, v9
  v_rcp_f32 v10, v10
  v_rcp_f32 v11, v11
  v_rcp_f32 v12, v12
  v_rcp_f32 v13, v13
  v_pk_mul_f32 v[6:7], v[136:137], v[6:7]
  v_pk_mul_f32 v[8:9], v[138:139], v[8:9]
  v_pk_mul_f32 v[10:11], v[168:169], v[10:11]
  v_pk_mul_f32 v[12:13], v[170:171], v[12:13]
  v_cvt_pk_bf16_f32 v152, v6, v7
  v_cvt_pk_bf16_f32 v153, v8, v9
  v_cvt_pk_bf16_f32 v154, v10, v11
  v_cvt_pk_bf16_f32 v155, v12, v13
  buffer_store_dwordx4 v[152:155], v2, s[52:55], s75 offen offset:2048 sc1
  v_pk_mul_f32 v[14:15], v[140:141], s[70:71] neg_lo:[0,1] neg_hi:[0,1]
  v_pk_mul_f32 v[16:17], v[142:143], s[70:71] neg_lo:[0,1] neg_hi:[0,1]
  v_pk_mul_f32 v[18:19], v[172:173], s[70:71] neg_lo:[0,1] neg_hi:[0,1]
  v_pk_mul_f32 v[20:21], v[174:175], s[70:71] neg_lo:[0,1] neg_hi:[0,1]
  v_exp_f32 v14, v14
  v_exp_f32 v15, v15
  v_exp_f32 v16, v16
  v_exp_f32 v17, v17
  v_exp_f32 v18, v18
  v_exp_f32 v19, v19
  v_exp_f32 v20, v20
  v_exp_f32 v21, v21
  v_pk_mul_f32 v[140:141], v[140:141], v[156:157]
  v_pk_mul_f32 v[142:143], v[142:143], v[158:159]
  v_pk_mul_f32 v[172:173], v[172:173], v[188:189]
  v_pk_mul_f32 v[174:175], v[174:175], v[190:191]
  v_pk_add_f32 v[14:15], v[14:15], 1.0 op_sel_hi:[1,0]
  v_pk_add_f32 v[16:17], v[16:17], 1.0 op_sel_hi:[1,0]
  v_pk_add_f32 v[18:19], v[18:19], 1.0 op_sel_hi:[1,0]
  v_pk_add_f32 v[20:21], v[20:21], 1.0 op_sel_hi:[1,0]
  v_rcp_f32 v14, v14
  v_rcp_f32 v15, v15
  v_rcp_f32 v16, v16
  v_rcp_f32 v17, v17
  v_rcp_f32 v18, v18
  v_rcp_f32 v19, v19
  v_rcp_f32 v20, v20
  v_rcp_f32 v21, v21
  v_pk_mul_f32 v[14:15], v[140:141], v[14:15]
  v_pk_mul_f32 v[16:17], v[142:143], v[16:17]
  v_pk_mul_f32 v[18:19], v[172:173], v[18:19]
  v_pk_mul_f32 v[20:21], v[174:175], v[20:21]
  v_cvt_pk_bf16_f32 v156, v14, v15
  v_cvt_pk_bf16_f32 v157, v16, v17
  v_cvt_pk_bf16_f32 v158, v18, v19
  v_cvt_pk_bf16_f32 v159, v20, v21
  buffer_store_dwordx4 v[156:159], v2, s[52:55], s75 offen offset:3072 sc1
  s_add_u32 s75, s75, 4096
  v_pk_mul_f32 v[6:7], v[192:193], s[70:71] neg_lo:[0,1] neg_hi:[0,1]
  v_pk_mul_f32 v[8:9], v[194:195], s[70:71] neg_lo:[0,1] neg_hi:[0,1]
  v_pk_mul_f32 v[10:11], v[224:225], s[70:71] neg_lo:[0,1] neg_hi:[0,1]
  v_pk_mul_f32 v[12:13], v[226:227], s[70:71] neg_lo:[0,1] neg_hi:[0,1]
  v_exp_f32 v6, v6
  v_exp_f32 v7, v7
  v_exp_f32 v8, v8
  v_exp_f32 v9, v9
  v_exp_f32 v10, v10
  v_exp_f32 v11, v11
  v_exp_f32 v12, v12
  v_exp_f32 v13, v13
  v_pk_mul_f32 v[192:193], v[192:193], v[208:209]
  v_pk_mul_f32 v[194:195], v[194:195], v[210:211]
  v_pk_mul_f32 v[224:225], v[224:225], v[240:241]
  v_pk_mul_f32 v[226:227], v[226:227], v[242:243]
  v_pk_add_f32 v[6:7], v[6:7], 1.0 op_sel_hi:[1,0]
  v_pk_add_f32 v[8:9], v[8:9], 1.0 op_sel_hi:[1,0]
  v_pk_add_f32 v[10:11], v[10:11], 1.0 op_sel_hi:[1,0]
  v_pk_add_f32 v[12:13], v[12:13], 1.0 op_sel_hi:[1,0]
  v_rcp_f32 v6, v6
  v_rcp_f32 v7, v7
  v_rcp_f32 v8, v8
  v_rcp_f32 v9, v9
  v_rcp_f32 v10, v10
  v_rcp_f32 v11, v11
  v_rcp_f32 v12, v12
  v_rcp_f32 v13, v13
  v_pk_mul_f32 v[6:7], v[192:193], v[6:7]
  v_pk_mul_f32 v[8:9], v[194:195], v[8:9]
  v_pk_mul_f32 v[10:11], v[224:225], v[10:11]
  v_pk_mul_f32 v[12:13], v[226:227], v[12:13]
  v_cvt_pk_bf16_f32 v208, v6, v7
  v_cvt_pk_bf16_f32 v209, v8, v9
  v_cvt_pk_bf16_f32 v210, v10, v11
  v_cvt_pk_bf16_f32 v211, v12, v13
  buffer_store_dwordx4 v[208:211], v2, s[52:55], s75 offen offset:0 sc1
  v_pk_mul_f32 v[14:15], v[196:197], s[70:71] neg_lo:[0,1] neg_hi:[0,1]
  v_pk_mul_f32 v[16:17], v[198:199], s[70:71] neg_lo:[0,1] neg_hi:[0,1]
  v_pk_mul_f32 v[18:19], v[228:229], s[70:71] neg_lo:[0,1] neg_hi:[0,1]
  v_pk_mul_f32 v[20:21], v[230:231], s[70:71] neg_lo:[0,1] neg_hi:[0,1]
  v_exp_f32 v14, v14
  v_exp_f32 v15, v15
  v_exp_f32 v16, v16
  v_exp_f32 v17, v17
  v_exp_f32 v18, v18
  v_exp_f32 v19, v19
  v_exp_f32 v20, v20
  v_exp_f32 v21, v21
  v_pk_mul_f32 v[196:197], v[196:197], v[212:213]
  v_pk_mul_f32 v[198:199], v[198:199], v[214:215]
  v_pk_mul_f32 v[228:229], v[228:229], v[244:245]
  v_pk_mul_f32 v[230:231], v[230:231], v[246:247]
  v_pk_add_f32 v[14:15], v[14:15], 1.0 op_sel_hi:[1,0]
  v_pk_add_f32 v[16:17], v[16:17], 1.0 op_sel_hi:[1,0]
  v_pk_add_f32 v[18:19], v[18:19], 1.0 op_sel_hi:[1,0]
  v_pk_add_f32 v[20:21], v[20:21], 1.0 op_sel_hi:[1,0]
  v_rcp_f32 v14, v14
  v_rcp_f32 v15, v15
  v_rcp_f32 v16, v16
  v_rcp_f32 v17, v17
  v_rcp_f32 v18, v18
  v_rcp_f32 v19, v19
  v_rcp_f32 v20, v20
  v_rcp_f32 v21, v21
  v_pk_mul_f32 v[14:15], v[196:197], v[14:15]
  v_pk_mul_f32 v[16:17], v[198:199], v[16:17]
  v_pk_mul_f32 v[18:19], v[228:229], v[18:19]
  v_pk_mul_f32 v[20:21], v[230:231], v[20:21]
  v_cvt_pk_bf16_f32 v212, v14, v15
  v_cvt_pk_bf16_f32 v213, v16, v17
  v_cvt_pk_bf16_f32 v214, v18, v19
  v_cvt_pk_bf16_f32 v215, v20, v21
  buffer_store_dwordx4 v[212:215], v2, s[52:55], s75 offen offset:1024 sc1
  v_pk_mul_f32 v[6:7], v[200:201], s[70:71] neg_lo:[0,1] neg_hi:[0,1]
  v_pk_mul_f32 v[8:9], v[202:203], s[70:71] neg_lo:[0,1] neg_hi:[0,1]
  v_pk_mul_f32 v[10:11], v[232:233], s[70:71] neg_lo:[0,1] neg_hi:[0,1]
  v_pk_mul_f32 v[12:13], v[234:235], s[70:71] neg_lo:[0,1] neg_hi:[0,1]
  v_exp_f32 v6, v6
  v_exp_f32 v7, v7
  v_exp_f32 v8, v8
  v_exp_f32 v9, v9
  v_exp_f32 v10, v10
  v_exp_f32 v11, v11
  v_exp_f32 v12, v12
  v_exp_f32 v13, v13
  v_pk_mul_f32 v[200:201], v[200:201], v[216:217]
  v_pk_mul_f32 v[202:203], v[202:203], v[218:219]
  v_pk_mul_f32 v[232:233], v[232:233], v[248:249]
  v_pk_mul_f32 v[234:235], v[234:235], v[250:251]
  v_pk_add_f32 v[6:7], v[6:7], 1.0 op_sel_hi:[1,0]
  v_pk_add_f32 v[8:9], v[8:9], 1.0 op_sel_hi:[1,0]
  v_pk_add_f32 v[10:11], v[10:11], 1.0 op_sel_hi:[1,0]
  v_pk_add_f32 v[12:13], v[12:13], 1.0 op_sel_hi:[1,0]
  v_rcp_f32 v6, v6
  v_rcp_f32 v7, v7
  v_rcp_f32 v8, v8
  v_rcp_f32 v9, v9
  v_rcp_f32 v10, v10
  v_rcp_f32 v11, v11
  v_rcp_f32 v12, v12
  v_rcp_f32 v13, v13
  v_pk_mul_f32 v[6:7], v[200:201], v[6:7]
  v_pk_mul_f32 v[8:9], v[202:203], v[8:9]
  v_pk_mul_f32 v[10:11], v[232:233], v[10:11]
  v_pk_mul_f32 v[12:13], v[234:235], v[12:13]
  v_cvt_pk_bf16_f32 v216, v6, v7
  v_cvt_pk_bf16_f32 v217, v8, v9
  v_cvt_pk_bf16_f32 v218, v10, v11
  v_cvt_pk_bf16_f32 v219, v12, v13
  buffer_store_dwordx4 v[216:219], v2, s[52:55], s75 offen offset:2048 sc1
  v_pk_mul_f32 v[14:15], v[204:205], s[70:71] neg_lo:[0,1] neg_hi:[0,1]
  v_pk_mul_f32 v[16:17], v[206:207], s[70:71] neg_lo:[0,1] neg_hi:[0,1]
  v_pk_mul_f32 v[18:19], v[236:237], s[70:71] neg_lo:[0,1] neg_hi:[0,1]
  v_pk_mul_f32 v[20:21], v[238:239], s[70:71] neg_lo:[0,1] neg_hi:[0,1]
  v_exp_f32 v14, v14
  v_exp_f32 v15, v15
  v_exp_f32 v16, v16
  v_exp_f32 v17, v17
  v_exp_f32 v18, v18
  v_exp_f32 v19, v19
  v_exp_f32 v20, v20
  v_exp_f32 v21, v21
  v_pk_mul_f32 v[204:205], v[204:205], v[220:221]
  v_pk_mul_f32 v[206:207], v[206:207], v[222:223]
  v_pk_mul_f32 v[236:237], v[236:237], v[252:253]
  v_pk_mul_f32 v[238:239], v[238:239], v[254:255]
  v_pk_add_f32 v[14:15], v[14:15], 1.0 op_sel_hi:[1,0]
  v_pk_add_f32 v[16:17], v[16:17], 1.0 op_sel_hi:[1,0]
  v_pk_add_f32 v[18:19], v[18:19], 1.0 op_sel_hi:[1,0]
  v_pk_add_f32 v[20:21], v[20:21], 1.0 op_sel_hi:[1,0]
  v_rcp_f32 v14, v14
  v_rcp_f32 v15, v15
  v_rcp_f32 v16, v16
  v_rcp_f32 v17, v17
  v_rcp_f32 v18, v18
  v_rcp_f32 v19, v19
  v_rcp_f32 v20, v20
  v_rcp_f32 v21, v21
  v_pk_mul_f32 v[14:15], v[204:205], v[14:15]
  v_pk_mul_f32 v[16:17], v[206:207], v[16:17]
  v_pk_mul_f32 v[18:19], v[236:237], v[18:19]
  v_pk_mul_f32 v[20:21], v[238:239], v[20:21]
  v_cvt_pk_bf16_f32 v220, v14, v15
  v_cvt_pk_bf16_f32 v221, v16, v17
  v_cvt_pk_bf16_f32 v222, v18, v19
  v_cvt_pk_bf16_f32 v223, v20, v21
  buffer_store_dwordx4 v[220:223], v2, s[52:55], s75 offen offset:3072 sc1
  s_cmp_ge_u32 s36, 8
  s_cbranch_scc1 L_f1
  v_and_b32 v24, 15, v0
  v_lshrrev_b32 v25, 4, v0
  s_mul_i32 s64, s37, 303104
  s_add_u32 s40, s30, s64
  s_addc_u32 s41, s31, 0
  s_and_b32 s41, s41, 0xffff
  s_mov_b32 s42, 0x4a000
  s_mov_b32 s43, 0x20000
  s_add_u32 s80, s32, 20
  s_lshl_b32 s80, s80, 12
  s_add_u32 s75, s32, 0
  s_and_b32 s75, s75, 3
  s_lshl_b32 s75, s75, 10
  v_add_u32 v26, s75, v2
  s_add_u32 s75, s32, 1
  s_and_b32 s75, s75, 3
  s_lshl_b32 s75, s75, 10
  v_add_u32 v27, s75, v2
  s_add_u32 s75, s32, 2
  s_and_b32 s75, s75, 3
  s_lshl_b32 s75, s75, 10
  v_add_u32 v28, s75, v2
  s_add_u32 s75, s32, 3
  s_and_b32 s75, s75, 3
  s_lshl_b32 s75, s75, 10
  v_add_u32 v29, s75, v2
  s_add_u32 s48, s30, 0x1200000
  s_addc_u32 s49, s31, 0
  s_and_b32 s49, s49, 0xffff
  s_mov_b32 s50, 0x2000
  s_mov_b32 s51, 0x20000
  s_add_u32 s56, s30, 0x1800000
  s_addc_u32 s57, s31, 0
  s_and_b32 s57, s57, 0xffff
  s_mov_b32 s58, 0x500000
  s_mov_b32 s59, 0x20000
  s_add_u32 s44, s30, 0x10e0000
  s_addc_u32 s45, s31, 0
  s_and_b32 s45, s45, 0xffff
  s_mov_b32 s46, 0x10000
  s_mov_b32 s47, 0x20000
  s_mov_b32 s52, s30
  s_and_b32 s53, s31, 0xffff
  s_mov_b32 s54, 0x940000
  s_mov_b32 s55, 0x20000
  v_lshlrev_b32 v6, 2, v24
  v_lshlrev_b32 v7, 4, v24
  s_mul_i32 s72, s39, 327680
  s_lshl_b32 s75, s83, 2
  s_add_u32 s75, s75, s32
  s_mul_i32 s81, s75, 2560
  s_add_u32 s81, s81, s72
  s_add_u32 s101, s81, 163840
  s_lshl_b32 s66, s75, 7
  s_lshl_b32 s75, s83, 1
  v_min_u32 v17, 1, v0
  v_mul_u32_u24 v17, 3, v17
  v_add_u32 v17, s75, v17
  v_mul_u32_u24 v17, 171, v17
  v_lshrrev_b32 v17, 9, v17
  s_lshr_b32 s75, s39, 2
  s_mul_i32 s75, s75, 12
  s_add_u32 s75, s75, 32
  v_add_u32_e64 v17, s75, v17
  v_mul_u32_u24 v17, 4352, v17
  v_mov_b32 v30, 0x7fffffff
  s_mul_i32 s72, s39, 5
  v_add_u32 v9, s72, v25
  v_lshrrev_b32 v5, 2, v9
  v_lshlrev_b32 v5, 12, v5
  v_and_b32_e64 v8, 3, v9
  v_lshl_add_u32 v5, v8, 8, v5
  v_lshl_add_u32 v5, v24, 4, v5
  v_cmp_gt_u32 vcc, 3, v25
  s_nop 1
  v_cndmask_b32 v12, v30, v5, vcc
  v_add_u32 v9, s72, v25
  v_add_u32 v9, 3, v9
  v_lshrrev_b32 v5, 2, v9
  v_lshlrev_b32 v5, 12, v5
  v_and_b32 v8, 3, v9
  v_lshl_add_u32 v5, v8, 8, v5
  v_lshl_add_u32 v5, v24, 4, v5
  v_cmp_gt_u32 vcc, 2, v25
  s_nop 1
  v_cndmask_b32 v13, v30, v5, vcc
  s_lshl_b32 s73, s83, 1
  s_add_u32 s73, s73, s34
  s_mul_i32 s73, s73, 303104
  s_lshl_b32 s75, s33, 11
  s_add_u32 s73, s73, s75
  s_lshl_b32 s74, s39, 2
  s_add_u32 s74, s74, s32
  s_lshl_b32 s74, s74, 10
  v_bfe_u32 v5, v0, 2, 2
  v_and_b32 v8, 3, v0
  v_lshl_add_u32 v9, v5, 3, v8
  v_add_u32 v16, 0, v9
  v_min_u32_e64 v16, 20, v16
  v_mul_u32_u24 v16, 80, v16
  v_add_u32 v18, 122880, v16
  v_add_u32 v16, 4, v9
  v_min_u32 v16, 20, v16
  v_mul_u32_u24 v16, 80, v16
  v_add_u32 v19, 122880, v16
  v_mov_b32 v20, 124480
  v_add_u32_e64 v16, 4, v9
  v_min_u32 v16, 20, v16
  v_cmp_eq_u32 vcc, 2, v5
  s_nop 1
  v_cndmask_b32 v16, v16, v8, vcc
  v_mul_u32_u24 v16, 80, v16
  v_add_u32 v21, 124560, v16
  v_add_u32 v16, 8, v9
  v_min_u32 v16, 20, v16
  v_mul_u32_u24 v16, 80, v16
  v_add_u32 v22, 124560, v16
  v_mov_b32 v23, 126160
  v_cmp_eq_u32 s[78:79], 0, v25
  v_cmp_eq_u32 s[76:77], 2, v25
  v_mov_b32 v30, 126400
  s_lshl_b32 s75, s32, 10
  s_add_u32 s75, s75, 122880
  v_add_u32 v10, s75, v2
  s_waitcnt vmcnt(0)
  s_barrier
  s_cmp_lg_u32 s32, 0
  s_cbranch_scc1 Lsg_6
  v_mov_b32 v14, s69
  v_mov_b32 v15, 1
  s_mov_b64 exec, 1
  global_atomic_add v14, v15, s[90:91] sc1
  s_mov_b64 exec, -1
Lsg_6:
  buffer_load_dwordx4 a[116:119], v2, s[84:87], s88 offen offset:1024 sc1
  buffer_load_dwordx4 a[0:3], v2, s[84:87], s88 offen offset:2048 sc1
  buffer_load_dwordx4 a[4:7], v2, s[84:87], s88 offen offset:3072 sc1
  buffer_load_dwordx4 a[8:11], v3, s[84:87], s88 offen sc1
  s_add_u32 s88, s89, 307200
  buffer_load_dwordx4 a[12:15], v2, s[84:87], s88 offen offset:0 sc1
  buffer_load_dwordx4 a[16:19], v2, s[84:87], s88 offen offset:1024 sc1
  buffer_load_dwordx4 a[20:23], v2, s[84:87], s88 offen offset:2048 sc1
  buffer_load_dwordx4 a[24:27], v2, s[84:87], s88 offen offset:3072 sc1
  buffer_load_dwordx4 a[28:31], v3, s[84:87], s88 offen sc1
  s_add_u32 s88, s89, 327680
  buffer_load_dwordx4 a[32:35], v2, s[84:87], s88 offen offset:0 sc1
  buffer_load_dwordx4 a[36:39], v2, s[84:87], s88 offen offset:1024 sc1
  buffer_load_dwordx4 a[40:43], v2, s[84:87], s88 offen offset:2048 sc1
  buffer_load_dwordx4 a[44:47], v2, s[84:87], s88 offen offset:3072 sc1
  buffer_load_dwordx4 a[96:99], v3, s[84:87], s88 offen sc1
  s_add_u32 s88, s89, 348160
  buffer_load_dwordx4 a[100:103], v2, s[84:87], s88 offen offset:0 sc1
  buffer_load_dwordx4 a[104:107], v2, s[84:87], s88 offen offset:1024 sc1
  s_lshr_b32 s82, s37, 1
  s_mul_i32 s82, s82, 4352
  v_mov_b32 v4, s82
  s_cmp_lg_u32 s32, 0
  s_cbranch_scc1 Lp0_7
  global_load_dword v31, v4, s[90:91] sc1
  s_branch Lp1_8
Lp0_7:
  v_mov_b32 v4, 0
  global_load_dword v31, v4, s[8:9]
Lp1_8:
  s_add_u32 s100, s89, 61440
  s_add_u32 m0, s89, 61440
  s_nop 0
  buffer_load_dwordx4 v2, s[84:87], s100 offen offset:0 sc1 lds
  s_add_u32 m0, s89, 61440
  s_nop 0
  buffer_load_dwordx4 v2, s[84:87], s100 offen offset:1024 sc1 lds
  s_add_u32 m0, s89, 61440
  s_nop 0
  buffer_load_dwordx4 v2, s[84:87], s100 offen offset:2048 sc1 lds
  s_add_u32 m0, s89, 61440
  s_nop 0
  buffer_load_dwordx4 v2, s[84:87], s100 offen offset:3072 sc1 lds
  s_waitcnt vmcnt(4)
  s_cmp_lg_u32 s32, 0
  s_cbranch_scc1 Lpd_10
  v_cmp_gt_u32 vcc, 9, v31
  s_mov_b32 s95, 0x8000
  s_cmp_eq_u64 vcc, 0
  s_cbranch_scc1 Lpd_10
Lpoll_9:
  s_sleep 2
  global_load_dword v31, v4, s[90:91] sc1
  s_waitcnt vmcnt(0)
  v_cmp_gt_u32 vcc, 9, v31
  s_sub_u32 s95, s95, 1
  s_cmp_eq_u64 vcc, 0
  s_cbranch_scc1 Lpd_10
  s_cmp_lg_u32 s95, 0
  s_cbranch_scc1 Lpoll_9
Lpd_10:
  s_barrier
  s_nop 0
  buffer_load_dwordx4 v[148:151], v27, s[40:43], s80 offen sc1
  buffer_load_dwordx4 v[152:155], v28, s[40:43], s80 offen sc1
  buffer_load_dwordx4 v[156:159], v29, s[40:43], s80 offen sc1
  buffer_load_dwordx4 v[144:147], v26, s[40:43], s80 offen sc1
  s_add_u32 s80, s80, 16384
  buffer_load_dwordx4 v[164:167], v27, s[40:43], s80 offen sc1
  buffer_load_dwordx4 v[168:171], v28, s[40:43], s80 offen sc1
  buffer_load_dwordx4 v[172:175], v29, s[40:43], s80 offen sc1
  buffer_load_dwordx4 v[160:163], v26, s[40:43], s80 offen sc1
  s_add_u32 s80, s80, 16384
  buffer_load_dwordx4 v[180:183], v27, s[40:43], s80 offen sc1
  buffer_load_dwordx4 v[184:187], v28, s[40:43], s80 offen sc1
  buffer_load_dwordx4 v[188:191], v29, s[40:43], s80 offen sc1
  buffer_load_dwordx4 v[176:179], v26, s[40:43], s80 offen sc1
  s_add_u32 s80, s80, 16384
  s_waitcnt vmcnt(11)
  v_mfma_f32_16x16x32_bf16 v[84:87], a[128:131], v[148:151], 0
  v_mfma_f32_16x16x32_bf16 v[88:91], a[132:135], v[148:151], 0
  s_add_u32 m0, s89, 65536
  s_nop 0
  buffer_load_dwordx4 v3, s[84:87], s100 offen sc1 lds
  v_mfma_f32_16x16x32_bf16 v[92:95], a[136:139], v[148:151], 0
  v_mfma_f32_16x16x32_bf16 v[96:99], a[140:143], v[148:151], 0
  s_add_u32 s100, s89, 81920
  s_add_u32 m0, s89, 81920
  s_nop 0
  buffer_load_dwordx4 v2, s[84:87], s100 offen offset:0 sc1 lds
  v_mfma_f32_16x16x32_bf16 v[100:103], a[144:147], v[148:151], 0
  buffer_load_dwordx4 v[148:151], v27, s[40:43], s80 offen sc1
  v_mov_b32 v4, 128
  s_cmp_lg_u32 s32, 0
  s_cbranch_scc1 Lp0_11
  global_load_dword v31, v4, s[28:29] sc1
  s_branch Lp1_12
Lp0_11:
  v_mov_b32 v4, 0
  global_load_dword v31, v4, s[8:9]
Lp1_12:
  s_waitcnt vmcnt(14)
  v_mfma_f32_16x16x32_bf16 v[104:107], a[128:131], v[152:155], 0
  v_mfma_f32_16x16x32_bf16 v[108:111], a[132:135], v[152:155], 0
  s_add_u32 m0, s89, 81920
  s_nop 0
  buffer_load_dwordx4 v2, s[84:87], s100 offen offset:1024 sc1 lds
  v_mfma_f32_16x16x32_bf16 v[112:115], a[136:139], v[152:155], 0
  v_mfma_f32_16x16x32_bf16 v[116:119], a[140:143], v[152:155], 0
  s_add_u32 m0, s89, 81920
  s_nop 0
  buffer_load_dwordx4 v2, s[84:87], s100 offen offset:2048 sc1 lds
  v_mfma_f32_16x16x32_bf16 v[120:123], a[144:147], v[152:155], 0
  buffer_load_dwordx4 v[152:155], v28, s[40:43], s80 offen sc1
  s_waitcnt vmcnt(16)
  v_mfma_f32_16x16x32_bf16 v[124:127], a[128:131], v[156:159], 0
  v_mfma_f32_16x16x32_bf16 v[128:131], a[132:135], v[156:159], 0
  s_add_u32 m0, s89, 81920
  s_nop 0
  buffer_load_dwordx4 v2, s[84:87], s100 offen offset:3072 sc1 lds
  v_mfma_f32_16x16x32_bf16 v[132:135], a[136:139], v[156:159], 0
  v_mfma_f32_16x16x32_bf16 v[136:139], a[140:143], v[156:159], 0
  s_add_u32 m0, s89, 86016
  s_nop 0
  buffer_load_dwordx4 v3, s[84:87], s100 offen sc1 lds
  v_mfma_f32_16x16x32_bf16 v[140:143], a[144:147], v[156:159], 0
  buffer_load_dwordx4 v[156:159], v29, s[40:43], s80 offen sc1
  s_waitcnt vmcnt(18)
  v_mfma_f32_16x16x32_bf16 v[64:67], a[128:131], v[144:147], 0
  v_mfma_f32_16x16x32_bf16 v[68:71], a[132:135], v[144:147], 0
  v_mfma_f32_16x16x32_bf16 v[72:75], a[136:139], v[144:147], 0
  v_mfma_f32_16x16x32_bf16 v[76:79], a[140:143], v[144:147], 0
  v_mfma_f32_16x16x32_bf16 v[80:83], a[144:147], v[144:147], 0
  buffer_load_dwordx4 v[144:147], v26, s[40:43], s80 offen sc1
  s_add_u32 s80, s80, 16384
  s_waitcnt vmcnt(18)
  v_mfma_f32_16x16x32_bf16 v[84:87], a[148:151], v[164:167], v[84:87]
  v_mfma_f32_16x16x32_bf16 v[88:91], a[152:155], v[164:167], v[88:91]
  v_mfma_f32_16x16x32_bf16 v[92:95], a[156:159], v[164:167], v[92:95]
  v_mfma_f32_16x16x32_bf16 v[96:99], a[160:163], v[164:167], v[96:99]
  v_mfma_f32_16x16x32_bf16 v[100:103], a[164:167], v[164:167], v[100:103]
  buffer_load_dwordx4 v[164:167], v27, s[40:43], s80 offen sc1
  s_waitcnt vmcnt(18)
  v_mfma_f32_16x16x32_bf16 v[104:107], a[148:151], v[168:171], v[104:107]
  v_mfma_f32_16x16x32_bf16 v[108:111], a[152:155], v[168:171], v[108:111]
  v_mfma_f32_16x16x32_bf16 v[112:115], a[156:159], v[168:171], v[112:115]
  v_mfma_f32_16x16x32_bf16 v[116:119], a[160:163], v[168:171], v[116:119]
  v_mfma_f32_16x16x32_bf16 v[120:123], a[164:167], v[168:171], v[120:123]
  buffer_load_dwordx4 v[168:171], v28, s[40:43], s80 offen sc1
  s_waitcnt vmcnt(9)
  s_cmp_lg_u32 s32, 0
  s_cbranch_scc1 Lpd_14
  v_cmp_gt_u32 vcc, 4, v31
  s_mov_b32 s95, 0x8000
  s_cmp_eq_u64 vcc, 0
  s_cbranch_scc1 Lpd_14
Lpoll_13:
  s_sleep 8
  global_load_dword v31, v4, s[28:29] sc1
  s_waitcnt vmcnt(0)
  v_cmp_gt_u32 vcc, 4, v31
  s_sub_u32 s95, s95, 1
  s_cmp_eq_u64 vcc, 0
  s_cbranch_scc1 Lpd_14
  s_cmp_lg_u32 s95, 0
  s_cbranch_scc1 Lpoll_13
Lpd_14:
  v_mfma_f32_16x16x32_bf16 v[124:127], a[148:151], v[172:175], v[124:127]
  v_mfma_f32_16x16x32_bf16 v[128:131], a[152:155], v[172:175], v[128:131]
  v_mfma_f32_16x16x32_bf16 v[132:135], a[156:159], v[172:175], v[132:135]
  v_mfma_f32_16x16x32_bf16 v[136:139], a[160:163], v[172:175], v[136:139]
  v_mfma_f32_16x16x32_bf16 v[140:143], a[164:167], v[172:175], v[140:143]
  buffer_load_dwordx4 v[172:175], v29, s[40:43], s80 offen sc1
  v_mfma_f32_16x16x32_bf16 v[64:67], a[148:151], v[160:163], v[64:67]
  v_mfma_f32_16x16x32_bf16 v[68:71], a[152:155], v[160:163], v[68:71]
  v_mfma_f32_16x16x32_bf16 v[72:75], a[156:159], v[160:163], v[72:75]
  v_mfma_f32_16x16x32_bf16 v[76:79], a[160:163], v[160:163], v[76:79]
  v_mfma_f32_16x16x32_bf16 v[80:83], a[164:167], v[160:163], v[80:83]
  buffer_load_dwordx4 v[160:163], v26, s[40:43], s80 offen sc1
  s_add_u32 s80, s80, 16384
  v_mfma_f32_16x16x32_bf16 v[84:87], a[168:171], v[180:183], v[84:87]
  v_mfma_f32_16x16x32_bf16 v[88:91], a[172:175], v[180:183], v[88:91]
  v_mfma_f32_16x16x32_bf16 v[92:95], a[176:179], v[180:183], v[92:95]
  v_mfma_f32_16x16x32_bf16 v[96:99], a[180:183], v[180:183], v[96:99]
  v_mfma_f32_16x16x32_bf16 v[100:103], a[184:187], v[180:183], v[100:103]
  buffer_load_dwordx4 v[180:183], v27, s[40:43], s80 offen sc1
  v_mfma_f32_16x16x32_bf16 v[104:107], a[168:171], v[184:187], v[104:107]
  v_mfma_f32_16x16x32_bf16 v[108:111], a[172:175], v[184:187], v[108:111]
  v_mfma_f32_16x16x32_bf16 v[112:115], a[176:179], v[184:187], v[112:115]
  v_mfma_f32_16x16x32_bf16 v[116:119], a[180:183], v[184:187], v[116:119]
  v_mfma_f32_16x16x32_bf16 v[120:123], a[184:187], v[184:187], v[120:123]
  buffer_load_dwordx4 v[184:187], v28, s[40:43], s80 offen sc1
  v_mfma_f32_16x16x32_bf16 v[124:127], a[168:171], v[188:191], v[124:127]
  v_mfma_f32_16x16x32_bf16 v[128:131], a[172:175], v[188:191], v[128:131]
  v_mfma_f32_16x16x32_bf16 v[132:135], a[176:179], v[188:191], v[132:135]
  v_mfma_f32_16x16x32_bf16 v[136:139], a[180:183], v[188:191], v[136:139]
  v_mfma_f32_16x16x32_bf16 v[140:143], a[184:187], v[188:191], v[140:143]
  buffer_load_dwordx4 v[188:191], v29, s[40:43], s80 offen sc1
  v_mfma_f32_16x16x32_bf16 v[64:67], a[168:171], v[176:179], v[64:67]
  v_mfma_f32_16x16x32_bf16 v[68:71], a[172:175], v[176:179], v[68:71]
  v_mfma_f32_16x16x32_bf16 v[72:75], a[176:179], v[176:179], v[72:75]
  v_mfma_f32_16x16x32_bf16 v[76:79], a[180:183], v[176:179], v[76:79]
  v_mfma_f32_16x16x32_bf16 v[80:83], a[184:187], v[176:179], v[80:83]
  buffer_load_dwordx4 v[176:179], v26, s[40:43], s80 offen sc1
  s_add_u32 s80, s80, 16384
  v_mov_b32 v4, v17
  s_cmp_lg_u32 s32, 0
  s_cbranch_scc1 Lp0_15
  global_load_dword v31, v4, s[90:91] sc1
  s_branch Lp1_16
Lp0_15:
  v_mov_b32_e64 v4, 0
  global_load_dword v31, v4, s[8:9]
Lp1_16:
  v_mfma_f32_16x16x32_bf16 v[84:87], a[188:191], v[148:151], v[84:87]
  v_mfma_f32_16x16x32_bf16 v[88:91], a[192:195], v[148:151], v[88:91]
  v_mfma_f32_16x16x32_bf16 v[92:95], a[196:199], v[148:151], v[92:95]
  v_mfma_f32_16x16x32_bf16 v[96:99], a[200:203], v[148:151], v[96:99]
  v_mfma_f32_16x16x32_bf16 v[100:103], a[204:207], v[148:151], v[100:103]
  buffer_load_dwordx4 v[148:151], v27, s[40:43], s80 offen sc1
  s_waitcnt vmcnt(14)
  v_mfma_f32_16x16x32_bf16 v[104:107], a[188:191], v[152:155], v[104:107]
  v_mfma_f32_16x16x32_bf16 v[108:111], a[192:195], v[152:155], v[108:111]
  v_mfma_f32_16x16x32_bf16 v[112:115], a[196:199], v[152:155], v[112:115]
  v_mfma_f32_16x16x32_bf16 v[116:119], a[200:203], v[152:155], v[116:119]
  v_mfma_f32_16x16x32_bf16 v[120:123], a[204:207], v[152:155], v[120:123]
  buffer_load_dwordx4 v[152:155], v28, s[40:43], s80 offen sc1
  s_waitcnt vmcnt(12)
  v_mfma_f32_16x16x32_bf16 v[124:127], a[188:191], v[156:159], v[124:127]
  v_mfma_f32_16x16x32_bf16 v[128:131], a[192:195], v[156:159], v[128:131]
  v_mfma_f32_16x16x32_bf16 v[132:135], a[196:199], v[156:159], v[132:135]
  v_mfma_f32_16x16x32_bf16 v[136:139], a[200:203], v[156:159], v[136:139]
  v_mfma_f32_16x16x32_bf16 v[140:143], a[204:207], v[156:159], v[140:143]
  buffer_load_dwordx4 v[156:159], v29, s[40:43], s80 offen sc1
  s_waitcnt vmcnt(12)
  v_mfma_f32_16x16x32_bf16 v[64:67], a[188:191], v[144:147], v[64:67]
  v_mfma_f32_16x16x32_bf16 v[68:71], a[192:195], v[144:147], v[68:71]
  v_mfma_f32_16x16x32_bf16 v[72:75], a[196:199], v[144:147], v[72:75]
  v_mfma_f32_16x16x32_bf16 v[76:79], a[200:203], v[144:147], v[76:79]
  v_mfma_f32_16x16x32_bf16 v[80:83], a[204:207], v[144:147], v[80:83]
  buffer_load_dwordx4 v[144:147], v26, s[40:43], s80 offen sc1
  s_add_u32 s80, s80, 16384
  s_waitcnt vmcnt(12)
  v_mfma_f32_16x16x32_bf16 v[84:87], a[208:211], v[164:167], v[84:87]
  v_mfma_f32_16x16x32_bf16 v[88:91], a[212:215], v[164:167], v[88:91]
  v_mfma_f32_16x16x32_bf16 v[92:95], a[216:219], v[164:167], v[92:95]
  v_mfma_f32_16x16x32_bf16 v[96:99], a[220:223], v[164:167], v[96:99]
  v_mfma_f32_16x16x32_bf16 v[100:103], a[224:227], v[164:167], v[100:103]
  buffer_load_dwordx4 v[164:167], v27, s[40:43], s80 offen sc1
  s_waitcnt vmcnt(5)
  s_cmp_lg_u32 s32, 0
  s_cbranch_scc1 Lpd_18
  v_cmp_gt_u32 vcc, 1, v31
  s_mov_b32 s95, 0x8000
  s_cmp_eq_u64 vcc, 0
  s_cbranch_scc1 Lpd_18
Lpoll_17:
  s_sleep 2
  global_load_dword v31, v4, s[90:91] sc1
  s_waitcnt vmcnt(0)
  v_cmp_gt_u32 vcc, 1, v31
  s_sub_u32 s95, s95, 1
  s_cmp_eq_u64 vcc, 0
  s_cbranch_scc1 Lpd_18
  s_cmp_lg_u32 s95, 0
  s_cbranch_scc1 Lpoll_17
Lpd_18:
  s_barrier
  s_nop 0
  buffer_load_dwordx4 a[176:179], v2, s[56:59], s81 offen offset:0 sc1
  v_mfma_f32_16x16x32_bf16 v[104:107], a[208:211], v[168:171], v[104:107]
  buffer_load_dwordx4 a[180:183], v7, s[56:59], s81 offen offset:1024 sc1
  v_mfma_f32_16x16x32_bf16 v[108:111], a[212:215], v[168:171], v[108:111]
  buffer_load_dwordx4 a[184:187], v2, s[56:59], s81 offen offset:1280 sc1
  v_mfma_f32_16x16x32_bf16 v[112:115], a[216:219], v[168:171], v[112:115]
  buffer_load_dwordx4 a[188:191], v7, s[56:59], s81 offen offset:2304 sc1
  v_mfma_f32_16x16x32_bf16 v[116:119], a[220:223], v[168:171], v[116:119]
  buffer_load_dwordx4 a[192:195], v2, s[56:59], s101 offen offset:0 sc1
  v_mfma_f32_16x16x32_bf16 v[120:123], a[224:227], v[168:171], v[120:123]
  buffer_load_dwordx4 v[168:171], v28, s[40:43], s80 offen sc1
  buffer_load_dwordx4 a[196:199], v7, s[56:59], s101 offen offset:1024 sc1
  v_mfma_f32_16x16x32_bf16 v[124:127], a[208:211], v[172:175], v[124:127]
  buffer_load_dwordx4 a[200:203], v2, s[56:59], s101 offen offset:1280 sc1
  v_mfma_f32_16x16x32_bf16 v[128:131], a[212:215], v[172:175], v[128:131]
  buffer_load_dwordx4 a[204:207], v7, s[56:59], s101 offen offset:2304 sc1
  v_mfma_f32_16x16x32_bf16 v[132:135], a[216:219], v[172:175], v[132:135]
  buffer_load_dword v250, v6, s[48:51], s66 offen offset:0 sc1
  v_mfma_f32_16x16x32_bf16 v[136:139], a[220:223], v[172:175], v[136:139]
  buffer_load_dword v251, v6, s[48:51], s66 offen offset:64 sc1
  v_mfma_f32_16x16x32_bf16 v[140:143], a[224:227], v[172:175], v[140:143]
  buffer_load_dwordx4 v[172:175], v29, s[40:43], s80 offen sc1
  buffer_load_dword v252, v6, s[48:51], s66 offen offset:512 sc1
  v_mfma_f32_16x16x32_bf16 v[64:67], a[208:211], v[160:163], v[64:67]
  buffer_load_dword v253, v6, s[48:51], s66 offen offset:576 sc1
  v_mfma_f32_16x16x32_bf16 v[68:71], a[212:215], v[160:163], v[68:71]
  buffer_load_dwordx4 v[192:195], v2, s[44:47], s74 offen sc1
  v_mfma_f32_16x16x32_bf16 v[72:75], a[216:219], v[160:163], v[72:75]
  v_mfma_f32_16x16x32_bf16 v[76:79], a[220:223], v[160:163], v[76:79]
  v_mfma_f32_16x16x32_bf16 v[80:83], a[224:227], v[160:163], v[80:83]
  buffer_load_dwordx4 v[160:163], v26, s[40:43], s80 offen sc1
  s_add_u32 s80, s80, 16384
  v_mfma_f32_16x16x32_bf16 v[84:87], a[228:231], v[180:183], v[84:87]
  v_mfma_f32_16x16x32_bf16 v[88:91], a[232:235], v[180:183], v[88:91]
  v_mfma_f32_16x16x32_bf16 v[92:95], a[236:239], v[180:183], v[92:95]
  v_mfma_f32_16x16x32_bf16 v[96:99], a[240:243], v[180:183], v[96:99]
  v_mfma_f32_16x16x32_bf16 v[100:103], a[244:247], v[180:183], v[100:103]
  buffer_load_dwordx4 v[180:183], v27, s[40:43], s80 offen sc1
  v_mfma_f32_16x16x32_bf16 v[104:107], a[228:231], v[184:187], v[104:107]
  v_mfma_f32_16x16x32_bf16 v[108:111], a[232:235], v[184:187], v[108:111]
  v_mfma_f32_16x16x32_bf16 v[112:115], a[236:239], v[184:187], v[112:115]
  v_mfma_f32_16x16x32_bf16 v[116:119], a[240:243], v[184:187], v[116:119]
  v_mfma_f32_16x16x32_bf16 v[120:123], a[244:247], v[184:187], v[120:123]
  buffer_load_dwordx4 v[184:187], v28, s[40:43], s80 offen sc1
  v_mfma_f32_16x16x32_bf16 v[124:127], a[228:231], v[188:191], v[124:127]
  v_mfma_f32_16x16x32_bf16 v[128:131], a[232:235], v[188:191], v[128:131]
  v_mfma_f32_16x16x32_bf16 v[132:135], a[236:239], v[188:191], v[132:135]
  v_mfma_f32_16x16x32_bf16 v[136:139], a[240:243], v[188:191], v[136:139]
  v_mfma_f32_16x16x32_bf16 v[140:143], a[244:247], v[188:191], v[140:143]
  buffer_load_dwordx4 v[188:191], v29, s[40:43], s80 offen sc1
  v_mfma_f32_16x16x32_bf16 v[64:67], a[228:231], v[176:179], v[64:67]
  v_mfma_f32_16x16x32_bf16 v[68:71], a[232:235], v[176:179], v[68:71]
  v_mfma_f32_16x16x32_bf16 v[72:75], a[236:239], v[176:179], v[72:75]
  v_mfma_f32_16x16x32_bf16 v[76:79], a[240:243], v[176:179], v[76:79]
  v_mfma_f32_16x16x32_bf16 v[80:83], a[244:247], v[176:179], v[80:83]
  buffer_load_dwordx4 v[176:179], v26, s[40:43], s80 offen sc1
  s_add_u32 s80, s80, 16384
  s_waitcnt vmcnt(5)
  s_mov_b32 s95, 0x8000
Lkf_19:
  v_max3_u32 v196, v192, v193, v194
  v_max_u32 v196, v196, v195
  v_cmp_eq_u32 vcc, -1, v196
  s_sub_u32 s95, s95, 1
  s_cmp_eq_u64 vcc, 0
  s_cbranch_scc1 Lkg_20
  s_sleep 2
  buffer_load_dwordx4 v[192:195], v2, s[44:47], s74 offen sc1
  s_waitcnt vmcnt(0)
  s_cmp_lg_u32 s95, 0
  s_cbranch_scc1 Lkf_19
Lkg_20:
  ds_write_b128 v10, v[192:195]
  v_mfma_f32_16x16x32_bf16 v[84:87], a[248:251], v[148:151], v[84:87]
  v_mfma_f32_16x16x32_bf16 v[88:91], a[252:255], v[148:151], v[88:91]
  v_mfma_f32_16x16x32_bf16 v[92:95], a[48:51], v[148:151], v[92:95]
  v_mfma_f32_16x16x32_bf16 v[96:99], a[52:55], v[148:151], v[96:99]
  s_waitcnt lgkmcnt(0)
  s_barrier
  v_lshl_add_u32 v15, v25, 4, v18
  v_cndmask_b32 v14, v30, v18, s[78:79]
  ds_read_b128 a[128:131], v15
  ds_read_b128 a[132:135], v14 offset:64
  v_lshl_add_u32 v15, v25, 4, v19
  v_cndmask_b32 v14, v30, v19, s[78:79]
  v_mfma_f32_16x16x32_bf16 v[100:103], a[56:59], v[148:151], v[100:103]
  buffer_load_dwordx4 v[148:151], v27, s[40:43], s80 offen sc1
  ds_read_b128 a[136:139], v15
  ds_read_b128 a[140:143], v14 offset:64
  v_lshl_add_u32 v15, v25, 4, v20
  v_cndmask_b32 v14, v30, v20, s[78:79]
  ds_read_b128 a[144:147], v15
  ds_read_b128 a[148:151], v14 offset:64
  v_mfma_f32_16x16x32_bf16 v[104:107], a[248:251], v[152:155], v[104:107]
  v_lshl_add_u32 v15, v25, 4, v21
  v_cndmask_b32 v14, v30, v21, s[78:79]
  ds_read_b128 a[152:155], v15
  ds_read_b128 a[156:159], v14 offset:64
  v_lshl_add_u32 v15, v25, 4, v22
  v_cndmask_b32 v14, v30, v22, s[78:79]
  v_mfma_f32_16x16x32_bf16 v[108:111], a[252:255], v[152:155], v[108:111]
  ds_read_b128 a[160:163], v15
  ds_read_b128 a[164:167], v14 offset:64
  v_lshl_add_u32 v15, v25, 4, v23
  v_cndmask_b32 v14, v30, v23, s[78:79]
  ds_read_b128 a[168:171], v15
  ds_read_b128 a[172:175], v14 offset:64
  v_mfma_f32_16x16x32_bf16 v[112:115], a[48:51], v[152:155], v[112:115]
  v_mfma_f32_16x16x32_bf16 v[116:119], a[52:55], v[152:155], v[116:119]
  v_mfma_f32_16x16x32_bf16 v[120:123], a[56:59], v[152:155], v[120:123]
  buffer_load_dwordx4 v[152:155], v28, s[40:43], s80 offen sc1
  v_mfma_f32_16x16x32_bf16 v[124:127], a[248:251], v[156:159], v[124:127]
  v_mfma_f32_16x16x32_bf16 v[128:131], a[252:255], v[156:159], v[128:131]
  s_add_u32 s81, s81, 10240
  s_add_u32 s101, s101, 10240
  v_mfma_f32_16x16x32_bf16 v[132:135], a[48:51], v[156:159], v[132:135]
  buffer_load_dwordx4 a[208:211], v2, s[56:59], s81 offen offset:0 sc1
  buffer_load_dwordx4 a[212:215], v7, s[56:59], s81 offen offset:1024 sc1
  v_mfma_f32_16x16x32_bf16 v[136:139], a[52:55], v[156:159], v[136:139]
  buffer_load_dwordx4 a[216:219], v2, s[56:59], s81 offen offset:1280 sc1
  buffer_load_dwordx4 a[220:223], v7, s[56:59], s81 offen offset:2304 sc1
  v_mfma_f32_16x16x32_bf16 v[140:143], a[56:59], v[156:159], v[140:143]
  buffer_load_dwordx4 v[156:159], v29, s[40:43], s80 offen sc1
  buffer_load_dwordx4 a[224:227], v2, s[56:59], s101 offen offset:0 sc1
  buffer_load_dwordx4 a[228:231], v7, s[56:59], s101 offen offset:1024 sc1
  v_mfma_f32_16x16x32_bf16 v[64:67], a[248:251], v[144:147], v[64:67]
  buffer_load_dwordx4 a[232:235], v2, s[56:59], s101 offen offset:1280 sc1
  buffer_load_dwordx4 a[236:239], v7, s[56:59], s101 offen offset:2304 sc1
  v_mfma_f32_16x16x32_bf16 v[68:71], a[252:255], v[144:147], v[68:71]
  s_waitcnt lgkmcnt(6)
  s_nop 0
  v_mfma_f32_16x16x32_bf16 v[200:203], a[144:147], a[176:179], 0
  v_mfma_f32_16x16x32_bf16 v[192:195], a[128:131], a[176:179], 0
  v_mfma_f32_16x16x32_bf16 v[196:199], a[136:139], a[176:179], 0
  v_mfma_f32_16x16x32_bf16 v[212:215], a[144:147], a[184:187], 0
  v_mfma_f32_16x16x32_bf16 v[204:207], a[128:131], a[184:187], 0
  v_mfma_f32_16x16x32_bf16 v[208:211], a[136:139], a[184:187], 0
  v_mfma_f32_16x16x32_bf16 v[200:203], a[148:151], a[180:183], v[200:203]
  v_mfma_f32_16x16x32_bf16 v[192:195], a[132:135], a[180:183], v[192:195]
  v_mfma_f32_16x16x32_bf16 v[196:199], a[140:143], a[180:183], v[196:199]
  v_mfma_f32_16x16x32_bf16 v[212:215], a[148:151], a[188:191], v[212:215]
  v_mfma_f32_16x16x32_bf16 v[204:207], a[132:135], a[188:191], v[204:207]
  v_mfma_f32_16x16x32_bf16 v[208:211], a[140:143], a[188:191], v[208:211]
  s_waitcnt lgkmcnt(0)
  s_nop 0
  v_mfma_f32_16x16x32_bf16 v[224:227], a[168:171], a[192:195], 0
  v_mfma_f32_16x16x32_bf16 v[216:219], a[152:155], a[192:195], 0
  v_mfma_f32_16x16x32_bf16 v[220:223], a[160:163], a[192:195], 0
  v_mfma_f32_16x16x32_bf16 v[236:239], a[168:171], a[200:203], 0
  v_mfma_f32_16x16x32_bf16 v[228:231], a[152:155], a[200:203], 0
  v_mfma_f32_16x16x32_bf16 v[232:235], a[160:163], a[200:203], 0
  v_mfma_f32_16x16x32_bf16 v[224:227], a[172:175], a[196:199], v[224:227]
  v_mfma_f32_16x16x32_bf16 v[216:219], a[156:159], a[196:199], v[216:219]
  v_mfma_f32_16x16x32_bf16 v[220:223], a[164:167], a[196:199], v[220:223]
  v_mfma_f32_16x16x32_bf16 v[236:239], a[172:175], a[204:207], v[236:239]
  v_mfma_f32_16x16x32_bf16 v[228:231], a[156:159], a[204:207], v[228:231]
  v_mfma_f32_16x16x32_bf16 v[232:235], a[164:167], a[204:207], v[232:235]
  v_add_f32 v200, 0x358637bd, v200
  v_add_f32 v212, 0x358637bd, v212
  s_nop 0
  v_add_f32 v224, 0x358637bd, v224
  s_nop 1
  v_add_f32 v236, 0x358637bd, v236
  v_rcp_f32 v200, v200
  v_rcp_f32 v212, v212
  v_rcp_f32 v224, v224
  v_rcp_f32 v236, v236
  v_mul_f32 v200, v200, v250
  v_mul_f32 v212, v212, v251
  v_mul_f32 v224, v224, v250
  v_mul_f32 v236, v236, v251
  v_mfma_f32_16x16x32_bf16 v[72:75], a[48:51], v[144:147], v[72:75]
  v_mul_f32 v216, v216, v224
  v_mul_f32 v217, v217, v224
  v_mul_f32 v218, v218, v224
  v_mul_f32 v219, v219, v224
  v_mul_f32 v220, v220, v224
  v_mul_f32 v221, v221, v224
  v_mul_f32 v222, v222, v224
  v_mul_f32 v223, v223, v224
  v_cvt_pk_bf16_f32 v224, v216, v217
  v_cvt_pk_bf16_f32 v225, v218, v219
  v_cvt_pk_bf16_f32 v226, v220, v221
  v_cvt_pk_bf16_f32 v227, v222, v223
  v_mfma_f32_16x16x32_bf16 v[76:79], a[52:55], v[144:147], v[76:79]
  buffer_store_dwordx4 v[224:227], v13, s[52:55], s73 offen offset:0 sc1
  v_mul_f32 v192, v192, v200
  v_mul_f32 v193, v193, v200
  v_mul_f32 v194, v194, v200
  v_mul_f32 v195, v195, v200
  v_mul_f32 v196, v196, v200
  v_mul_f32 v197, v197, v200
  v_mul_f32 v198, v198, v200
  v_mul_f32 v199, v199, v200
  v_cvt_pk_bf16_f32 v200, v192, v193
  v_cvt_pk_bf16_f32 v201, v194, v195
  v_cvt_pk_bf16_f32 v202, v196, v197
  v_mfma_f32_16x16x32_bf16 v[80:83], a[56:59], v[144:147], v[80:83]
  buffer_load_dwordx4 v[144:147], v26, s[40:43], s80 offen sc1
  s_add_u32 s80, s80, 16384
  v_cvt_pk_bf16_f32 v203, v198, v199
  v_cndmask_b32 v202, v202, v224, s[76:77]
  v_cndmask_b32 v203, v203, v225, s[76:77]
  buffer_store_dwordx4 v[200:203], v12, s[52:55], s73 offen offset:0 sc1
  v_mul_f32 v228, v228, v236
  v_mul_f32 v229, v229, v236
  v_mul_f32 v230, v230, v236
  v_mul_f32 v231, v231, v236
  v_mul_f32 v232, v232, v236
  v_mul_f32 v233, v233, v236
  v_mul_f32 v234, v234, v236
  v_mul_f32 v235, v235, v236
  v_mfma_f32_16x16x32_bf16 v[84:87], a[60:63], v[164:167], v[84:87]
  v_cvt_pk_bf16_f32 v236, v228, v229
  v_cvt_pk_bf16_f32 v237, v230, v231
  v_cvt_pk_bf16_f32 v238, v232, v233
  v_cvt_pk_bf16_f32 v239, v234, v235
  buffer_store_dwordx4 v[236:239], v13, s[52:55], s73 offen offset:1024 sc1
  v_mul_f32 v204, v204, v212
  v_mul_f32 v205, v205, v212
  v_mul_f32 v206, v206, v212
  v_mul_f32 v207, v207, v212
  v_mul_f32 v208, v208, v212
  v_mul_f32 v209, v209, v212
  v_mul_f32 v210, v210, v212
  v_mfma_f32_16x16x32_bf16 v[88:91], a[64:67], v[164:167], v[88:91]
  v_mul_f32 v211, v211, v212
  v_cvt_pk_bf16_f32 v212, v204, v205
  v_cvt_pk_bf16_f32 v213, v206, v207
  v_cvt_pk_bf16_f32 v214, v208, v209
  v_cvt_pk_bf16_f32 v215, v210, v211
  v_cndmask_b32 v214, v214, v236, s[76:77]
  v_cndmask_b32 v215, v215, v237, s[76:77]
  buffer_store_dwordx4 v[212:215], v12, s[52:55], s73 offen offset:1024 sc1
  s_add_u32 s73, s73, 606208
  s_waitcnt vmcnt(5)
  s_nop 0
  v_mfma_f32_16x16x32_bf16 v[200:203], a[144:147], a[208:211], 0
  v_mfma_f32_16x16x32_bf16 v[192:195], a[128:131], a[208:211], 0
  v_mfma_f32_16x16x32_bf16 v[196:199], a[136:139], a[208:211], 0
  v_mfma_f32_16x16x32_bf16 v[212:215], a[144:147], a[216:219], 0
  v_mfma_f32_16x16x32_bf16 v[204:207], a[128:131], a[216:219], 0
  v_mfma_f32_16x16x32_bf16 v[208:211], a[136:139], a[216:219], 0
  v_mfma_f32_16x16x32_bf16 v[200:203], a[148:151], a[212:215], v[200:203]
  v_mfma_f32_16x16x32_bf16 v[192:195], a[132:135], a[212:215], v[192:195]
  v_mfma_f32_16x16x32_bf16 v[196:199], a[140:143], a[212:215], v[196:199]
  v_mfma_f32_16x16x32_bf16 v[212:215], a[148:151], a[220:223], v[212:215]
  v_mfma_f32_16x16x32_bf16 v[204:207], a[132:135], a[220:223], v[204:207]
  v_mfma_f32_16x16x32_bf16 v[208:211], a[140:143], a[220:223], v[208:211]
  v_mfma_f32_16x16x32_bf16 v[224:227], a[168:171], a[224:227], 0
  v_mfma_f32_16x16x32_bf16 v[216:219], a[152:155], a[224:227], 0
  v_mfma_f32_16x16x32_bf16 v[220:223], a[160:163], a[224:227], 0
  v_mfma_f32_16x16x32_bf16 v[236:239], a[168:171], a[232:235], 0
  v_mfma_f32_16x16x32_bf16 v[228:231], a[152:155], a[232:235], 0
  v_mfma_f32_16x16x32_bf16 v[232:235], a[160:163], a[232:235], 0
  v_mfma_f32_16x16x32_bf16 v[224:227], a[172:175], a[228:231], v[224:227]
  v_mfma_f32_16x16x32_bf16 v[216:219], a[156:159], a[228:231], v[216:219]
  v_mfma_f32_16x16x32_bf16 v[220:223], a[164:167], a[228:231], v[220:223]
  v_mfma_f32_16x16x32_bf16 v[236:239], a[172:175], a[236:239], v[236:239]
  v_mfma_f32_16x16x32_bf16 v[228:231], a[156:159], a[236:239], v[228:231]
  v_mfma_f32_16x16x32_bf16 v[232:235], a[164:167], a[236:239], v[232:235]
  v_add_f32 v200, 0x358637bd, v200
  v_add_f32 v212, 0x358637bd, v212
  s_nop 0
  v_add_f32 v224, 0x358637bd, v224
  s_nop 1
  v_add_f32 v236, 0x358637bd, v236
  v_rcp_f32 v200, v200
  v_rcp_f32 v212, v212
  v_rcp_f32 v224, v224
  v_rcp_f32 v236, v236
  v_mul_f32 v200, v200, v252
  v_mul_f32 v212, v212, v253
  v_mul_f32 v224, v224, v252
  v_mul_f32 v236, v236, v253
  v_mfma_f32_16x16x32_bf16 v[92:95], a[68:71], v[164:167], v[92:95]
  v_mul_f32 v216, v216, v224
  v_mul_f32 v217, v217, v224
  v_mul_f32 v218, v218, v224
  v_mul_f32 v219, v219, v224
  v_mul_f32 v220, v220, v224
  v_mul_f32 v221, v221, v224
  v_mul_f32 v222, v222, v224
  v_mul_f32 v223, v223, v224
  v_cvt_pk_bf16_f32 v224, v216, v217
  v_cvt_pk_bf16_f32 v225, v218, v219
  v_cvt_pk_bf16_f32 v226, v220, v221
  v_cvt_pk_bf16_f32 v227, v222, v223
  v_mfma_f32_16x16x32_bf16 v[96:99], a[72:75], v[164:167], v[96:99]
  buffer_store_dwordx4 v[224:227], v13, s[52:55], s73 offen offset:0 sc1
  v_mul_f32 v192, v192, v200
  v_mul_f32 v193, v193, v200
  v_mul_f32 v194, v194, v200
  v_mul_f32 v195, v195, v200
  v_mul_f32 v196, v196, v200
  v_mul_f32 v197, v197, v200
  v_mul_f32 v198, v198, v200
  v_mul_f32 v199, v199, v200
  v_cvt_pk_bf16_f32 v200, v192, v193
  v_cvt_pk_bf16_f32 v201, v194, v195
  v_cvt_pk_bf16_f32 v202, v196, v197
  v_mfma_f32_16x16x32_bf16 v[100:103], a[76:79], v[164:167], v[100:103]
  buffer_load_dwordx4 v[164:167], v27, s[40:43], s80 offen sc1
  v_cvt_pk_bf16_f32 v203, v198, v199
  v_cndmask_b32 v202, v202, v224, s[76:77]
  v_cndmask_b32 v203, v203, v225, s[76:77]
  buffer_store_dwordx4 v[200:203], v12, s[52:55], s73 offen offset:0 sc1
  v_mul_f32 v228, v228, v236
  v_mul_f32 v229, v229, v236
  v_mul_f32 v230, v230, v236
  v_mul_f32 v231, v231, v236
  v_mul_f32 v232, v232, v236
  v_mul_f32 v233, v233, v236
  v_mul_f32 v234, v234, v236
  v_mul_f32 v235, v235, v236
  v_mfma_f32_16x16x32_bf16 v[104:107], a[60:63], v[168:171], v[104:107]
  v_cvt_pk_bf16_f32 v236, v228, v229
  v_cvt_pk_bf16_f32 v237, v230, v231
  v_cvt_pk_bf16_f32 v238, v232, v233
  v_cvt_pk_bf16_f32 v239, v234, v235
  buffer_store_dwordx4 v[236:239], v13, s[52:55], s73 offen offset:1024 sc1
  v_mul_f32 v204, v204, v212
  v_mul_f32 v205, v205, v212
  v_mul_f32 v206, v206, v212
  v_mul_f32 v207, v207, v212
  v_mul_f32 v208, v208, v212
  v_mul_f32 v209, v209, v212
  v_mul_f32 v210, v210, v212
  v_mfma_f32_16x16x32_bf16 v[108:111], a[64:67], v[168:171], v[108:111]
  v_mul_f32 v211, v211, v212
  v_cvt_pk_bf16_f32 v212, v204, v205
  v_cvt_pk_bf16_f32 v213, v206, v207
  v_cvt_pk_bf16_f32 v214, v208, v209
  v_cvt_pk_bf16_f32 v215, v210, v211
  v_cndmask_b32 v214, v214, v236, s[76:77]
  v_cndmask_b32 v215, v215, v237, s[76:77]
  buffer_store_dwordx4 v[212:215], v12, s[52:55], s73 offen offset:1024 sc1
  v_mfma_f32_16x16x32_bf16 v[112:115], a[68:71], v[168:171], v[112:115]
  v_mfma_f32_16x16x32_bf16 v[116:119], a[72:75], v[168:171], v[116:119]
  v_mfma_f32_16x16x32_bf16 v[120:123], a[76:79], v[168:171], v[120:123]
  buffer_load_dwordx4 v[168:171], v28, s[40:43], s80 offen sc1
  v_mfma_f32_16x16x32_bf16 v[124:127], a[60:63], v[172:175], v[124:127]
  v_mfma_f32_16x16x32_bf16 v[128:131], a[64:67], v[172:175], v[128:131]
  v_mfma_f32_16x16x32_bf16 v[132:135], a[68:71], v[172:175], v[132:135]
  v_mfma_f32_16x16x32_bf16 v[136:139], a[72:75], v[172:175], v[136:139]
  v_mfma_f32_16x16x32_bf16 v[140:143], a[76:79], v[172:175], v[140:143]
  buffer_load_dwordx4 v[172:175], v29, s[40:43], s80 offen sc1
  v_mfma_f32_16x16x32_bf16 v[64:67], a[60:63], v[160:163], v[64:67]
  v_mfma_f32_16x16x32_bf16 v[68:71], a[64:67], v[160:163], v[68:71]
  v_mfma_f32_16x16x32_bf16 v[72:75], a[68:71], v[160:163], v[72:75]
  v_mfma_f32_16x16x32_bf16 v[76:79], a[72:75], v[160:163], v[76:79]
  v_mfma_f32_16x16x32_bf16 v[80:83], a[76:79], v[160:163], v[80:83]
  buffer_load_dwordx4 v[160:163], v26, s[40:43], s80 offen sc1
  s_add_u32 s80, s80, 16384
  v_mfma_f32_16x16x32_bf16 v[84:87], a[80:83], v[180:183], v[84:87]
  v_mfma_f32_16x16x32_bf16 v[88:91], a[84:87], v[180:183], v[88:91]
  v_mfma_f32_16x16x32_bf16 v[92:95], a[88:91], v[180:183], v[92:95]
  v_mfma_f32_16x16x32_bf16 v[96:99], a[92:95], v[180:183], v[96:99]
  v_mfma_f32_16x16x32_bf16 v[100:103], a[108:111], v[180:183], v[100:103]
  buffer_load_dwordx4 v[180:183], v27, s[40:43], s80 offen sc1
  v_mfma_f32_16x16x32_bf16 v[104:107], a[80:83], v[184:187], v[104:107]
  v_mfma_f32_16x16x32_bf16 v[108:111], a[84:87], v[184:187], v[108:111]
  s_waitcnt vmcnt(4)
  s_add_u32 s82, s83, 16
  s_mul_i32 s82, s82, 4352
  s_barrier
  s_cmp_lg_u32 s32, 0
  s_cbranch_scc1 Lsg_21
  v_mul_u32_u24 v4, 4352, v0
  v_add_u32 v4, s82, v4
  v_mov_b32 v31, 1
  s_mov_b64 exec, 3
  global_atomic_add v4, v31, s[90:91] sc1
  s_mov_b64 exec, -1
Lsg_21:
  s_add_u32 s75, s32, 1
  s_and_b32 s75, s75, 3
  v_mfma_f32_16x16x32_bf16 v[112:115], a[88:91], v[184:187], v[112:115]
  s_mul_i32 s75, s75, 15360
  s_add_u32 s75, s75, 102400
  v_mfma_f32_16x16x32_bf16 v[116:119], a[92:95], v[184:187], v[116:119]
  v_add_u32 v11, s75, v2
  s_add_u32 s75, s32, 2
  v_mfma_f32_16x16x32_bf16 v[120:123], a[108:111], v[184:187], v[120:123]
  buffer_load_dwordx4 v[184:187], v28, s[40:43], s80 offen sc1
  s_and_b32 s75, s75, 3
  s_mul_i32 s75, s75, 15360
  v_mfma_f32_16x16x32_bf16 v[124:127], a[80:83], v[188:191], v[124:127]
  s_add_u32 s75, s75, 107520
  v_add_u32 v12, s75, v2
  v_mfma_f32_16x16x32_bf16 v[128:131], a[84:87], v[188:191], v[128:131]
  s_add_u32 s75, s32, 3
  s_and_b32 s75, s75, 3
  v_mfma_f32_16x16x32_bf16 v[132:135], a[88:91], v[188:191], v[132:135]
  s_mul_i32 s75, s75, 15360
  s_add_u32 s75, s75, 112640
  v_mfma_f32_16x16x32_bf16 v[136:139], a[92:95], v[188:191], v[136:139]
  v_add_u32 v13, s75, v2
  s_mul_i32 s75, s32, 15360
  v_mfma_f32_16x16x32_bf16 v[140:143], a[108:111], v[188:191], v[140:143]
  buffer_load_dwordx4 v[188:191], v29, s[40:43], s80 offen sc1
  s_add_u32 s75, s75, 102400
  v_add_u32_e64 v8, s75, v2
  v_mfma_f32_16x16x32_bf16 v[64:67], a[80:83], v[176:179], v[64:67]
  v_add_u32 v9, 51200, v2
  s_mov_b32 s52, s26
  v_mfma_f32_16x16x32_bf16 v[68:71], a[84:87], v[176:179], v[68:71]
  s_and_b32 s53, s27, 0xffff
  s_mov_b32 s54, 0x280000
  v_mfma_f32_16x16x32_bf16 v[72:75], a[88:91], v[176:179], v[72:75]
  s_mov_b32 s55, 0x20000
  s_lshl_b32 s81, s37, 6
  v_mfma_f32_16x16x32_bf16 v[76:79], a[92:95], v[176:179], v[76:79]
  s_lshl_b32 s75, s32, 4
  s_add_u32 s81, s81, s75
  v_mfma_f32_16x16x32_bf16 v[80:83], a[108:111], v[176:179], v[80:83]
  buffer_load_dwordx4 v[176:179], v26, s[40:43], s80 offen sc1
  s_add_u32 s80, s80, 16384
  s_lshl_b32 s74, s81, 2
  s_mul_i32 s81, s81, 1280
  v_mfma_f32_16x16x32_bf16 v[84:87], a[112:115], v[148:151], v[84:87]
  s_mul_i32 s75, s38, 160
  s_add_u32 s81, s81, s75
  v_mfma_f32_16x16x32_bf16 v[88:91], a[116:119], v[148:151], v[88:91]
  v_mul_u32_u24 v16, 1280, v24
  v_lshl_add_u32 v16, v25, 3, v16
  v_mfma_f32_16x16x32_bf16 v[92:95], a[0:3], v[148:151], v[92:95]
  s_lshr_b32 s82, s37, 1
  s_add_u32 s82, s82, 16
  v_mfma_f32_16x16x32_bf16 v[96:99], a[4:7], v[148:151], v[96:99]
  s_mul_i32 s82, s82, 4352
  s_mov_b32 s73, 0
  v_mfma_f32_16x16x32_bf16 v[100:103], a[8:11], v[148:151], v[100:103]
  buffer_load_dwordx4 v[148:151], v27, s[40:43], s80 offen sc1
  s_mul_i32 s75, s32, 15360
  s_add_u32 s75, s75, 102400
  v_mfma_f32_16x16x32_bf16 v[104:107], a[112:115], v[152:155], v[104:107]
  v_mul_u32_u24 v17, 176, v24
  v_lshl_add_u32 v17, v25, 3, v17
  v_mfma_f32_16x16x32_bf16 v[108:111], a[116:119], v[152:155], v[108:111]
  v_add_u32 v17, s75, v17
  v_mov_b32 v30, 0x7fffffff
  v_mfma_f32_16x16x32_bf16 v[112:115], a[0:3], v[152:155], v[112:115]
  v_add_u32_e64 v14, 0, v0
  v_mul_u32_u24 v15, 205, v14
  v_mfma_f32_16x16x32_bf16 v[116:119], a[4:7], v[152:155], v[116:119]
  v_lshrrev_b32 v15, 11, v15
  v_mul_u32_u24 v7, 10, v15
  v_mfma_f32_16x16x32_bf16 v[120:123], a[8:11], v[152:155], v[120:123]
  buffer_load_dwordx4 v[152:155], v28, s[40:43], s80 offen sc1
  v_sub_u32 v14, v14, v7
  v_lshlrev_b32 v14, 4, v14
  v_mfma_f32_16x16x32_bf16 v[124:127], a[112:115], v[156:159], v[124:127]
  v_mul_u32_u24 v7, 176, v15
  v_add3_u32 v18, v7, v14, s75
  v_mfma_f32_16x16x32_bf16 v[128:131], a[116:119], v[156:159], v[128:131]
  v_mul_u32_u24 v7, 1280, v15
  v_add_u32 v21, v7, v14
  v_mfma_f32_16x16x32_bf16 v[132:135], a[0:3], v[156:159], v[132:135]
  v_add_u32 v14, 64, v0
  v_mul_u32_u24 v15, 205, v14
  v_mfma_f32_16x16x32_bf16 v[136:139], a[4:7], v[156:159], v[136:139]
  v_lshrrev_b32 v15, 11, v15
  v_mul_u32_u24 v7, 10, v15
  v_mfma_f32_16x16x32_bf16 v[140:143], a[8:11], v[156:159], v[140:143]
  buffer_load_dwordx4 v[156:159], v29, s[40:43], s80 offen sc1
  v_sub_u32 v14, v14, v7
  v_lshlrev_b32 v14, 4, v14
  v_mfma_f32_16x16x32_bf16 v[64:67], a[112:115], v[144:147], v[64:67]
  v_mul_u32_u24 v7, 176, v15
  v_add3_u32 v19, v7, v14, s75
  v_mfma_f32_16x16x32_bf16 v[68:71], a[116:119], v[144:147], v[68:71]
  v_mul_u32_u24 v7, 1280, v15
  v_add_u32_e64 v22, v7, v14
  v_mfma_f32_16x16x32_bf16 v[72:75], a[0:3], v[144:147], v[72:75]
  v_add_u32 v14, 128, v0
  v_mul_u32_u24 v15, 205, v14
  v_mfma_f32_16x16x32_bf16 v[76:79], a[4:7], v[144:147], v[76:79]
  v_lshrrev_b32 v15, 11, v15
  v_mul_u32_u24 v7, 10, v15
  v_mfma_f32_16x16x32_bf16 v[80:83], a[8:11], v[144:147], v[80:83]
  buffer_load_dwordx4 v[144:147], v26, s[40:43], s80 offen sc1
  s_add_u32 s80, s80, 16384
  v_sub_u32 v14, v14, v7
  v_lshlrev_b32 v14, 4, v14
  v_mfma_f32_16x16x32_bf16 v[84:87], a[12:15], v[164:167], v[84:87]
  v_mul_u32_u24 v7, 176, v15
  v_add3_u32 v20, v7, v14, s75
  v_mfma_f32_16x16x32_bf16 v[88:91], a[16:19], v[164:167], v[88:91]
  v_mul_u32_u24 v7, 1280, v15
  v_add_u32 v23, v7, v14
  v_mfma_f32_16x16x32_bf16 v[92:95], a[20:23], v[164:167], v[92:95]
  v_cmp_gt_u32 vcc, 32, v0
  s_nop 1
  v_cndmask_b32 v23, v30, v23, vcc
  v_mfma_f32_16x16x32_bf16 v[96:99], a[24:27], v[164:167], v[96:99]
  v_mfma_f32_16x16x32_bf16 v[100:103], a[28:31], v[164:167], v[100:103]
  ds_read_b128 a[128:131], v2 offset:0
  buffer_load_dwordx4 v[164:167], v27, s[40:43], s80 offen sc1
  s_waitcnt vmcnt(11)
  s_nop 0
  v_mfma_f32_16x16x32_bf16 v[104:107], a[12:15], v[168:171], v[104:107]
  ds_read_b128 a[132:135], v2 offset:1024
  v_mfma_f32_16x16x32_bf16 v[108:111], a[16:19], v[168:171], v[108:111]
  ds_read_b128 a[136:139], v2 offset:2048
  v_mfma_f32_16x16x32_bf16 v[112:115], a[20:23], v[168:171], v[112:115]
  ds_read_b128 a[140:143], v2 offset:3072
  v_mfma_f32_16x16x32_bf16 v[116:119], a[24:27], v[168:171], v[116:119]
  ds_read_b128 a[144:147], v2 offset:4096
  v_mfma_f32_16x16x32_bf16 v[120:123], a[28:31], v[168:171], v[120:123]
  ds_read_b128 a[148:151], v2 offset:5120
  buffer_load_dwordx4 v[168:171], v28, s[40:43], s80 offen sc1
  s_waitcnt vmcnt(11)
  s_nop 0
  v_mfma_f32_16x16x32_bf16 v[124:127], a[12:15], v[172:175], v[124:127]
  ds_read_b128 a[152:155], v2 offset:6144
  v_mfma_f32_16x16x32_bf16 v[128:131], a[16:19], v[172:175], v[128:131]
  ds_read_b128 a[156:159], v2 offset:7168
  v_mfma_f32_16x16x32_bf16 v[132:135], a[20:23], v[172:175], v[132:135]
  ds_read_b128 a[160:163], v2 offset:8192
  v_mfma_f32_16x16x32_bf16 v[136:139], a[24:27], v[172:175], v[136:139]
  ds_read_b128 a[164:167], v2 offset:9216
  v_mfma_f32_16x16x32_bf16 v[140:143], a[28:31], v[172:175], v[140:143]
  ds_read_b128 a[168:171], v2 offset:10240
  buffer_load_dwordx4 v[172:175], v29, s[40:43], s80 offen sc1
  s_waitcnt vmcnt(11)
  v_mfma_f32_16x16x32_bf16 v[64:67], a[12:15], v[160:163], v[64:67]
  ds_read_b128 a[172:175], v2 offset:11264
  v_mfma_f32_16x16x32_bf16 v[68:71], a[16:19], v[160:163], v[68:71]
  ds_read_b128 a[176:179], v2 offset:12288
  v_mfma_f32_16x16x32_bf16 v[72:75], a[20:23], v[160:163], v[72:75]
  ds_read_b128 a[180:183], v2 offset:13312
  v_mov_b32 v4, s82
  s_cmp_lg_u32 s32, 0
  s_cbranch_scc1 Lp0_22
  global_load_dword v31, v4, s[90:91] sc1
  s_branch Lp1_23
Lp0_22:
  v_mov_b32 v4, 0
  global_load_dword v31, v4, s[8:9]
Lp1_23:
  v_mfma_f32_16x16x32_bf16 v[76:79], a[24:27], v[160:163], v[76:79]
  ds_read_b128 a[184:187], v2 offset:14336
  v_mfma_f32_16x16x32_bf16 v[80:83], a[28:31], v[160:163], v[80:83]
  ds_read_b128 a[188:191], v2 offset:15360
  buffer_load_dwordx4 v[160:163], v26, s[40:43], s80 offen sc1
  s_add_u32 s80, s80, 16384
  s_waitcnt vmcnt(12)
  s_nop 0
  v_mfma_f32_16x16x32_bf16 v[84:87], a[32:35], v[180:183], v[84:87]
  ds_read_b128 a[192:195], v2 offset:16384
  v_mfma_f32_16x16x32_bf16 v[88:91], a[36:39], v[180:183], v[88:91]
  ds_read_b128 a[196:199], v2 offset:17408
  v_mfma_f32_16x16x32_bf16 v[92:95], a[40:43], v[180:183], v[92:95]
  ds_read_b128 a[200:203], v2 offset:18432
  v_mfma_f32_16x16x32_bf16 v[96:99], a[44:47], v[180:183], v[96:99]
  ds_read_b128 a[204:207], v2 offset:19456
  v_mfma_f32_16x16x32_bf16 v[100:103], a[96:99], v[180:183], v[100:103]
  ds_read_b128 a[208:211], v2 offset:20480
  s_waitcnt vmcnt(8)
  s_nop 0
  v_mfma_f32_16x16x32_bf16 v[84:87], a[100:103], v[148:151], v[84:87]
  ds_read_b128 a[212:215], v2 offset:21504
  v_mfma_f32_16x16x32_bf16 v[88:91], a[104:107], v[148:151], v[88:91]
  ds_read_b128 a[216:219], v2 offset:22528
  v_mfma_f32_16x16x32_bf16 v[92:95], v[32:35], v[148:151], v[92:95]
  ds_read_b128 a[220:223], v2 offset:23552
  v_mfma_f32_16x16x32_bf16 v[96:99], v[36:39], v[148:151], v[96:99]
  ds_read_b128 a[224:227], v2 offset:24576
  v_mfma_f32_16x16x32_bf16 v[100:103], v[40:43], v[148:151], v[100:103]
  ds_read_b128 a[228:231], v2 offset:25600
  s_waitcnt vmcnt(4)
  s_nop 0
  v_mfma_f32_16x16x32_bf16 v[84:87], v[44:47], v[164:167], v[84:87]
  ds_read_b128 a[232:235], v2 offset:26624
  v_mfma_f32_16x16x32_bf16 v[88:91], v[48:51], v[164:167], v[88:91]
  ds_read_b128 a[236:239], v2 offset:27648
  v_mfma_f32_16x16x32_bf16 v[92:95], v[52:55], v[164:167], v[92:95]
  ds_read_b128 a[240:243], v2 offset:28672
  v_mfma_f32_16x16x32_bf16 v[96:99], v[56:59], v[164:167], v[96:99]
  ds_read_b128 a[244:247], v2 offset:29696
  v_mfma_f32_16x16x32_bf16 v[100:103], v[60:63], v[164:167], v[100:103]
  ds_read_b128 a[248:251], v2 offset:30720
  v_mfma_f32_16x16x32_bf16 v[104:107], a[32:35], v[184:187], v[104:107]
  ds_read_b128 a[252:255], v2 offset:31744
  v_mfma_f32_16x16x32_bf16 v[108:111], a[36:39], v[184:187], v[108:111]
  ds_read_b128 a[48:51], v2 offset:32768
  v_mfma_f32_16x16x32_bf16 v[112:115], a[40:43], v[184:187], v[112:115]
  ds_read_b128 a[52:55], v2 offset:33792
  s_waitcnt vmcnt(1)
  s_cmp_lg_u32 s32, 0
  s_cbranch_scc1 Lpd_25
  v_cmp_gt_u32 vcc, 16, v31
  s_mov_b32 s95, 0x8000
  s_cmp_eq_u64 vcc, 0
  s_cbranch_scc1 Lpd_25
Lpoll_24:
  s_sleep 2
  global_load_dword v31, v4, s[90:91] sc1
  s_waitcnt vmcnt(0)
  v_cmp_gt_u32 vcc, 16, v31
  s_sub_u32 s95, s95, 1
  s_cmp_eq_u64 vcc, 0
  s_cbranch_scc1 Lpd_25
  s_cmp_lg_u32 s95, 0
  s_cbranch_scc1 Lpoll_24
Lpd_25:
  s_barrier
  s_nop 0
  buffer_load_dword v5, v6, s[48:51], s74 offen sc1
  buffer_load_dwordx4 v[192:195], v26, s[40:43], s73 offen sc1
  s_add_u32 s73, s73, 4096
  buffer_load_dwordx4 v[196:199], v26, s[40:43], s73 offen sc1
  s_add_u32 s73, s73, 4096
  buffer_load_dwordx4 v[200:203], v26, s[40:43], s73 offen sc1
  s_add_u32 s73, s73, 4096
  buffer_load_dwordx4 v[204:207], v26, s[40:43], s73 offen sc1
  s_add_u32 s73, s73, 4096
  buffer_load_dwordx4 v[208:211], v26, s[40:43], s73 offen sc1
  s_add_u32 s73, s73, 4096
  buffer_load_dwordx4 v[212:215], v26, s[40:43], s73 offen sc1
  v_mfma_f32_16x16x32_bf16 v[116:119], a[44:47], v[184:187], v[116:119]
  ds_write_b128 v11, v[84:87] offset:0
  s_add_u32 s73, s73, 4096
  buffer_load_dwordx4 v[216:219], v26, s[40:43], s73 offen sc1
  v_mfma_f32_16x16x32_bf16 v[120:123], a[96:99], v[184:187], v[120:123]
  ds_write_b128 v11, v[88:91] offset:1024
  v_mfma_f32_16x16x32_bf16 v[104:107], a[100:103], v[152:155], v[104:107]
  ds_write_b128 v11, v[92:95] offset:2048
  v_mfma_f32_16x16x32_bf16 v[108:111], a[104:107], v[152:155], v[108:111]
  ds_write_b128 v11, v[96:99] offset:3072
  s_add_u32 s73, s73, 4096
  buffer_load_dwordx4 v[220:223], v26, s[40:43], s73 offen sc1
  v_mfma_f32_16x16x32_bf16 v[112:115], v[32:35], v[152:155], v[112:115]
  ds_write_b128 v11, v[100:103] offset:4096
  v_mfma_f32_16x16x32_bf16 v[116:119], v[36:39], v[152:155], v[116:119]
  ds_read_b128 a[56:59], v2 offset:34816
  s_add_u32 s73, s73, 4096
  buffer_load_dwordx4 v[224:227], v26, s[40:43], s73 offen sc1
  v_mfma_f32_16x16x32_bf16 v[120:123], v[40:43], v[152:155], v[120:123]
  ds_read_b128 a[60:63], v2 offset:35840
  v_mfma_f32_16x16x32_bf16 v[104:107], v[44:47], v[168:171], v[104:107]
  ds_read_b128 a[64:67], v2 offset:36864
  v_mfma_f32_16x16x32_bf16 v[108:111], v[48:51], v[168:171], v[108:111]
  ds_read_b128 a[68:71], v2 offset:37888
  s_add_u32 s73, s73, 4096
  buffer_load_dwordx4 v[228:231], v26, s[40:43], s73 offen sc1
  v_mfma_f32_16x16x32_bf16 v[112:115], v[52:55], v[168:171], v[112:115]
  ds_read_b128 a[72:75], v2 offset:38912
  v_mfma_f32_16x16x32_bf16 v[116:119], v[56:59], v[168:171], v[116:119]
  ds_read_b128 a[76:79], v2 offset:39936
  s_add_u32 s73, s73, 4096
  buffer_load_dwordx4 v[232:235], v26, s[40:43], s73 offen sc1
  v_mfma_f32_16x16x32_bf16 v[120:123], v[60:63], v[168:171], v[120:123]
  ds_read_b128 a[80:83], v2 offset:40960
  v_mfma_f32_16x16x32_bf16 v[124:127], a[32:35], v[188:191], v[124:127]
  ds_read_b128 a[84:87], v2 offset:41984
  v_mfma_f32_16x16x32_bf16 v[128:131], a[36:39], v[188:191], v[128:131]
  ds_read_b128 a[88:91], v2 offset:43008
  s_add_u32 s73, s73, 4096
  buffer_load_dwordx4 v[236:239], v26, s[40:43], s73 offen sc1
  v_mfma_f32_16x16x32_bf16 v[132:135], a[40:43], v[188:191], v[132:135]
  ds_read_b128 a[92:95], v2 offset:44032
  v_mfma_f32_16x16x32_bf16 v[136:139], a[44:47], v[188:191], v[136:139]
  ds_write_b128 v12, v[104:107] offset:0
  s_add_u32 s73, s73, 4096
  buffer_load_dwordx4 v[240:243], v26, s[40:43], s73 offen sc1
  v_mfma_f32_16x16x32_bf16 v[140:143], a[96:99], v[188:191], v[140:143]
  ds_write_b128 v12, v[108:111] offset:1024
  v_mfma_f32_16x16x32_bf16 v[124:127], a[100:103], v[156:159], v[124:127]
  ds_write_b128 v12, v[112:115] offset:2048
  v_mfma_f32_16x16x32_bf16 v[128:131], a[104:107], v[156:159], v[128:131]
  ds_write_b128 v12, v[116:119] offset:3072
  s_add_u32 s73, s73, 4096
  buffer_load_dwordx4 v[244:247], v26, s[40:43], s73 offen sc1
  v_mfma_f32_16x16x32_bf16 v[132:135], v[32:35], v[156:159], v[132:135]
  ds_write_b128 v12, v[120:123] offset:4096
  v_mfma_f32_16x16x32_bf16 v[136:139], v[36:39], v[156:159], v[136:139]
  ds_read_b128 a[108:111], v2 offset:45056
  s_add_u32 s73, s73, 4096
  buffer_load_dwordx4 v[248:251], v26, s[40:43], s73 offen sc1
  v_mfma_f32_16x16x32_bf16 v[140:143], v[40:43], v[156:159], v[140:143]
  ds_read_b128 a[112:115], v2 offset:46080
  v_mfma_f32_16x16x32_bf16 v[124:127], v[44:47], v[172:175], v[124:127]
  ds_read_b128 a[116:119], v2 offset:47104
  v_mfma_f32_16x16x32_bf16 v[128:131], v[48:51], v[172:175], v[128:131]
  ds_read_b128 a[0:3], v2 offset:48128
  s_add_u32 s73, s73, 4096
  buffer_load_dwordx4 v[252:255], v26, s[40:43], s73 offen sc1
  v_mfma_f32_16x16x32_bf16 v[132:135], v[52:55], v[172:175], v[132:135]
  ds_read_b128 a[4:7], v2 offset:49152
  v_mfma_f32_16x16x32_bf16 v[136:139], v[56:59], v[172:175], v[136:139]
  ds_read_b128 a[8:11], v2 offset:50176
  v_mfma_f32_16x16x32_bf16 v[140:143], v[60:63], v[172:175], v[140:143]
  ds_read_b128 a[12:15], v9 offset:0
  v_mfma_f32_16x16x32_bf16 v[64:67], a[32:35], v[176:179], v[64:67]
  ds_read_b128 a[16:19], v9 offset:1024
  v_mfma_f32_16x16x32_bf16 v[68:71], a[36:39], v[176:179], v[68:71]
  ds_read_b128 a[20:23], v9 offset:2048
  v_mfma_f32_16x16x32_bf16 v[72:75], a[40:43], v[176:179], v[72:75]
  ds_read_b128 a[24:27], v9 offset:3072
  v_mfma_f32_16x16x32_bf16 v[76:79], a[44:47], v[176:179], v[76:79]
  ds_write_b128 v13, v[124:127] offset:0
  v_mfma_f32_16x16x32_bf16 v[80:83], a[96:99], v[176:179], v[80:83]
  ds_write_b128 v13, v[128:131] offset:1024
  v_mfma_f32_16x16x32_bf16 v[64:67], a[100:103], v[144:147], v[64:67]
  ds_write_b128 v13, v[132:135] offset:2048
  v_mfma_f32_16x16x32_bf16 v[68:71], a[104:107], v[144:147], v[68:71]
  ds_write_b128 v13, v[136:139] offset:3072
  v_mfma_f32_16x16x32_bf16 v[72:75], v[32:35], v[144:147], v[72:75]
  ds_write_b128 v13, v[140:143] offset:4096
  v_mfma_f32_16x16x32_bf16 v[76:79], v[36:39], v[144:147], v[76:79]
  ds_read_b128 a[28:31], v9 offset:4096
  v_mfma_f32_16x16x32_bf16 v[80:83], v[40:43], v[144:147], v[80:83]
  s_waitcnt vmcnt(17)
  s_nop 0
  v_mfma_f32_16x16x32_bf16 v[64:67], v[44:47], v[160:163], v[64:67]
  v_mfma_f32_16x16x32_bf16 v[68:71], v[48:51], v[160:163], v[68:71]
  v_mfma_f32_16x16x32_bf16 v[72:75], v[52:55], v[160:163], v[72:75]
  v_mfma_f32_16x16x32_bf16 v[76:79], v[56:59], v[160:163], v[76:79]
  v_mfma_f32_16x16x32_bf16 v[80:83], v[60:63], v[160:163], v[80:83]
  s_add_u32 s73, s73, 4096
  buffer_load_dwordx4 v[148:151], v26, s[40:43], s73 offen sc1
  s_add_u32 s73, s73, 4096
  buffer_load_dwordx4 v[164:167], v26, s[40:43], s73 offen sc1
  s_add_u32 s73, s73, 4096
  buffer_load_dwordx4 v[180:183], v26, s[40:43], s73 offen sc1
  s_add_u32 s73, s73, 4096
  buffer_load_dwordx4 v[152:155], v26, s[40:43], s73 offen sc1
  s_waitcnt vmcnt(20)
  v_sub_f32 v10, 1.0, v5
  v_pk_mul_f32 v[64:65], v[64:65], v[10:11] op_sel_hi:[1,0]
  v_pk_mul_f32 v[66:67], v[66:67], v[10:11] op_sel_hi:[1,0]
  v_pk_mul_f32 v[68:69], v[68:69], v[10:11] op_sel_hi:[1,0]
  v_pk_mul_f32 v[70:71], v[70:71], v[10:11] op_sel_hi:[1,0]
  v_pk_mul_f32 v[72:73], v[72:73], v[10:11] op_sel_hi:[1,0]
  v_pk_mul_f32 v[74:75], v[74:75], v[10:11] op_sel_hi:[1,0]
  v_pk_mul_f32 v[76:77], v[76:77], v[10:11] op_sel_hi:[1,0]
  v_pk_mul_f32 v[78:79], v[78:79], v[10:11] op_sel_hi:[1,0]
  v_pk_mul_f32 v[80:81], v[80:81], v[10:11] op_sel_hi:[1,0]
  v_pk_mul_f32 v[82:83], v[82:83], v[10:11] op_sel_hi:[1,0]
  s_waitcnt lgkmcnt(1)
  s_barrier
  s_waitcnt vmcnt(19)
  s_nop 0
  v_mfma_f32_16x16x32_bf16 v[64:67], a[128:131], v[192:195], v[64:67]
  ds_read_b128 a[32:35], v9 offset:5120
  v_mfma_f32_16x16x32_bf16 v[68:71], a[132:135], v[192:195], v[68:71]
  ds_read_b128 a[36:39], v9 offset:6144
  v_mfma_f32_16x16x32_bf16 v[72:75], a[136:139], v[192:195], v[72:75]
  ds_read_b128 a[40:43], v9 offset:7168
  v_mfma_f32_16x16x32_bf16 v[76:79], a[140:143], v[192:195], v[76:79]
  ds_read_b128 a[44:47], v9 offset:8192
  v_mfma_f32_16x16x32_bf16 v[80:83], a[144:147], v[192:195], v[80:83]
  ds_read_b128 a[96:99], v9 offset:9216
  s_waitcnt vmcnt(18)
  s_nop 0
  v_mfma_f32_16x16x32_bf16 v[64:67], a[148:151], v[196:199], v[64:67]
  ds_read_b128 a[100:103], v9 offset:10240
  v_mfma_f32_16x16x32_bf16 v[68:71], a[152:155], v[196:199], v[68:71]
  ds_read_b128 a[104:107], v9 offset:11264
  v_mfma_f32_16x16x32_bf16 v[72:75], a[156:159], v[196:199], v[72:75]
  ds_read_b128 v[32:35], v9 offset:12288
  v_mfma_f32_16x16x32_bf16 v[76:79], a[160:163], v[196:199], v[76:79]
  ds_read_b128 v[36:39], v9 offset:13312
  v_mfma_f32_16x16x32_bf16 v[80:83], a[164:167], v[196:199], v[80:83]
  ds_read_b128 v[40:43], v9 offset:14336
  s_waitcnt vmcnt(17)
  s_nop 0
  v_mfma_f32_16x16x32_bf16 v[64:67], a[168:171], v[200:203], v[64:67]
  ds_read_b128 v[44:47], v9 offset:15360
  v_mfma_f32_16x16x32_bf16 v[68:71], a[172:175], v[200:203], v[68:71]
  ds_read_b128 v[48:51], v9 offset:16384
  v_mfma_f32_16x16x32_bf16 v[72:75], a[176:179], v[200:203], v[72:75]
  ds_read_b128 v[52:55], v9 offset:17408
  v_mfma_f32_16x16x32_bf16 v[76:79], a[180:183], v[200:203], v[76:79]
  ds_read_b128 v[56:59], v9 offset:18432
  v_mfma_f32_16x16x32_bf16 v[80:83], a[184:187], v[200:203], v[80:83]
  ds_read_b128 v[60:63], v9 offset:19456
  s_waitcnt vmcnt(16)
  s_nop 0
  v_mfma_f32_16x16x32_bf16 v[64:67], a[188:191], v[204:207], v[64:67]
  ds_read_b128 a[128:131], v9 offset:20480
  v_mfma_f32_16x16x32_bf16 v[68:71], a[192:195], v[204:207], v[68:71]
  ds_read_b128 a[132:135], v9 offset:21504
  v_mfma_f32_16x16x32_bf16 v[72:75], a[196:199], v[204:207], v[72:75]
  ds_read_b128 a[136:139], v9 offset:22528
  v_mfma_f32_16x16x32_bf16 v[76:79], a[200:203], v[204:207], v[76:79]
  ds_read_b128 a[140:143], v9 offset:23552
  v_mfma_f32_16x16x32_bf16 v[80:83], a[204:207], v[204:207], v[80:83]
  ds_read_b128 a[144:147], v9 offset:24576
  s_waitcnt vmcnt(15)
  s_nop 0
  v_mfma_f32_16x16x32_bf16 v[64:67], a[208:211], v[208:211], v[64:67]
  ds_read_b128 a[148:151], v9 offset:25600
  v_mfma_f32_16x16x32_bf16 v[68:71], a[212:215], v[208:211], v[68:71]
  ds_read_b128 a[152:155], v9 offset:26624
  v_mfma_f32_16x16x32_bf16 v[72:75], a[216:219], v[208:211], v[72:75]
  ds_read_b128 a[156:159], v9 offset:27648
  v_mfma_f32_16x16x32_bf16 v[76:79], a[220:223], v[208:211], v[76:79]
  ds_read_b128 a[160:163], v9 offset:28672
  v_mfma_f32_16x16x32_bf16 v[80:83], a[224:227], v[208:211], v[80:83]
  ds_read_b128 a[164:167], v9 offset:29696
  s_waitcnt vmcnt(14)
  s_nop 0
  v_mfma_f32_16x16x32_bf16 v[64:67], a[228:231], v[212:215], v[64:67]
  ds_read_b128 a[168:171], v9 offset:30720
  v_mfma_f32_16x16x32_bf16 v[68:71], a[232:235], v[212:215], v[68:71]
  ds_read_b128 a[172:175], v9 offset:31744
  v_mfma_f32_16x16x32_bf16 v[72:75], a[236:239], v[212:215], v[72:75]
  ds_read_b128 a[176:179], v9 offset:32768
  v_mfma_f32_16x16x32_bf16 v[76:79], a[240:243], v[212:215], v[76:79]
  ds_read_b128 a[180:183], v9 offset:33792
  v_mfma_f32_16x16x32_bf16 v[80:83], a[244:247], v[212:215], v[80:83]
  ds_read_b128 a[184:187], v9 offset:34816
  s_waitcnt vmcnt(13)
  s_nop 0
  v_mfma_f32_16x16x32_bf16 v[64:67], a[248:251], v[216:219], v[64:67]
  ds_read_b128 a[188:191], v9 offset:35840
  v_mfma_f32_16x16x32_bf16 v[68:71], a[252:255], v[216:219], v[68:71]
  ds_read_b128 a[192:195], v9 offset:36864
  v_mfma_f32_16x16x32_bf16 v[72:75], a[48:51], v[216:219], v[72:75]
  ds_read_b128 a[196:199], v9 offset:37888
  v_mfma_f32_16x16x32_bf16 v[76:79], a[52:55], v[216:219], v[76:79]
  ds_read_b128 a[200:203], v9 offset:38912
  v_mfma_f32_16x16x32_bf16 v[80:83], a[56:59], v[216:219], v[80:83]
  ds_read_b128 a[204:207], v9 offset:39936
  s_waitcnt vmcnt(12)
  s_nop 0
  v_mfma_f32_16x16x32_bf16 v[64:67], a[60:63], v[220:223], v[64:67]
  ds_read_b128 a[208:211], v9 offset:40960
  v_mfma_f32_16x16x32_bf16 v[68:71], a[64:67], v[220:223], v[68:71]
  ds_read_b128 a[212:215], v9 offset:41984
  v_mfma_f32_16x16x32_bf16 v[72:75], a[68:71], v[220:223], v[72:75]
  ds_read_b128 a[216:219], v9 offset:43008
  v_mfma_f32_16x16x32_bf16 v[76:79], a[72:75], v[220:223], v[76:79]
  ds_read_b128 a[220:223], v9 offset:44032
  v_mfma_f32_16x16x32_bf16 v[80:83], a[76:79], v[220:223], v[80:83]
  ds_read_b128 a[224:227], v9 offset:45056
  s_waitcnt vmcnt(11)
  s_nop 0
  v_mfma_f32_16x16x32_bf16 v[64:67], a[80:83], v[224:227], v[64:67]
  ds_read_b128 a[228:231], v9 offset:46080
  v_mfma_f32_16x16x32_bf16 v[68:71], a[84:87], v[224:227], v[68:71]
  ds_read_b128 a[232:235], v9 offset:47104
  v_mfma_f32_16x16x32_bf16 v[72:75], a[88:91], v[224:227], v[72:75]
  ds_read_b128 a[236:239], v9 offset:48128
  v_mfma_f32_16x16x32_bf16 v[76:79], a[92:95], v[224:227], v[76:79]
  ds_read_b128 a[240:243], v9 offset:49152
  v_mfma_f32_16x16x32_bf16 v[80:83], a[108:111], v[224:227], v[80:83]
  ds_read_b128 a[244:247], v9 offset:50176
  s_waitcnt vmcnt(10)
  s_nop 0
  v_mfma_f32_16x16x32_bf16 v[64:67], a[112:115], v[228:231], v[64:67]
  ds_read_b128 v[84:87], v8 offset:0
  v_mfma_f32_16x16x32_bf16 v[68:71], a[116:119], v[228:231], v[68:71]
  ds_read_b128 v[88:91], v8 offset:1024
  v_mfma_f32_16x16x32_bf16 v[72:75], a[0:3], v[228:231], v[72:75]
  ds_read_b128 v[92:95], v8 offset:2048
  v_mfma_f32_16x16x32_bf16 v[76:79], a[4:7], v[228:231], v[76:79]
  ds_read_b128 v[96:99], v8 offset:3072
  v_mfma_f32_16x16x32_bf16 v[80:83], a[8:11], v[228:231], v[80:83]
  ds_read_b128 v[100:103], v8 offset:4096
  s_waitcnt vmcnt(9) lgkmcnt(14)
  s_nop 0
  v_mfma_f32_16x16x32_bf16 v[64:67], a[12:15], v[232:235], v[64:67]
  ds_read_b128 v[104:107], v8 offset:5120
  v_mfma_f32_16x16x32_bf16 v[68:71], a[16:19], v[232:235], v[68:71]
  ds_read_b128 v[108:111], v8 offset:6144
  v_mfma_f32_16x16x32_bf16 v[72:75], a[20:23], v[232:235], v[72:75]
  ds_read_b128 v[112:115], v8 offset:7168
  v_mfma_f32_16x16x32_bf16 v[76:79], a[24:27], v[232:235], v[76:79]
  ds_read_b128 v[116:119], v8 offset:8192
  v_mfma_f32_16x16x32_bf16 v[80:83], a[28:31], v[232:235], v[80:83]
  ds_read_b128 v[120:123], v8 offset:9216
  s_waitcnt vmcnt(8)
  s_nop 0
  v_mfma_f32_16x16x32_bf16 v[64:67], a[32:35], v[236:239], v[64:67]
  ds_read_b128 v[124:127], v8 offset:10240
  v_mfma_f32_16x16x32_bf16 v[68:71], a[36:39], v[236:239], v[68:71]
  ds_read_b128 v[128:131], v8 offset:11264
  v_mfma_f32_16x16x32_bf16 v[72:75], a[40:43], v[236:239], v[72:75]
  ds_read_b128 v[132:135], v8 offset:12288
  v_mfma_f32_16x16x32_bf16 v[76:79], a[44:47], v[236:239], v[76:79]
  ds_read_b128 v[136:139], v8 offset:13312
  v_mfma_f32_16x16x32_bf16 v[80:83], a[96:99], v[236:239], v[80:83]
  ds_read_b128 v[140:143], v8 offset:14336
  s_waitcnt vmcnt(7)
  v_mfma_f32_16x16x32_bf16 v[64:67], a[100:103], v[240:243], v[64:67]
  v_mfma_f32_16x16x32_bf16 v[68:71], a[104:107], v[240:243], v[68:71]
  v_mfma_f32_16x16x32_bf16 v[72:75], v[32:35], v[240:243], v[72:75]
  v_mfma_f32_16x16x32_bf16 v[76:79], v[36:39], v[240:243], v[76:79]
  v_mfma_f32_16x16x32_bf16 v[80:83], v[40:43], v[240:243], v[80:83]
  s_waitcnt vmcnt(6)
  v_mfma_f32_16x16x32_bf16 v[64:67], v[44:47], v[244:247], v[64:67]
  v_mfma_f32_16x16x32_bf16 v[68:71], v[48:51], v[244:247], v[68:71]
  v_mfma_f32_16x16x32_bf16 v[72:75], v[52:55], v[244:247], v[72:75]
  v_mfma_f32_16x16x32_bf16 v[76:79], v[56:59], v[244:247], v[76:79]
  v_mfma_f32_16x16x32_bf16 v[80:83], v[60:63], v[244:247], v[80:83]
  s_waitcnt vmcnt(5)
  v_mfma_f32_16x16x32_bf16 v[64:67], a[128:131], v[248:251], v[64:67]
  v_mfma_f32_16x16x32_bf16 v[68:71], a[132:135], v[248:251], v[68:71]
  v_mfma_f32_16x16x32_bf16 v[72:75], a[136:139], v[248:251], v[72:75]
  v_mfma_f32_16x16x32_bf16 v[76:79], a[140:143], v[248:251], v[76:79]
  v_mfma_f32_16x16x32_bf16 v[80:83], a[144:147], v[248:251], v[80:83]
  s_waitcnt vmcnt(4)
  v_mfma_f32_16x16x32_bf16 v[64:67], a[148:151], v[252:255], v[64:67]
  v_mfma_f32_16x16x32_bf16 v[68:71], a[152:155], v[252:255], v[68:71]
  v_mfma_f32_16x16x32_bf16 v[72:75], a[156:159], v[252:255], v[72:75]
  v_mfma_f32_16x16x32_bf16 v[76:79], a[160:163], v[252:255], v[76:79]
  v_mfma_f32_16x16x32_bf16 v[80:83], a[164:167], v[252:255], v[80:83]
  s_waitcnt vmcnt(3)
  v_mfma_f32_16x16x32_bf16 v[64:67], a[168:171], v[148:151], v[64:67]
  v_mfma_f32_16x16x32_bf16 v[68:71], a[172:175], v[148:151], v[68:71]
  v_mfma_f32_16x16x32_bf16 v[72:75], a[176:179], v[148:151], v[72:75]
  v_mfma_f32_16x16x32_bf16 v[76:79], a[180:183], v[148:151], v[76:79]
  v_mfma_f32_16x16x32_bf16 v[80:83], a[184:187], v[148:151], v[80:83]
  s_waitcnt vmcnt(2)
  v_mfma_f32_16x16x32_bf16 v[64:67], a[188:191], v[164:167], v[64:67]
  v_mfma_f32_16x16x32_bf16 v[68:71], a[192:195], v[164:167], v[68:71]
  v_mfma_f32_16x16x32_bf16 v[72:75], a[196:199], v[164:167], v[72:75]
  v_mfma_f32_16x16x32_bf16 v[76:79], a[200:203], v[164:167], v[76:79]
  v_mfma_f32_16x16x32_bf16 v[80:83], a[204:207], v[164:167], v[80:83]
  s_waitcnt vmcnt(1) lgkmcnt(14)
  v_mfma_f32_16x16x32_bf16 v[64:67], a[208:211], v[180:183], v[64:67]
  v_mfma_f32_16x16x32_bf16 v[68:71], a[212:215], v[180:183], v[68:71]
  v_mfma_f32_16x16x32_bf16 v[72:75], a[216:219], v[180:183], v[72:75]
  v_mfma_f32_16x16x32_bf16 v[76:79], a[220:223], v[180:183], v[76:79]
  v_mfma_f32_16x16x32_bf16 v[80:83], a[224:227], v[180:183], v[80:83]
  s_waitcnt vmcnt(0)
  v_mfma_f32_16x16x32_bf16 v[64:67], a[228:231], v[152:155], v[64:67]
  v_mfma_f32_16x16x32_bf16 v[68:71], a[232:235], v[152:155], v[68:71]
  v_mfma_f32_16x16x32_bf16 v[72:75], a[236:239], v[152:155], v[72:75]
  v_mfma_f32_16x16x32_bf16 v[76:79], a[240:243], v[152:155], v[76:79]
  v_mfma_f32_16x16x32_bf16 v[80:83], a[244:247], v[152:155], v[80:83]
  s_waitcnt lgkmcnt(0)
  s_nop 0
  v_pk_add_f32 v[84:85], v[84:85], v[104:105]
  v_pk_add_f32 v[86:87], v[86:87], v[106:107]
  v_pk_add_f32 v[88:89], v[88:89], v[108:109]
  v_pk_add_f32 v[90:91], v[90:91], v[110:111]
  v_pk_add_f32 v[92:93], v[92:93], v[112:113]
  v_pk_add_f32 v[94:95], v[94:95], v[114:115]
  v_pk_add_f32 v[96:97], v[96:97], v[116:117]
  v_pk_add_f32 v[98:99], v[98:99], v[118:119]
  v_pk_add_f32 v[100:101], v[100:101], v[120:121]
  v_pk_add_f32 v[102:103], v[102:103], v[122:123]
  v_pk_add_f32 v[84:85], v[84:85], v[124:125]
  v_pk_add_f32 v[86:87], v[86:87], v[126:127]
  v_pk_add_f32 v[88:89], v[88:89], v[128:129]
  v_pk_add_f32 v[90:91], v[90:91], v[130:131]
  v_pk_add_f32 v[92:93], v[92:93], v[132:133]
  v_pk_add_f32 v[94:95], v[94:95], v[134:135]
  v_pk_add_f32 v[96:97], v[96:97], v[136:137]
  v_pk_add_f32 v[98:99], v[98:99], v[138:139]
  v_pk_add_f32 v[100:101], v[100:101], v[140:141]
  v_pk_add_f32 v[102:103], v[102:103], v[142:143]
  v_pk_fma_f32 v[64:65], v[84:85], v[10:11], v[64:65] op_sel_hi:[1,0,1]
  v_pk_fma_f32 v[66:67], v[86:87], v[10:11], v[66:67] op_sel_hi:[1,0,1]
  v_cvt_pk_bf16_f32 v104, v64, v65
  v_cvt_pk_bf16_f32 v105, v66, v67
  ds_write_b64 v17, v[104:105] offset:0
  v_pk_fma_f32 v[68:69], v[88:89], v[10:11], v[68:69] op_sel_hi:[1,0,1]
  v_pk_fma_f32 v[70:71], v[90:91], v[10:11], v[70:71] op_sel_hi:[1,0,1]
  v_cvt_pk_bf16_f32 v106, v68, v69
  v_cvt_pk_bf16_f32 v107, v70, v71
  ds_write_b64 v17, v[106:107] offset:32
  v_pk_fma_f32 v[72:73], v[92:93], v[10:11], v[72:73] op_sel_hi:[1,0,1]
  v_pk_fma_f32 v[74:75], v[94:95], v[10:11], v[74:75] op_sel_hi:[1,0,1]
  v_cvt_pk_bf16_f32 v108, v72, v73
  v_cvt_pk_bf16_f32 v109, v74, v75
  ds_write_b64 v17, v[108:109] offset:64
  v_pk_fma_f32 v[76:77], v[96:97], v[10:11], v[76:77] op_sel_hi:[1,0,1]
  v_pk_fma_f32 v[78:79], v[98:99], v[10:11], v[78:79] op_sel_hi:[1,0,1]
  v_cvt_pk_bf16_f32 v110, v76, v77
  v_cvt_pk_bf16_f32 v111, v78, v79
  ds_write_b64 v17, v[110:111] offset:96
  v_pk_fma_f32 v[80:81], v[100:101], v[10:11], v[80:81] op_sel_hi:[1,0,1]
  v_pk_fma_f32 v[82:83], v[102:103], v[10:11], v[82:83] op_sel_hi:[1,0,1]
  v_cvt_pk_bf16_f32 v112, v80, v81
  v_cvt_pk_bf16_f32 v113, v82, v83
  ds_write_b64 v17, v[112:113] offset:128
  ds_read_b128 v[64:67], v18
  ds_read_b128 v[68:71], v19
  ds_read_b128 v[72:75], v20
  s_waitcnt lgkmcnt(2)
  buffer_store_dwordx4 v[64:67], v21, s[52:55], s81 offen sc1
  s_waitcnt lgkmcnt(1)
  buffer_store_dwordx4 v[68:71], v22, s[52:55], s81 offen sc1
  s_waitcnt lgkmcnt(0)
  buffer_store_dwordx4 v[72:75], v23, s[52:55], s81 offen sc1
  s_endpgm
L_f1:
  v_and_b32 v24, 15, v0
  v_lshrrev_b32 v25, 4, v0
  s_mul_i32 s64, s37, 303104
  s_add_u32 s40, s30, s64
  s_addc_u32 s41, s31, 0
  s_and_b32 s41, s41, 0xffff
  s_mov_b32 s42, 0x4a000
  s_mov_b32 s43, 0x20000
  s_add_u32 s80, s32, 20
  s_lshl_b32 s80, s80, 12
  s_add_u32 s75, s32, 0
  s_and_b32 s75, s75, 3
  s_lshl_b32 s75, s75, 10
  v_add_u32 v26, s75, v2
  s_add_u32 s75, s32, 1
  s_and_b32 s75, s75, 3
  s_lshl_b32 s75, s75, 10
  v_add_u32 v27, s75, v2
  s_add_u32 s75, s32, 2
  s_and_b32 s75, s75, 3
  s_lshl_b32 s75, s75, 10
  v_add_u32 v28, s75, v2
  s_add_u32 s75, s32, 3
  s_and_b32 s75, s75, 3
  s_lshl_b32 s75, s75, 10
  v_add_u32 v29, s75, v2
  s_add_u32 s48, s30, 0x1200000
  s_addc_u32 s49, s31, 0
  s_and_b32 s49, s49, 0xffff
  s_mov_b32 s50, 0x2000
  s_mov_b32 s51, 0x20000
  v_lshlrev_b32 v6, 2, v24
  s_waitcnt vmcnt(0)
  s_barrier
  s_cmp_lg_u32 s32, 0
  s_cbranch_scc1 Lsg_26
  v_mov_b32 v14, s69
  v_mov_b32 v15, 1
  s_mov_b64 exec, 1
  global_atomic_add v14, v15, s[90:91] sc1
  s_mov_b64 exec, -1
Lsg_26:
  buffer_load_dwordx4 a[116:119], v2, s[84:87], s88 offen offset:1024 sc1
  buffer_load_dwordx4 a[0:3], v2, s[84:87], s88 offen offset:2048 sc1
  buffer_load_dwordx4 a[4:7], v2, s[84:87], s88 offen offset:3072 sc1
  buffer_load_dwordx4 a[8:11], v3, s[84:87], s88 offen sc1
  s_add_u32 s88, s89, 307200
  buffer_load_dwordx4 a[12:15], v2, s[84:87], s88 offen offset:0 sc1
  buffer_load_dwordx4 a[16:19], v2, s[84:87], s88 offen offset:1024 sc1
  buffer_load_dwordx4 a[20:23], v2, s[84:87], s88 offen offset:2048 sc1
  buffer_load_dwordx4 a[24:27], v2, s[84:87], s88 offen offset:3072 sc1
  buffer_load_dwordx4 a[28:31], v3, s[84:87], s88 offen sc1
  s_add_u32 s88, s89, 327680
  buffer_load_dwordx4 a[32:35], v2, s[84:87], s88 offen offset:0 sc1
  buffer_load_dwordx4 a[36:39], v2, s[84:87], s88 offen offset:1024 sc1
  buffer_load_dwordx4 a[40:43], v2, s[84:87], s88 offen offset:2048 sc1
  buffer_load_dwordx4 a[44:47], v2, s[84:87], s88 offen offset:3072 sc1
  buffer_load_dwordx4 a[96:99], v3, s[84:87], s88 offen sc1
  s_add_u32 s88, s89, 348160
  buffer_load_dwordx4 a[100:103], v2, s[84:87], s88 offen offset:0 sc1
  buffer_load_dwordx4 a[104:107], v2, s[84:87], s88 offen offset:1024 sc1
  s_lshr_b32 s82, s37, 1
  s_mul_i32 s82, s82, 4352
  v_mov_b32 v4, s82
  s_cmp_lg_u32 s32, 0
  s_cbranch_scc1 Lp0_27
  global_load_dword v31, v4, s[90:91] sc1
  s_branch Lp1_28
Lp0_27:
  v_mov_b32 v4, 0
  global_load_dword v31, v4, s[8:9]
Lp1_28:
  s_add_u32 s100, s89, 61440
  s_add_u32 m0, s89, 61440
  s_nop 0
  buffer_load_dwordx4 v2, s[84:87], s100 offen offset:0 sc1 lds
  s_add_u32 m0, s89, 61440
  s_nop 0
  buffer_load_dwordx4 v2, s[84:87], s100 offen offset:1024 sc1 lds
  s_add_u32 m0, s89, 61440
  s_nop 0
  buffer_load_dwordx4 v2, s[84:87], s100 offen offset:2048 sc1 lds
  s_add_u32 m0, s89, 61440
  s_nop 0
  buffer_load_dwordx4 v2, s[84:87], s100 offen offset:3072 sc1 lds
  s_waitcnt vmcnt(4)
  s_cmp_lg_u32 s32, 0
  s_cbranch_scc1 Lpd_30
  v_cmp_gt_u32 vcc, 9, v31
  s_mov_b32 s95, 0x8000
  s_cmp_eq_u64 vcc, 0
  s_cbranch_scc1 Lpd_30
Lpoll_29:
  s_sleep 2
  global_load_dword v31, v4, s[90:91] sc1
  s_waitcnt vmcnt(0)
  v_cmp_gt_u32 vcc, 9, v31
  s_sub_u32 s95, s95, 1
  s_cmp_eq_u64 vcc, 0
  s_cbranch_scc1 Lpd_30
  s_cmp_lg_u32 s95, 0
  s_cbranch_scc1 Lpoll_29
Lpd_30:
  s_barrier
  s_nop 0
  buffer_load_dwordx4 v[148:151], v27, s[40:43], s80 offen sc1
  buffer_load_dwordx4 v[152:155], v28, s[40:43], s80 offen sc1
  buffer_load_dwordx4 v[156:159], v29, s[40:43], s80 offen sc1
  buffer_load_dwordx4 v[144:147], v26, s[40:43], s80 offen sc1
  s_add_u32 s80, s80, 16384
  buffer_load_dwordx4 v[164:167], v27, s[40:43], s80 offen sc1
  buffer_load_dwordx4 v[168:171], v28, s[40:43], s80 offen sc1
  buffer_load_dwordx4 v[172:175], v29, s[40:43], s80 offen sc1
  buffer_load_dwordx4 v[160:163], v26, s[40:43], s80 offen sc1
  s_add_u32 s80, s80, 16384
  buffer_load_dwordx4 v[180:183], v27, s[40:43], s80 offen sc1
  buffer_load_dwordx4 v[184:187], v28, s[40:43], s80 offen sc1
  buffer_load_dwordx4 v[188:191], v29, s[40:43], s80 offen sc1
  buffer_load_dwordx4 v[176:179], v26, s[40:43], s80 offen sc1
  s_add_u32 s80, s80, 16384
  s_add_u32 s44, s30, 0x10e0000
  s_addc_u32 s45, s31, 0
  s_and_b32 s45, s45, 0xffff
  s_mov_b32 s46, 0x10000
  s_mov_b32 s47, 0x20000
  s_lshl_b32 s74, s39, 2
  s_add_u32 s74, s74, s32
  s_lshl_b32 s74, s74, 10
  s_add_u32 s96, s30, 0x1000000
  s_addc_u32 s97, s31, 0
  s_and_b32 s97, s97, 0xffff
  s_mov_b32 s98, 0xe0000
  s_mov_b32 s99, 0x20000
  s_lshl_b32 s75, s32, 10
  v_add_u32_e64 v11, s75, v2
  v_mov_b32 v14, 0x7fffffff
  v_cmp_gt_u32 vcc, 3360, v11
  s_nop 1
  v_cndmask_b32 v11, v14, v11, vcc
  s_mul_i32 s72, s39, 57344
  v_bfe_u32 v5, v0, 2, 2
  v_and_b32 v8, 3, v0
  v_and_b32 v14, 1, v0
  v_lshlrev_b32 v14, 4, v14
  v_mov_b32 v15, 0x3f80
  v_lshlrev_b32 v14, v14, v15
  v_cmp_eq_u32 vcc, v5, v25
  s_nop 1
  v_cndmask_b32 v14, 0, v14, vcc
  v_cmp_gt_u32 vcc, 2, v8
  s_nop 1
  v_cndmask_b32 v15, 0, v14, vcc
  v_cndmask_b32 v14, v14, 0, vcc
  v_accvgpr_write_b32 a120, v15
  v_accvgpr_write_b32 a121, v14
  v_accvgpr_write_b32 a122, 0
  v_accvgpr_write_b32 a123, 0
  v_accvgpr_write_b32 a124, 0
  v_accvgpr_write_b32 a125, 0
  v_accvgpr_write_b32 a126, v15
  v_accvgpr_write_b32 a127, v14
  s_mov_b32 s95, 0x4000
Lkp_32:
  s_add_u32 s75, s72, 0
  s_nop 0
  buffer_load_dwordx4 v[192:195], v11, s[96:99], s75 offen sc1
  s_add_u32 s75, s72, 3584
  buffer_load_dwordx4 v[196:199], v11, s[96:99], s75 offen sc1
  s_add_u32 s75, s72, 7168
  buffer_load_dwordx4 v[200:203], v11, s[96:99], s75 offen sc1
  s_add_u32 s75, s72, 10752
  buffer_load_dwordx4 v[204:207], v11, s[96:99], s75 offen sc1
  s_add_u32 s75, s72, 14336
  buffer_load_dwordx4 v[208:211], v11, s[96:99], s75 offen sc1
  s_add_u32 s75, s72, 17920
  buffer_load_dwordx4 v[212:215], v11, s[96:99], s75 offen sc1
  s_add_u32 s75, s72, 21504
  buffer_load_dwordx4 v[216:219], v11, s[96:99], s75 offen sc1
  s_add_u32 s75, s72, 25088
  buffer_load_dwordx4 v[220:223], v11, s[96:99], s75 offen sc1
  s_add_u32 s75, s72, 28672
  buffer_load_dwordx4 v[224:227], v11, s[96:99], s75 offen sc1
  s_add_u32 s75, s72, 32256
  buffer_load_dwordx4 v[228:231], v11, s[96:99], s75 offen sc1
  s_add_u32 s75, s72, 35840
  buffer_load_dwordx4 v[232:235], v11, s[96:99], s75 offen sc1
  s_add_u32 s75, s72, 39424
  buffer_load_dwordx4 v[236:239], v11, s[96:99], s75 offen sc1
  s_add_u32 s75, s72, 43008
  buffer_load_dwordx4 v[240:243], v11, s[96:99], s75 offen sc1
  s_add_u32 s75, s72, 46592
  buffer_load_dwordx4 v[244:247], v11, s[96:99], s75 offen sc1
  s_waitcnt vmcnt(13)
  v_mfma_f32_16x16x32_bf16 v[248:251], a[120:123], v[192:195], 0
  v_mfma_f32_16x16x32_bf16 v[252:255], a[124:127], v[192:195], 0
  v_max3_u32 v9, v192, v193, v194
  v_max_u32 v9, v9, v195
  s_add_u32 s75, s72, 50176
  buffer_load_dwordx4 v[192:195], v11, s[96:99], s75 offen sc1
  s_waitcnt vmcnt(13)
  v_mfma_f32_16x16x32_bf16 v[248:251], a[120:123], v[196:199], v[248:251]
  v_mfma_f32_16x16x32_bf16 v[252:255], a[124:127], v[196:199], v[252:255]
  v_max3_u32 v9, v9, v196, v197
  v_max3_u32 v9, v9, v198, v199
  s_add_u32 s75, s72, 53760
  buffer_load_dwordx4 v[196:199], v11, s[96:99], s75 offen sc1
  s_waitcnt vmcnt(13)
  v_mfma_f32_16x16x32_bf16 v[248:251], a[120:123], v[200:203], v[248:251]
  v_mfma_f32_16x16x32_bf16 v[252:255], a[124:127], v[200:203], v[252:255]
  v_max3_u32 v9, v9, v200, v201
  v_max3_u32 v9, v9, v202, v203
  s_waitcnt vmcnt(12)
  v_mfma_f32_16x16x32_bf16 v[248:251], a[120:123], v[204:207], v[248:251]
  v_mfma_f32_16x16x32_bf16 v[252:255], a[124:127], v[204:207], v[252:255]
  v_max3_u32 v9, v9, v204, v205
  v_max3_u32 v9, v9, v206, v207
  s_waitcnt vmcnt(11)
  v_mfma_f32_16x16x32_bf16 v[248:251], a[120:123], v[208:211], v[248:251]
  v_mfma_f32_16x16x32_bf16 v[252:255], a[124:127], v[208:211], v[252:255]
  v_max3_u32 v9, v9, v208, v209
  v_max3_u32 v9, v9, v210, v211
  s_waitcnt vmcnt(10)
  v_mfma_f32_16x16x32_bf16 v[248:251], a[120:123], v[212:215], v[248:251]
  v_mfma_f32_16x16x32_bf16 v[252:255], a[124:127], v[212:215], v[252:255]
  v_max3_u32 v9, v9, v212, v213
  v_max3_u32 v9, v9, v214, v215
  s_waitcnt vmcnt(9)
  v_mfma_f32_16x16x32_bf16 v[248:251], a[120:123], v[216:219], v[248:251]
  v_mfma_f32_16x16x32_bf16 v[252:255], a[124:127], v[216:219], v[252:255]
  v_max3_u32 v9, v9, v216, v217
  v_max3_u32 v9, v9, v218, v219
  s_waitcnt vmcnt(8)
  v_mfma_f32_16x16x32_bf16 v[248:251], a[120:123], v[220:223], v[248:251]
  v_mfma_f32_16x16x32_bf16 v[252:255], a[124:127], v[220:223], v[252:255]
  v_max3_u32 v9, v9, v220, v221
  v_max3_u32 v9, v9, v222, v223
  s_waitcnt vmcnt(7)
  v_mfma_f32_16x16x32_bf16 v[248:251], a[120:123], v[224:227], v[248:251]
  v_mfma_f32_16x16x32_bf16 v[252:255], a[124:127], v[224:227], v[252:255]
  v_max3_u32 v9, v9, v224, v225
  v_max3_u32 v9, v9, v226, v227
  s_waitcnt vmcnt(6)
  v_mfma_f32_16x16x32_bf16 v[248:251], a[120:123], v[228:231], v[248:251]
  v_mfma_f32_16x16x32_bf16 v[252:255], a[124:127], v[228:231], v[252:255]
  v_max3_u32 v9, v9, v228, v229
  v_max3_u32 v9, v9, v230, v231
  s_waitcnt vmcnt(5)
  v_mfma_f32_16x16x32_bf16 v[248:251], a[120:123], v[232:235], v[248:251]
  v_mfma_f32_16x16x32_bf16 v[252:255], a[124:127], v[232:235], v[252:255]
  v_max3_u32 v9, v9, v232, v233
  v_max3_u32 v9, v9, v234, v235
  s_waitcnt vmcnt(4)
  v_mfma_f32_16x16x32_bf16 v[248:251], a[120:123], v[236:239], v[248:251]
  v_mfma_f32_16x16x32_bf16 v[252:255], a[124:127], v[236:239], v[252:255]
  v_max3_u32 v9, v9, v236, v237
  v_max3_u32 v9, v9, v238, v239
  s_waitcnt vmcnt(3)
  v_mfma_f32_16x16x32_bf16 v[248:251], a[120:123], v[240:243], v[248:251]
  v_mfma_f32_16x16x32_bf16 v[252:255], a[124:127], v[240:243], v[252:255]
  v_max3_u32 v9, v9, v240, v241
  v_max3_u32 v9, v9, v242, v243
  s_waitcnt vmcnt(2)
  v_mfma_f32_16x16x32_bf16 v[248:251], a[120:123], v[244:247], v[248:251]
  v_mfma_f32_16x16x32_bf16 v[252:255], a[124:127], v[244:247], v[252:255]
  v_max3_u32 v9, v9, v244, v245
  v_max3_u32 v9, v9, v246, v247
  s_waitcnt vmcnt(1)
  v_mfma_f32_16x16x32_bf16 v[248:251], a[120:123], v[192:195], v[248:251]
  v_mfma_f32_16x16x32_bf16 v[252:255], a[124:127], v[192:195], v[252:255]
  v_max3_u32 v9, v9, v192, v193
  v_max3_u32 v9, v9, v194, v195
  s_waitcnt vmcnt(0)
  v_mfma_f32_16x16x32_bf16 v[248:251], a[120:123], v[196:199], v[248:251]
  v_mfma_f32_16x16x32_bf16 v[252:255], a[124:127], v[196:199], v[252:255]
  v_max3_u32 v9, v9, v196, v197
  v_max3_u32 v9, v9, v198, v199
  v_cmp_eq_u32 vcc, -1, v9
  s_sub_u32 s95, s95, 1
  s_cmp_eq_u64 vcc, 0
  s_cbranch_scc1 Lkd_33
  s_cmp_lg_u32 s95, 0
  s_cbranch_scc1 Lkp_32
Lkd_33:
  s_nop 3
  v_cvt_pk_bf16_f32 v192, v248, v249
  v_cvt_pk_bf16_f32 v193, v250, v251
  v_cvt_pk_bf16_f32 v194, v252, v253
  v_cvt_pk_bf16_f32 v195, v254, v255
  buffer_store_dwordx4 v[192:195], v2, s[44:47], s74 offen sc1
Lnr_31:
  s_add_u32 s75, s32, 1
  s_and_b32 s75, s75, 3
  s_waitcnt vmcnt(11)
  v_mfma_f32_16x16x32_bf16 v[84:87], a[128:131], v[148:151], 0
  s_mul_i32 s75, s75, 15360
  s_add_u32 s75, s75, 102400
  v_mfma_f32_16x16x32_bf16 v[88:91], a[132:135], v[148:151], 0
  s_add_u32 m0, s89, 65536
  s_nop 0
  buffer_load_dwordx4 v3, s[84:87], s100 offen sc1 lds
  v_add_u32 v11, s75, v2
  s_add_u32 s75, s32, 2
  v_mfma_f32_16x16x32_bf16 v[92:95], a[136:139], v[148:151], 0
  s_and_b32 s75, s75, 3
  s_mul_i32 s75, s75, 15360
  v_mfma_f32_16x16x32_bf16 v[96:99], a[140:143], v[148:151], 0
  s_add_u32 s100, s89, 81920
  s_add_u32 m0, s89, 81920
  s_nop 0
  buffer_load_dwordx4 v2, s[84:87], s100 offen offset:0 sc1 lds
  s_add_u32 s75, s75, 107520
  v_add_u32_e64 v12, s75, v2
  v_mfma_f32_16x16x32_bf16 v[100:103], a[144:147], v[148:151], 0
  buffer_load_dwordx4 v[148:151], v27, s[40:43], s80 offen sc1
  s_add_u32 s75, s32, 3
  s_and_b32 s75, s75, 3
  s_waitcnt vmcnt(13)
  v_mfma_f32_16x16x32_bf16 v[104:107], a[128:131], v[152:155], 0
  s_mul_i32 s75, s75, 15360
  s_add_u32 s75, s75, 112640
  v_mfma_f32_16x16x32_bf16 v[108:111], a[132:135], v[152:155], 0
  s_add_u32 m0, s89, 81920
  s_nop 0
  buffer_load_dwordx4 v2, s[84:87], s100 offen offset:1024 sc1 lds
  v_add_u32_e64 v13, s75, v2
  s_mul_i32 s75, s32, 15360
  v_mfma_f32_16x16x32_bf16 v[112:115], a[136:139], v[152:155], 0
  s_add_u32 s75, s75, 102400
  v_add_u32_e64 v8, s75, v2
  v_mfma_f32_16x16x32_bf16 v[116:119], a[140:143], v[152:155], 0
  s_add_u32 m0, s89, 81920
  s_nop 0
  buffer_load_dwordx4 v2, s[84:87], s100 offen offset:2048 sc1 lds
  v_add_u32 v9, 51200, v2
  s_mov_b32 s52, s26
  v_mfma_f32_16x16x32_bf16 v[120:123], a[144:147], v[152:155], 0
  buffer_load_dwordx4 v[152:155], v28, s[40:43], s80 offen sc1
  s_and_b32 s53, s27, 0xffff
  s_mov_b32 s54, 0x280000
  s_waitcnt vmcnt(15)
  v_mfma_f32_16x16x32_bf16 v[124:127], a[128:131], v[156:159], 0
  s_mov_b32 s55, 0x20000
  s_lshl_b32 s81, s37, 6
  v_mfma_f32_16x16x32_bf16 v[128:131], a[132:135], v[156:159], 0
  s_add_u32 m0, s89, 81920
  s_nop 0
  buffer_load_dwordx4 v2, s[84:87], s100 offen offset:3072 sc1 lds
  s_lshl_b32 s75, s32, 4
  s_add_u32 s81, s81, s75
  v_mfma_f32_16x16x32_bf16 v[132:135], a[136:139], v[156:159], 0
  s_lshl_b32 s74, s81, 2
  s_mul_i32 s81, s81, 1280
  v_mfma_f32_16x16x32_bf16 v[136:139], a[140:143], v[156:159], 0
  s_add_u32 m0, s89, 86016
  s_nop 0
  buffer_load_dwordx4 v3, s[84:87], s100 offen sc1 lds
  s_mul_i32 s75, s38, 160
  s_add_u32 s81, s81, s75
  v_mfma_f32_16x16x32_bf16 v[140:143], a[144:147], v[156:159], 0
  buffer_load_dwordx4 v[156:159], v29, s[40:43], s80 offen sc1
  v_mul_u32_u24 v16, 1280, v24
  v_lshl_add_u32 v16, v25, 3, v16
  s_waitcnt vmcnt(17)
  v_mfma_f32_16x16x32_bf16 v[64:67], a[128:131], v[144:147], 0
  s_lshr_b32 s82, s37, 1
  s_add_u32 s82, s82, 16
  v_mfma_f32_16x16x32_bf16 v[68:71], a[132:135], v[144:147], 0
  s_mul_i32 s82, s82, 4352
  s_mov_b32 s73, 0
  v_mfma_f32_16x16x32_bf16 v[72:75], a[136:139], v[144:147], 0
  s_mul_i32 s75, s32, 15360
  s_add_u32 s75, s75, 102400
  v_mfma_f32_16x16x32_bf16 v[76:79], a[140:143], v[144:147], 0
  v_mul_u32_u24 v17, 176, v24
  v_lshl_add_u32 v17, v25, 3, v17
  v_mfma_f32_16x16x32_bf16 v[80:83], a[144:147], v[144:147], 0
  buffer_load_dwordx4 v[144:147], v26, s[40:43], s80 offen sc1
  s_add_u32 s80, s80, 16384
  v_add_u32 v17, s75, v17
  v_mov_b32 v30, 0x7fffffff
  s_waitcnt vmcnt(17)
  v_mfma_f32_16x16x32_bf16 v[84:87], a[148:151], v[164:167], v[84:87]
  v_add_u32_e64 v14, 0, v0
  v_mul_u32_u24 v15, 205, v14
  v_mfma_f32_16x16x32_bf16 v[88:91], a[152:155], v[164:167], v[88:91]
  v_lshrrev_b32 v15, 11, v15
  v_mul_u32_u24 v7, 10, v15
  v_mfma_f32_16x16x32_bf16 v[92:95], a[156:159], v[164:167], v[92:95]
  v_sub_u32 v14, v14, v7
  v_lshlrev_b32 v14, 4, v14
  v_mfma_f32_16x16x32_bf16 v[96:99], a[160:163], v[164:167], v[96:99]
  v_mul_u32_u24 v7, 176, v15
  v_add3_u32 v18, v7, v14, s75
  v_mfma_f32_16x16x32_bf16 v[100:103], a[164:167], v[164:167], v[100:103]
  buffer_load_dwordx4 v[164:167], v27, s[40:43], s80 offen sc1
  v_mul_u32_u24 v7, 1280, v15
  v_add_u32 v21, v7, v14
  s_waitcnt vmcnt(17)
  v_mfma_f32_16x16x32_bf16 v[104:107], a[148:151], v[168:171], v[104:107]
  v_add_u32_e64 v14, 64, v0
  v_mul_u32_u24 v15, 205, v14
  v_mfma_f32_16x16x32_bf16 v[108:111], a[152:155], v[168:171], v[108:111]
  v_lshrrev_b32 v15, 11, v15
  v_mul_u32_u24 v7, 10, v15
  v_mfma_f32_16x16x32_bf16 v[112:115], a[156:159], v[168:171], v[112:115]
  v_sub_u32 v14, v14, v7
  v_lshlrev_b32 v14, 4, v14
  v_mfma_f32_16x16x32_bf16 v[116:119], a[160:163], v[168:171], v[116:119]
  v_mul_u32_u24 v7, 176, v15
  v_add3_u32 v19, v7, v14, s75
  v_mfma_f32_16x16x32_bf16 v[120:123], a[164:167], v[168:171], v[120:123]
  buffer_load_dwordx4 v[168:171], v28, s[40:43], s80 offen sc1
  v_mul_u32_u24 v7, 1280, v15
  v_add_u32 v22, v7, v14
  s_waitcnt vmcnt(17)
  v_mfma_f32_16x16x32_bf16 v[124:127], a[148:151], v[172:175], v[124:127]
  v_add_u32 v14, 128, v0
  v_mul_u32_u24 v15, 205, v14
  v_mfma_f32_16x16x32_bf16 v[128:131], a[152:155], v[172:175], v[128:131]
  v_lshrrev_b32 v15, 11, v15
  v_mul_u32_u24 v7, 10, v15
  v_mfma_f32_16x16x32_bf16 v[132:135], a[156:159], v[172:175], v[132:135]
  v_sub_u32 v14, v14, v7
  v_lshlrev_b32 v14, 4, v14
  v_mfma_f32_16x16x32_bf16 v[136:139], a[160:163], v[172:175], v[136:139]
  v_mul_u32_u24 v7, 176, v15
  v_add3_u32 v20, v7, v14, s75
  v_mfma_f32_16x16x32_bf16 v[140:143], a[164:167], v[172:175], v[140:143]
  buffer_load_dwordx4 v[172:175], v29, s[40:43], s80 offen sc1
  v_mul_u32_u24 v7, 1280, v15
  v_add_u32 v23, v7, v14
  s_waitcnt vmcnt(17)
  v_mfma_f32_16x16x32_bf16 v[64:67], a[148:151], v[160:163], v[64:67]
  v_cmp_gt_u32 vcc, 32, v0
  s_nop 1
  v_cndmask_b32 v23, v30, v23, vcc
  v_mfma_f32_16x16x32_bf16 v[68:71], a[152:155], v[160:163], v[68:71]
  v_mfma_f32_16x16x32_bf16 v[72:75], a[156:159], v[160:163], v[72:75]
  v_mfma_f32_16x16x32_bf16 v[76:79], a[160:163], v[160:163], v[76:79]
  v_mfma_f32_16x16x32_bf16 v[80:83], a[164:167], v[160:163], v[80:83]
  buffer_load_dwordx4 v[160:163], v26, s[40:43], s80 offen sc1
  s_add_u32 s80, s80, 16384
  s_waitcnt vmcnt(17)
  v_mfma_f32_16x16x32_bf16 v[84:87], a[168:171], v[180:183], v[84:87]
  v_mfma_f32_16x16x32_bf16 v[88:91], a[172:175], v[180:183], v[88:91]
  v_mfma_f32_16x16x32_bf16 v[92:95], a[176:179], v[180:183], v[92:95]
  v_mfma_f32_16x16x32_bf16 v[96:99], a[180:183], v[180:183], v[96:99]
  v_mfma_f32_16x16x32_bf16 v[100:103], a[184:187], v[180:183], v[100:103]
  buffer_load_dwordx4 v[180:183], v27, s[40:43], s80 offen sc1
  s_waitcnt vmcnt(17)
  v_mfma_f32_16x16x32_bf16 v[104:107], a[168:171], v[184:187], v[104:107]
  v_mfma_f32_16x16x32_bf16 v[108:111], a[172:175], v[184:187], v[108:111]
  v_mfma_f32_16x16x32_bf16 v[112:115], a[176:179], v[184:187], v[112:115]
  v_mfma_f32_16x16x32_bf16 v[116:119], a[180:183], v[184:187], v[116:119]
  v_mfma_f32_16x16x32_bf16 v[120:123], a[184:187], v[184:187], v[120:123]
  buffer_load_dwordx4 v[184:187], v28, s[40:43], s80 offen sc1
  s_waitcnt vmcnt(17)
  v_mfma_f32_16x16x32_bf16 v[124:127], a[168:171], v[188:191], v[124:127]
  v_mfma_f32_16x16x32_bf16 v[128:131], a[172:175], v[188:191], v[128:131]
  v_mfma_f32_16x16x32_bf16 v[132:135], a[176:179], v[188:191], v[132:135]
  v_mfma_f32_16x16x32_bf16 v[136:139], a[180:183], v[188:191], v[136:139]
  v_mfma_f32_16x16x32_bf16 v[140:143], a[184:187], v[188:191], v[140:143]
  buffer_load_dwordx4 v[188:191], v29, s[40:43], s80 offen sc1
  s_waitcnt vmcnt(17)
  v_mfma_f32_16x16x32_bf16 v[64:67], a[168:171], v[176:179], v[64:67]
  v_mfma_f32_16x16x32_bf16 v[68:71], a[172:175], v[176:179], v[68:71]
  v_mfma_f32_16x16x32_bf16 v[72:75], a[176:179], v[176:179], v[72:75]
  v_mfma_f32_16x16x32_bf16 v[76:79], a[180:183], v[176:179], v[76:79]
  v_mfma_f32_16x16x32_bf16 v[80:83], a[184:187], v[176:179], v[80:83]
  buffer_load_dwordx4 v[176:179], v26, s[40:43], s80 offen sc1
  s_add_u32 s80, s80, 16384
  s_waitcnt vmcnt(15)
  v_mfma_f32_16x16x32_bf16 v[84:87], a[188:191], v[148:151], v[84:87]
  v_mfma_f32_16x16x32_bf16 v[88:91], a[192:195], v[148:151], v[88:91]
  v_mfma_f32_16x16x32_bf16 v[92:95], a[196:199], v[148:151], v[92:95]
  v_mfma_f32_16x16x32_bf16 v[96:99], a[200:203], v[148:151], v[96:99]
  v_mfma_f32_16x16x32_bf16 v[100:103], a[204:207], v[148:151], v[100:103]
  buffer_load_dwordx4 v[148:151], v27, s[40:43], s80 offen sc1
  s_waitcnt vmcnt(13)
  v_mfma_f32_16x16x32_bf16 v[104:107], a[188:191], v[152:155], v[104:107]
  v_mfma_f32_16x16x32_bf16 v[108:111], a[192:195], v[152:155], v[108:111]
  v_mfma_f32_16x16x32_bf16 v[112:115], a[196:199], v[152:155], v[112:115]
  v_mfma_f32_16x16x32_bf16 v[116:119], a[200:203], v[152:155], v[116:119]
  v_mfma_f32_16x16x32_bf16 v[120:123], a[204:207], v[152:155], v[120:123]
  buffer_load_dwordx4 v[152:155], v28, s[40:43], s80 offen sc1
  s_waitcnt vmcnt(11)
  v_mfma_f32_16x16x32_bf16 v[124:127], a[188:191], v[156:159], v[124:127]
  v_mfma_f32_16x16x32_bf16 v[128:131], a[192:195], v[156:159], v[128:131]
  v_mfma_f32_16x16x32_bf16 v[132:135], a[196:199], v[156:159], v[132:135]
  v_mfma_f32_16x16x32_bf16 v[136:139], a[200:203], v[156:159], v[136:139]
  v_mfma_f32_16x16x32_bf16 v[140:143], a[204:207], v[156:159], v[140:143]
  buffer_load_dwordx4 v[156:159], v29, s[40:43], s80 offen sc1
  s_waitcnt vmcnt(11)
  v_mfma_f32_16x16x32_bf16 v[64:67], a[188:191], v[144:147], v[64:67]
  v_mfma_f32_16x16x32_bf16 v[68:71], a[192:195], v[144:147], v[68:71]
  s_barrier
  v_mfma_f32_16x16x32_bf16 v[72:75], a[196:199], v[144:147], v[72:75]
  ds_read_b128 a[128:131], v2 offset:0
  v_mfma_f32_16x16x32_bf16 v[76:79], a[200:203], v[144:147], v[76:79]
  ds_read_b128 a[132:135], v2 offset:1024
  v_mfma_f32_16x16x32_bf16 v[80:83], a[204:207], v[144:147], v[80:83]
  ds_read_b128 a[136:139], v2 offset:2048
  buffer_load_dwordx4 v[144:147], v26, s[40:43], s80 offen sc1
  s_add_u32 s80, s80, 16384
  s_waitcnt vmcnt(11)
  s_nop 0
  v_mfma_f32_16x16x32_bf16 v[84:87], a[208:211], v[164:167], v[84:87]
  ds_read_b128 a[140:143], v2 offset:3072
  v_mfma_f32_16x16x32_bf16 v[88:91], a[212:215], v[164:167], v[88:91]
  ds_read_b128 a[144:147], v2 offset:4096
  v_mfma_f32_16x16x32_bf16 v[92:95], a[216:219], v[164:167], v[92:95]
  ds_read_b128 a[148:151], v2 offset:5120
  v_mfma_f32_16x16x32_bf16 v[96:99], a[220:223], v[164:167], v[96:99]
  ds_read_b128 a[152:155], v2 offset:6144
  v_mfma_f32_16x16x32_bf16 v[100:103], a[224:227], v[164:167], v[100:103]
  ds_read_b128 a[156:159], v2 offset:7168
  buffer_load_dwordx4 v[164:167], v27, s[40:43], s80 offen sc1
  s_waitcnt vmcnt(11)
  s_nop 0
  v_mfma_f32_16x16x32_bf16 v[104:107], a[208:211], v[168:171], v[104:107]
  ds_read_b128 a[160:163], v2 offset:8192
  v_mfma_f32_16x16x32_bf16 v[108:111], a[212:215], v[168:171], v[108:111]
  ds_read_b128 a[164:167], v2 offset:9216
  v_mfma_f32_16x16x32_bf16 v[112:115], a[216:219], v[168:171], v[112:115]
  ds_read_b128 a[168:171], v2 offset:10240
  v_mfma_f32_16x16x32_bf16 v[116:119], a[220:223], v[168:171], v[116:119]
  ds_read_b128 a[172:175], v2 offset:11264
  v_mfma_f32_16x16x32_bf16 v[120:123], a[224:227], v[168:171], v[120:123]
  ds_read_b128 a[176:179], v2 offset:12288
  buffer_load_dwordx4 v[168:171], v28, s[40:43], s80 offen sc1
  s_waitcnt vmcnt(11)
  s_nop 0
  v_mfma_f32_16x16x32_bf16 v[124:127], a[208:211], v[172:175], v[124:127]
  ds_read_b128 a[180:183], v2 offset:13312
  v_mfma_f32_16x16x32_bf16 v[128:131], a[212:215], v[172:175], v[128:131]
  ds_read_b128 a[184:187], v2 offset:14336
  v_mfma_f32_16x16x32_bf16 v[132:135], a[216:219], v[172:175], v[132:135]
  ds_read_b128 a[188:191], v2 offset:15360
  v_mfma_f32_16x16x32_bf16 v[136:139], a[220:223], v[172:175], v[136:139]
  ds_read_b128 a[192:195], v2 offset:16384
  v_mfma_f32_16x16x32_bf16 v[140:143], a[224:227], v[172:175], v[140:143]
  ds_read_b128 a[196:199], v2 offset:17408
  buffer_load_dwordx4 v[172:175], v29, s[40:43], s80 offen sc1
  s_waitcnt vmcnt(11)
  v_mfma_f32_16x16x32_bf16 v[64:67], a[208:211], v[160:163], v[64:67]
  ds_read_b128 a[200:203], v2 offset:18432
  v_mfma_f32_16x16x32_bf16 v[68:71], a[212:215], v[160:163], v[68:71]
  ds_read_b128 a[204:207], v2 offset:19456
  v_mfma_f32_16x16x32_bf16 v[72:75], a[216:219], v[160:163], v[72:75]
  v_mfma_f32_16x16x32_bf16 v[76:79], a[220:223], v[160:163], v[76:79]
  v_mfma_f32_16x16x32_bf16 v[80:83], a[224:227], v[160:163], v[80:83]
  buffer_load_dwordx4 v[160:163], v26, s[40:43], s80 offen sc1
  s_add_u32 s80, s80, 16384
  s_waitcnt vmcnt(11)
  v_mfma_f32_16x16x32_bf16 v[84:87], a[228:231], v[180:183], v[84:87]
  ds_read_b128 a[208:211], v2 offset:20480
  v_mfma_f32_16x16x32_bf16 v[88:91], a[232:235], v[180:183], v[88:91]
  ds_read_b128 a[212:215], v2 offset:21504
  v_mfma_f32_16x16x32_bf16 v[92:95], a[236:239], v[180:183], v[92:95]
  ds_read_b128 a[216:219], v2 offset:22528
  v_mfma_f32_16x16x32_bf16 v[96:99], a[240:243], v[180:183], v[96:99]
  ds_read_b128 a[220:223], v2 offset:23552
  v_mfma_f32_16x16x32_bf16 v[100:103], a[244:247], v[180:183], v[100:103]
  ds_read_b128 a[224:227], v2 offset:24576
  buffer_load_dwordx4 v[180:183], v27, s[40:43], s80 offen sc1
  s_waitcnt vmcnt(11)
  v_mfma_f32_16x16x32_bf16 v[104:107], a[228:231], v[184:187], v[104:107]
  v_mfma_f32_16x16x32_bf16 v[108:111], a[232:235], v[184:187], v[108:111]
  v_mfma_f32_16x16x32_bf16 v[112:115], a[236:239], v[184:187], v[112:115]
  v_mfma_f32_16x16x32_bf16 v[116:119], a[240:243], v[184:187], v[116:119]
  v_mfma_f32_16x16x32_bf16 v[120:123], a[244:247], v[184:187], v[120:123]
  buffer_load_dwordx4 v[184:187], v28, s[40:43], s80 offen sc1
  s_waitcnt vmcnt(11)
  v_mfma_f32_16x16x32_bf16 v[124:127], a[228:231], v[188:191], v[124:127]
  v_mfma_f32_16x16x32_bf16 v[128:131], a[232:235], v[188:191], v[128:131]
  v_mfma_f32_16x16x32_bf16 v[132:135], a[236:239], v[188:191], v[132:135]
  v_mfma_f32_16x16x32_bf16 v[136:139], a[240:243], v[188:191], v[136:139]
  v_mfma_f32_16x16x32_bf16 v[140:143], a[244:247], v[188:191], v[140:143]
  buffer_load_dwordx4 v[188:191], v29, s[40:43], s80 offen sc1
  s_waitcnt vmcnt(11)
  v_mfma_f32_16x16x32_bf16 v[64:67], a[228:231], v[176:179], v[64:67]
  v_mfma_f32_16x16x32_bf16 v[68:71], a[232:235], v[176:179], v[68:71]
  v_mfma_f32_16x16x32_bf16 v[72:75], a[236:239], v[176:179], v[72:75]
  v_mfma_f32_16x16x32_bf16 v[76:79], a[240:243], v[176:179], v[76:79]
  v_mfma_f32_16x16x32_bf16 v[80:83], a[244:247], v[176:179], v[80:83]
  buffer_load_dwordx4 v[176:179], v26, s[40:43], s80 offen sc1
  s_add_u32 s80, s80, 16384
  s_waitcnt vmcnt(11)
  v_mfma_f32_16x16x32_bf16 v[84:87], a[248:251], v[148:151], v[84:87]
  ds_read_b128 a[228:231], v2 offset:25600
  v_mfma_f32_16x16x32_bf16 v[88:91], a[252:255], v[148:151], v[88:91]
  ds_read_b128 a[232:235], v2 offset:26624
  v_mfma_f32_16x16x32_bf16 v[92:95], a[48:51], v[148:151], v[92:95]
  ds_read_b128 a[236:239], v2 offset:27648
  v_mfma_f32_16x16x32_bf16 v[96:99], a[52:55], v[148:151], v[96:99]
  ds_read_b128 a[240:243], v2 offset:28672
  v_mfma_f32_16x16x32_bf16 v[100:103], a[56:59], v[148:151], v[100:103]
  ds_read_b128 a[244:247], v2 offset:29696
  buffer_load_dwordx4 v[148:151], v27, s[40:43], s80 offen sc1
  s_waitcnt vmcnt(11)
  v_mfma_f32_16x16x32_bf16 v[104:107], a[248:251], v[152:155], v[104:107]
  v_mfma_f32_16x16x32_bf16 v[108:111], a[252:255], v[152:155], v[108:111]
  v_mfma_f32_16x16x32_bf16 v[112:115], a[48:51], v[152:155], v[112:115]
  v_mfma_f32_16x16x32_bf16 v[116:119], a[52:55], v[152:155], v[116:119]
  v_mfma_f32_16x16x32_bf16 v[120:123], a[56:59], v[152:155], v[120:123]
  buffer_load_dwordx4 v[152:155], v28, s[40:43], s80 offen sc1
  s_waitcnt vmcnt(11)
  v_mfma_f32_16x16x32_bf16 v[124:127], a[248:251], v[156:159], v[124:127]
  v_mfma_f32_16x16x32_bf16 v[128:131], a[252:255], v[156:159], v[128:131]
  v_mfma_f32_16x16x32_bf16 v[132:135], a[48:51], v[156:159], v[132:135]
  v_mfma_f32_16x16x32_bf16 v[136:139], a[52:55], v[156:159], v[136:139]
  v_mfma_f32_16x16x32_bf16 v[140:143], a[56:59], v[156:159], v[140:143]
  buffer_load_dwordx4 v[156:159], v29, s[40:43], s80 offen sc1
  s_waitcnt vmcnt(11)
  v_mfma_f32_16x16x32_bf16 v[64:67], a[248:251], v[144:147], v[64:67]
  v_mfma_f32_16x16x32_bf16 v[68:71], a[252:255], v[144:147], v[68:71]
  v_mfma_f32_16x16x32_bf16 v[72:75], a[48:51], v[144:147], v[72:75]
  v_mfma_f32_16x16x32_bf16 v[76:79], a[52:55], v[144:147], v[76:79]
  v_mfma_f32_16x16x32_bf16 v[80:83], a[56:59], v[144:147], v[80:83]
  buffer_load_dwordx4 v[144:147], v26, s[40:43], s80 offen sc1
  s_add_u32 s80, s80, 16384
  s_waitcnt vmcnt(11)
  v_mfma_f32_16x16x32_bf16 v[84:87], a[60:63], v[164:167], v[84:87]
  ds_read_b128 a[248:251], v2 offset:30720
  v_mfma_f32_16x16x32_bf16 v[88:91], a[64:67], v[164:167], v[88:91]
  ds_read_b128 a[252:255], v2 offset:31744
  v_mfma_f32_16x16x32_bf16 v[92:95], a[68:71], v[164:167], v[92:95]
  ds_read_b128 a[48:51], v2 offset:32768
  v_mfma_f32_16x16x32_bf16 v[96:99], a[72:75], v[164:167], v[96:99]
  ds_read_b128 a[52:55], v2 offset:33792
  v_mfma_f32_16x16x32_bf16 v[100:103], a[76:79], v[164:167], v[100:103]
  ds_read_b128 a[56:59], v2 offset:34816
  buffer_load_dwordx4 v[164:167], v27, s[40:43], s80 offen sc1
  s_waitcnt vmcnt(11)
  v_mfma_f32_16x16x32_bf16 v[104:107], a[60:63], v[168:171], v[104:107]
  v_mfma_f32_16x16x32_bf16 v[108:111], a[64:67], v[168:171], v[108:111]
  v_mfma_f32_16x16x32_bf16 v[112:115], a[68:71], v[168:171], v[112:115]
  v_mfma_f32_16x16x32_bf16 v[116:119], a[72:75], v[168:171], v[116:119]
  v_mfma_f32_16x16x32_bf16 v[120:123], a[76:79], v[168:171], v[120:123]
  buffer_load_dwordx4 v[168:171], v28, s[40:43], s80 offen sc1
  s_waitcnt vmcnt(11)
  v_mfma_f32_16x16x32_bf16 v[124:127], a[60:63], v[172:175], v[124:127]
  v_mfma_f32_16x16x32_bf16 v[128:131], a[64:67], v[172:175], v[128:131]
  v_mfma_f32_16x16x32_bf16 v[132:135], a[68:71], v[172:175], v[132:135]
  v_mfma_f32_16x16x32_bf16 v[136:139], a[72:75], v[172:175], v[136:139]
  v_mfma_f32_16x16x32_bf16 v[140:143], a[76:79], v[172:175], v[140:143]
  buffer_load_dwordx4 v[172:175], v29, s[40:43], s80 offen sc1
  s_waitcnt vmcnt(11)
  v_mfma_f32_16x16x32_bf16 v[64:67], a[60:63], v[160:163], v[64:67]
  v_mfma_f32_16x16x32_bf16 v[68:71], a[64:67], v[160:163], v[68:71]
  v_mfma_f32_16x16x32_bf16 v[72:75], a[68:71], v[160:163], v[72:75]
  v_mfma_f32_16x16x32_bf16 v[76:79], a[72:75], v[160:163], v[76:79]
  v_mfma_f32_16x16x32_bf16 v[80:83], a[76:79], v[160:163], v[80:83]
  buffer_load_dwordx4 v[160:163], v26, s[40:43], s80 offen sc1
  s_add_u32 s80, s80, 16384
  s_waitcnt vmcnt(11)
  v_mfma_f32_16x16x32_bf16 v[84:87], a[80:83], v[180:183], v[84:87]
  ds_read_b128 a[60:63], v2 offset:35840
  v_mfma_f32_16x16x32_bf16 v[88:91], a[84:87], v[180:183], v[88:91]
  ds_read_b128 a[64:67], v2 offset:36864
  v_mfma_f32_16x16x32_bf16 v[92:95], a[88:91], v[180:183], v[92:95]
  ds_read_b128 a[68:71], v2 offset:37888
  v_mfma_f32_16x16x32_bf16 v[96:99], a[92:95], v[180:183], v[96:99]
  ds_read_b128 a[72:75], v2 offset:38912
  v_mfma_f32_16x16x32_bf16 v[100:103], a[108:111], v[180:183], v[100:103]
  ds_read_b128 a[76:79], v2 offset:39936
  buffer_load_dwordx4 v[180:183], v27, s[40:43], s80 offen sc1
  s_waitcnt vmcnt(11)
  v_mfma_f32_16x16x32_bf16 v[104:107], a[80:83], v[184:187], v[104:107]
  v_mfma_f32_16x16x32_bf16 v[108:111], a[84:87], v[184:187], v[108:111]
  v_mfma_f32_16x16x32_bf16 v[112:115], a[88:91], v[184:187], v[112:115]
  v_mfma_f32_16x16x32_bf16 v[116:119], a[92:95], v[184:187], v[116:119]
  v_mfma_f32_16x16x32_bf16 v[120:123], a[108:111], v[184:187], v[120:123]
  buffer_load_dwordx4 v[184:187], v28, s[40:43], s80 offen sc1
  s_waitcnt vmcnt(11)
  v_mfma_f32_16x16x32_bf16 v[124:127], a[80:83], v[188:191], v[124:127]
  v_mfma_f32_16x16x32_bf16 v[128:131], a[84:87], v[188:191], v[128:131]
  v_mfma_f32_16x16x32_bf16 v[132:135], a[88:91], v[188:191], v[132:135]
  v_mfma_f32_16x16x32_bf16 v[136:139], a[92:95], v[188:191], v[136:139]
  v_mfma_f32_16x16x32_bf16 v[140:143], a[108:111], v[188:191], v[140:143]
  buffer_load_dwordx4 v[188:191], v29, s[40:43], s80 offen sc1
  s_waitcnt vmcnt(11)
  v_mfma_f32_16x16x32_bf16 v[64:67], a[80:83], v[176:179], v[64:67]
  v_mfma_f32_16x16x32_bf16 v[68:71], a[84:87], v[176:179], v[68:71]
  v_mfma_f32_16x16x32_bf16 v[72:75], a[88:91], v[176:179], v[72:75]
  v_mfma_f32_16x16x32_bf16 v[76:79], a[92:95], v[176:179], v[76:79]
  v_mfma_f32_16x16x32_bf16 v[80:83], a[108:111], v[176:179], v[80:83]
  buffer_load_dwordx4 v[176:179], v26, s[40:43], s80 offen sc1
  s_add_u32 s80, s80, 16384
  s_waitcnt vmcnt(11)
  v_mfma_f32_16x16x32_bf16 v[84:87], a[112:115], v[148:151], v[84:87]
  ds_read_b128 a[80:83], v2 offset:40960
  v_mfma_f32_16x16x32_bf16 v[88:91], a[116:119], v[148:151], v[88:91]
  ds_read_b128 a[84:87], v2 offset:41984
  v_mfma_f32_16x16x32_bf16 v[92:95], a[0:3], v[148:151], v[92:95]
  ds_read_b128 a[88:91], v2 offset:43008
  v_mfma_f32_16x16x32_bf16 v[96:99], a[4:7], v[148:151], v[96:99]
  ds_read_b128 a[92:95], v2 offset:44032
  v_mfma_f32_16x16x32_bf16 v[100:103], a[8:11], v[148:151], v[100:103]
  ds_read_b128 a[108:111], v2 offset:45056
  buffer_load_dwordx4 v[148:151], v27, s[40:43], s80 offen sc1
  s_waitcnt vmcnt(11)
  v_mfma_f32_16x16x32_bf16 v[104:107], a[112:115], v[152:155], v[104:107]
  v_mfma_f32_16x16x32_bf16 v[108:111], a[116:119], v[152:155], v[108:111]
  v_mfma_f32_16x16x32_bf16 v[112:115], a[0:3], v[152:155], v[112:115]
  v_mfma_f32_16x16x32_bf16 v[116:119], a[4:7], v[152:155], v[116:119]
  v_mfma_f32_16x16x32_bf16 v[120:123], a[8:11], v[152:155], v[120:123]
  buffer_load_dwordx4 v[152:155], v28, s[40:43], s80 offen sc1
  s_waitcnt vmcnt(11)
  v_mfma_f32_16x16x32_bf16 v[124:127], a[112:115], v[156:159], v[124:127]
  v_mfma_f32_16x16x32_bf16 v[128:131], a[116:119], v[156:159], v[128:131]
  v_mfma_f32_16x16x32_bf16 v[132:135], a[0:3], v[156:159], v[132:135]
  v_mfma_f32_16x16x32_bf16 v[136:139], a[4:7], v[156:159], v[136:139]
  v_mfma_f32_16x16x32_bf16 v[140:143], a[8:11], v[156:159], v[140:143]
  buffer_load_dwordx4 v[156:159], v29, s[40:43], s80 offen sc1
  s_waitcnt vmcnt(11)
  v_mfma_f32_16x16x32_bf16 v[64:67], a[112:115], v[144:147], v[64:67]
  v_mfma_f32_16x16x32_bf16 v[68:71], a[116:119], v[144:147], v[68:71]
  v_mfma_f32_16x16x32_bf16 v[72:75], a[0:3], v[144:147], v[72:75]
  v_mfma_f32_16x16x32_bf16 v[76:79], a[4:7], v[144:147], v[76:79]
  v_mfma_f32_16x16x32_bf16 v[80:83], a[8:11], v[144:147], v[80:83]
  buffer_load_dwordx4 v[144:147], v26, s[40:43], s80 offen sc1
  s_add_u32 s80, s80, 16384
  s_waitcnt vmcnt(11)
  v_mfma_f32_16x16x32_bf16 v[84:87], a[12:15], v[164:167], v[84:87]
  ds_read_b128 a[112:115], v2 offset:46080
  v_mfma_f32_16x16x32_bf16 v[88:91], a[16:19], v[164:167], v[88:91]
  ds_read_b128 a[116:119], v2 offset:47104
  v_mfma_f32_16x16x32_bf16 v[92:95], a[20:23], v[164:167], v[92:95]
  ds_read_b128 a[0:3], v2 offset:48128
  v_mfma_f32_16x16x32_bf16 v[96:99], a[24:27], v[164:167], v[96:99]
  ds_read_b128 a[4:7], v2 offset:49152
  v_mfma_f32_16x16x32_bf16 v[100:103], a[28:31], v[164:167], v[100:103]
  ds_read_b128 a[8:11], v2 offset:50176
  buffer_load_dwordx4 v[164:167], v27, s[40:43], s80 offen sc1
  s_waitcnt vmcnt(11)
  v_mfma_f32_16x16x32_bf16 v[104:107], a[12:15], v[168:171], v[104:107]
  v_mfma_f32_16x16x32_bf16 v[108:111], a[16:19], v[168:171], v[108:111]
  v_mfma_f32_16x16x32_bf16 v[112:115], a[20:23], v[168:171], v[112:115]
  v_mfma_f32_16x16x32_bf16 v[116:119], a[24:27], v[168:171], v[116:119]
  v_mfma_f32_16x16x32_bf16 v[120:123], a[28:31], v[168:171], v[120:123]
  buffer_load_dwordx4 v[168:171], v28, s[40:43], s80 offen sc1
  s_waitcnt vmcnt(11)
  v_mfma_f32_16x16x32_bf16 v[124:127], a[12:15], v[172:175], v[124:127]
  v_mfma_f32_16x16x32_bf16 v[128:131], a[16:19], v[172:175], v[128:131]
  v_mfma_f32_16x16x32_bf16 v[132:135], a[20:23], v[172:175], v[132:135]
  v_mfma_f32_16x16x32_bf16 v[136:139], a[24:27], v[172:175], v[136:139]
  v_mfma_f32_16x16x32_bf16 v[140:143], a[28:31], v[172:175], v[140:143]
  buffer_load_dwordx4 v[172:175], v29, s[40:43], s80 offen sc1
  s_waitcnt vmcnt(11)
  v_mfma_f32_16x16x32_bf16 v[64:67], a[12:15], v[160:163], v[64:67]
  v_mfma_f32_16x16x32_bf16 v[68:71], a[16:19], v[160:163], v[68:71]
  v_mfma_f32_16x16x32_bf16 v[72:75], a[20:23], v[160:163], v[72:75]
  v_mov_b32 v4, s82
  s_cmp_lg_u32 s32, 0
  s_cbranch_scc1 Lp0_34
  global_load_dword v31, v4, s[90:91] sc1
  s_branch Lp1_35
Lp0_34:
  v_mov_b32 v4, 0
  global_load_dword v31, v4, s[8:9]
Lp1_35:
  v_mfma_f32_16x16x32_bf16 v[76:79], a[24:27], v[160:163], v[76:79]
  v_mfma_f32_16x16x32_bf16 v[80:83], a[28:31], v[160:163], v[80:83]
  buffer_load_dwordx4 v[160:163], v26, s[40:43], s80 offen sc1
  s_add_u32 s80, s80, 16384
  s_waitcnt vmcnt(12)
  s_nop 0
  v_mfma_f32_16x16x32_bf16 v[84:87], a[32:35], v[180:183], v[84:87]
  ds_read_b128 a[12:15], v9 offset:0
  v_mfma_f32_16x16x32_bf16 v[88:91], a[36:39], v[180:183], v[88:91]
  ds_read_b128 a[16:19], v9 offset:1024
  v_mfma_f32_16x16x32_bf16 v[92:95], a[40:43], v[180:183], v[92:95]
  ds_read_b128 a[20:23], v9 offset:2048
  v_mfma_f32_16x16x32_bf16 v[96:99], a[44:47], v[180:183], v[96:99]
  ds_read_b128 a[24:27], v9 offset:3072
  v_mfma_f32_16x16x32_bf16 v[100:103], a[96:99], v[180:183], v[100:103]
  ds_read_b128 a[28:31], v9 offset:4096
  s_waitcnt vmcnt(8)
  v_mfma_f32_16x16x32_bf16 v[84:87], a[100:103], v[148:151], v[84:87]
  v_mfma_f32_16x16x32_bf16 v[88:91], a[104:107], v[148:151], v[88:91]
  v_mfma_f32_16x16x32_bf16 v[92:95], v[32:35], v[148:151], v[92:95]
  v_mfma_f32_16x16x32_bf16 v[96:99], v[36:39], v[148:151], v[96:99]
  v_mfma_f32_16x16x32_bf16 v[100:103], v[40:43], v[148:151], v[100:103]
  s_waitcnt vmcnt(4)
  v_mfma_f32_16x16x32_bf16 v[84:87], v[44:47], v[164:167], v[84:87]
  v_mfma_f32_16x16x32_bf16 v[88:91], v[48:51], v[164:167], v[88:91]
  v_mfma_f32_16x16x32_bf16 v[92:95], v[52:55], v[164:167], v[92:95]
  v_mfma_f32_16x16x32_bf16 v[96:99], v[56:59], v[164:167], v[96:99]
  v_mfma_f32_16x16x32_bf16 v[100:103], v[60:63], v[164:167], v[100:103]
  v_mfma_f32_16x16x32_bf16 v[104:107], a[32:35], v[184:187], v[104:107]
  v_mfma_f32_16x16x32_bf16 v[108:111], a[36:39], v[184:187], v[108:111]
  v_mfma_f32_16x16x32_bf16 v[112:115], a[40:43], v[184:187], v[112:115]
  s_waitcnt vmcnt(1)
  s_cmp_lg_u32 s32, 0
  s_cbranch_scc1 Lpd_37
  v_cmp_gt_u32 vcc, 16, v31
  s_mov_b32 s95, 0x8000
  s_cmp_eq_u64 vcc, 0
  s_cbranch_scc1 Lpd_37
Lpoll_36:
  s_sleep 2
  global_load_dword v31, v4, s[90:91] sc1
  s_waitcnt vmcnt(0)
  v_cmp_gt_u32 vcc, 16, v31
  s_sub_u32 s95, s95, 1
  s_cmp_eq_u64 vcc, 0
  s_cbranch_scc1 Lpd_37
  s_cmp_lg_u32 s95, 0
  s_cbranch_scc1 Lpoll_36
Lpd_37:
  s_barrier
  s_nop 0
  buffer_load_dword v5, v6, s[48:51], s74 offen sc1
  buffer_load_dwordx4 v[192:195], v26, s[40:43], s73 offen sc1
  s_add_u32 s73, s73, 4096
  buffer_load_dwordx4 v[196:199], v26, s[40:43], s73 offen sc1
  s_add_u32 s73, s73, 4096
  buffer_load_dwordx4 v[200:203], v26, s[40:43], s73 offen sc1
  s_add_u32 s73, s73, 4096
  buffer_load_dwordx4 v[204:207], v26, s[40:43], s73 offen sc1
  s_add_u32 s73, s73, 4096
  buffer_load_dwordx4 v[208:211], v26, s[40:43], s73 offen sc1
  s_add_u32 s73, s73, 4096
  buffer_load_dwordx4 v[212:215], v26, s[40:43], s73 offen sc1
  v_mfma_f32_16x16x32_bf16 v[116:119], a[44:47], v[184:187], v[116:119]
  ds_write_b128 v11, v[84:87] offset:0
  s_add_u32 s73, s73, 4096
  buffer_load_dwordx4 v[216:219], v26, s[40:43], s73 offen sc1
  v_mfma_f32_16x16x32_bf16 v[120:123], a[96:99], v[184:187], v[120:123]
  ds_write_b128 v11, v[88:91] offset:1024
  v_mfma_f32_16x16x32_bf16 v[104:107], a[100:103], v[152:155], v[104:107]
  ds_write_b128 v11, v[92:95] offset:2048
  v_mfma_f32_16x16x32_bf16 v[108:111], a[104:107], v[152:155], v[108:111]
  ds_write_b128 v11, v[96:99] offset:3072
  s_add_u32 s73, s73, 4096
  buffer_load_dwordx4 v[220:223], v26, s[40:43], s73 offen sc1
  v_mfma_f32_16x16x32_bf16 v[112:115], v[32:35], v[152:155], v[112:115]
  ds_write_b128 v11, v[100:103] offset:4096
  v_mfma_f32_16x16x32_bf16 v[116:119], v[36:39], v[152:155], v[116:119]
  s_add_u32 s73, s73, 4096
  buffer_load_dwordx4 v[224:227], v26, s[40:43], s73 offen sc1
  v_mfma_f32_16x16x32_bf16 v[120:123], v[40:43], v[152:155], v[120:123]
  v_mfma_f32_16x16x32_bf16 v[104:107], v[44:47], v[168:171], v[104:107]
  v_mfma_f32_16x16x32_bf16 v[108:111], v[48:51], v[168:171], v[108:111]
  s_add_u32 s73, s73, 4096
  buffer_load_dwordx4 v[228:231], v26, s[40:43], s73 offen sc1
  v_mfma_f32_16x16x32_bf16 v[112:115], v[52:55], v[168:171], v[112:115]
  v_mfma_f32_16x16x32_bf16 v[116:119], v[56:59], v[168:171], v[116:119]
  s_add_u32 s73, s73, 4096
  buffer_load_dwordx4 v[232:235], v26, s[40:43], s73 offen sc1
  v_mfma_f32_16x16x32_bf16 v[120:123], v[60:63], v[168:171], v[120:123]
  v_mfma_f32_16x16x32_bf16 v[124:127], a[32:35], v[188:191], v[124:127]
  v_mfma_f32_16x16x32_bf16 v[128:131], a[36:39], v[188:191], v[128:131]
  s_add_u32 s73, s73, 4096
  buffer_load_dwordx4 v[236:239], v26, s[40:43], s73 offen sc1
  v_mfma_f32_16x16x32_bf16 v[132:135], a[40:43], v[188:191], v[132:135]
  v_mfma_f32_16x16x32_bf16 v[136:139], a[44:47], v[188:191], v[136:139]
  ds_write_b128 v12, v[104:107] offset:0
  s_add_u32 s73, s73, 4096
  buffer_load_dwordx4 v[240:243], v26, s[40:43], s73 offen sc1
  v_mfma_f32_16x16x32_bf16 v[140:143], a[96:99], v[188:191], v[140:143]
  ds_write_b128 v12, v[108:111] offset:1024
  v_mfma_f32_16x16x32_bf16 v[124:127], a[100:103], v[156:159], v[124:127]
  ds_write_b128 v12, v[112:115] offset:2048
  v_mfma_f32_16x16x32_bf16 v[128:131], a[104:107], v[156:159], v[128:131]
  ds_write_b128 v12, v[116:119] offset:3072
  s_add_u32 s73, s73, 4096
  buffer_load_dwordx4 v[244:247], v26, s[40:43], s73 offen sc1
  v_mfma_f32_16x16x32_bf16 v[132:135], v[32:35], v[156:159], v[132:135]
  ds_write_b128 v12, v[120:123] offset:4096
  v_mfma_f32_16x16x32_bf16 v[136:139], v[36:39], v[156:159], v[136:139]
  s_add_u32 s73, s73, 4096
  buffer_load_dwordx4 v[248:251], v26, s[40:43], s73 offen sc1
  v_mfma_f32_16x16x32_bf16 v[140:143], v[40:43], v[156:159], v[140:143]
  v_mfma_f32_16x16x32_bf16 v[124:127], v[44:47], v[172:175], v[124:127]
  v_mfma_f32_16x16x32_bf16 v[128:131], v[48:51], v[172:175], v[128:131]
  s_add_u32 s73, s73, 4096
  buffer_load_dwordx4 v[252:255], v26, s[40:43], s73 offen sc1
  v_mfma_f32_16x16x32_bf16 v[132:135], v[52:55], v[172:175], v[132:135]
  v_mfma_f32_16x16x32_bf16 v[136:139], v[56:59], v[172:175], v[136:139]
  v_mfma_f32_16x16x32_bf16 v[140:143], v[60:63], v[172:175], v[140:143]
  v_mfma_f32_16x16x32_bf16 v[64:67], a[32:35], v[176:179], v[64:67]
  v_mfma_f32_16x16x32_bf16 v[68:71], a[36:39], v[176:179], v[68:71]
  v_mfma_f32_16x16x32_bf16 v[72:75], a[40:43], v[176:179], v[72:75]
  v_mfma_f32_16x16x32_bf16 v[76:79], a[44:47], v[176:179], v[76:79]
  ds_write_b128 v13, v[124:127] offset:0
  v_mfma_f32_16x16x32_bf16 v[80:83], a[96:99], v[176:179], v[80:83]
  ds_write_b128 v13, v[128:131] offset:1024
  v_mfma_f32_16x16x32_bf16 v[64:67], a[100:103], v[144:147], v[64:67]
  ds_write_b128 v13, v[132:135] offset:2048
  v_mfma_f32_16x16x32_bf16 v[68:71], a[104:107], v[144:147], v[68:71]
  ds_write_b128 v13, v[136:139] offset:3072
  v_mfma_f32_16x16x32_bf16 v[72:75], v[32:35], v[144:147], v[72:75]
  ds_write_b128 v13, v[140:143] offset:4096
  v_mfma_f32_16x16x32_bf16 v[76:79], v[36:39], v[144:147], v[76:79]
  v_mfma_f32_16x16x32_bf16 v[80:83], v[40:43], v[144:147], v[80:83]
  s_waitcnt vmcnt(17)
  s_nop 0
  v_mfma_f32_16x16x32_bf16 v[64:67], v[44:47], v[160:163], v[64:67]
  v_mfma_f32_16x16x32_bf16 v[68:71], v[48:51], v[160:163], v[68:71]
  v_mfma_f32_16x16x32_bf16 v[72:75], v[52:55], v[160:163], v[72:75]
  v_mfma_f32_16x16x32_bf16 v[76:79], v[56:59], v[160:163], v[76:79]
  v_mfma_f32_16x16x32_bf16 v[80:83], v[60:63], v[160:163], v[80:83]
  s_add_u32 s73, s73, 4096
  buffer_load_dwordx4 v[148:151], v26, s[40:43], s73 offen sc1
  s_add_u32 s73, s73, 4096
  buffer_load_dwordx4 v[164:167], v26, s[40:43], s73 offen sc1
  s_add_u32 s73, s73, 4096
  buffer_load_dwordx4 v[180:183], v26, s[40:43], s73 offen sc1
  s_add_u32 s73, s73, 4096
  buffer_load_dwordx4 v[152:155], v26, s[40:43], s73 offen sc1
  s_waitcnt vmcnt(20)
  v_sub_f32 v10, 1.0, v5
  v_pk_mul_f32 v[64:65], v[64:65], v[10:11] op_sel_hi:[1,0]
  v_pk_mul_f32 v[66:67], v[66:67], v[10:11] op_sel_hi:[1,0]
  v_pk_mul_f32 v[68:69], v[68:69], v[10:11] op_sel_hi:[1,0]
  v_pk_mul_f32 v[70:71], v[70:71], v[10:11] op_sel_hi:[1,0]
  v_pk_mul_f32 v[72:73], v[72:73], v[10:11] op_sel_hi:[1,0]
  v_pk_mul_f32 v[74:75], v[74:75], v[10:11] op_sel_hi:[1,0]
  v_pk_mul_f32 v[76:77], v[76:77], v[10:11] op_sel_hi:[1,0]
  v_pk_mul_f32 v[78:79], v[78:79], v[10:11] op_sel_hi:[1,0]
  v_pk_mul_f32 v[80:81], v[80:81], v[10:11] op_sel_hi:[1,0]
  v_pk_mul_f32 v[82:83], v[82:83], v[10:11] op_sel_hi:[1,0]
  s_waitcnt lgkmcnt(0)
  s_barrier
  s_waitcnt vmcnt(19)
  s_nop 0
  v_mfma_f32_16x16x32_bf16 v[64:67], a[128:131], v[192:195], v[64:67]
  ds_read_b128 a[32:35], v9 offset:5120
  v_mfma_f32_16x16x32_bf16 v[68:71], a[132:135], v[192:195], v[68:71]
  ds_read_b128 a[36:39], v9 offset:6144
  v_mfma_f32_16x16x32_bf16 v[72:75], a[136:139], v[192:195], v[72:75]
  ds_read_b128 a[40:43], v9 offset:7168
  v_mfma_f32_16x16x32_bf16 v[76:79], a[140:143], v[192:195], v[76:79]
  ds_read_b128 a[44:47], v9 offset:8192
  v_mfma_f32_16x16x32_bf16 v[80:83], a[144:147], v[192:195], v[80:83]
  ds_read_b128 a[96:99], v9 offset:9216
  s_waitcnt vmcnt(18)
  s_nop 0
  v_mfma_f32_16x16x32_bf16 v[64:67], a[148:151], v[196:199], v[64:67]
  ds_read_b128 a[100:103], v9 offset:10240
  v_mfma_f32_16x16x32_bf16 v[68:71], a[152:155], v[196:199], v[68:71]
  ds_read_b128 a[104:107], v9 offset:11264
  v_mfma_f32_16x16x32_bf16 v[72:75], a[156:159], v[196:199], v[72:75]
  ds_read_b128 v[32:35], v9 offset:12288
  v_mfma_f32_16x16x32_bf16 v[76:79], a[160:163], v[196:199], v[76:79]
  ds_read_b128 v[36:39], v9 offset:13312
  v_mfma_f32_16x16x32_bf16 v[80:83], a[164:167], v[196:199], v[80:83]
  ds_read_b128 v[40:43], v9 offset:14336
  s_waitcnt vmcnt(17)
  s_nop 0
  v_mfma_f32_16x16x32_bf16 v[64:67], a[168:171], v[200:203], v[64:67]
  ds_read_b128 v[44:47], v9 offset:15360
  v_mfma_f32_16x16x32_bf16 v[68:71], a[172:175], v[200:203], v[68:71]
  ds_read_b128 v[48:51], v9 offset:16384
  v_mfma_f32_16x16x32_bf16 v[72:75], a[176:179], v[200:203], v[72:75]
  ds_read_b128 v[52:55], v9 offset:17408
  v_mfma_f32_16x16x32_bf16 v[76:79], a[180:183], v[200:203], v[76:79]
  ds_read_b128 v[56:59], v9 offset:18432
  v_mfma_f32_16x16x32_bf16 v[80:83], a[184:187], v[200:203], v[80:83]
  ds_read_b128 v[60:63], v9 offset:19456
  s_waitcnt vmcnt(16)
  s_nop 0
  v_mfma_f32_16x16x32_bf16 v[64:67], a[188:191], v[204:207], v[64:67]
  ds_read_b128 a[128:131], v9 offset:20480
  v_mfma_f32_16x16x32_bf16 v[68:71], a[192:195], v[204:207], v[68:71]
  ds_read_b128 a[132:135], v9 offset:21504
  v_mfma_f32_16x16x32_bf16 v[72:75], a[196:199], v[204:207], v[72:75]
  ds_read_b128 a[136:139], v9 offset:22528
  v_mfma_f32_16x16x32_bf16 v[76:79], a[200:203], v[204:207], v[76:79]
  ds_read_b128 a[140:143], v9 offset:23552
  v_mfma_f32_16x16x32_bf16 v[80:83], a[204:207], v[204:207], v[80:83]
  ds_read_b128 a[144:147], v9 offset:24576
  s_waitcnt vmcnt(15)
  s_nop 0
  v_mfma_f32_16x16x32_bf16 v[64:67], a[208:211], v[208:211], v[64:67]
  ds_read_b128 a[148:151], v9 offset:25600
  v_mfma_f32_16x16x32_bf16 v[68:71], a[212:215], v[208:211], v[68:71]
  ds_read_b128 a[152:155], v9 offset:26624
  v_mfma_f32_16x16x32_bf16 v[72:75], a[216:219], v[208:211], v[72:75]
  ds_read_b128 a[156:159], v9 offset:27648
  v_mfma_f32_16x16x32_bf16 v[76:79], a[220:223], v[208:211], v[76:79]
  ds_read_b128 a[160:163], v9 offset:28672
  v_mfma_f32_16x16x32_bf16 v[80:83], a[224:227], v[208:211], v[80:83]
  ds_read_b128 a[164:167], v9 offset:29696
  s_waitcnt vmcnt(14)
  s_nop 0
  v_mfma_f32_16x16x32_bf16 v[64:67], a[228:231], v[212:215], v[64:67]
  ds_read_b128 a[168:171], v9 offset:30720
  v_mfma_f32_16x16x32_bf16 v[68:71], a[232:235], v[212:215], v[68:71]
  ds_read_b128 a[172:175], v9 offset:31744
  v_mfma_f32_16x16x32_bf16 v[72:75], a[236:239], v[212:215], v[72:75]
  ds_read_b128 a[176:179], v9 offset:32768
  v_mfma_f32_16x16x32_bf16 v[76:79], a[240:243], v[212:215], v[76:79]
  ds_read_b128 a[180:183], v9 offset:33792
  v_mfma_f32_16x16x32_bf16 v[80:83], a[244:247], v[212:215], v[80:83]
  ds_read_b128 a[184:187], v9 offset:34816
  s_waitcnt vmcnt(13)
  s_nop 0
  v_mfma_f32_16x16x32_bf16 v[64:67], a[248:251], v[216:219], v[64:67]
  ds_read_b128 a[188:191], v9 offset:35840
  v_mfma_f32_16x16x32_bf16 v[68:71], a[252:255], v[216:219], v[68:71]
  ds_read_b128 a[192:195], v9 offset:36864
  v_mfma_f32_16x16x32_bf16 v[72:75], a[48:51], v[216:219], v[72:75]
  ds_read_b128 a[196:199], v9 offset:37888
  v_mfma_f32_16x16x32_bf16 v[76:79], a[52:55], v[216:219], v[76:79]
  ds_read_b128 a[200:203], v9 offset:38912
  v_mfma_f32_16x16x32_bf16 v[80:83], a[56:59], v[216:219], v[80:83]
  ds_read_b128 a[204:207], v9 offset:39936
  s_waitcnt vmcnt(12)
  s_nop 0
  v_mfma_f32_16x16x32_bf16 v[64:67], a[60:63], v[220:223], v[64:67]
  ds_read_b128 a[208:211], v9 offset:40960
  v_mfma_f32_16x16x32_bf16 v[68:71], a[64:67], v[220:223], v[68:71]
  ds_read_b128 a[212:215], v9 offset:41984
  v_mfma_f32_16x16x32_bf16 v[72:75], a[68:71], v[220:223], v[72:75]
  ds_read_b128 a[216:219], v9 offset:43008
  v_mfma_f32_16x16x32_bf16 v[76:79], a[72:75], v[220:223], v[76:79]
  ds_read_b128 a[220:223], v9 offset:44032
  v_mfma_f32_16x16x32_bf16 v[80:83], a[76:79], v[220:223], v[80:83]
  ds_read_b128 a[224:227], v9 offset:45056
  s_waitcnt vmcnt(11)
  s_nop 0
  v_mfma_f32_16x16x32_bf16 v[64:67], a[80:83], v[224:227], v[64:67]
  ds_read_b128 a[228:231], v9 offset:46080
  v_mfma_f32_16x16x32_bf16 v[68:71], a[84:87], v[224:227], v[68:71]
  ds_read_b128 a[232:235], v9 offset:47104
  v_mfma_f32_16x16x32_bf16 v[72:75], a[88:91], v[224:227], v[72:75]
  ds_read_b128 a[236:239], v9 offset:48128
  v_mfma_f32_16x16x32_bf16 v[76:79], a[92:95], v[224:227], v[76:79]
  ds_read_b128 a[240:243], v9 offset:49152
  v_mfma_f32_16x16x32_bf16 v[80:83], a[108:111], v[224:227], v[80:83]
  ds_read_b128 a[244:247], v9 offset:50176
  s_waitcnt vmcnt(10)
  s_nop 0
  v_mfma_f32_16x16x32_bf16 v[64:67], a[112:115], v[228:231], v[64:67]
  ds_read_b128 v[84:87], v8 offset:0
  v_mfma_f32_16x16x32_bf16 v[68:71], a[116:119], v[228:231], v[68:71]
  ds_read_b128 v[88:91], v8 offset:1024
  v_mfma_f32_16x16x32_bf16 v[72:75], a[0:3], v[228:231], v[72:75]
  ds_read_b128 v[92:95], v8 offset:2048
  v_mfma_f32_16x16x32_bf16 v[76:79], a[4:7], v[228:231], v[76:79]
  ds_read_b128 v[96:99], v8 offset:3072
  v_mfma_f32_16x16x32_bf16 v[80:83], a[8:11], v[228:231], v[80:83]
  ds_read_b128 v[100:103], v8 offset:4096
  s_waitcnt vmcnt(9)
  s_nop 0
  v_mfma_f32_16x16x32_bf16 v[64:67], a[12:15], v[232:235], v[64:67]
  ds_read_b128 v[104:107], v8 offset:5120
  v_mfma_f32_16x16x32_bf16 v[68:71], a[16:19], v[232:235], v[68:71]
  ds_read_b128 v[108:111], v8 offset:6144
  v_mfma_f32_16x16x32_bf16 v[72:75], a[20:23], v[232:235], v[72:75]
  ds_read_b128 v[112:115], v8 offset:7168
  v_mfma_f32_16x16x32_bf16 v[76:79], a[24:27], v[232:235], v[76:79]
  ds_read_b128 v[116:119], v8 offset:8192
  v_mfma_f32_16x16x32_bf16 v[80:83], a[28:31], v[232:235], v[80:83]
  ds_read_b128 v[120:123], v8 offset:9216
  s_waitcnt vmcnt(8) lgkmcnt(14)
  s_nop 0
  v_mfma_f32_16x16x32_bf16 v[64:67], a[32:35], v[236:239], v[64:67]
  ds_read_b128 v[124:127], v8 offset:10240
  v_mfma_f32_16x16x32_bf16 v[68:71], a[36:39], v[236:239], v[68:71]
  ds_read_b128 v[128:131], v8 offset:11264
  v_mfma_f32_16x16x32_bf16 v[72:75], a[40:43], v[236:239], v[72:75]
  ds_read_b128 v[132:135], v8 offset:12288
  v_mfma_f32_16x16x32_bf16 v[76:79], a[44:47], v[236:239], v[76:79]
  ds_read_b128 v[136:139], v8 offset:13312
  v_mfma_f32_16x16x32_bf16 v[80:83], a[96:99], v[236:239], v[80:83]
  ds_read_b128 v[140:143], v8 offset:14336
  s_waitcnt vmcnt(7)
  v_mfma_f32_16x16x32_bf16 v[64:67], a[100:103], v[240:243], v[64:67]
  v_mfma_f32_16x16x32_bf16 v[68:71], a[104:107], v[240:243], v[68:71]
  v_mfma_f32_16x16x32_bf16 v[72:75], v[32:35], v[240:243], v[72:75]
  v_mfma_f32_16x16x32_bf16 v[76:79], v[36:39], v[240:243], v[76:79]
  v_mfma_f32_16x16x32_bf16 v[80:83], v[40:43], v[240:243], v[80:83]
  s_waitcnt vmcnt(6)
  v_mfma_f32_16x16x32_bf16 v[64:67], v[44:47], v[244:247], v[64:67]
  v_mfma_f32_16x16x32_bf16 v[68:71], v[48:51], v[244:247], v[68:71]
  v_mfma_f32_16x16x32_bf16 v[72:75], v[52:55], v[244:247], v[72:75]
  v_mfma_f32_16x16x32_bf16 v[76:79], v[56:59], v[244:247], v[76:79]
  v_mfma_f32_16x16x32_bf16 v[80:83], v[60:63], v[244:247], v[80:83]
  s_waitcnt vmcnt(5)
  v_mfma_f32_16x16x32_bf16 v[64:67], a[128:131], v[248:251], v[64:67]
  v_mfma_f32_16x16x32_bf16 v[68:71], a[132:135], v[248:251], v[68:71]
  v_mfma_f32_16x16x32_bf16 v[72:75], a[136:139], v[248:251], v[72:75]
  v_mfma_f32_16x16x32_bf16 v[76:79], a[140:143], v[248:251], v[76:79]
  v_mfma_f32_16x16x32_bf16 v[80:83], a[144:147], v[248:251], v[80:83]
  s_waitcnt vmcnt(4)
  v_mfma_f32_16x16x32_bf16 v[64:67], a[148:151], v[252:255], v[64:67]
  v_mfma_f32_16x16x32_bf16 v[68:71], a[152:155], v[252:255], v[68:71]
  v_mfma_f32_16x16x32_bf16 v[72:75], a[156:159], v[252:255], v[72:75]
  v_mfma_f32_16x16x32_bf16 v[76:79], a[160:163], v[252:255], v[76:79]
  v_mfma_f32_16x16x32_bf16 v[80:83], a[164:167], v[252:255], v[80:83]
  s_waitcnt vmcnt(3)
  v_mfma_f32_16x16x32_bf16 v[64:67], a[168:171], v[148:151], v[64:67]
  v_mfma_f32_16x16x32_bf16 v[68:71], a[172:175], v[148:151], v[68:71]
  v_mfma_f32_16x16x32_bf16 v[72:75], a[176:179], v[148:151], v[72:75]
  v_mfma_f32_16x16x32_bf16 v[76:79], a[180:183], v[148:151], v[76:79]
  v_mfma_f32_16x16x32_bf16 v[80:83], a[184:187], v[148:151], v[80:83]
  s_waitcnt vmcnt(2)
  v_mfma_f32_16x16x32_bf16 v[64:67], a[188:191], v[164:167], v[64:67]
  v_mfma_f32_16x16x32_bf16 v[68:71], a[192:195], v[164:167], v[68:71]
  v_mfma_f32_16x16x32_bf16 v[72:75], a[196:199], v[164:167], v[72:75]
  v_mfma_f32_16x16x32_bf16 v[76:79], a[200:203], v[164:167], v[76:79]
  v_mfma_f32_16x16x32_bf16 v[80:83], a[204:207], v[164:167], v[80:83]
  s_waitcnt vmcnt(1)
  v_mfma_f32_16x16x32_bf16 v[64:67], a[208:211], v[180:183], v[64:67]
  v_mfma_f32_16x16x32_bf16 v[68:71], a[212:215], v[180:183], v[68:71]
  v_mfma_f32_16x16x32_bf16 v[72:75], a[216:219], v[180:183], v[72:75]
  v_mfma_f32_16x16x32_bf16 v[76:79], a[220:223], v[180:183], v[76:79]
  v_mfma_f32_16x16x32_bf16 v[80:83], a[224:227], v[180:183], v[80:83]
  s_waitcnt vmcnt(0) lgkmcnt(14)
  v_mfma_f32_16x16x32_bf16 v[64:67], a[228:231], v[152:155], v[64:67]
  v_mfma_f32_16x16x32_bf16 v[68:71], a[232:235], v[152:155], v[68:71]
  v_mfma_f32_16x16x32_bf16 v[72:75], a[236:239], v[152:155], v[72:75]
  v_mfma_f32_16x16x32_bf16 v[76:79], a[240:243], v[152:155], v[76:79]
  v_mfma_f32_16x16x32_bf16 v[80:83], a[244:247], v[152:155], v[80:83]
  s_waitcnt lgkmcnt(0)
  s_nop 0
  v_pk_add_f32 v[84:85], v[84:85], v[104:105]
  v_pk_add_f32 v[86:87], v[86:87], v[106:107]
  v_pk_add_f32 v[88:89], v[88:89], v[108:109]
  v_pk_add_f32 v[90:91], v[90:91], v[110:111]
  v_pk_add_f32 v[92:93], v[92:93], v[112:113]
  v_pk_add_f32 v[94:95], v[94:95], v[114:115]
  v_pk_add_f32 v[96:97], v[96:97], v[116:117]
  v_pk_add_f32 v[98:99], v[98:99], v[118:119]
  v_pk_add_f32 v[100:101], v[100:101], v[120:121]
  v_pk_add_f32 v[102:103], v[102:103], v[122:123]
  v_pk_add_f32 v[84:85], v[84:85], v[124:125]
  v_pk_add_f32 v[86:87], v[86:87], v[126:127]
  v_pk_add_f32 v[88:89], v[88:89], v[128:129]
  v_pk_add_f32 v[90:91], v[90:91], v[130:131]
  v_pk_add_f32 v[92:93], v[92:93], v[132:133]
  v_pk_add_f32 v[94:95], v[94:95], v[134:135]
  v_pk_add_f32 v[96:97], v[96:97], v[136:137]
  v_pk_add_f32 v[98:99], v[98:99], v[138:139]
  v_pk_add_f32 v[100:101], v[100:101], v[140:141]
  v_pk_add_f32 v[102:103], v[102:103], v[142:143]
  v_pk_fma_f32 v[64:65], v[84:85], v[10:11], v[64:65] op_sel_hi:[1,0,1]
  v_pk_fma_f32 v[66:67], v[86:87], v[10:11], v[66:67] op_sel_hi:[1,0,1]
  v_cvt_pk_bf16_f32 v104, v64, v65
  v_cvt_pk_bf16_f32 v105, v66, v67
  ds_write_b64 v17, v[104:105] offset:0
  v_pk_fma_f32 v[68:69], v[88:89], v[10:11], v[68:69] op_sel_hi:[1,0,1]
  v_pk_fma_f32 v[70:71], v[90:91], v[10:11], v[70:71] op_sel_hi:[1,0,1]
  v_cvt_pk_bf16_f32 v106, v68, v69
  v_cvt_pk_bf16_f32 v107, v70, v71
  ds_write_b64 v17, v[106:107] offset:32
  v_pk_fma_f32 v[72:73], v[92:93], v[10:11], v[72:73] op_sel_hi:[1,0,1]
  v_pk_fma_f32 v[74:75], v[94:95], v[10:11], v[74:75] op_sel_hi:[1,0,1]
  v_cvt_pk_bf16_f32 v108, v72, v73
  v_cvt_pk_bf16_f32 v109, v74, v75
  ds_write_b64 v17, v[108:109] offset:64
  v_pk_fma_f32 v[76:77], v[96:97], v[10:11], v[76:77] op_sel_hi:[1,0,1]
  v_pk_fma_f32 v[78:79], v[98:99], v[10:11], v[78:79] op_sel_hi:[1,0,1]
  v_cvt_pk_bf16_f32 v110, v76, v77
  v_cvt_pk_bf16_f32 v111, v78, v79
  ds_write_b64 v17, v[110:111] offset:96
  v_pk_fma_f32 v[80:81], v[100:101], v[10:11], v[80:81] op_sel_hi:[1,0,1]
  v_pk_fma_f32 v[82:83], v[102:103], v[10:11], v[82:83] op_sel_hi:[1,0,1]
  v_cvt_pk_bf16_f32 v112, v80, v81
  v_cvt_pk_bf16_f32 v113, v82, v83
  ds_write_b64 v17, v[112:113] offset:128
  ds_read_b128 v[64:67], v18
  ds_read_b128 v[68:71], v19
  ds_read_b128 v[72:75], v20
  s_waitcnt lgkmcnt(2)
  buffer_store_dwordx4 v[64:67], v21, s[52:55], s81 offen sc1
  s_waitcnt lgkmcnt(1)
  buffer_store_dwordx4 v[68:71], v22, s[52:55], s81 offen sc1
  s_waitcnt lgkmcnt(0)
  buffer_store_dwordx4 v[72:75], v23, s[52:55], s81 offen sc1
  s_endpgm
L_att:
  s_lshl_b32 s79, s79, 1
  s_add_u32 s79, s79, s34
  s_mul_i32 s80, s79, 3200
  s_add_u32 s56, s12, s80
  s_addc_u32 s57, s13, 0
  s_and_b32 s57, s57, 0xffff
  s_mov_b32 s58, 0xc80
  s_mov_b32 s59, 0x20000
  v_and_b32 v54, 15, v0
  v_lshrrev_b32 v55, 4, v0
  v_bfe_u32 v26, v54, 1, 3
  v_xor_b32 v26, v26, v55
  s_lshl_b32 s64, s33, 13
  s_add_u32 s64, s64, 98304
  v_lshlrev_b32 v27, 7, v54
  v_add_u32 v27, s64, v27
  v_lshl_add_u32 v10, v26, 4, v27
  v_xor_b32 v11, 64, v10
  v_bfe_u32 v26, v0, 2, 2
  v_and_b32 v27, 3, v0
  v_lshrrev_b32 v28, 1, v26
  v_and_b32 v29, 1, v55
  v_lshl_or_b32 v28, v29, 1, v28
  v_lshlrev_b32_e64 v28, 5, v28
  v_mul_u32_u24 v29, 6144, v55
  v_lshl_add_u32 v29, v26, 7, v29
  s_mul_i32 s64, s34, 160
  s_add_u32 s64, s64, s68
  v_mul_u32_u24 v27, 40, v27
  v_add_u32 v27, s64, v27
  v_add_u32 v30, 0, v27
  v_lshrrev_b32 v31, 7, v30
  v_and_b32 v30, 127, v30
  v_xor_b32 v30, v30, v28
  v_lshl_add_u32 v31, v31, 10, v29
  v_add_u32 v12, v30, v31
  v_add_u32 v18, 49152, v12
  v_add_u32 v30, 8, v27
  v_lshrrev_b32 v31, 7, v30
  v_and_b32 v30, 127, v30
  v_xor_b32 v30, v30, v28
  v_lshl_add_u32 v31, v31, 10, v29
  v_add_u32 v13, v30, v31
  v_add_u32 v19, 49152, v13
  v_add_u32 v30, 16, v27
  v_lshrrev_b32 v31, 7, v30
  v_and_b32 v30, 127, v30
  v_xor_b32 v30, v30, v28
  v_lshl_add_u32 v31, v31, 10, v29
  v_add_u32 v14, v30, v31
  v_add_u32 v20, 49152, v14
  v_add_u32 v30, 24, v27
  v_lshrrev_b32 v31, 7, v30
  v_and_b32 v30, 127, v30
  v_xor_b32 v30, v30, v28
  v_lshl_add_u32 v31, v31, 10, v29
  v_add_u32 v15, v30, v31
  v_add_u32 v21, 49152, v15
  v_add_u32 v30, 32, v27
  v_lshrrev_b32 v31, 7, v30
  v_and_b32 v30, 127, v30
  v_xor_b32 v30, v30, v28
  v_lshl_add_u32 v31, v31, 10, v29
  v_add_u32_e64 v16, v30, v31
  v_add_u32 v22, 49152, v16
  s_add_u32 m0, s62, 24576
  s_nop 0
  buffer_load_dwordx4 v5, s[44:47], s61 offen offset:0 lds
  s_add_u32 m0, s62, 25472
  s_nop 0
  buffer_load_dwordx4 v5, s[44:47], s61 offen offset:128 lds
  s_add_u32 m0, s62, 26368
  s_nop 0
  buffer_load_dwordx4 v5, s[44:47], s61 offen offset:256 lds
  s_add_u32 m0, s62, 27648
  s_nop 0
  buffer_load_dwordx4 v5, s[48:51], s61 offen offset:0 lds
  s_add_u32 m0, s62, 28544
  s_nop 0
  buffer_load_dwordx4 v5, s[48:51], s61 offen offset:128 lds
  s_add_u32 m0, s62, 29440
  s_nop 0
  buffer_load_dwordx4 v5, s[48:51], s61 offen offset:256 lds
  s_add_u32 s61, s61, s67
  s_waitcnt vmcnt(8)
  s_barrier
  s_nop 0
  ds_read_b128 a[96:99], v10 offset:0
  ds_read_b128 a[100:103], v10 offset:2048
  ds_read_b128 a[104:107], v10 offset:4096
  ds_read_b128 a[108:111], v10 offset:6144
  ds_read_b64_tr_b16 a[0:1], v12 offset:0
  ds_read_b64_tr_b16 a[2:3], v12 offset:512
  ds_read_b64_tr_b16 a[4:5], v12 offset:3072
  ds_read_b64_tr_b16 a[6:7], v12 offset:3584
  ds_read_b64_tr_b16 a[8:9], v13 offset:0
  ds_read_b64_tr_b16 a[10:11], v13 offset:512
  ds_read_b64_tr_b16 a[12:13], v13 offset:3072
  ds_read_b64_tr_b16 a[14:15], v13 offset:3584
  ds_read_b64_tr_b16 a[16:17], v14 offset:0
  ds_read_b64_tr_b16 a[18:19], v14 offset:512
  ds_read_b64_tr_b16 a[20:21], v14 offset:3072
  ds_read_b64_tr_b16 a[22:23], v14 offset:3584
  ds_read_b64_tr_b16 a[24:25], v15 offset:0
  ds_read_b64_tr_b16 a[26:27], v15 offset:512
  ds_read_b64_tr_b16 a[28:29], v15 offset:3072
  ds_read_b64_tr_b16 a[30:31], v15 offset:3584
  ds_read_b64_tr_b16 a[32:33], v16 offset:0
  ds_read_b64_tr_b16 a[34:35], v16 offset:512
  ds_read_b64_tr_b16 a[36:37], v16 offset:3072
  ds_read_b64_tr_b16 a[38:39], v16 offset:3584
  s_waitcnt lgkmcnt(14)
  s_nop 0
  v_mfma_f32_16x16x32_bf16 v[64:67], a[0:3], a[96:99], 0
  s_add_u32 m0, s63, 16256
  v_mfma_f32_16x16x32_bf16 v[68:71], a[0:3], a[100:103], 0
  buffer_load_dwordx4 v6, s[40:43], 0 offen offset:128 lds
  v_mfma_f32_16x16x32_bf16 v[72:75], a[0:3], a[104:107], 0
  s_add_u32 m0, s63, 17280
  v_mfma_f32_16x16x32_bf16 v[76:79], a[0:3], a[108:111], 0
  buffer_load_dwordx4 v7, s[40:43], 0 offen offset:128 lds
  v_mfma_f32_16x16x32_bf16 v[80:83], a[4:7], a[96:99], 0
  s_add_u32 m0, s63, 18304
  v_mfma_f32_16x16x32_bf16 v[84:87], a[4:7], a[100:103], 0
  buffer_load_dwordx4 v8, s[40:43], 0 offen offset:128 lds
  v_mfma_f32_16x16x32_bf16 v[88:91], a[4:7], a[104:107], 0
  s_add_u32 m0, s63, 19328
  v_mfma_f32_16x16x32_bf16 v[92:95], a[4:7], a[108:111], 0
  buffer_load_dwordx4 v9, s[40:43], 0 offen offset:128 lds
  v_mfma_f32_16x16x32_bf16 v[96:99], a[8:11], a[96:99], 0
  v_mfma_f32_16x16x32_bf16 v[100:103], a[8:11], a[100:103], 0
  s_add_u32 m0, s62, 49152
  v_mfma_f32_16x16x32_bf16 v[104:107], a[8:11], a[104:107], 0
  buffer_load_dwordx4 v5, s[44:47], s61 offen offset:0 lds
  v_mfma_f32_16x16x32_bf16 v[108:111], a[8:11], a[108:111], 0
  s_add_u32 m0, s62, 50048
  s_waitcnt lgkmcnt(12)
  v_mfma_f32_16x16x32_bf16 v[112:115], a[12:15], a[96:99], 0
  buffer_load_dwordx4 v5, s[44:47], s61 offen offset:128 lds
  v_mfma_f32_16x16x32_bf16 v[116:119], a[12:15], a[100:103], 0
  s_add_u32 m0, s62, 50944
  v_mfma_f32_16x16x32_bf16 v[120:123], a[12:15], a[104:107], 0
  buffer_load_dwordx4 v5, s[44:47], s61 offen offset:256 lds
  v_mfma_f32_16x16x32_bf16 v[124:127], a[12:15], a[108:111], 0
  s_waitcnt lgkmcnt(10)
  v_mfma_f32_16x16x32_bf16 v[128:131], a[16:19], a[96:99], 0
  s_add_u32 m0, s62, 52224
  v_mfma_f32_16x16x32_bf16 v[132:135], a[16:19], a[100:103], 0
  buffer_load_dwordx4 v5, s[48:51], s61 offen offset:0 lds
  v_mfma_f32_16x16x32_bf16 v[136:139], a[16:19], a[104:107], 0
  s_add_u32 m0, s62, 53120
  v_mfma_f32_16x16x32_bf16 v[140:143], a[16:19], a[108:111], 0
  buffer_load_dwordx4 v5, s[48:51], s61 offen offset:128 lds
  s_waitcnt lgkmcnt(8)
  v_mfma_f32_16x16x32_bf16 v[144:147], a[20:23], a[96:99], 0
  s_add_u32 m0, s62, 54016
  v_mfma_f32_16x16x32_bf16 v[148:151], a[20:23], a[100:103], 0
  buffer_load_dwordx4 v5, s[48:51], s61 offen offset:256 lds
  s_add_u32 s61, s61, s67
  v_mfma_f32_16x16x32_bf16 v[152:155], a[20:23], a[104:107], 0
  v_mfma_f32_16x16x32_bf16 v[156:159], a[20:23], a[108:111], 0
  s_add_u32 m0, s62, 73728
  s_waitcnt lgkmcnt(6)
  s_waitcnt vmcnt(10) lgkmcnt(0)
  s_barrier
  s_nop 0
  v_mfma_f32_16x16x32_bf16 v[160:163], a[24:27], a[96:99], 0
  ds_read_b128 a[112:115], v11 offset:0
  ds_read_b128 a[116:119], v11 offset:2048
  buffer_load_dwordx4 v5, s[44:47], s61 offen offset:0 lds
  v_mfma_f32_16x16x32_bf16 v[164:167], a[24:27], a[100:103], 0
  ds_read_b128 a[120:123], v11 offset:4096
  ds_read_b128 a[124:127], v11 offset:6144
  s_add_u32 m0, s62, 74624
  v_mfma_f32_16x16x32_bf16 v[168:171], a[24:27], a[104:107], 0
  ds_read_b64_tr_b16 a[48:49], v12 offset:24576
  ds_read_b64_tr_b16 a[50:51], v12 offset:25088
  buffer_load_dwordx4 v5, s[44:47], s61 offen offset:128 lds
  v_mfma_f32_16x16x32_bf16 v[172:175], a[24:27], a[108:111], 0
  ds_read_b64_tr_b16 a[52:53], v12 offset:27648
  ds_read_b64_tr_b16 a[54:55], v12 offset:28160
  s_add_u32 m0, s62, 75520
  v_mfma_f32_16x16x32_bf16 v[176:179], a[28:31], a[96:99], 0
  ds_read_b64_tr_b16 a[56:57], v13 offset:24576
  ds_read_b64_tr_b16 a[58:59], v13 offset:25088
  buffer_load_dwordx4 v5, s[44:47], s61 offen offset:256 lds
  v_mfma_f32_16x16x32_bf16 v[180:183], a[28:31], a[100:103], 0
  ds_read_b64_tr_b16 a[60:61], v13 offset:27648
  ds_read_b64_tr_b16 a[62:63], v13 offset:28160
  v_mfma_f32_16x16x32_bf16 v[184:187], a[28:31], a[104:107], 0
  ds_read_b64_tr_b16 a[64:65], v14 offset:24576
  ds_read_b64_tr_b16 a[66:67], v14 offset:25088
  s_add_u32 m0, s62, 76800
  v_mfma_f32_16x16x32_bf16 v[188:191], a[28:31], a[108:111], 0
  ds_read_b64_tr_b16 a[68:69], v14 offset:27648
  ds_read_b64_tr_b16 a[70:71], v14 offset:28160
  buffer_load_dwordx4 v5, s[48:51], s61 offen offset:0 lds
  v_mfma_f32_16x16x32_bf16 v[192:195], a[32:35], a[96:99], 0
  ds_read_b64_tr_b16 a[72:73], v15 offset:24576
  ds_read_b64_tr_b16 a[74:75], v15 offset:25088
  s_add_u32 m0, s62, 77696
  v_mfma_f32_16x16x32_bf16 v[196:199], a[32:35], a[100:103], 0
  ds_read_b64_tr_b16 a[76:77], v15 offset:27648
  ds_read_b64_tr_b16 a[78:79], v15 offset:28160
  buffer_load_dwordx4 v5, s[48:51], s61 offen offset:128 lds
  v_mfma_f32_16x16x32_bf16 v[200:203], a[32:35], a[104:107], 0
  ds_read_b64_tr_b16 a[80:81], v16 offset:24576
  ds_read_b64_tr_b16 a[82:83], v16 offset:25088
  s_add_u32 m0, s62, 78592
  v_mfma_f32_16x16x32_bf16 v[204:207], a[32:35], a[108:111], 0
  ds_read_b64_tr_b16 a[84:85], v16 offset:27648
  ds_read_b64_tr_b16 a[86:87], v16 offset:28160
  buffer_load_dwordx4 v5, s[48:51], s61 offen offset:256 lds
  s_add_u32 s61, s61, s67
  v_mfma_f32_16x16x32_bf16 v[208:211], a[36:39], a[96:99], 0
  v_mfma_f32_16x16x32_bf16 v[212:215], a[36:39], a[100:103], 0
  v_mfma_f32_16x16x32_bf16 v[216:219], a[36:39], a[104:107], 0
  v_mfma_f32_16x16x32_bf16 v[220:223], a[36:39], a[108:111], 0
  s_waitcnt vmcnt(6) lgkmcnt(0)
  s_barrier
  s_nop 0
  v_mfma_f32_16x16x32_bf16 v[64:67], a[48:51], a[112:115], v[64:67]
  ds_read_b128 a[96:99], v10 offset:16384
  s_add_u32 m0, s63, 32512
  v_mfma_f32_16x16x32_bf16 v[68:71], a[48:51], a[116:119], v[68:71]
  ds_read_b128 a[100:103], v10 offset:18432
  buffer_load_dwordx4 v6, s[40:43], 0 offen offset:256 lds
  v_mfma_f32_16x16x32_bf16 v[72:75], a[48:51], a[120:123], v[72:75]
  ds_read_b128 a[104:107], v10 offset:20480
  s_add_u32 m0, s63, 33536
  v_mfma_f32_16x16x32_bf16 v[76:79], a[48:51], a[124:127], v[76:79]
  ds_read_b128 a[108:111], v10 offset:22528
  buffer_load_dwordx4 v7, s[40:43], 0 offen offset:256 lds
  v_mfma_f32_16x16x32_bf16 v[80:83], a[52:55], a[112:115], v[80:83]
  ds_read_b64_tr_b16 a[0:1], v18 offset:0
  s_and_b32 s65, s2, 7
  v_mfma_f32_16x16x32_bf16 v[84:87], a[52:55], a[116:119], v[84:87]
  ds_read_b64_tr_b16 a[2:3], v18 offset:512
  s_add_u32 m0, s63, 34560
  v_mfma_f32_16x16x32_bf16 v[88:91], a[52:55], a[120:123], v[88:91]
  ds_read_b64_tr_b16 a[4:5], v18 offset:3072
  buffer_load_dwordx4 v8, s[40:43], 0 offen offset:256 lds
  v_mfma_f32_16x16x32_bf16 v[92:95], a[52:55], a[124:127], v[92:95]
  ds_read_b64_tr_b16 a[6:7], v18 offset:3584
  s_lshr_b32 s39, s2, 3
  v_mfma_f32_16x16x32_bf16 v[96:99], a[56:59], a[112:115], v[96:99]
  ds_read_b64_tr_b16 a[8:9], v19 offset:0
  s_add_u32 m0, s63, 35584
  v_mfma_f32_16x16x32_bf16 v[100:103], a[56:59], a[116:119], v[100:103]
  ds_read_b64_tr_b16 a[10:11], v19 offset:512
  buffer_load_dwordx4 v9, s[40:43], 0 offen offset:256 lds
  v_mfma_f32_16x16x32_bf16 v[104:107], a[56:59], a[120:123], v[104:107]
  ds_read_b64_tr_b16 a[12:13], v19 offset:3072
  s_lshl_b32 s37, s65, 2
  v_mfma_f32_16x16x32_bf16 v[108:111], a[56:59], a[124:127], v[108:111]
  ds_read_b64_tr_b16 a[14:15], v19 offset:3584
  s_add_u32 m0, s62, 0
  v_mfma_f32_16x16x32_bf16 v[112:115], a[60:63], a[112:115], v[112:115]
  ds_read_b64_tr_b16 a[16:17], v20 offset:0
  buffer_load_dwordx4 v5, s[44:47], s61 offen offset:0 lds
  v_mfma_f32_16x16x32_bf16 v[116:119], a[60:63], a[116:119], v[116:119]
  ds_read_b64_tr_b16 a[18:19], v20 offset:512
  s_and_b32 s64, s39, 3
  v_mfma_f32_16x16x32_bf16 v[120:123], a[60:63], a[120:123], v[120:123]
  ds_read_b64_tr_b16 a[20:21], v20 offset:3072
  s_add_u32 m0, s62, 896
  v_mfma_f32_16x16x32_bf16 v[124:127], a[60:63], a[124:127], v[124:127]
  ds_read_b64_tr_b16 a[22:23], v20 offset:3584
  buffer_load_dwordx4 v5, s[44:47], s61 offen offset:128 lds
  v_mfma_f32_16x16x32_bf16 v[128:131], a[64:67], a[112:115], v[128:131]
  ds_read_b64_tr_b16 a[24:25], v21 offset:0
  s_add_u32 s37, s37, s64
  v_mfma_f32_16x16x32_bf16 v[132:135], a[64:67], a[116:119], v[132:135]
  ds_read_b64_tr_b16 a[26:27], v21 offset:512
  s_add_u32 m0, s62, 1792
  v_mfma_f32_16x16x32_bf16 v[136:139], a[64:67], a[120:123], v[136:139]
  ds_read_b64_tr_b16 a[28:29], v21 offset:3072
  buffer_load_dwordx4 v5, s[44:47], s61 offen offset:256 lds
  v_mfma_f32_16x16x32_bf16 v[140:143], a[64:67], a[124:127], v[140:143]
  ds_read_b64_tr_b16 a[30:31], v21 offset:3584
  s_add_u32 m0, s62, 3072
  v_mfma_f32_16x16x32_bf16 v[144:147], a[68:71], a[112:115], v[144:147]
  ds_read_b64_tr_b16 a[32:33], v22 offset:0
  buffer_load_dwordx4 v5, s[48:51], s61 offen offset:0 lds
  v_mfma_f32_16x16x32_bf16 v[148:151], a[68:71], a[116:119], v[148:151]
  ds_read_b64_tr_b16 a[34:35], v22 offset:512
  s_lshr_b32 s38, s39, 2
  v_mfma_f32_16x16x32_bf16 v[152:155], a[68:71], a[120:123], v[152:155]
  ds_read_b64_tr_b16 a[36:37], v22 offset:3072
  s_add_u32 m0, s62, 3968
  v_mfma_f32_16x16x32_bf16 v[156:159], a[68:71], a[124:127], v[156:159]
  ds_read_b64_tr_b16 a[38:39], v22 offset:3584
  buffer_load_dwordx4 v5, s[48:51], s61 offen offset:128 lds
  v_mfma_f32_16x16x32_bf16 v[160:163], a[72:75], a[112:115], v[160:163]
  s_lshr_b32 s83, s39, 1
  s_lshl_b32 s83, s83, 1
  v_mfma_f32_16x16x32_bf16 v[164:167], a[72:75], a[116:119], v[164:167]
  s_add_u32 m0, s62, 4864
  s_and_b32 s39, s39, 1
  v_mfma_f32_16x16x32_bf16 v[168:171], a[72:75], a[120:123], v[168:171]
  buffer_load_dwordx4 v5, s[48:51], s61 offen offset:256 lds
  s_add_u32 s61, s61, s67
  s_lshl_b32 s64, s65, 1
  v_mfma_f32_16x16x32_bf16 v[172:175], a[72:75], a[124:127], v[172:175]
  s_add_u32 s39, s39, s64
  s_mul_i32 s64, s38, 378880
  v_mfma_f32_16x16x32_bf16 v[176:179], a[76:79], a[112:115], v[176:179]
  s_add_u32 m0, s62, 24576
  s_add_u32 s84, s30, s64
  s_addc_u32 s85, s31, 0
  v_mfma_f32_16x16x32_bf16 v[180:183], a[76:79], a[116:119], v[180:183]
  buffer_load_dwordx4 v5, s[44:47], s61 offen offset:0 lds
  s_add_u32 s84, s84, 0xa00000
  s_addc_u32 s85, s85, 0
  v_mfma_f32_16x16x32_bf16 v[184:187], a[76:79], a[120:123], v[184:187]
  s_and_b32 s85, s85, 0xffff
  s_mov_b32 s86, 0x5c800
  v_mfma_f32_16x16x32_bf16 v[188:191], a[76:79], a[124:127], v[188:191]
  s_mul_i32 s101, s60, 256
  s_mov_b32 s87, 0x20000
  v_mfma_f32_16x16x32_bf16 v[192:195], a[80:83], a[112:115], v[192:195]
  s_bfm_b64 exec, 24, 0
  buffer_load_dword v63, v24, s[96:99], s101 offen
  s_mov_b64 exec, -1
  s_mul_i32 s89, s32, 5120
  v_mfma_f32_16x16x32_bf16 v[196:199], a[80:83], a[116:119], v[196:199]
  s_add_u32 s90, s30, 0x1300000
  s_addc_u32 s91, s31, 0
  v_add_u32 v3, 4096, v2
  v_mfma_f32_16x16x32_bf16 v[200:203], a[80:83], a[120:123], v[200:203]
  s_mov_b32 s70, 0x3fb8aa3b
  s_mov_b32 s71, 0x3fb8aa3b
  v_mfma_f32_16x16x32_bf16 v[204:207], a[80:83], a[124:127], v[204:207]
  s_bfm_b64 exec, 12, 0
  buffer_load_dword v63, v25, s[40:43], 0 offen offset:512
  s_mov_b64 exec, -1
  v_lshrrev_b32 v50, 4, v0
  v_mfma_f32_16x16x32_bf16 v[208:211], a[84:87], a[112:115], v[208:211]
  v_and_b32_e64 v51, 15, v0
  v_bfe_u32 v52, v0, 2, 2
  v_mfma_f32_16x16x32_bf16 v[212:215], a[84:87], a[116:119], v[212:215]
  v_and_b32_e64 v53, 3, v0
  v_mul_u32_u24 v48, 800, v50
  v_mfma_f32_16x16x32_bf16 v[216:219], a[84:87], a[120:123], v[216:219]
  v_mad_u32_u24 v48, v52, 40, v48
  v_cmp_eq_u32 vcc, v50, v53
  v_mfma_f32_16x16x32_bf16 v[220:223], a[84:87], a[124:127], v[220:223]
  v_mov_b32 v49, 3200
  v_cndmask_b32 v48, v49, v48, vcc
  s_add_u32 s66, s63, 16384
  s_waitcnt vmcnt(13) lgkmcnt(0)
  s_barrier
  v_mfma_f32_16x16x32_bf16 v[64:67], a[0:3], a[96:99], v[64:67]
  ds_read_b128 a[112:115], v11 offset:16384
  s_add_u32 m0, s62, 25472
  v_mfma_f32_16x16x32_bf16 v[68:71], a[0:3], a[100:103], v[68:71]
  ds_read_b128 a[116:119], v11 offset:18432
  buffer_load_dwordx4 v5, s[44:47], s61 offen offset:128 lds
  v_mfma_f32_16x16x32_bf16 v[72:75], a[0:3], a[104:107], v[72:75]
  ds_read_b128 a[120:123], v11 offset:20480
  v_add_u32_e64 v23, s66, v48
  v_mfma_f32_16x16x32_bf16 v[76:79], a[0:3], a[108:111], v[76:79]
  ds_read_b128 a[124:127], v11 offset:22528
  s_add_u32 m0, s62, 26368
  v_mfma_f32_16x16x32_bf16 v[80:83], a[4:7], a[96:99], v[80:83]
  ds_read_b64_tr_b16 a[48:49], v18 offset:24576
  buffer_load_dwordx4 v5, s[44:47], s61 offen offset:256 lds
  v_mfma_f32_16x16x32_bf16 v[84:87], a[4:7], a[100:103], v[84:87]
  ds_read_b64_tr_b16 a[50:51], v18 offset:25088
  v_add_u32_e64 v26, s66, v49
  v_mfma_f32_16x16x32_bf16 v[88:91], a[4:7], a[104:107], v[88:91]
  ds_read_b64_tr_b16 a[52:53], v18 offset:27648
  s_add_u32 m0, s62, 27648
  v_mfma_f32_16x16x32_bf16 v[92:95], a[4:7], a[108:111], v[92:95]
  ds_read_b64_tr_b16 a[54:55], v18 offset:28160
  buffer_load_dwordx4 v5, s[48:51], s61 offen offset:0 lds
  v_mfma_f32_16x16x32_bf16 v[96:99], a[8:11], a[96:99], v[96:99]
  ds_read_b64_tr_b16 a[56:57], v19 offset:24576
  s_lshl_b32 s64, s33, 6
  v_mfma_f32_16x16x32_bf16 v[100:103], a[8:11], a[100:103], v[100:103]
  ds_read_b64_tr_b16 a[58:59], v19 offset:25088
  v_add_u32 v48, s64, v51
  v_mfma_f32_16x16x32_bf16 v[104:107], a[8:11], a[104:107], v[104:107]
  ds_read_b64_tr_b16 a[60:61], v19 offset:27648
  s_add_u32 m0, s62, 28544
  v_mfma_f32_16x16x32_bf16 v[108:111], a[8:11], a[108:111], v[108:111]
  ds_read_b64_tr_b16 a[62:63], v19 offset:28160
  buffer_load_dwordx4 v5, s[48:51], s61 offen offset:128 lds
  v_mfma_f32_16x16x32_bf16 v[112:115], a[12:15], a[96:99], v[112:115]
  ds_read_b64_tr_b16 a[64:65], v20 offset:24576
  s_mul_i32 s64, s34, 45056
  v_mfma_f32_16x16x32_bf16 v[116:119], a[12:15], a[100:103], v[116:119]
  ds_read_b64_tr_b16 a[66:67], v20 offset:25088
  s_add_u32 m0, s62, 29440
  v_mfma_f32_16x16x32_bf16 v[120:123], a[12:15], a[104:107], v[120:123]
  ds_read_b64_tr_b16 a[68:69], v20 offset:27648
  buffer_load_dwordx4 v5, s[48:51], s61 offen offset:256 lds
  s_add_u32 s61, s61, s67
  s_nop 0
  v_mfma_f32_16x16x32_bf16 v[124:127], a[12:15], a[108:111], v[124:127]
  ds_read_b64_tr_b16 a[70:71], v20 offset:28160
  v_mul_u32_u24 v27, 352, v48
  v_mfma_f32_16x16x32_bf16 v[128:131], a[16:19], a[96:99], v[128:131]
  ds_read_b64_tr_b16 a[72:73], v21 offset:24576
  s_add_u32 m0, s63, -384
  v_mfma_f32_16x16x32_bf16 v[132:135], a[16:19], a[100:103], v[132:135]
  ds_read_b64_tr_b16 a[74:75], v21 offset:25088
  buffer_load_dwordx4 v6, s[40:43], 0 offen offset:384 lds
  v_mfma_f32_16x16x32_bf16 v[136:139], a[16:19], a[104:107], v[136:139]
  ds_read_b64_tr_b16 a[76:77], v21 offset:27648
  v_mul_u32_u24 v49, 80, v50
  v_mfma_f32_16x16x32_bf16 v[140:143], a[16:19], a[108:111], v[140:143]
  ds_read_b64_tr_b16 a[78:79], v21 offset:28160
  v_add3_u32 v27, v27, v49, s64
  v_mfma_f32_16x16x32_bf16 v[144:147], a[20:23], a[96:99], v[144:147]
  ds_read_b64_tr_b16 a[80:81], v22 offset:24576
  s_add_u32 m0, s63, 640
  v_mfma_f32_16x16x32_bf16 v[148:151], a[20:23], a[100:103], v[148:151]
  ds_read_b64_tr_b16 a[82:83], v22 offset:25088
  buffer_load_dwordx4 v7, s[40:43], 0 offen offset:384 lds
  v_mfma_f32_16x16x32_bf16 v[152:155], a[20:23], a[104:107], v[152:155]
  ds_read_b64_tr_b16 a[84:85], v22 offset:27648
  s_mul_i32 s65, s34, 28672
  v_mfma_f32_16x16x32_bf16 v[156:159], a[20:23], a[108:111], v[156:159]
  ds_read_b64_tr_b16 a[86:87], v22 offset:28160
  s_add_u32 m0, s63, 1664
  v_mfma_f32_16x16x32_bf16 v[160:163], a[24:27], a[96:99], v[160:163]
  buffer_load_dwordx4 v8, s[40:43], 0 offen offset:384 lds
  s_add_u32 s65, s65, 90112
  v_mfma_f32_16x16x32_bf16 v[164:167], a[24:27], a[100:103], v[164:167]
  v_mul_u32_u24 v28, 224, v48
  v_mul_u32_u24_e64 v49, 48, v50
  v_mfma_f32_16x16x32_bf16 v[168:171], a[24:27], a[104:107], v[168:171]
  s_add_u32 m0, s63, 2688
  v_add3_u32 v28, v28, v49, s65
  v_mfma_f32_16x16x32_bf16 v[172:175], a[24:27], a[108:111], v[172:175]
  buffer_load_dwordx4 v9, s[40:43], 0 offen offset:384 lds
  v_lshrrev_b32 v48, 2, v0
  v_mfma_f32_16x16x32_bf16 v[176:179], a[28:31], a[96:99], v[176:179]
  v_lshlrev_b32 v49, 3, v53
  s_mul_i32 s66, s33, 160
  v_mfma_f32_16x16x32_bf16 v[180:183], a[28:31], a[100:103], v[180:183]
  s_add_u32 s64, s64, s66
  v_mul_u32_u24 v29, 352, v48
  v_mfma_f32_16x16x32_bf16 v[184:187], a[28:31], a[104:107], v[184:187]
  s_add_u32 m0, s62, 49152
  v_add3_u32 v29, v29, v49, s64
  v_mfma_f32_16x16x32_bf16 v[188:191], a[28:31], a[108:111], v[188:191]
  buffer_load_dwordx4 v5, s[44:47], s61 offen offset:0 lds
  s_mul_i32 s66, s33, 96
  v_mfma_f32_16x16x32_bf16 v[192:195], a[32:35], a[96:99], v[192:195]
  s_add_u32 s65, s65, s66
  v_mul_u32_u24 v30, 224, v48
  v_mfma_f32_16x16x32_bf16 v[196:199], a[32:35], a[100:103], v[196:199]
  s_add_u32 m0, s62, 50048
  v_add3_u32 v30, v30, v49, s65
  v_mfma_f32_16x16x32_bf16 v[200:203], a[32:35], a[104:107], v[200:203]
  buffer_load_dwordx4 v5, s[44:47], s61 offen offset:128 lds
  s_add_u32 s66, s63, 49152
  v_mfma_f32_16x16x32_bf16 v[204:207], a[32:35], a[108:111], v[204:207]
  v_mul_u32_u24 v48, 80, v51
  v_lshl_add_u32 v48, v50, 3, v48
  v_mfma_f32_16x16x32_bf16 v[208:211], a[36:39], a[96:99], v[208:211]
  v_add_u32 v61, s66, v48
  v_add_u32 v62, s66, v2
  v_mfma_f32_16x16x32_bf16 v[212:215], a[36:39], a[100:103], v[212:215]
  v_mov_b32 v48, 0x7fffffff
  v_cmp_gt_u32 vcc, 32, v0
  s_nop 1
  v_cndmask_b32 v60, v48, v2, vcc
  v_mfma_f32_16x16x32_bf16 v[216:219], a[36:39], a[104:107], v[216:219]
  s_lshl_b32 s78, s79, 1
  s_add_u32 s78, s78, s33
  v_mfma_f32_16x16x32_bf16 v[220:223], a[36:39], a[108:111], v[220:223]
  s_lshl_b32 s78, s78, 4
  s_add_u32 s78, s78, s35
  s_waitcnt vmcnt(14) lgkmcnt(0)
  s_barrier
  s_nop 0
  v_mfma_f32_16x16x32_bf16 v[64:67], a[48:51], a[112:115], v[64:67]
  ds_read_b128 a[96:99], v10 offset:32768
  s_add_u32 m0, s62, 50944
  v_mfma_f32_16x16x32_bf16 v[68:71], a[48:51], a[116:119], v[68:71]
  ds_read_b128 a[100:103], v10 offset:34816
  buffer_load_dwordx4 v5, s[44:47], s61 offen offset:256 lds
  v_mfma_f32_16x16x32_bf16 v[72:75], a[48:51], a[120:123], v[72:75]
  ds_read_b128 a[104:107], v10 offset:36864
  s_add_u32 m0, s62, 52224
  v_mfma_f32_16x16x32_bf16 v[76:79], a[48:51], a[124:127], v[76:79]
  ds_read_b128 a[108:111], v10 offset:38912
  buffer_load_dwordx4 v5, s[48:51], s61 offen offset:0 lds
  v_mfma_f32_16x16x32_bf16 v[80:83], a[52:55], a[112:115], v[80:83]
  ds_read_b64_tr_b16 a[0:1], v12 offset:0
  s_add_u32 m0, s62, 53120
  v_mfma_f32_16x16x32_bf16 v[84:87], a[52:55], a[116:119], v[84:87]
  ds_read_b64_tr_b16 a[2:3], v12 offset:512
  buffer_load_dwordx4 v5, s[48:51], s61 offen offset:128 lds
  v_mfma_f32_16x16x32_bf16 v[88:91], a[52:55], a[120:123], v[88:91]
  ds_read_b64_tr_b16 a[4:5], v12 offset:3072
  s_mul_i32 s78, s78, 3584
  v_mfma_f32_16x16x32_bf16 v[92:95], a[52:55], a[124:127], v[92:95]
  ds_read_b64_tr_b16 a[6:7], v12 offset:3584
  s_add_u32 m0, s62, 54016
  v_mfma_f32_16x16x32_bf16 v[96:99], a[56:59], a[112:115], v[96:99]
  ds_read_b64_tr_b16 a[8:9], v13 offset:0
  buffer_load_dwordx4 v5, s[48:51], s61 offen offset:256 lds
  s_add_u32 s61, s61, s67
  s_nop 0
  v_mfma_f32_16x16x32_bf16 v[100:103], a[56:59], a[116:119], v[100:103]
  ds_read_b64_tr_b16 a[10:11], v13 offset:512
  s_add_u32 m0, s62, 73728
  v_mfma_f32_16x16x32_bf16 v[104:107], a[56:59], a[120:123], v[104:107]
  ds_read_b64_tr_b16 a[12:13], v13 offset:3072
  buffer_load_dwordx4 v5, s[44:47], s61 offen offset:0 lds
  v_mfma_f32_16x16x32_bf16 v[108:111], a[56:59], a[124:127], v[108:111]
  ds_read_b64_tr_b16 a[14:15], v13 offset:3584
  v_cmp_gt_u32 s[72:73], 2, v50
  v_mfma_f32_16x16x32_bf16 v[112:115], a[60:63], a[112:115], v[112:115]
  ds_read_b64_tr_b16 a[16:17], v14 offset:0
  s_add_u32 m0, s62, 74624
  v_mfma_f32_16x16x32_bf16 v[116:119], a[60:63], a[116:119], v[116:119]
  ds_read_b64_tr_b16 a[18:19], v14 offset:512
  buffer_load_dwordx4 v5, s[44:47], s61 offen offset:128 lds
  v_mfma_f32_16x16x32_bf16 v[120:123], a[60:63], a[120:123], v[120:123]
  ds_read_b64_tr_b16 a[20:21], v14 offset:3072
  s_add_u32 m0, s62, 75520
  v_mfma_f32_16x16x32_bf16 v[124:127], a[60:63], a[124:127], v[124:127]
  ds_read_b64_tr_b16 a[22:23], v14 offset:3584
  buffer_load_dwordx4 v5, s[44:47], s61 offen offset:256 lds
  v_mfma_f32_16x16x32_bf16 v[128:131], a[64:67], a[112:115], v[128:131]
  ds_read_b64_tr_b16 a[24:25], v15 offset:0
  v_cmp_gt_u32 s[74:75], 5, v51
  s_nop 0
  s_and_b64 s[76:77], s[72:73], s[74:75]
  v_mfma_f32_16x16x32_bf16 v[132:135], a[64:67], a[116:119], v[132:135]
  ds_read_b64_tr_b16 a[26:27], v15 offset:512
  s_add_u32 m0, s63, 49152
  v_mfma_f32_16x16x32_bf16 v[136:139], a[64:67], a[120:123], v[136:139]
  ds_read_b64_tr_b16 a[28:29], v15 offset:3072
  buffer_load_dwordx4 v2, s[56:59], 0 offen offset:0 lds
  v_mfma_f32_16x16x32_bf16 v[140:143], a[64:67], a[124:127], v[140:143]
  ds_read_b64_tr_b16 a[30:31], v15 offset:3584
  s_add_u32 m0, s62, 76800
  v_mfma_f32_16x16x32_bf16 v[144:147], a[68:71], a[112:115], v[144:147]
  ds_read_b64_tr_b16 a[32:33], v16 offset:0
  buffer_load_dwordx4 v5, s[48:51], s61 offen offset:0 lds
  v_mfma_f32_16x16x32_bf16 v[148:151], a[68:71], a[116:119], v[148:151]
  ds_read_b64_tr_b16 a[34:35], v16 offset:512
  s_add_u32 s52, s30, 0x1000000
  s_addc_u32 s53, s31, 0
  s_nop 0
  v_mfma_f32_16x16x32_bf16 v[152:155], a[68:71], a[120:123], v[152:155]
  ds_read_b64_tr_b16 a[36:37], v16 offset:3072
  s_add_u32 m0, s63, 49152
  v_mfma_f32_16x16x32_bf16 v[156:159], a[68:71], a[124:127], v[156:159]
  ds_read_b64_tr_b16 a[38:39], v16 offset:3584
  buffer_load_dwordx4 v2, s[56:59], 0 offen offset:1024 lds
  v_mfma_f32_16x16x32_bf16 v[160:163], a[72:75], a[112:115], v[160:163]
  s_add_u32 m0, s62, 77696
  s_and_b32 s53, s53, 0xffff
  v_mfma_f32_16x16x32_bf16 v[164:167], a[72:75], a[116:119], v[164:167]
  buffer_load_dwordx4 v5, s[48:51], s61 offen offset:128 lds
  s_mov_b32 s54, 0xe0000
  v_mfma_f32_16x16x32_bf16 v[168:171], a[72:75], a[120:123], v[168:171]
  s_mov_b32 s55, 0x20000
  v_mov_b32_e64 v42, 0
  v_mfma_f32_16x16x32_bf16 v[172:175], a[72:75], a[124:127], v[172:175]
  s_add_u32 m0, s63, 49152
  v_mov_b32_e64 v43, 0
  v_mfma_f32_16x16x32_bf16 v[176:179], a[76:79], a[112:115], v[176:179]
  buffer_load_dwordx4 v2, s[56:59], 0 offen offset:2048 lds
  v_mov_b32_e64 v54, 0
  v_mfma_f32_16x16x32_bf16 v[180:183], a[76:79], a[116:119], v[180:183]
  s_add_u32 m0, s62, 78592
  v_mov_b32_e64 v55, 0
  v_mfma_f32_16x16x32_bf16 v[184:187], a[76:79], a[120:123], v[184:187]
  buffer_load_dwordx4 v5, s[48:51], s61 offen offset:256 lds
  s_add_u32 s61, s61, s67
  s_nop 0
  v_mfma_f32_16x16x32_bf16 v[188:191], a[76:79], a[124:127], v[188:191]
  v_mfma_f32_16x16x32_bf16 v[192:195], a[80:83], a[112:115], v[192:195]
  s_add_u32 m0, s63, 49152
  v_mfma_f32_16x16x32_bf16 v[196:199], a[80:83], a[116:119], v[196:199]
  buffer_load_dwordx4 v2, s[56:59], 0 offen offset:3072 lds
  v_mfma_f32_16x16x32_bf16 v[200:203], a[80:83], a[120:123], v[200:203]
  s_add_u32 m0, s63, 15872
  v_mfma_f32_16x16x32_bf16 v[204:207], a[80:83], a[124:127], v[204:207]
  buffer_load_dwordx4 v6, s[40:43], 0 offen offset:512 lds
  v_mfma_f32_16x16x32_bf16 v[208:211], a[84:87], a[112:115], v[208:211]
  v_mfma_f32_16x16x32_bf16 v[212:215], a[84:87], a[116:119], v[212:215]
  v_mfma_f32_16x16x32_bf16 v[216:219], a[84:87], a[120:123], v[216:219]
  v_mfma_f32_16x16x32_bf16 v[220:223], a[84:87], a[124:127], v[220:223]
  s_waitcnt vmcnt(21) lgkmcnt(0)
  s_barrier
  v_mfma_f32_16x16x32_bf16 v[64:67], a[0:3], a[96:99], v[64:67]
  ds_read_b128 a[112:115], v11 offset:32768
  s_add_u32 m0, s63, 16896
  v_mfma_f32_16x16x32_bf16 v[68:71], a[0:3], a[100:103], v[68:71]
  ds_read_b128 a[116:119], v11 offset:34816
  buffer_load_dwordx4 v7, s[40:43], 0 offen offset:512 lds
  v_mfma_f32_16x16x32_bf16 v[72:75], a[0:3], a[104:107], v[72:75]
  ds_read_b128 a[120:123], v11 offset:36864
  v_mfma_f32_16x16x32_bf16 v[76:79], a[0:3], a[108:111], v[76:79]
  ds_read_b128 a[124:127], v11 offset:38912
  s_add_u32 m0, s63, 17920
  v_mfma_f32_16x16x32_bf16 v[80:83], a[4:7], a[96:99], v[80:83]
  ds_read_b64_tr_b16 a[48:49], v12 offset:24576
  buffer_load_dwordx4 v8, s[40:43], 0 offen offset:512 lds
  v_mfma_f32_16x16x32_bf16 v[84:87], a[4:7], a[100:103], v[84:87]
  ds_read_b64_tr_b16 a[50:51], v12 offset:25088
  v_mfma_f32_16x16x32_bf16 v[88:91], a[4:7], a[104:107], v[88:91]
  ds_read_b64_tr_b16 a[52:53], v12 offset:27648
  s_add_u32 m0, s63, 18944
  v_mfma_f32_16x16x32_bf16 v[92:95], a[4:7], a[108:111], v[92:95]
  ds_read_b64_tr_b16 a[54:55], v12 offset:28160
  buffer_load_dwordx4 v9, s[40:43], 0 offen offset:512 lds
  v_mfma_f32_16x16x32_bf16 v[96:99], a[8:11], a[96:99], v[96:99]
  ds_read_b64_tr_b16 a[56:57], v13 offset:24576
  v_mfma_f32_16x16x32_bf16 v[100:103], a[8:11], a[100:103], v[100:103]
  ds_read_b64_tr_b16 a[58:59], v13 offset:25088
  v_mfma_f32_16x16x32_bf16 v[104:107], a[8:11], a[104:107], v[104:107]
  ds_read_b64_tr_b16 a[60:61], v13 offset:27648
  s_add_u32 m0, s62, 0
  s_nop 0
  v_mfma_f32_16x16x32_bf16 v[108:111], a[8:11], a[108:111], v[108:111]
  ds_read_b64_tr_b16 a[62:63], v13 offset:28160
  buffer_load_dwordx4 v5, s[44:47], s61 offen offset:0 lds
  v_mfma_f32_16x16x32_bf16 v[112:115], a[12:15], a[96:99], v[112:115]
  ds_read_b64_tr_b16 a[64:65], v14 offset:24576
  v_mfma_f32_16x16x32_bf16 v[116:119], a[12:15], a[100:103], v[116:119]
  ds_read_b64_tr_b16 a[66:67], v14 offset:25088
  s_add_u32 m0, s62, 896
  v_mfma_f32_16x16x32_bf16 v[120:123], a[12:15], a[104:107], v[120:123]
  ds_read_b64_tr_b16 a[68:69], v14 offset:27648
  buffer_load_dwordx4 v5, s[44:47], s61 offen offset:128 lds
  v_mfma_f32_16x16x32_bf16 v[124:127], a[12:15], a[108:111], v[124:127]
  ds_read_b64_tr_b16 a[70:71], v14 offset:28160
  v_mfma_f32_16x16x32_bf16 v[128:131], a[16:19], a[96:99], v[128:131]
  ds_read_b64_tr_b16 a[72:73], v15 offset:24576
  s_add_u32 m0, s62, 1792
  v_mfma_f32_16x16x32_bf16 v[132:135], a[16:19], a[100:103], v[132:135]
  ds_read_b64_tr_b16 a[74:75], v15 offset:25088
  buffer_load_dwordx4 v5, s[44:47], s61 offen offset:256 lds
  v_mfma_f32_16x16x32_bf16 v[136:139], a[16:19], a[104:107], v[136:139]
  ds_read_b64_tr_b16 a[76:77], v15 offset:27648
  v_mfma_f32_16x16x32_bf16 v[140:143], a[16:19], a[108:111], v[140:143]
  ds_read_b64_tr_b16 a[78:79], v15 offset:28160
  v_mfma_f32_16x16x32_bf16 v[144:147], a[20:23], a[96:99], v[144:147]
  ds_read_b64_tr_b16 a[80:81], v16 offset:24576
  s_add_u32 m0, s62, 3072
  v_mfma_f32_16x16x32_bf16 v[148:151], a[20:23], a[100:103], v[148:151]
  ds_read_b64_tr_b16 a[82:83], v16 offset:25088
  buffer_load_dwordx4 v5, s[48:51], s61 offen offset:0 lds
  v_mfma_f32_16x16x32_bf16 v[152:155], a[20:23], a[104:107], v[152:155]
  ds_read_b64_tr_b16 a[84:85], v16 offset:27648
  v_mfma_f32_16x16x32_bf16 v[156:159], a[20:23], a[108:111], v[156:159]
  ds_read_b64_tr_b16 a[86:87], v16 offset:28160
  s_add_u32 m0, s62, 3968
  v_mfma_f32_16x16x32_bf16 v[160:163], a[24:27], a[96:99], v[160:163]
  buffer_load_dwordx4 v5, s[48:51], s61 offen offset:128 lds
  v_mfma_f32_16x16x32_bf16 v[164:167], a[24:27], a[100:103], v[164:167]
  v_mfma_f32_16x16x32_bf16 v[168:171], a[24:27], a[104:107], v[168:171]
  s_add_u32 m0, s62, 4864
  v_mfma_f32_16x16x32_bf16 v[172:175], a[24:27], a[108:111], v[172:175]
  buffer_load_dwordx4 v5, s[48:51], s61 offen offset:256 lds
  s_add_u32 s61, s61, s67
  v_mfma_f32_16x16x32_bf16 v[176:179], a[28:31], a[96:99], v[176:179]
  v_mfma_f32_16x16x32_bf16 v[180:183], a[28:31], a[100:103], v[180:183]
  v_mfma_f32_16x16x32_bf16 v[184:187], a[28:31], a[104:107], v[184:187]
  s_mul_i32 s101, s60, 448
  v_mfma_f32_16x16x32_bf16 v[188:191], a[28:31], a[108:111], v[188:191]
  s_bfm_b64 exec, 24, 0
  buffer_load_dword v63, v24, s[96:99], s101 offen
  s_mov_b64 exec, -1
  v_mfma_f32_16x16x32_bf16 v[192:195], a[32:35], a[96:99], v[192:195]
  v_mfma_f32_16x16x32_bf16 v[196:199], a[32:35], a[100:103], v[196:199]
  v_mfma_f32_16x16x32_bf16 v[200:203], a[32:35], a[104:107], v[200:203]
  s_bfm_b64 exec, 12, 0
  buffer_load_dword v63, v25, s[40:43], 0 offen offset:896
  s_mov_b64 exec, -1
  v_mfma_f32_16x16x32_bf16 v[204:207], a[32:35], a[108:111], v[204:207]
  v_mfma_f32_16x16x32_bf16 v[208:211], a[36:39], a[96:99], v[208:211]
  v_mfma_f32_16x16x32_bf16 v[212:215], a[36:39], a[100:103], v[212:215]
  v_mfma_f32_16x16x32_bf16 v[216:219], a[36:39], a[104:107], v[216:219]
  v_mfma_f32_16x16x32_bf16 v[220:223], a[36:39], a[108:111], v[220:223]
  s_waitcnt vmcnt(22) lgkmcnt(0)
  s_barrier
  s_nop 0
  v_mfma_f32_16x16x32_bf16 v[64:67], a[48:51], a[112:115], v[64:67]
  ds_read_b128 a[96:99], v10 offset:0
  s_add_u32 m0, s62, 24576
  v_mfma_f32_16x16x32_bf16 v[68:71], a[48:51], a[116:119], v[68:71]
  ds_read_b128 a[100:103], v10 offset:2048
  buffer_load_dwordx4 v5, s[44:47], s61 offen offset:0 lds
  v_mfma_f32_16x16x32_bf16 v[72:75], a[48:51], a[120:123], v[72:75]
  ds_read_b128 a[104:107], v10 offset:4096
  v_mfma_f32_16x16x32_bf16 v[76:79], a[48:51], a[124:127], v[76:79]
  ds_read_b128 a[108:111], v10 offset:6144
  s_add_u32 m0, s62, 25472
  v_mfma_f32_16x16x32_bf16 v[80:83], a[52:55], a[112:115], v[80:83]
  ds_read_b64_tr_b16 a[0:1], v18 offset:0
  buffer_load_dwordx4 v5, s[44:47], s61 offen offset:128 lds
  v_mfma_f32_16x16x32_bf16 v[84:87], a[52:55], a[116:119], v[84:87]
  ds_read_b64_tr_b16 a[2:3], v18 offset:512
  v_mfma_f32_16x16x32_bf16 v[88:91], a[52:55], a[120:123], v[88:91]
  ds_read_b64_tr_b16 a[4:5], v18 offset:3072
  v_mfma_f32_16x16x32_bf16 v[92:95], a[52:55], a[124:127], v[92:95]
  ds_read_b64_tr_b16 a[6:7], v18 offset:3584
  s_add_u32 m0, s62, 26368
  v_mfma_f32_16x16x32_bf16 v[96:99], a[56:59], a[112:115], v[96:99]
  ds_read_b64_tr_b16 a[8:9], v19 offset:0
  buffer_load_dwordx4 v5, s[44:47], s61 offen offset:256 lds
  v_mfma_f32_16x16x32_bf16 v[100:103], a[56:59], a[116:119], v[100:103]
  ds_read_b64_tr_b16 a[10:11], v19 offset:512
  v_mfma_f32_16x16x32_bf16 v[104:107], a[56:59], a[120:123], v[104:107]
  ds_read_b64_tr_b16 a[12:13], v19 offset:3072
  v_mfma_f32_16x16x32_bf16 v[108:111], a[56:59], a[124:127], v[108:111]
  ds_read_b64_tr_b16 a[14:15], v19 offset:3584
  s_add_u32 m0, s62, 27648
  v_mfma_f32_16x16x32_bf16 v[112:115], a[60:63], a[112:115], v[112:115]
  ds_read_b64_tr_b16 a[16:17], v20 offset:0
  buffer_load_dwordx4 v5, s[48:51], s61 offen offset:0 lds
  v_mfma_f32_16x16x32_bf16 v[116:119], a[60:63], a[116:119], v[116:119]
  ds_read_b64_tr_b16 a[18:19], v20 offset:512
  v_mfma_f32_16x16x32_bf16 v[120:123], a[60:63], a[120:123], v[120:123]
  ds_read_b64_tr_b16 a[20:21], v20 offset:3072
  s_add_u32 m0, s62, 28544
  v_mfma_f32_16x16x32_bf16 v[124:127], a[60:63], a[124:127], v[124:127]
  ds_read_b64_tr_b16 a[22:23], v20 offset:3584
  buffer_load_dwordx4 v5, s[48:51], s61 offen offset:128 lds
  v_mfma_f32_16x16x32_bf16 v[128:131], a[64:67], a[112:115], v[128:131]
  ds_read_b64_tr_b16 a[24:25], v21 offset:0
  v_mfma_f32_16x16x32_bf16 v[132:135], a[64:67], a[116:119], v[132:135]
  ds_read_b64_tr_b16 a[26:27], v21 offset:512
  v_mfma_f32_16x16x32_bf16 v[136:139], a[64:67], a[120:123], v[136:139]
  ds_read_b64_tr_b16 a[28:29], v21 offset:3072
  s_add_u32 m0, s62, 29440
  v_mfma_f32_16x16x32_bf16 v[140:143], a[64:67], a[124:127], v[140:143]
  ds_read_b64_tr_b16 a[30:31], v21 offset:3584
  buffer_load_dwordx4 v5, s[48:51], s61 offen offset:256 lds
  s_add_u32 s61, s61, s67
  s_nop 0
  v_mfma_f32_16x16x32_bf16 v[144:147], a[68:71], a[112:115], v[144:147]
  ds_read_b64_tr_b16 a[32:33], v22 offset:0
  v_mfma_f32_16x16x32_bf16 v[148:151], a[68:71], a[116:119], v[148:151]
  ds_read_b64_tr_b16 a[34:35], v22 offset:512
  v_mfma_f32_16x16x32_bf16 v[152:155], a[68:71], a[120:123], v[152:155]
  ds_read_b64_tr_b16 a[36:37], v22 offset:3072
  s_add_u32 m0, s63, 32128
  v_mfma_f32_16x16x32_bf16 v[156:159], a[68:71], a[124:127], v[156:159]
  ds_read_b64_tr_b16 a[38:39], v22 offset:3584
  buffer_load_dwordx4 v6, s[40:43], 0 offen offset:640 lds
  v_mfma_f32_16x16x32_bf16 v[160:163], a[72:75], a[112:115], v[160:163]
  v_mfma_f32_16x16x32_bf16 v[164:167], a[72:75], a[116:119], v[164:167]
  s_add_u32 m0, s63, 33152
  v_mfma_f32_16x16x32_bf16 v[168:171], a[72:75], a[120:123], v[168:171]
  buffer_load_dwordx4 v7, s[40:43], 0 offen offset:640 lds
  v_mfma_f32_16x16x32_bf16 v[172:175], a[72:75], a[124:127], v[172:175]
  v_mfma_f32_16x16x32_bf16 v[176:179], a[76:79], a[112:115], v[176:179]
  v_mfma_f32_16x16x32_bf16 v[180:183], a[76:79], a[116:119], v[180:183]
  s_add_u32 m0, s63, 34176
  v_mfma_f32_16x16x32_bf16 v[184:187], a[76:79], a[120:123], v[184:187]
  buffer_load_dwordx4 v8, s[40:43], 0 offen offset:640 lds
  v_mfma_f32_16x16x32_bf16 v[188:191], a[76:79], a[124:127], v[188:191]
  v_mfma_f32_16x16x32_bf16 v[192:195], a[80:83], a[112:115], v[192:195]
  v_mfma_f32_16x16x32_bf16 v[196:199], a[80:83], a[116:119], v[196:199]
  s_add_u32 m0, s63, 35200
  v_mfma_f32_16x16x32_bf16 v[200:203], a[80:83], a[120:123], v[200:203]
  buffer_load_dwordx4 v9, s[40:43], 0 offen offset:640 lds
  v_mfma_f32_16x16x32_bf16 v[204:207], a[80:83], a[124:127], v[204:207]
  v_mfma_f32_16x16x32_bf16 v[208:211], a[84:87], a[112:115], v[208:211]
  v_mfma_f32_16x16x32_bf16 v[212:215], a[84:87], a[116:119], v[212:215]
  v_mfma_f32_16x16x32_bf16 v[216:219], a[84:87], a[120:123], v[216:219]
  v_mfma_f32_16x16x32_bf16 v[220:223], a[84:87], a[124:127], v[220:223]
  s_waitcnt vmcnt(23) lgkmcnt(0)
  s_barrier
  v_mfma_f32_16x16x32_bf16 v[64:67], a[0:3], a[96:99], v[64:67]
  ds_read_b128 a[112:115], v11 offset:0
  s_add_u32 m0, s62, 49152
  v_mfma_f32_16x16x32_bf16 v[68:71], a[0:3], a[100:103], v[68:71]
  ds_read_b128 a[116:119], v11 offset:2048
  buffer_load_dwordx4 v5, s[44:47], s61 offen offset:0 lds
  v_mfma_f32_16x16x32_bf16 v[72:75], a[0:3], a[104:107], v[72:75]
  ds_read_b128 a[120:123], v11 offset:4096
  v_mfma_f32_16x16x32_bf16 v[76:79], a[0:3], a[108:111], v[76:79]
  ds_read_b128 a[124:127], v11 offset:6144
  v_mfma_f32_16x16x32_bf16 v[80:83], a[4:7], a[96:99], v[80:83]
  ds_read_b64_tr_b16 a[48:49], v18 offset:24576
  v_mfma_f32_16x16x32_bf16 v[84:87], a[4:7], a[100:103], v[84:87]
  ds_read_b64_tr_b16 a[50:51], v18 offset:25088
  v_mfma_f32_16x16x32_bf16 v[88:91], a[4:7], a[104:107], v[88:91]
  ds_read_b64_tr_b16 a[52:53], v18 offset:27648
  s_add_u32 m0, s62, 50048
  v_mfma_f32_16x16x32_bf16 v[92:95], a[4:7], a[108:111], v[92:95]
  ds_read_b64_tr_b16 a[54:55], v18 offset:28160
  buffer_load_dwordx4 v5, s[44:47], s61 offen offset:128 lds
  v_mfma_f32_16x16x32_bf16 v[96:99], a[8:11], a[96:99], v[96:99]
  ds_read_b64_tr_b16 a[56:57], v19 offset:24576
  v_mfma_f32_16x16x32_bf16 v[100:103], a[8:11], a[100:103], v[100:103]
  ds_read_b64_tr_b16 a[58:59], v19 offset:25088
  v_mfma_f32_16x16x32_bf16 v[104:107], a[8:11], a[104:107], v[104:107]
  ds_read_b64_tr_b16 a[60:61], v19 offset:27648
  v_mfma_f32_16x16x32_bf16 v[108:111], a[8:11], a[108:111], v[108:111]
  ds_read_b64_tr_b16 a[62:63], v19 offset:28160
  v_mfma_f32_16x16x32_bf16 v[112:115], a[12:15], a[96:99], v[112:115]
  ds_read_b64_tr_b16 a[64:65], v20 offset:24576
  s_add_u32 m0, s62, 50944
  v_mfma_f32_16x16x32_bf16 v[116:119], a[12:15], a[100:103], v[116:119]
  ds_read_b64_tr_b16 a[66:67], v20 offset:25088
  buffer_load_dwordx4 v5, s[44:47], s61 offen offset:256 lds
  v_mfma_f32_16x16x32_bf16 v[120:123], a[12:15], a[104:107], v[120:123]
  ds_read_b64_tr_b16 a[68:69], v20 offset:27648
  v_mfma_f32_16x16x32_bf16 v[124:127], a[12:15], a[108:111], v[124:127]
  ds_read_b64_tr_b16 a[70:71], v20 offset:28160
  v_mfma_f32_16x16x32_bf16 v[128:131], a[16:19], a[96:99], v[128:131]
  ds_read_b64_tr_b16 a[72:73], v21 offset:24576
  v_mfma_f32_16x16x32_bf16 v[132:135], a[16:19], a[100:103], v[132:135]
  ds_read_b64_tr_b16 a[74:75], v21 offset:25088
  v_mfma_f32_16x16x32_bf16 v[136:139], a[16:19], a[104:107], v[136:139]
  ds_read_b64_tr_b16 a[76:77], v21 offset:27648
  s_add_u32 m0, s62, 52224
  v_mfma_f32_16x16x32_bf16 v[140:143], a[16:19], a[108:111], v[140:143]
  ds_read_b64_tr_b16 a[78:79], v21 offset:28160
  buffer_load_dwordx4 v5, s[48:51], s61 offen offset:0 lds
  v_mfma_f32_16x16x32_bf16 v[144:147], a[20:23], a[96:99], v[144:147]
  ds_read_b64_tr_b16 a[80:81], v22 offset:24576
  v_mfma_f32_16x16x32_bf16 v[148:151], a[20:23], a[100:103], v[148:151]
  ds_read_b64_tr_b16 a[82:83], v22 offset:25088
  v_mfma_f32_16x16x32_bf16 v[152:155], a[20:23], a[104:107], v[152:155]
  ds_read_b64_tr_b16 a[84:85], v22 offset:27648
  v_mfma_f32_16x16x32_bf16 v[156:159], a[20:23], a[108:111], v[156:159]
  ds_read_b64_tr_b16 a[86:87], v22 offset:28160
  v_mfma_f32_16x16x32_bf16 v[160:163], a[24:27], a[96:99], v[160:163]
  s_add_u32 m0, s62, 53120
  v_mfma_f32_16x16x32_bf16 v[164:167], a[24:27], a[100:103], v[164:167]
  buffer_load_dwordx4 v5, s[48:51], s61 offen offset:128 lds
  v_mfma_f32_16x16x32_bf16 v[168:171], a[24:27], a[104:107], v[168:171]
  v_mfma_f32_16x16x32_bf16 v[172:175], a[24:27], a[108:111], v[172:175]
  v_mfma_f32_16x16x32_bf16 v[176:179], a[28:31], a[96:99], v[176:179]
  v_mfma_f32_16x16x32_bf16 v[180:183], a[28:31], a[100:103], v[180:183]
  v_mfma_f32_16x16x32_bf16 v[184:187], a[28:31], a[104:107], v[184:187]
  s_add_u32 m0, s62, 54016
  v_mfma_f32_16x16x32_bf16 v[188:191], a[28:31], a[108:111], v[188:191]
  buffer_load_dwordx4 v5, s[48:51], s61 offen offset:256 lds
  s_add_u32 s61, s61, s67
  v_mfma_f32_16x16x32_bf16 v[192:195], a[32:35], a[96:99], v[192:195]
  v_mfma_f32_16x16x32_bf16 v[196:199], a[32:35], a[100:103], v[196:199]
  v_mfma_f32_16x16x32_bf16 v[200:203], a[32:35], a[104:107], v[200:203]
  v_mfma_f32_16x16x32_bf16 v[204:207], a[32:35], a[108:111], v[204:207]
  v_mfma_f32_16x16x32_bf16 v[208:211], a[36:39], a[96:99], v[208:211]
  v_mfma_f32_16x16x32_bf16 v[212:215], a[36:39], a[100:103], v[212:215]
  v_mfma_f32_16x16x32_bf16 v[216:219], a[36:39], a[104:107], v[216:219]
  v_mfma_f32_16x16x32_bf16 v[220:223], a[36:39], a[108:111], v[220:223]
  s_waitcnt vmcnt(18) lgkmcnt(0)
  s_barrier
  s_nop 0
  v_mfma_f32_16x16x32_bf16 v[64:67], a[48:51], a[112:115], v[64:67]
  ds_read_b128 a[96:99], v10 offset:16384
  s_add_u32 m0, s62, 73728
  v_mfma_f32_16x16x32_bf16 v[68:71], a[48:51], a[116:119], v[68:71]
  ds_read_b128 a[100:103], v10 offset:18432
  buffer_load_dwordx4 v5, s[44:47], s61 offen offset:0 lds
  v_mfma_f32_16x16x32_bf16 v[72:75], a[48:51], a[120:123], v[72:75]
  ds_read_b128 a[104:107], v10 offset:20480
  v_mfma_f32_16x16x32_bf16 v[76:79], a[48:51], a[124:127], v[76:79]
  ds_read_b128 a[108:111], v10 offset:22528
  s_add_u32 m0, s62, 74624
  v_mfma_f32_16x16x32_bf16 v[80:83], a[52:55], a[112:115], v[80:83]
  ds_read_b64_tr_b16 a[0:1], v12 offset:0
  buffer_load_dwordx4 v5, s[44:47], s61 offen offset:128 lds
  v_mfma_f32_16x16x32_bf16 v[84:87], a[52:55], a[116:119], v[84:87]
  ds_read_b64_tr_b16 a[2:3], v12 offset:512
  v_mfma_f32_16x16x32_bf16 v[88:91], a[52:55], a[120:123], v[88:91]
  ds_read_b64_tr_b16 a[4:5], v12 offset:3072
  v_mfma_f32_16x16x32_bf16 v[92:95], a[52:55], a[124:127], v[92:95]
  ds_read_b64_tr_b16 a[6:7], v12 offset:3584
  s_add_u32 m0, s62, 75520
  v_mfma_f32_16x16x32_bf16 v[96:99], a[56:59], a[112:115], v[96:99]
  ds_read_b64_tr_b16 a[8:9], v13 offset:0
  buffer_load_dwordx4 v5, s[44:47], s61 offen offset:256 lds
  v_mfma_f32_16x16x32_bf16 v[100:103], a[56:59], a[116:119], v[100:103]
  ds_read_b64_tr_b16 a[10:11], v13 offset:512
  v_mfma_f32_16x16x32_bf16 v[104:107], a[56:59], a[120:123], v[104:107]
  ds_read_b64_tr_b16 a[12:13], v13 offset:3072
  v_mfma_f32_16x16x32_bf16 v[108:111], a[56:59], a[124:127], v[108:111]
  ds_read_b64_tr_b16 a[14:15], v13 offset:3584
  s_add_u32 m0, s62, 76800
  v_mfma_f32_16x16x32_bf16 v[112:115], a[60:63], a[112:115], v[112:115]
  ds_read_b64_tr_b16 a[16:17], v14 offset:0
  buffer_load_dwordx4 v5, s[48:51], s61 offen offset:0 lds
  v_mfma_f32_16x16x32_bf16 v[116:119], a[60:63], a[116:119], v[116:119]
  ds_read_b64_tr_b16 a[18:19], v14 offset:512
  v_mfma_f32_16x16x32_bf16 v[120:123], a[60:63], a[120:123], v[120:123]
  ds_read_b64_tr_b16 a[20:21], v14 offset:3072
  s_add_u32 m0, s62, 77696
  v_mfma_f32_16x16x32_bf16 v[124:127], a[60:63], a[124:127], v[124:127]
  ds_read_b64_tr_b16 a[22:23], v14 offset:3584
  buffer_load_dwordx4 v5, s[48:51], s61 offen offset:128 lds
  v_mfma_f32_16x16x32_bf16 v[128:131], a[64:67], a[112:115], v[128:131]
  ds_read_b64_tr_b16 a[24:25], v15 offset:0
  v_mfma_f32_16x16x32_bf16 v[132:135], a[64:67], a[116:119], v[132:135]
  ds_read_b64_tr_b16 a[26:27], v15 offset:512
  v_mfma_f32_16x16x32_bf16 v[136:139], a[64:67], a[120:123], v[136:139]
  ds_read_b64_tr_b16 a[28:29], v15 offset:3072
  s_add_u32 m0, s62, 78592
  v_mfma_f32_16x16x32_bf16 v[140:143], a[64:67], a[124:127], v[140:143]
  ds_read_b64_tr_b16 a[30:31], v15 offset:3584
  buffer_load_dwordx4 v5, s[48:51], s61 offen offset:256 lds
  s_add_u32 s61, s61, s67
  s_nop 0
  v_mfma_f32_16x16x32_bf16 v[144:147], a[68:71], a[112:115], v[144:147]
  ds_read_b64_tr_b16 a[32:33], v16 offset:0
  v_mfma_f32_16x16x32_bf16 v[148:151], a[68:71], a[116:119], v[148:151]
  ds_read_b64_tr_b16 a[34:35], v16 offset:512
  v_mfma_f32_16x16x32_bf16 v[152:155], a[68:71], a[120:123], v[152:155]
  ds_read_b64_tr_b16 a[36:37], v16 offset:3072
  s_add_u32 m0, s63, -768
  v_mfma_f32_16x16x32_bf16 v[156:159], a[68:71], a[124:127], v[156:159]
  ds_read_b64_tr_b16 a[38:39], v16 offset:3584
  buffer_load_dwordx4 v6, s[40:43], 0 offen offset:768 lds
  v_mfma_f32_16x16x32_bf16 v[160:163], a[72:75], a[112:115], v[160:163]
  v_mfma_f32_16x16x32_bf16 v[164:167], a[72:75], a[116:119], v[164:167]
  s_add_u32 m0, s63, 256
  v_mfma_f32_16x16x32_bf16 v[168:171], a[72:75], a[120:123], v[168:171]
  buffer_load_dwordx4 v7, s[40:43], 0 offen offset:768 lds
  v_mfma_f32_16x16x32_bf16 v[172:175], a[72:75], a[124:127], v[172:175]
  v_mfma_f32_16x16x32_bf16 v[176:179], a[76:79], a[112:115], v[176:179]
  v_mfma_f32_16x16x32_bf16 v[180:183], a[76:79], a[116:119], v[180:183]
  s_add_u32 m0, s63, 1280
  v_mfma_f32_16x16x32_bf16 v[184:187], a[76:79], a[120:123], v[184:187]
  buffer_load_dwordx4 v8, s[40:43], 0 offen offset:768 lds
  v_mfma_f32_16x16x32_bf16 v[188:191], a[76:79], a[124:127], v[188:191]
  v_mfma_f32_16x16x32_bf16 v[192:195], a[80:83], a[112:115], v[192:195]
  v_mfma_f32_16x16x32_bf16 v[196:199], a[80:83], a[116:119], v[196:199]
  s_add_u32 m0, s63, 2304
  v_mfma_f32_16x16x32_bf16 v[200:203], a[80:83], a[120:123], v[200:203]
  buffer_load_dwordx4 v9, s[40:43], 0 offen offset:768 lds
  v_mfma_f32_16x16x32_bf16 v[204:207], a[80:83], a[124:127], v[204:207]
  v_mfma_f32_16x16x32_bf16 v[208:211], a[84:87], a[112:115], v[208:211]
  v_mfma_f32_16x16x32_bf16 v[212:215], a[84:87], a[116:119], v[212:215]
  v_mfma_f32_16x16x32_bf16 v[216:219], a[84:87], a[120:123], v[216:219]
  v_mfma_f32_16x16x32_bf16 v[220:223], a[84:87], a[124:127], v[220:223]
  s_waitcnt vmcnt(20) lgkmcnt(0)
  s_barrier
  v_mfma_f32_16x16x32_bf16 v[64:67], a[0:3], a[96:99], v[64:67]
  ds_read_b128 a[112:115], v11 offset:16384
  s_add_u32 m0, s62, 0
  s_nop 0
  v_mfma_f32_16x16x32_bf16 v[68:71], a[0:3], a[100:103], v[68:71]
  ds_read_b128 a[116:119], v11 offset:18432
  buffer_load_dwordx4 v5, s[44:47], s61 offen offset:0 lds
  v_mfma_f32_16x16x32_bf16 v[72:75], a[0:3], a[104:107], v[72:75]
  ds_read_b128 a[120:123], v11 offset:20480
  v_mfma_f32_16x16x32_bf16 v[76:79], a[0:3], a[108:111], v[76:79]
  ds_read_b128 a[124:127], v11 offset:22528
  v_mfma_f32_16x16x32_bf16 v[80:83], a[4:7], a[96:99], v[80:83]
  ds_read_b64_tr_b16 a[48:49], v12 offset:24576
  v_mfma_f32_16x16x32_bf16 v[84:87], a[4:7], a[100:103], v[84:87]
  ds_read_b64_tr_b16 a[50:51], v12 offset:25088
  v_mfma_f32_16x16x32_bf16 v[88:91], a[4:7], a[104:107], v[88:91]
  ds_read_b64_tr_b16 a[52:53], v12 offset:27648
  s_add_u32 m0, s62, 896
  v_mfma_f32_16x16x32_bf16 v[92:95], a[4:7], a[108:111], v[92:95]
  ds_read_b64_tr_b16 a[54:55], v12 offset:28160
  buffer_load_dwordx4 v5, s[44:47], s61 offen offset:128 lds
  v_mfma_f32_16x16x32_bf16 v[96:99], a[8:11], a[96:99], v[96:99]
  ds_read_b64_tr_b16 a[56:57], v13 offset:24576
  v_mfma_f32_16x16x32_bf16 v[100:103], a[8:11], a[100:103], v[100:103]
  ds_read_b64_tr_b16 a[58:59], v13 offset:25088
  v_mfma_f32_16x16x32_bf16 v[104:107], a[8:11], a[104:107], v[104:107]
  ds_read_b64_tr_b16 a[60:61], v13 offset:27648
  v_mfma_f32_16x16x32_bf16 v[108:111], a[8:11], a[108:111], v[108:111]
  ds_read_b64_tr_b16 a[62:63], v13 offset:28160
  v_mfma_f32_16x16x32_bf16 v[112:115], a[12:15], a[96:99], v[112:115]
  ds_read_b64_tr_b16 a[64:65], v14 offset:24576
  s_add_u32 m0, s62, 1792
  v_mfma_f32_16x16x32_bf16 v[116:119], a[12:15], a[100:103], v[116:119]
  ds_read_b64_tr_b16 a[66:67], v14 offset:25088
  buffer_load_dwordx4 v5, s[44:47], s61 offen offset:256 lds
  v_mfma_f32_16x16x32_bf16 v[120:123], a[12:15], a[104:107], v[120:123]
  ds_read_b64_tr_b16 a[68:69], v14 offset:27648
  v_mfma_f32_16x16x32_bf16 v[124:127], a[12:15], a[108:111], v[124:127]
  ds_read_b64_tr_b16 a[70:71], v14 offset:28160
  v_mfma_f32_16x16x32_bf16 v[128:131], a[16:19], a[96:99], v[128:131]
  ds_read_b64_tr_b16 a[72:73], v15 offset:24576
  v_mfma_f32_16x16x32_bf16 v[132:135], a[16:19], a[100:103], v[132:135]
  ds_read_b64_tr_b16 a[74:75], v15 offset:25088
  v_mfma_f32_16x16x32_bf16 v[136:139], a[16:19], a[104:107], v[136:139]
  ds_read_b64_tr_b16 a[76:77], v15 offset:27648
  s_add_u32 m0, s62, 3072
  v_mfma_f32_16x16x32_bf16 v[140:143], a[16:19], a[108:111], v[140:143]
  ds_read_b64_tr_b16 a[78:79], v15 offset:28160
  buffer_load_dwordx4 v5, s[48:51], s61 offen offset:0 lds
  v_mfma_f32_16x16x32_bf16 v[144:147], a[20:23], a[96:99], v[144:147]
  ds_read_b64_tr_b16 a[80:81], v16 offset:24576
  v_mfma_f32_16x16x32_bf16 v[148:151], a[20:23], a[100:103], v[148:151]
  ds_read_b64_tr_b16 a[82:83], v16 offset:25088
  v_mfma_f32_16x16x32_bf16 v[152:155], a[20:23], a[104:107], v[152:155]
  ds_read_b64_tr_b16 a[84:85], v16 offset:27648
  v_mfma_f32_16x16x32_bf16 v[156:159], a[20:23], a[108:111], v[156:159]
  ds_read_b64_tr_b16 a[86:87], v16 offset:28160
  v_mfma_f32_16x16x32_bf16 v[160:163], a[24:27], a[96:99], v[160:163]
  s_add_u32 m0, s62, 3968
  v_mfma_f32_16x16x32_bf16 v[164:167], a[24:27], a[100:103], v[164:167]
  buffer_load_dwordx4 v5, s[48:51], s61 offen offset:128 lds
  v_mfma_f32_16x16x32_bf16 v[168:171], a[24:27], a[104:107], v[168:171]
  v_mfma_f32_16x16x32_bf16 v[172:175], a[24:27], a[108:111], v[172:175]
  v_mfma_f32_16x16x32_bf16 v[176:179], a[28:31], a[96:99], v[176:179]
  v_mfma_f32_16x16x32_bf16 v[180:183], a[28:31], a[100:103], v[180:183]
  v_mfma_f32_16x16x32_bf16 v[184:187], a[28:31], a[104:107], v[184:187]
  s_add_u32 m0, s62, 4864
  v_mfma_f32_16x16x32_bf16 v[188:191], a[28:31], a[108:111], v[188:191]
  buffer_load_dwordx4 v5, s[48:51], s61 offen offset:256 lds
  s_add_u32 s61, s61, s67
  v_mfma_f32_16x16x32_bf16 v[192:195], a[32:35], a[96:99], v[192:195]
  v_mfma_f32_16x16x32_bf16 v[196:199], a[32:35], a[100:103], v[196:199]
  v_mfma_f32_16x16x32_bf16 v[200:203], a[32:35], a[104:107], v[200:203]
  v_mfma_f32_16x16x32_bf16 v[204:207], a[32:35], a[108:111], v[204:207]
  v_mfma_f32_16x16x32_bf16 v[208:211], a[36:39], a[96:99], v[208:211]
  v_mfma_f32_16x16x32_bf16 v[212:215], a[36:39], a[100:103], v[212:215]
  v_mfma_f32_16x16x32_bf16 v[216:219], a[36:39], a[104:107], v[216:219]
  v_mfma_f32_16x16x32_bf16 v[220:223], a[36:39], a[108:111], v[220:223]
  s_waitcnt vmcnt(16) lgkmcnt(0)
  s_barrier
  s_nop 0
  v_mfma_f32_16x16x32_bf16 v[64:67], a[48:51], a[112:115], v[64:67]
  ds_read_b128 a[96:99], v10 offset:32768
  s_add_u32 m0, s62, 24576
  v_mfma_f32_16x16x32_bf16 v[68:71], a[48:51], a[116:119], v[68:71]
  ds_read_b128 a[100:103], v10 offset:34816
  buffer_load_dwordx4 v5, s[44:47], s61 offen offset:0 lds
  v_mfma_f32_16x16x32_bf16 v[72:75], a[48:51], a[120:123], v[72:75]
  ds_read_b128 a[104:107], v10 offset:36864
  v_mfma_f32_16x16x32_bf16 v[76:79], a[48:51], a[124:127], v[76:79]
  ds_read_b128 a[108:111], v10 offset:38912
  s_add_u32 m0, s62, 25472
  v_mfma_f32_16x16x32_bf16 v[80:83], a[52:55], a[112:115], v[80:83]
  ds_read_b64_tr_b16 a[0:1], v18 offset:0
  buffer_load_dwordx4 v5, s[44:47], s61 offen offset:128 lds
  v_mfma_f32_16x16x32_bf16 v[84:87], a[52:55], a[116:119], v[84:87]
  ds_read_b64_tr_b16 a[2:3], v18 offset:512
  v_mfma_f32_16x16x32_bf16 v[88:91], a[52:55], a[120:123], v[88:91]
  ds_read_b64_tr_b16 a[4:5], v18 offset:3072
  v_mfma_f32_16x16x32_bf16 v[92:95], a[52:55], a[124:127], v[92:95]
  ds_read_b64_tr_b16 a[6:7], v18 offset:3584
  s_add_u32 m0, s62, 26368
  v_mfma_f32_16x16x32_bf16 v[96:99], a[56:59], a[112:115], v[96:99]
  ds_read_b64_tr_b16 a[8:9], v19 offset:0
  buffer_load_dwordx4 v5, s[44:47], s61 offen offset:256 lds
  v_mfma_f32_16x16x32_bf16 v[100:103], a[56:59], a[116:119], v[100:103]
  ds_read_b64_tr_b16 a[10:11], v19 offset:512
  v_mfma_f32_16x16x32_bf16 v[104:107], a[56:59], a[120:123], v[104:107]
  ds_read_b64_tr_b16 a[12:13], v19 offset:3072
  v_mfma_f32_16x16x32_bf16 v[108:111], a[56:59], a[124:127], v[108:111]
  ds_read_b64_tr_b16 a[14:15], v19 offset:3584
  s_add_u32 m0, s62, 27648
  v_mfma_f32_16x16x32_bf16 v[112:115], a[60:63], a[112:115], v[112:115]
  ds_read_b64_tr_b16 a[16:17], v20 offset:0
  buffer_load_dwordx4 v5, s[48:51], s61 offen offset:0 lds
  v_mfma_f32_16x16x32_bf16 v[116:119], a[60:63], a[116:119], v[116:119]
  ds_read_b64_tr_b16 a[18:19], v20 offset:512
  v_mfma_f32_16x16x32_bf16 v[120:123], a[60:63], a[120:123], v[120:123]
  ds_read_b64_tr_b16 a[20:21], v20 offset:3072
  s_add_u32 m0, s62, 28544
  v_mfma_f32_16x16x32_bf16 v[124:127], a[60:63], a[124:127], v[124:127]
  ds_read_b64_tr_b16 a[22:23], v20 offset:3584
  buffer_load_dwordx4 v5, s[48:51], s61 offen offset:128 lds
  v_mfma_f32_16x16x32_bf16 v[128:131], a[64:67], a[112:115], v[128:131]
  ds_read_b64_tr_b16 a[24:25], v21 offset:0
  v_mfma_f32_16x16x32_bf16 v[132:135], a[64:67], a[116:119], v[132:135]
  ds_read_b64_tr_b16 a[26:27], v21 offset:512
  v_mfma_f32_16x16x32_bf16 v[136:139], a[64:67], a[120:123], v[136:139]
  ds_read_b64_tr_b16 a[28:29], v21 offset:3072
  s_add_u32 m0, s62, 29440
  v_mfma_f32_16x16x32_bf16 v[140:143], a[64:67], a[124:127], v[140:143]
  ds_read_b64_tr_b16 a[30:31], v21 offset:3584
  buffer_load_dwordx4 v5, s[48:51], s61 offen offset:256 lds
  s_add_u32 s61, s61, s67
  s_nop 0
  v_mfma_f32_16x16x32_bf16 v[144:147], a[68:71], a[112:115], v[144:147]
  ds_read_b64_tr_b16 a[32:33], v22 offset:0
  v_mfma_f32_16x16x32_bf16 v[148:151], a[68:71], a[116:119], v[148:151]
  ds_read_b64_tr_b16 a[34:35], v22 offset:512
  v_mfma_f32_16x16x32_bf16 v[152:155], a[68:71], a[120:123], v[152:155]
  ds_read_b64_tr_b16 a[36:37], v22 offset:3072
  s_add_u32 m0, s63, 15488
  v_mfma_f32_16x16x32_bf16 v[156:159], a[68:71], a[124:127], v[156:159]
  ds_read_b64_tr_b16 a[38:39], v22 offset:3584
  buffer_load_dwordx4 v6, s[40:43], 0 offen offset:896 lds
  v_mfma_f32_16x16x32_bf16 v[160:163], a[72:75], a[112:115], v[160:163]
  v_mfma_f32_16x16x32_bf16 v[164:167], a[72:75], a[116:119], v[164:167]
  s_add_u32 m0, s63, 16512
  v_mfma_f32_16x16x32_bf16 v[168:171], a[72:75], a[120:123], v[168:171]
  buffer_load_dwordx4 v7, s[40:43], 0 offen offset:896 lds
  v_mfma_f32_16x16x32_bf16 v[172:175], a[72:75], a[124:127], v[172:175]
  v_mfma_f32_16x16x32_bf16 v[176:179], a[76:79], a[112:115], v[176:179]
  v_mfma_f32_16x16x32_bf16 v[180:183], a[76:79], a[116:119], v[180:183]
  s_add_u32 m0, s63, 17536
  v_mfma_f32_16x16x32_bf16 v[184:187], a[76:79], a[120:123], v[184:187]
  buffer_load_dwordx4 v8, s[40:43], 0 offen offset:896 lds
  v_mfma_f32_16x16x32_bf16 v[188:191], a[76:79], a[124:127], v[188:191]
  v_mfma_f32_16x16x32_bf16 v[192:195], a[80:83], a[112:115], v[192:195]
  v_mfma_f32_16x16x32_bf16 v[196:199], a[80:83], a[116:119], v[196:199]
  s_add_u32 m0, s63, 18560
  v_mfma_f32_16x16x32_bf16 v[200:203], a[80:83], a[120:123], v[200:203]
  buffer_load_dwordx4 v9, s[40:43], 0 offen offset:896 lds
  v_mfma_f32_16x16x32_bf16 v[204:207], a[80:83], a[124:127], v[204:207]
  v_mfma_f32_16x16x32_bf16 v[208:211], a[84:87], a[112:115], v[208:211]
  v_mfma_f32_16x16x32_bf16 v[212:215], a[84:87], a[116:119], v[212:215]
  v_mfma_f32_16x16x32_bf16 v[216:219], a[84:87], a[120:123], v[216:219]
  v_mfma_f32_16x16x32_bf16 v[220:223], a[84:87], a[124:127], v[220:223]
  s_waitcnt vmcnt(20) lgkmcnt(0)
  s_barrier
  v_mfma_f32_16x16x32_bf16 v[64:67], a[0:3], a[96:99], v[64:67]
  ds_read_b128 a[112:115], v11 offset:32768
  s_add_u32 m0, s62, 49152
  v_mfma_f32_16x16x32_bf16 v[68:71], a[0:3], a[100:103], v[68:71]
  ds_read_b128 a[116:119], v11 offset:34816
  buffer_load_dwordx4 v5, s[44:47], s61 offen offset:0 lds
  v_mfma_f32_16x16x32_bf16 v[72:75], a[0:3], a[104:107], v[72:75]
  ds_read_b128 a[120:123], v11 offset:36864
  v_mfma_f32_16x16x32_bf16 v[76:79], a[0:3], a[108:111], v[76:79]
  ds_read_b128 a[124:127], v11 offset:38912
  v_mfma_f32_16x16x32_bf16 v[80:83], a[4:7], a[96:99], v[80:83]
  ds_read_b64_tr_b16 a[48:49], v18 offset:24576
  v_mfma_f32_16x16x32_bf16 v[84:87], a[4:7], a[100:103], v[84:87]
  ds_read_b64_tr_b16 a[50:51], v18 offset:25088
  v_mfma_f32_16x16x32_bf16 v[88:91], a[4:7], a[104:107], v[88:91]
  ds_read_b64_tr_b16 a[52:53], v18 offset:27648
  s_add_u32 m0, s62, 50048
  v_mfma_f32_16x16x32_bf16 v[92:95], a[4:7], a[108:111], v[92:95]
  ds_read_b64_tr_b16 a[54:55], v18 offset:28160
  buffer_load_dwordx4 v5, s[44:47], s61 offen offset:128 lds
  v_mfma_f32_16x16x32_bf16 v[96:99], a[8:11], a[96:99], v[96:99]
  ds_read_b64_tr_b16 a[56:57], v19 offset:24576
  v_mfma_f32_16x16x32_bf16 v[100:103], a[8:11], a[100:103], v[100:103]
  ds_read_b64_tr_b16 a[58:59], v19 offset:25088
  v_mfma_f32_16x16x32_bf16 v[104:107], a[8:11], a[104:107], v[104:107]
  ds_read_b64_tr_b16 a[60:61], v19 offset:27648
  v_mfma_f32_16x16x32_bf16 v[108:111], a[8:11], a[108:111], v[108:111]
  ds_read_b64_tr_b16 a[62:63], v19 offset:28160
  v_mfma_f32_16x16x32_bf16 v[112:115], a[12:15], a[96:99], v[112:115]
  ds_read_b64_tr_b16 a[64:65], v20 offset:24576
  s_add_u32 m0, s62, 50944
  v_mfma_f32_16x16x32_bf16 v[116:119], a[12:15], a[100:103], v[116:119]
  ds_read_b64_tr_b16 a[66:67], v20 offset:25088
  buffer_load_dwordx4 v5, s[44:47], s61 offen offset:256 lds
  v_mfma_f32_16x16x32_bf16 v[120:123], a[12:15], a[104:107], v[120:123]
  ds_read_b64_tr_b16 a[68:69], v20 offset:27648
  v_mfma_f32_16x16x32_bf16 v[124:127], a[12:15], a[108:111], v[124:127]
  ds_read_b64_tr_b16 a[70:71], v20 offset:28160
  v_mfma_f32_16x16x32_bf16 v[128:131], a[16:19], a[96:99], v[128:131]
  ds_read_b64_tr_b16 a[72:73], v21 offset:24576
  v_mfma_f32_16x16x32_bf16 v[132:135], a[16:19], a[100:103], v[132:135]
  ds_read_b64_tr_b16 a[74:75], v21 offset:25088
  v_mfma_f32_16x16x32_bf16 v[136:139], a[16:19], a[104:107], v[136:139]
  ds_read_b64_tr_b16 a[76:77], v21 offset:27648
  s_add_u32 m0, s62, 52224
  v_mfma_f32_16x16x32_bf16 v[140:143], a[16:19], a[108:111], v[140:143]
  ds_read_b64_tr_b16 a[78:79], v21 offset:28160
  buffer_load_dwordx4 v5, s[48:51], s61 offen offset:0 lds
  v_mfma_f32_16x16x32_bf16 v[144:147], a[20:23], a[96:99], v[144:147]
  ds_read_b64_tr_b16 a[80:81], v22 offset:24576
  v_mfma_f32_16x16x32_bf16 v[148:151], a[20:23], a[100:103], v[148:151]
  ds_read_b64_tr_b16 a[82:83], v22 offset:25088
  v_mfma_f32_16x16x32_bf16 v[152:155], a[20:23], a[104:107], v[152:155]
  ds_read_b64_tr_b16 a[84:85], v22 offset:27648
  v_mfma_f32_16x16x32_bf16 v[156:159], a[20:23], a[108:111], v[156:159]
  ds_read_b64_tr_b16 a[86:87], v22 offset:28160
  v_mfma_f32_16x16x32_bf16 v[160:163], a[24:27], a[96:99], v[160:163]
  s_add_u32 m0, s62, 53120
  v_mfma_f32_16x16x32_bf16 v[164:167], a[24:27], a[100:103], v[164:167]
  buffer_load_dwordx4 v5, s[48:51], s61 offen offset:128 lds
  v_mfma_f32_16x16x32_bf16 v[168:171], a[24:27], a[104:107], v[168:171]
  v_mfma_f32_16x16x32_bf16 v[172:175], a[24:27], a[108:111], v[172:175]
  v_mfma_f32_16x16x32_bf16 v[176:179], a[28:31], a[96:99], v[176:179]
  v_mfma_f32_16x16x32_bf16 v[180:183], a[28:31], a[100:103], v[180:183]
  v_mfma_f32_16x16x32_bf16 v[184:187], a[28:31], a[104:107], v[184:187]
  s_add_u32 m0, s62, 54016
  v_mfma_f32_16x16x32_bf16 v[188:191], a[28:31], a[108:111], v[188:191]
  buffer_load_dwordx4 v5, s[48:51], s61 offen offset:256 lds
  s_add_u32 s61, s61, s67
  v_mfma_f32_16x16x32_bf16 v[192:195], a[32:35], a[96:99], v[192:195]
  v_mfma_f32_16x16x32_bf16 v[196:199], a[32:35], a[100:103], v[196:199]
  v_mfma_f32_16x16x32_bf16 v[200:203], a[32:35], a[104:107], v[200:203]
  v_mfma_f32_16x16x32_bf16 v[204:207], a[32:35], a[108:111], v[204:207]
  v_mfma_f32_16x16x32_bf16 v[208:211], a[36:39], a[96:99], v[208:211]
  v_mfma_f32_16x16x32_bf16 v[212:215], a[36:39], a[100:103], v[212:215]
  v_mfma_f32_16x16x32_bf16 v[216:219], a[36:39], a[104:107], v[216:219]
  v_mfma_f32_16x16x32_bf16 v[220:223], a[36:39], a[108:111], v[220:223]
  s_waitcnt vmcnt(16) lgkmcnt(0)
  s_barrier
  s_nop 0
  v_mfma_f32_16x16x32_bf16 v[64:67], a[48:51], a[112:115], v[64:67]
  ds_read_b128 a[96:99], v10 offset:0
  s_add_u32 m0, s62, 73728
  v_mfma_f32_16x16x32_bf16 v[68:71], a[48:51], a[116:119], v[68:71]
  ds_read_b128 a[100:103], v10 offset:2048
  buffer_load_dwordx4 v5, s[44:47], s61 offen offset:0 lds
  v_mfma_f32_16x16x32_bf16 v[72:75], a[48:51], a[120:123], v[72:75]
  ds_read_b128 a[104:107], v10 offset:4096
  v_mfma_f32_16x16x32_bf16 v[76:79], a[48:51], a[124:127], v[76:79]
  ds_read_b128 a[108:111], v10 offset:6144
  s_add_u32 m0, s62, 74624
  v_mfma_f32_16x16x32_bf16 v[80:83], a[52:55], a[112:115], v[80:83]
  ds_read_b64_tr_b16 a[0:1], v12 offset:0
  buffer_load_dwordx4 v5, s[44:47], s61 offen offset:128 lds
  v_mfma_f32_16x16x32_bf16 v[84:87], a[52:55], a[116:119], v[84:87]
  ds_read_b64_tr_b16 a[2:3], v12 offset:512
  v_mfma_f32_16x16x32_bf16 v[88:91], a[52:55], a[120:123], v[88:91]
  ds_read_b64_tr_b16 a[4:5], v12 offset:3072
  v_mfma_f32_16x16x32_bf16 v[92:95], a[52:55], a[124:127], v[92:95]
  ds_read_b64_tr_b16 a[6:7], v12 offset:3584
  s_add_u32 m0, s62, 75520
  v_mfma_f32_16x16x32_bf16 v[96:99], a[56:59], a[112:115], v[96:99]
  ds_read_b64_tr_b16 a[8:9], v13 offset:0
  buffer_load_dwordx4 v5, s[44:47], s61 offen offset:256 lds
  v_mfma_f32_16x16x32_bf16 v[100:103], a[56:59], a[116:119], v[100:103]
  ds_read_b64_tr_b16 a[10:11], v13 offset:512
  v_mfma_f32_16x16x32_bf16 v[104:107], a[56:59], a[120:123], v[104:107]
  ds_read_b64_tr_b16 a[12:13], v13 offset:3072
  v_mfma_f32_16x16x32_bf16 v[108:111], a[56:59], a[124:127], v[108:111]
  ds_read_b64_tr_b16 a[14:15], v13 offset:3584
  s_add_u32 m0, s62, 76800
  v_mfma_f32_16x16x32_bf16 v[112:115], a[60:63], a[112:115], v[112:115]
  ds_read_b64_tr_b16 a[16:17], v14 offset:0
  buffer_load_dwordx4 v5, s[48:51], s61 offen offset:0 lds
  v_mfma_f32_16x16x32_bf16 v[116:119], a[60:63], a[116:119], v[116:119]
  ds_read_b64_tr_b16 a[18:19], v14 offset:512
  v_mfma_f32_16x16x32_bf16 v[120:123], a[60:63], a[120:123], v[120:123]
  ds_read_b64_tr_b16 a[20:21], v14 offset:3072
  s_add_u32 m0, s62, 77696
  v_mfma_f32_16x16x32_bf16 v[124:127], a[60:63], a[124:127], v[124:127]
  ds_read_b64_tr_b16 a[22:23], v14 offset:3584
  buffer_load_dwordx4 v5, s[48:51], s61 offen offset:128 lds
  v_mfma_f32_16x16x32_bf16 v[128:131], a[64:67], a[112:115], v[128:131]
  ds_read_b64_tr_b16 a[24:25], v15 offset:0
  v_mfma_f32_16x16x32_bf16 v[132:135], a[64:67], a[116:119], v[132:135]
  ds_read_b64_tr_b16 a[26:27], v15 offset:512
  v_mfma_f32_16x16x32_bf16 v[136:139], a[64:67], a[120:123], v[136:139]
  ds_read_b64_tr_b16 a[28:29], v15 offset:3072
  s_add_u32 m0, s62, 78592
  v_mfma_f32_16x16x32_bf16 v[140:143], a[64:67], a[124:127], v[140:143]
  ds_read_b64_tr_b16 a[30:31], v15 offset:3584
  buffer_load_dwordx4 v5, s[48:51], s61 offen offset:256 lds
  s_add_u32 s61, s61, s67
  s_nop 0
  v_mfma_f32_16x16x32_bf16 v[144:147], a[68:71], a[112:115], v[144:147]
  ds_read_b64_tr_b16 a[32:33], v16 offset:0
  v_mfma_f32_16x16x32_bf16 v[148:151], a[68:71], a[116:119], v[148:151]
  ds_read_b64_tr_b16 a[34:35], v16 offset:512
  v_mfma_f32_16x16x32_bf16 v[152:155], a[68:71], a[120:123], v[152:155]
  ds_read_b64_tr_b16 a[36:37], v16 offset:3072
  s_add_u32 m0, s63, 31744
  v_mfma_f32_16x16x32_bf16 v[156:159], a[68:71], a[124:127], v[156:159]
  ds_read_b64_tr_b16 a[38:39], v16 offset:3584
  buffer_load_dwordx4 v6, s[40:43], 0 offen offset:1024 lds
  v_mfma_f32_16x16x32_bf16 v[160:163], a[72:75], a[112:115], v[160:163]
  v_mfma_f32_16x16x32_bf16 v[164:167], a[72:75], a[116:119], v[164:167]
  s_add_u32 m0, s63, 32768
  v_mfma_f32_16x16x32_bf16 v[168:171], a[72:75], a[120:123], v[168:171]
  buffer_load_dwordx4 v7, s[40:43], 0 offen offset:1024 lds
  v_mfma_f32_16x16x32_bf16 v[172:175], a[72:75], a[124:127], v[172:175]
  v_mfma_f32_16x16x32_bf16 v[176:179], a[76:79], a[112:115], v[176:179]
  v_mfma_f32_16x16x32_bf16 v[180:183], a[76:79], a[116:119], v[180:183]
  s_add_u32 m0, s63, 33792
  v_mfma_f32_16x16x32_bf16 v[184:187], a[76:79], a[120:123], v[184:187]
  buffer_load_dwordx4 v8, s[40:43], 0 offen offset:1024 lds
  v_mfma_f32_16x16x32_bf16 v[188:191], a[76:79], a[124:127], v[188:191]
  v_mfma_f32_16x16x32_bf16 v[192:195], a[80:83], a[112:115], v[192:195]
  v_mfma_f32_16x16x32_bf16 v[196:199], a[80:83], a[116:119], v[196:199]
  s_add_u32 m0, s63, 34816
  v_mfma_f32_16x16x32_bf16 v[200:203], a[80:83], a[120:123], v[200:203]
  buffer_load_dwordx4 v9, s[40:43], 0 offen offset:1024 lds
  v_mfma_f32_16x16x32_bf16 v[204:207], a[80:83], a[124:127], v[204:207]
  v_mfma_f32_16x16x32_bf16 v[208:211], a[84:87], a[112:115], v[208:211]
  v_mfma_f32_16x16x32_bf16 v[212:215], a[84:87], a[116:119], v[212:215]
  v_mfma_f32_16x16x32_bf16 v[216:219], a[84:87], a[120:123], v[216:219]
  v_mfma_f32_16x16x32_bf16 v[220:223], a[84:87], a[124:127], v[220:223]
  s_waitcnt vmcnt(20) lgkmcnt(0)
  s_barrier
  v_mfma_f32_16x16x32_bf16 v[64:67], a[0:3], a[96:99], v[64:67]
  ds_read_b128 a[112:115], v11 offset:0
  s_add_u32 m0, s62, 0
  s_nop 0
  v_mfma_f32_16x16x32_bf16 v[68:71], a[0:3], a[100:103], v[68:71]
  ds_read_b128 a[116:119], v11 offset:2048
  buffer_load_dwordx4 v5, s[44:47], s61 offen offset:0 lds
  v_mfma_f32_16x16x32_bf16 v[72:75], a[0:3], a[104:107], v[72:75]
  ds_read_b128 a[120:123], v11 offset:4096
  v_mfma_f32_16x16x32_bf16 v[76:79], a[0:3], a[108:111], v[76:79]
  ds_read_b128 a[124:127], v11 offset:6144
  v_mfma_f32_16x16x32_bf16 v[80:83], a[4:7], a[96:99], v[80:83]
  ds_read_b64_tr_b16 a[48:49], v12 offset:24576
  v_mfma_f32_16x16x32_bf16 v[84:87], a[4:7], a[100:103], v[84:87]
  ds_read_b64_tr_b16 a[50:51], v12 offset:25088
  v_mfma_f32_16x16x32_bf16 v[88:91], a[4:7], a[104:107], v[88:91]
  ds_read_b64_tr_b16 a[52:53], v12 offset:27648
  s_add_u32 m0, s62, 896
  v_mfma_f32_16x16x32_bf16 v[92:95], a[4:7], a[108:111], v[92:95]
  ds_read_b64_tr_b16 a[54:55], v12 offset:28160
  buffer_load_dwordx4 v5, s[44:47], s61 offen offset:128 lds
  v_mfma_f32_16x16x32_bf16 v[96:99], a[8:11], a[96:99], v[96:99]
  ds_read_b64_tr_b16 a[56:57], v13 offset:24576
  v_mfma_f32_16x16x32_bf16 v[100:103], a[8:11], a[100:103], v[100:103]
  ds_read_b64_tr_b16 a[58:59], v13 offset:25088
  v_mfma_f32_16x16x32_bf16 v[104:107], a[8:11], a[104:107], v[104:107]
  ds_read_b64_tr_b16 a[60:61], v13 offset:27648
  v_mfma_f32_16x16x32_bf16 v[108:111], a[8:11], a[108:111], v[108:111]
  ds_read_b64_tr_b16 a[62:63], v13 offset:28160
  v_mfma_f32_16x16x32_bf16 v[112:115], a[12:15], a[96:99], v[112:115]
  ds_read_b64_tr_b16 a[64:65], v14 offset:24576
  s_add_u32 m0, s62, 1792
  v_mfma_f32_16x16x32_bf16 v[116:119], a[12:15], a[100:103], v[116:119]
  ds_read_b64_tr_b16 a[66:67], v14 offset:25088
  buffer_load_dwordx4 v5, s[44:47], s61 offen offset:256 lds
  v_mfma_f32_16x16x32_bf16 v[120:123], a[12:15], a[104:107], v[120:123]
  ds_read_b64_tr_b16 a[68:69], v14 offset:27648
  v_mfma_f32_16x16x32_bf16 v[124:127], a[12:15], a[108:111], v[124:127]
  ds_read_b64_tr_b16 a[70:71], v14 offset:28160
  v_mfma_f32_16x16x32_bf16 v[128:131], a[16:19], a[96:99], v[128:131]
  ds_read_b64_tr_b16 a[72:73], v15 offset:24576
  v_mfma_f32_16x16x32_bf16 v[132:135], a[16:19], a[100:103], v[132:135]
  ds_read_b64_tr_b16 a[74:75], v15 offset:25088
  v_mfma_f32_16x16x32_bf16 v[136:139], a[16:19], a[104:107], v[136:139]
  ds_read_b64_tr_b16 a[76:77], v15 offset:27648
  s_add_u32 m0, s62, 3072
  v_mfma_f32_16x16x32_bf16 v[140:143], a[16:19], a[108:111], v[140:143]
  ds_read_b64_tr_b16 a[78:79], v15 offset:28160
  buffer_load_dwordx4 v5, s[48:51], s61 offen offset:0 lds
  v_mfma_f32_16x16x32_bf16 v[144:147], a[20:23], a[96:99], v[144:147]
  ds_read_b64_tr_b16 a[80:81], v16 offset:24576
  v_mfma_f32_16x16x32_bf16 v[148:151], a[20:23], a[100:103], v[148:151]
  ds_read_b64_tr_b16 a[82:83], v16 offset:25088
  v_mfma_f32_16x16x32_bf16 v[152:155], a[20:23], a[104:107], v[152:155]
  ds_read_b64_tr_b16 a[84:85], v16 offset:27648
  v_mfma_f32_16x16x32_bf16 v[156:159], a[20:23], a[108:111], v[156:159]
  ds_read_b64_tr_b16 a[86:87], v16 offset:28160
  v_mfma_f32_16x16x32_bf16 v[160:163], a[24:27], a[96:99], v[160:163]
  s_add_u32 m0, s62, 3968
  v_mfma_f32_16x16x32_bf16 v[164:167], a[24:27], a[100:103], v[164:167]
  buffer_load_dwordx4 v5, s[48:51], s61 offen offset:128 lds
  v_mfma_f32_16x16x32_bf16 v[168:171], a[24:27], a[104:107], v[168:171]
  v_mfma_f32_16x16x32_bf16 v[172:175], a[24:27], a[108:111], v[172:175]
  v_mfma_f32_16x16x32_bf16 v[176:179], a[28:31], a[96:99], v[176:179]
  v_mfma_f32_16x16x32_bf16 v[180:183], a[28:31], a[100:103], v[180:183]
  v_mfma_f32_16x16x32_bf16 v[184:187], a[28:31], a[104:107], v[184:187]
  s_add_u32 m0, s62, 4864
  v_mfma_f32_16x16x32_bf16 v[188:191], a[28:31], a[108:111], v[188:191]
  buffer_load_dwordx4 v5, s[48:51], s61 offen offset:256 lds
  s_add_u32 s61, s61, s67
  v_mfma_f32_16x16x32_bf16 v[192:195], a[32:35], a[96:99], v[192:195]
  v_mfma_f32_16x16x32_bf16 v[196:199], a[32:35], a[100:103], v[196:199]
  v_mfma_f32_16x16x32_bf16 v[200:203], a[32:35], a[104:107], v[200:203]
  v_mfma_f32_16x16x32_bf16 v[204:207], a[32:35], a[108:111], v[204:207]
  v_mfma_f32_16x16x32_bf16 v[208:211], a[36:39], a[96:99], v[208:211]
  v_mfma_f32_16x16x32_bf16 v[212:215], a[36:39], a[100:103], v[212:215]
  v_mfma_f32_16x16x32_bf16 v[216:219], a[36:39], a[104:107], v[216:219]
  v_mfma_f32_16x16x32_bf16 v[220:223], a[36:39], a[108:111], v[220:223]
  s_waitcnt vmcnt(16) lgkmcnt(0)
  s_barrier
  s_nop 0
  v_mfma_f32_16x16x32_bf16 v[64:67], a[48:51], a[112:115], v[64:67]
  ds_read_b128 a[96:99], v10 offset:16384
  s_add_u32 m0, s62, 24576
  v_mfma_f32_16x16x32_bf16 v[68:71], a[48:51], a[116:119], v[68:71]
  ds_read_b128 a[100:103], v10 offset:18432
  buffer_load_dwordx4 v5, s[44:47], s61 offen offset:0 lds
  v_mfma_f32_16x16x32_bf16 v[72:75], a[48:51], a[120:123], v[72:75]
  ds_read_b128 a[104:107], v10 offset:20480
  v_mfma_f32_16x16x32_bf16 v[76:79], a[48:51], a[124:127], v[76:79]
  ds_read_b128 a[108:111], v10 offset:22528
  s_add_u32 m0, s62, 25472
  v_mfma_f32_16x16x32_bf16 v[80:83], a[52:55], a[112:115], v[80:83]
  ds_read_b64_tr_b16 a[0:1], v18 offset:0
  buffer_load_dwordx4 v5, s[44:47], s61 offen offset:128 lds
  v_mfma_f32_16x16x32_bf16 v[84:87], a[52:55], a[116:119], v[84:87]
  ds_read_b64_tr_b16 a[2:3], v18 offset:512
  v_mfma_f32_16x16x32_bf16 v[88:91], a[52:55], a[120:123], v[88:91]
  ds_read_b64_tr_b16 a[4:5], v18 offset:3072
  v_mfma_f32_16x16x32_bf16 v[92:95], a[52:55], a[124:127], v[92:95]
  ds_read_b64_tr_b16 a[6:7], v18 offset:3584
  s_add_u32 m0, s62, 26368
  v_mfma_f32_16x16x32_bf16 v[96:99], a[56:59], a[112:115], v[96:99]
  ds_read_b64_tr_b16 a[8:9], v19 offset:0
  buffer_load_dwordx4 v5, s[44:47], s61 offen offset:256 lds
  v_mfma_f32_16x16x32_bf16 v[100:103], a[56:59], a[116:119], v[100:103]
  ds_read_b64_tr_b16 a[10:11], v19 offset:512
  v_mfma_f32_16x16x32_bf16 v[104:107], a[56:59], a[120:123], v[104:107]
  ds_read_b64_tr_b16 a[12:13], v19 offset:3072
  v_mfma_f32_16x16x32_bf16 v[108:111], a[56:59], a[124:127], v[108:111]
  ds_read_b64_tr_b16 a[14:15], v19 offset:3584
  s_add_u32 m0, s62, 27648
  v_mfma_f32_16x16x32_bf16 v[112:115], a[60:63], a[112:115], v[112:115]
  ds_read_b64_tr_b16 a[16:17], v20 offset:0
  buffer_load_dwordx4 v5, s[48:51], s61 offen offset:0 lds
  v_mfma_f32_16x16x32_bf16 v[116:119], a[60:63], a[116:119], v[116:119]
  ds_read_b64_tr_b16 a[18:19], v20 offset:512
  v_mfma_f32_16x16x32_bf16 v[120:123], a[60:63], a[120:123], v[120:123]
  ds_read_b64_tr_b16 a[20:21], v20 offset:3072
  s_add_u32 m0, s62, 28544
  v_mfma_f32_16x16x32_bf16 v[124:127], a[60:63], a[124:127], v[124:127]
  ds_read_b64_tr_b16 a[22:23], v20 offset:3584
  buffer_load_dwordx4 v5, s[48:51], s61 offen offset:128 lds
  v_mfma_f32_16x16x32_bf16 v[128:131], a[64:67], a[112:115], v[128:131]
  ds_read_b64_tr_b16 a[24:25], v21 offset:0
  v_mfma_f32_16x16x32_bf16 v[132:135], a[64:67], a[116:119], v[132:135]
  ds_read_b64_tr_b16 a[26:27], v21 offset:512
  v_mfma_f32_16x16x32_bf16 v[136:139], a[64:67], a[120:123], v[136:139]
  ds_read_b64_tr_b16 a[28:29], v21 offset:3072
  s_add_u32 m0, s62, 29440
  v_mfma_f32_16x16x32_bf16 v[140:143], a[64:67], a[124:127], v[140:143]
  ds_read_b64_tr_b16 a[30:31], v21 offset:3584
  buffer_load_dwordx4 v5, s[48:51], s61 offen offset:256 lds
  s_add_u32 s61, s61, s67
  s_nop 0
  v_mfma_f32_16x16x32_bf16 v[144:147], a[68:71], a[112:115], v[144:147]
  ds_read_b64_tr_b16 a[32:33], v22 offset:0
  v_mfma_f32_16x16x32_bf16 v[148:151], a[68:71], a[116:119], v[148:151]
  ds_read_b64_tr_b16 a[34:35], v22 offset:512
  v_mfma_f32_16x16x32_bf16 v[152:155], a[68:71], a[120:123], v[152:155]
  ds_read_b64_tr_b16 a[36:37], v22 offset:3072
  s_add_u32 m0, s63, -1152
  v_mfma_f32_16x16x32_bf16 v[156:159], a[68:71], a[124:127], v[156:159]
  ds_read_b64_tr_b16 a[38:39], v22 offset:3584
  buffer_load_dwordx4 v6, s[40:43], 0 offen offset:1152 lds
  v_mfma_f32_16x16x32_bf16 v[160:163], a[72:75], a[112:115], v[160:163]
  v_mfma_f32_16x16x32_bf16 v[164:167], a[72:75], a[116:119], v[164:167]
  s_add_u32 m0, s63, -128
  v_mfma_f32_16x16x32_bf16 v[168:171], a[72:75], a[120:123], v[168:171]
  buffer_load_dwordx4 v7, s[40:43], 0 offen offset:1152 lds
  v_mfma_f32_16x16x32_bf16 v[172:175], a[72:75], a[124:127], v[172:175]
  v_mfma_f32_16x16x32_bf16 v[176:179], a[76:79], a[112:115], v[176:179]
  v_mfma_f32_16x16x32_bf16 v[180:183], a[76:79], a[116:119], v[180:183]
  s_add_u32 m0, s63, 896
  v_mfma_f32_16x16x32_bf16 v[184:187], a[76:79], a[120:123], v[184:187]
  buffer_load_dwordx4 v8, s[40:43], 0 offen offset:1152 lds
  v_mfma_f32_16x16x32_bf16 v[188:191], a[76:79], a[124:127], v[188:191]
  v_mfma_f32_16x16x32_bf16 v[192:195], a[80:83], a[112:115], v[192:195]
  v_mfma_f32_16x16x32_bf16 v[196:199], a[80:83], a[116:119], v[196:199]
  s_add_u32 m0, s63, 1920
  v_mfma_f32_16x16x32_bf16 v[200:203], a[80:83], a[120:123], v[200:203]
  buffer_load_dwordx4 v9, s[40:43], 0 offen offset:1152 lds
  v_mfma_f32_16x16x32_bf16 v[204:207], a[80:83], a[124:127], v[204:207]
  v_mfma_f32_16x16x32_bf16 v[208:211], a[84:87], a[112:115], v[208:211]
  v_mfma_f32_16x16x32_bf16 v[212:215], a[84:87], a[116:119], v[212:215]
  v_mfma_f32_16x16x32_bf16 v[216:219], a[84:87], a[120:123], v[216:219]
  v_mfma_f32_16x16x32_bf16 v[220:223], a[84:87], a[124:127], v[220:223]
  s_waitcnt vmcnt(20) lgkmcnt(0)
  s_barrier
  v_mfma_f32_16x16x32_bf16 v[64:67], a[0:3], a[96:99], v[64:67]
  ds_read_b128 a[112:115], v11 offset:16384
  s_add_u32 m0, s62, 49152
  v_mfma_f32_16x16x32_bf16 v[68:71], a[0:3], a[100:103], v[68:71]
  ds_read_b128 a[116:119], v11 offset:18432
  buffer_load_dwordx4 v5, s[44:47], s61 offen offset:0 lds
  v_mfma_f32_16x16x32_bf16 v[72:75], a[0:3], a[104:107], v[72:75]
  ds_read_b128 a[120:123], v11 offset:20480
  v_mfma_f32_16x16x32_bf16 v[76:79], a[0:3], a[108:111], v[76:79]
  ds_read_b128 a[124:127], v11 offset:22528
  v_mfma_f32_16x16x32_bf16 v[80:83], a[4:7], a[96:99], v[80:83]
  ds_read_b64_tr_b16 a[48:49], v18 offset:24576
  v_mfma_f32_16x16x32_bf16 v[84:87], a[4:7], a[100:103], v[84:87]
  ds_read_b64_tr_b16 a[50:51], v18 offset:25088
  v_mfma_f32_16x16x32_bf16 v[88:91], a[4:7], a[104:107], v[88:91]
  ds_read_b64_tr_b16 a[52:53], v18 offset:27648
  s_add_u32 m0, s62, 50048
  v_mfma_f32_16x16x32_bf16 v[92:95], a[4:7], a[108:111], v[92:95]
  ds_read_b64_tr_b16 a[54:55], v18 offset:28160
  buffer_load_dwordx4 v5, s[44:47], s61 offen offset:128 lds
  v_mfma_f32_16x16x32_bf16 v[96:99], a[8:11], a[96:99], v[96:99]
  ds_read_b64_tr_b16 a[56:57], v19 offset:24576
  v_mfma_f32_16x16x32_bf16 v[100:103], a[8:11], a[100:103], v[100:103]
  ds_read_b64_tr_b16 a[58:59], v19 offset:25088
  v_mfma_f32_16x16x32_bf16 v[104:107], a[8:11], a[104:107], v[104:107]
  ds_read_b64_tr_b16 a[60:61], v19 offset:27648
  v_mfma_f32_16x16x32_bf16 v[108:111], a[8:11], a[108:111], v[108:111]
  ds_read_b64_tr_b16 a[62:63], v19 offset:28160
  v_mfma_f32_16x16x32_bf16 v[112:115], a[12:15], a[96:99], v[112:115]
  ds_read_b64_tr_b16 a[64:65], v20 offset:24576
  s_add_u32 m0, s62, 50944
  v_mfma_f32_16x16x32_bf16 v[116:119], a[12:15], a[100:103], v[116:119]
  ds_read_b64_tr_b16 a[66:67], v20 offset:25088
  buffer_load_dwordx4 v5, s[44:47], s61 offen offset:256 lds
  v_mfma_f32_16x16x32_bf16 v[120:123], a[12:15], a[104:107], v[120:123]
  ds_read_b64_tr_b16 a[68:69], v20 offset:27648
  v_mfma_f32_16x16x32_bf16 v[124:127], a[12:15], a[108:111], v[124:127]
  ds_read_b64_tr_b16 a[70:71], v20 offset:28160
  v_mfma_f32_16x16x32_bf16 v[128:131], a[16:19], a[96:99], v[128:131]
  ds_read_b64_tr_b16 a[72:73], v21 offset:24576
  v_mfma_f32_16x16x32_bf16 v[132:135], a[16:19], a[100:103], v[132:135]
  ds_read_b64_tr_b16 a[74:75], v21 offset:25088
  v_mfma_f32_16x16x32_bf16 v[136:139], a[16:19], a[104:107], v[136:139]
  ds_read_b64_tr_b16 a[76:77], v21 offset:27648
  s_add_u32 m0, s62, 52224
  v_mfma_f32_16x16x32_bf16 v[140:143], a[16:19], a[108:111], v[140:143]
  ds_read_b64_tr_b16 a[78:79], v21 offset:28160
  buffer_load_dwordx4 v5, s[48:51], s61 offen offset:0 lds
  v_mfma_f32_16x16x32_bf16 v[144:147], a[20:23], a[96:99], v[144:147]
  ds_read_b64_tr_b16 a[80:81], v22 offset:24576
  v_mfma_f32_16x16x32_bf16 v[148:151], a[20:23], a[100:103], v[148:151]
  ds_read_b64_tr_b16 a[82:83], v22 offset:25088
  v_mfma_f32_16x16x32_bf16 v[152:155], a[20:23], a[104:107], v[152:155]
  ds_read_b64_tr_b16 a[84:85], v22 offset:27648
  v_mfma_f32_16x16x32_bf16 v[156:159], a[20:23], a[108:111], v[156:159]
  ds_read_b64_tr_b16 a[86:87], v22 offset:28160
  v_mfma_f32_16x16x32_bf16 v[160:163], a[24:27], a[96:99], v[160:163]
  s_add_u32 m0, s62, 53120
  v_mfma_f32_16x16x32_bf16 v[164:167], a[24:27], a[100:103], v[164:167]
  buffer_load_dwordx4 v5, s[48:51], s61 offen offset:128 lds
  v_mfma_f32_16x16x32_bf16 v[168:171], a[24:27], a[104:107], v[168:171]
  v_mfma_f32_16x16x32_bf16 v[172:175], a[24:27], a[108:111], v[172:175]
  v_mfma_f32_16x16x32_bf16 v[176:179], a[28:31], a[96:99], v[176:179]
  v_mfma_f32_16x16x32_bf16 v[180:183], a[28:31], a[100:103], v[180:183]
  v_mfma_f32_16x16x32_bf16 v[184:187], a[28:31], a[104:107], v[184:187]
  s_add_u32 m0, s62, 54016
  v_mfma_f32_16x16x32_bf16 v[188:191], a[28:31], a[108:111], v[188:191]
  buffer_load_dwordx4 v5, s[48:51], s61 offen offset:256 lds
  s_add_u32 s61, s61, s67
  v_mfma_f32_16x16x32_bf16 v[192:195], a[32:35], a[96:99], v[192:195]
  v_mfma_f32_16x16x32_bf16 v[196:199], a[32:35], a[100:103], v[196:199]
  v_mfma_f32_16x16x32_bf16 v[200:203], a[32:35], a[104:107], v[200:203]
  v_mfma_f32_16x16x32_bf16 v[204:207], a[32:35], a[108:111], v[204:207]
  v_mfma_f32_16x16x32_bf16 v[208:211], a[36:39], a[96:99], v[208:211]
  v_mfma_f32_16x16x32_bf16 v[212:215], a[36:39], a[100:103], v[212:215]
  v_mfma_f32_16x16x32_bf16 v[216:219], a[36:39], a[104:107], v[216:219]
  v_mfma_f32_16x16x32_bf16 v[220:223], a[36:39], a[108:111], v[220:223]
  v_mov_b32 v4, 0
  s_cmp_lg_u32 s32, 0
  s_cbranch_scc1 Lp0_38
  global_load_dword v31, v4, s[28:29] sc1
  s_branch Lp1_39
Lp0_38:
  v_mov_b32 v4, 0
  global_load_dword v31, v4, s[8:9]
Lp1_39:
  s_waitcnt vmcnt(17) lgkmcnt(0)
  s_barrier
  v_mfma_f32_16x16x32_bf16 v[64:67], a[48:51], a[112:115], v[64:67]
  ds_read_b128 a[96:99], v10 offset:32768
  s_add_u32 m0, s62, 73728
  v_mfma_f32_16x16x32_bf16 v[68:71], a[48:51], a[116:119], v[68:71]
  ds_read_b128 a[100:103], v10 offset:34816
  buffer_load_dwordx4 v5, s[44:47], s61 offen offset:0 lds
  v_mfma_f32_16x16x32_bf16 v[72:75], a[48:51], a[120:123], v[72:75]
  ds_read_b128 a[104:107], v10 offset:36864
  v_mfma_f32_16x16x32_bf16 v[76:79], a[48:51], a[124:127], v[76:79]
  ds_read_b128 a[108:111], v10 offset:38912
  v_mfma_f32_16x16x32_bf16 v[80:83], a[52:55], a[112:115], v[80:83]
  ds_read_b64_tr_b16 a[0:1], v12 offset:0
  v_mfma_f32_16x16x32_bf16 v[84:87], a[52:55], a[116:119], v[84:87]
  ds_read_b64_tr_b16 a[2:3], v12 offset:512
  v_mfma_f32_16x16x32_bf16 v[88:91], a[52:55], a[120:123], v[88:91]
  ds_read_b64_tr_b16 a[4:5], v12 offset:3072
  s_add_u32 m0, s62, 74624
  v_mfma_f32_16x16x32_bf16 v[92:95], a[52:55], a[124:127], v[92:95]
  ds_read_b64_tr_b16 a[6:7], v12 offset:3584
  buffer_load_dwordx4 v5, s[44:47], s61 offen offset:128 lds
  v_mfma_f32_16x16x32_bf16 v[96:99], a[56:59], a[112:115], v[96:99]
  ds_read_b64_tr_b16 a[8:9], v13 offset:0
  v_mfma_f32_16x16x32_bf16 v[100:103], a[56:59], a[116:119], v[100:103]
  ds_read_b64_tr_b16 a[10:11], v13 offset:512
  v_mfma_f32_16x16x32_bf16 v[104:107], a[56:59], a[120:123], v[104:107]
  ds_read_b64_tr_b16 a[12:13], v13 offset:3072
  v_mfma_f32_16x16x32_bf16 v[108:111], a[56:59], a[124:127], v[108:111]
  ds_read_b64_tr_b16 a[14:15], v13 offset:3584
  v_mfma_f32_16x16x32_bf16 v[112:115], a[60:63], a[112:115], v[112:115]
  ds_read_b64_tr_b16 a[16:17], v14 offset:0
  s_add_u32 m0, s62, 75520
  v_mfma_f32_16x16x32_bf16 v[116:119], a[60:63], a[116:119], v[116:119]
  ds_read_b64_tr_b16 a[18:19], v14 offset:512
  buffer_load_dwordx4 v5, s[44:47], s61 offen offset:256 lds
  v_mfma_f32_16x16x32_bf16 v[120:123], a[60:63], a[120:123], v[120:123]
  ds_read_b64_tr_b16 a[20:21], v14 offset:3072
  v_mfma_f32_16x16x32_bf16 v[124:127], a[60:63], a[124:127], v[124:127]
  ds_read_b64_tr_b16 a[22:23], v14 offset:3584
  v_mfma_f32_16x16x32_bf16 v[128:131], a[64:67], a[112:115], v[128:131]
  ds_read_b64_tr_b16 a[24:25], v15 offset:0
  v_mfma_f32_16x16x32_bf16 v[132:135], a[64:67], a[116:119], v[132:135]
  ds_read_b64_tr_b16 a[26:27], v15 offset:512
  v_mfma_f32_16x16x32_bf16 v[136:139], a[64:67], a[120:123], v[136:139]
  ds_read_b64_tr_b16 a[28:29], v15 offset:3072
  s_add_u32 m0, s62, 76800
  v_mfma_f32_16x16x32_bf16 v[140:143], a[64:67], a[124:127], v[140:143]
  ds_read_b64_tr_b16 a[30:31], v15 offset:3584
  buffer_load_dwordx4 v5, s[48:51], s61 offen offset:0 lds
  v_mfma_f32_16x16x32_bf16 v[144:147], a[68:71], a[112:115], v[144:147]
  ds_read_b64_tr_b16 a[32:33], v16 offset:0
  v_mfma_f32_16x16x32_bf16 v[148:151], a[68:71], a[116:119], v[148:151]
  ds_read_b64_tr_b16 a[34:35], v16 offset:512
  v_mfma_f32_16x16x32_bf16 v[152:155], a[68:71], a[120:123], v[152:155]
  ds_read_b64_tr_b16 a[36:37], v16 offset:3072
  v_mfma_f32_16x16x32_bf16 v[156:159], a[68:71], a[124:127], v[156:159]
  ds_read_b64_tr_b16 a[38:39], v16 offset:3584
  v_mfma_f32_16x16x32_bf16 v[160:163], a[72:75], a[112:115], v[160:163]
  s_add_u32 m0, s62, 77696
  v_mfma_f32_16x16x32_bf16 v[164:167], a[72:75], a[116:119], v[164:167]
  buffer_load_dwordx4 v5, s[48:51], s61 offen offset:128 lds
  v_mfma_f32_16x16x32_bf16 v[168:171], a[72:75], a[120:123], v[168:171]
  v_mfma_f32_16x16x32_bf16 v[172:175], a[72:75], a[124:127], v[172:175]
  v_mfma_f32_16x16x32_bf16 v[176:179], a[76:79], a[112:115], v[176:179]
  v_mfma_f32_16x16x32_bf16 v[180:183], a[76:79], a[116:119], v[180:183]
  v_mfma_f32_16x16x32_bf16 v[184:187], a[76:79], a[120:123], v[184:187]
  s_add_u32 m0, s62, 78592
  v_mfma_f32_16x16x32_bf16 v[188:191], a[76:79], a[124:127], v[188:191]
  buffer_load_dwordx4 v5, s[48:51], s61 offen offset:256 lds
  s_add_u32 s61, s61, s67
  v_mfma_f32_16x16x32_bf16 v[192:195], a[80:83], a[112:115], v[192:195]
  v_mfma_f32_16x16x32_bf16 v[196:199], a[80:83], a[116:119], v[196:199]
  v_mfma_f32_16x16x32_bf16 v[200:203], a[80:83], a[120:123], v[200:203]
  v_mfma_f32_16x16x32_bf16 v[204:207], a[80:83], a[124:127], v[204:207]
  v_mfma_f32_16x16x32_bf16 v[208:211], a[84:87], a[112:115], v[208:211]
  v_mfma_f32_16x16x32_bf16 v[212:215], a[84:87], a[116:119], v[212:215]
  v_mfma_f32_16x16x32_bf16 v[216:219], a[84:87], a[120:123], v[216:219]
  v_mfma_f32_16x16x32_bf16 v[220:223], a[84:87], a[124:127], v[220:223]
  s_waitcnt vmcnt(17) lgkmcnt(0)
  s_waitcnt vmcnt(6)
  s_cmp_lg_u32 s32, 0
  s_cbranch_scc1 Lpd_41
  v_cmp_gt_u32 vcc, 48, v31
  s_mov_b32 s95, 0x8000
  s_cmp_eq_u64 vcc, 0
  s_cbranch_scc1 Lpd_41
Lpoll_40:
  s_sleep 8
  global_load_dword v31, v4, s[28:29] sc1
  s_waitcnt vmcnt(0)
  v_cmp_gt_u32 vcc, 48, v31
  s_sub_u32 s95, s95, 1
  s_cmp_eq_u64 vcc, 0
  s_cbranch_scc1 Lpd_41
  s_cmp_lg_u32 s95, 0
  s_cbranch_scc1 Lpoll_40
Lpd_41:
  s_barrier
  s_nop 0
  v_mfma_f32_16x16x32_bf16 v[64:67], a[0:3], a[96:99], v[64:67]
  ds_read_b128 a[112:115], v11 offset:32768
  s_add_u32 s88, s89, 102400
  v_mfma_f32_16x16x32_bf16 v[68:71], a[0:3], a[100:103], v[68:71]
  ds_read_b128 a[116:119], v11 offset:34816
  buffer_load_dwordx4 a[128:131], v2, s[84:87], s88 offen offset:0 sc1
  v_mfma_f32_16x16x32_bf16 v[72:75], a[0:3], a[104:107], v[72:75]
  ds_read_b128 a[120:123], v11 offset:36864
  v_mfma_f32_16x16x32_bf16 v[76:79], a[0:3], a[108:111], v[76:79]
  ds_read_b128 a[124:127], v11 offset:38912
  v_mfma_f32_16x16x32_bf16 v[80:83], a[4:7], a[96:99], v[80:83]
  ds_read_b64_tr_b16 a[48:49], v12 offset:24576
  v_mfma_f32_16x16x32_bf16 v[84:87], a[4:7], a[100:103], v[84:87]
  ds_read_b64_tr_b16 a[50:51], v12 offset:25088
  buffer_load_dwordx4 a[132:135], v2, s[84:87], s88 offen offset:1024 sc1
  v_mfma_f32_16x16x32_bf16 v[88:91], a[4:7], a[104:107], v[88:91]
  ds_read_b64_tr_b16 a[52:53], v12 offset:27648
  v_mfma_f32_16x16x32_bf16 v[92:95], a[4:7], a[108:111], v[92:95]
  ds_read_b64_tr_b16 a[54:55], v12 offset:28160
  v_mfma_f32_16x16x32_bf16 v[96:99], a[8:11], a[96:99], v[96:99]
  ds_read_b64_tr_b16 a[56:57], v13 offset:24576
  v_mfma_f32_16x16x32_bf16 v[100:103], a[8:11], a[100:103], v[100:103]
  ds_read_b64_tr_b16 a[58:59], v13 offset:25088
  v_mfma_f32_16x16x32_bf16 v[104:107], a[8:11], a[104:107], v[104:107]
  ds_read_b64_tr_b16 a[60:61], v13 offset:27648
  buffer_load_dwordx4 a[136:139], v2, s[84:87], s88 offen offset:2048 sc1
  v_mfma_f32_16x16x32_bf16 v[108:111], a[8:11], a[108:111], v[108:111]
  ds_read_b64_tr_b16 a[62:63], v13 offset:28160
  v_mfma_f32_16x16x32_bf16 v[112:115], a[12:15], a[96:99], v[112:115]
  ds_read_b64_tr_b16 a[64:65], v14 offset:24576
  v_mfma_f32_16x16x32_bf16 v[116:119], a[12:15], a[100:103], v[116:119]
  ds_read_b64_tr_b16 a[66:67], v14 offset:25088
  v_mfma_f32_16x16x32_bf16 v[120:123], a[12:15], a[104:107], v[120:123]
  ds_read_b64_tr_b16 a[68:69], v14 offset:27648
  buffer_load_dwordx4 a[140:143], v2, s[84:87], s88 offen offset:3072 sc1
  v_mfma_f32_16x16x32_bf16 v[124:127], a[12:15], a[108:111], v[124:127]
  ds_read_b64_tr_b16 a[70:71], v14 offset:28160
  v_mfma_f32_16x16x32_bf16 v[128:131], a[16:19], a[96:99], v[128:131]
  ds_read_b64_tr_b16 a[72:73], v15 offset:24576
  v_mfma_f32_16x16x32_bf16 v[132:135], a[16:19], a[100:103], v[132:135]
  ds_read_b64_tr_b16 a[74:75], v15 offset:25088
  v_mfma_f32_16x16x32_bf16 v[136:139], a[16:19], a[104:107], v[136:139]
  ds_read_b64_tr_b16 a[76:77], v15 offset:27648
  v_mfma_f32_16x16x32_bf16 v[140:143], a[16:19], a[108:111], v[140:143]
  ds_read_b64_tr_b16 a[78:79], v15 offset:28160
  buffer_load_dwordx4 a[144:147], v3, s[84:87], s88 offen sc1
  v_mfma_f32_16x16x32_bf16 v[144:147], a[20:23], a[96:99], v[144:147]
  ds_read_b64_tr_b16 a[80:81], v16 offset:24576
  v_mfma_f32_16x16x32_bf16 v[148:151], a[20:23], a[100:103], v[148:151]
  ds_read_b64_tr_b16 a[82:83], v16 offset:25088
  v_mfma_f32_16x16x32_bf16 v[152:155], a[20:23], a[104:107], v[152:155]
  ds_read_b64_tr_b16 a[84:85], v16 offset:27648
  v_mfma_f32_16x16x32_bf16 v[156:159], a[20:23], a[108:111], v[156:159]
  ds_read_b64_tr_b16 a[86:87], v16 offset:28160
  s_add_u32 s88, s89, 122880
  v_mfma_f32_16x16x32_bf16 v[160:163], a[24:27], a[96:99], v[160:163]
  buffer_load_dwordx4 a[148:151], v2, s[84:87], s88 offen offset:0 sc1
  v_mfma_f32_16x16x32_bf16 v[164:167], a[24:27], a[100:103], v[164:167]
  v_mfma_f32_16x16x32_bf16 v[168:171], a[24:27], a[104:107], v[168:171]
  v_mfma_f32_16x16x32_bf16 v[172:175], a[24:27], a[108:111], v[172:175]
  v_mfma_f32_16x16x32_bf16 v[176:179], a[28:31], a[96:99], v[176:179]
  buffer_load_dwordx4 a[152:155], v2, s[84:87], s88 offen offset:1024 sc1
  v_mfma_f32_16x16x32_bf16 v[180:183], a[28:31], a[100:103], v[180:183]
  v_mfma_f32_16x16x32_bf16 v[184:187], a[28:31], a[104:107], v[184:187]
  v_mfma_f32_16x16x32_bf16 v[188:191], a[28:31], a[108:111], v[188:191]
  v_mfma_f32_16x16x32_bf16 v[192:195], a[32:35], a[96:99], v[192:195]
  v_mfma_f32_16x16x32_bf16 v[196:199], a[32:35], a[100:103], v[196:199]
  buffer_load_dwordx4 a[156:159], v2, s[84:87], s88 offen offset:2048 sc1
  v_mfma_f32_16x16x32_bf16 v[200:203], a[32:35], a[104:107], v[200:203]
  v_mfma_f32_16x16x32_bf16 v[204:207], a[32:35], a[108:111], v[204:207]
  v_mfma_f32_16x16x32_bf16 v[208:211], a[36:39], a[96:99], v[208:211]
  v_mfma_f32_16x16x32_bf16 v[212:215], a[36:39], a[100:103], v[212:215]
  v_mfma_f32_16x16x32_bf16 v[216:219], a[36:39], a[104:107], v[216:219]
  v_mfma_f32_16x16x32_bf16 v[220:223], a[36:39], a[108:111], v[220:223]
  s_waitcnt lgkmcnt(0)
  s_barrier
  v_mfma_f32_16x16x32_bf16 v[64:67], a[48:51], a[112:115], v[64:67]
  ds_read_b128 a[96:99], v10 offset:0
  v_mfma_f32_16x16x32_bf16 v[68:71], a[48:51], a[116:119], v[68:71]
  ds_read_b128 a[100:103], v10 offset:2048
  buffer_load_dwordx4 a[160:163], v2, s[84:87], s88 offen offset:3072 sc1
  v_mfma_f32_16x16x32_bf16 v[72:75], a[48:51], a[120:123], v[72:75]
  ds_read_b128 a[104:107], v10 offset:4096
  v_mfma_f32_16x16x32_bf16 v[76:79], a[48:51], a[124:127], v[76:79]
  ds_read_b128 a[108:111], v10 offset:6144
  v_mfma_f32_16x16x32_bf16 v[80:83], a[52:55], a[112:115], v[80:83]
  ds_read_b64_tr_b16 a[0:1], v18 offset:0
  v_mfma_f32_16x16x32_bf16 v[84:87], a[52:55], a[116:119], v[84:87]
  ds_read_b64_tr_b16 a[2:3], v18 offset:512
  buffer_load_dwordx4 a[164:167], v3, s[84:87], s88 offen sc1
  v_mfma_f32_16x16x32_bf16 v[88:91], a[52:55], a[120:123], v[88:91]
  ds_read_b64_tr_b16 a[4:5], v18 offset:3072
  v_mfma_f32_16x16x32_bf16 v[92:95], a[52:55], a[124:127], v[92:95]
  ds_read_b64_tr_b16 a[6:7], v18 offset:3584
  v_mfma_f32_16x16x32_bf16 v[96:99], a[56:59], a[112:115], v[96:99]
  ds_read_b64_tr_b16 a[8:9], v19 offset:0
  v_mfma_f32_16x16x32_bf16 v[100:103], a[56:59], a[116:119], v[100:103]
  ds_read_b64_tr_b16 a[10:11], v19 offset:512
  s_add_u32 s88, s89, 143360
  v_mfma_f32_16x16x32_bf16 v[104:107], a[56:59], a[120:123], v[104:107]
  ds_read_b64_tr_b16 a[12:13], v19 offset:3072
  buffer_load_dwordx4 a[168:171], v2, s[84:87], s88 offen offset:0 sc1
  v_mfma_f32_16x16x32_bf16 v[108:111], a[56:59], a[124:127], v[108:111]
  ds_read_b64_tr_b16 a[14:15], v19 offset:3584
  v_mfma_f32_16x16x32_bf16 v[112:115], a[60:63], a[112:115], v[112:115]
  ds_read_b64_tr_b16 a[16:17], v20 offset:0
  v_mfma_f32_16x16x32_bf16 v[116:119], a[60:63], a[116:119], v[116:119]
  ds_read_b64_tr_b16 a[18:19], v20 offset:512
  v_mfma_f32_16x16x32_bf16 v[120:123], a[60:63], a[120:123], v[120:123]
  ds_read_b64_tr_b16 a[20:21], v20 offset:3072
  buffer_load_dwordx4 a[172:175], v2, s[84:87], s88 offen offset:1024 sc1
  v_mfma_f32_16x16x32_bf16 v[124:127], a[60:63], a[124:127], v[124:127]
  ds_read_b64_tr_b16 a[22:23], v20 offset:3584
  v_mfma_f32_16x16x32_bf16 v[128:131], a[64:67], a[112:115], v[128:131]
  ds_read_b64_tr_b16 a[24:25], v21 offset:0
  v_mfma_f32_16x16x32_bf16 v[132:135], a[64:67], a[116:119], v[132:135]
  ds_read_b64_tr_b16 a[26:27], v21 offset:512
  v_mfma_f32_16x16x32_bf16 v[136:139], a[64:67], a[120:123], v[136:139]
  ds_read_b64_tr_b16 a[28:29], v21 offset:3072
  v_mfma_f32_16x16x32_bf16 v[140:143], a[64:67], a[124:127], v[140:143]
  ds_read_b64_tr_b16 a[30:31], v21 offset:3584
  buffer_load_dwordx4 a[176:179], v2, s[84:87], s88 offen offset:2048 sc1
  v_mfma_f32_16x16x32_bf16 v[144:147], a[68:71], a[112:115], v[144:147]
  ds_read_b64_tr_b16 a[32:33], v22 offset:0
  v_mfma_f32_16x16x32_bf16 v[148:151], a[68:71], a[116:119], v[148:151]
  ds_read_b64_tr_b16 a[34:35], v22 offset:512
  v_mfma_f32_16x16x32_bf16 v[152:155], a[68:71], a[120:123], v[152:155]
  ds_read_b64_tr_b16 a[36:37], v22 offset:3072
  v_mfma_f32_16x16x32_bf16 v[156:159], a[68:71], a[124:127], v[156:159]
  ds_read_b64_tr_b16 a[38:39], v22 offset:3584
  v_mfma_f32_16x16x32_bf16 v[160:163], a[72:75], a[112:115], v[160:163]
  buffer_load_dwordx4 a[180:183], v2, s[84:87], s88 offen offset:3072 sc1
  v_mfma_f32_16x16x32_bf16 v[164:167], a[72:75], a[116:119], v[164:167]
  v_mfma_f32_16x16x32_bf16 v[168:171], a[72:75], a[120:123], v[168:171]
  v_mfma_f32_16x16x32_bf16 v[172:175], a[72:75], a[124:127], v[172:175]
  v_mfma_f32_16x16x32_bf16 v[176:179], a[76:79], a[112:115], v[176:179]
  buffer_load_dwordx4 a[184:187], v3, s[84:87], s88 offen sc1
  v_mfma_f32_16x16x32_bf16 v[180:183], a[76:79], a[116:119], v[180:183]
  v_mfma_f32_16x16x32_bf16 v[184:187], a[76:79], a[120:123], v[184:187]
  v_mfma_f32_16x16x32_bf16 v[188:191], a[76:79], a[124:127], v[188:191]
  v_mfma_f32_16x16x32_bf16 v[192:195], a[80:83], a[112:115], v[192:195]
  s_add_u32 s88, s89, 163840
  v_mfma_f32_16x16x32_bf16 v[196:199], a[80:83], a[116:119], v[196:199]
  buffer_load_dwordx4 a[188:191], v2, s[84:87], s88 offen offset:0 sc1
  v_mfma_f32_16x16x32_bf16 v[200:203], a[80:83], a[120:123], v[200:203]
  v_mfma_f32_16x16x32_bf16 v[204:207], a[80:83], a[124:127], v[204:207]
  v_mfma_f32_16x16x32_bf16 v[208:211], a[84:87], a[112:115], v[208:211]
  v_mfma_f32_16x16x32_bf16 v[212:215], a[84:87], a[116:119], v[212:215]
  v_mfma_f32_16x16x32_bf16 v[216:219], a[84:87], a[120:123], v[216:219]
  v_mfma_f32_16x16x32_bf16 v[220:223], a[84:87], a[124:127], v[220:223]
  s_waitcnt vmcnt(16) lgkmcnt(0)
  s_barrier
  v_mfma_f32_16x16x32_bf16 v[64:67], a[0:3], a[96:99], v[64:67]
  ds_read_b128 a[112:115], v11 offset:0
  v_mfma_f32_16x16x32_bf16 v[68:71], a[0:3], a[100:103], v[68:71]
  ds_read_b128 a[116:119], v11 offset:2048
  buffer_load_dwordx4 a[192:195], v2, s[84:87], s88 offen offset:1024 sc1
  v_mfma_f32_16x16x32_bf16 v[72:75], a[0:3], a[104:107], v[72:75]
  ds_read_b128 a[120:123], v11 offset:4096
  v_mfma_f32_16x16x32_bf16 v[76:79], a[0:3], a[108:111], v[76:79]
  ds_read_b128 a[124:127], v11 offset:6144
  v_mfma_f32_16x16x32_bf16 v[80:83], a[4:7], a[96:99], v[80:83]
  ds_read_b64_tr_b16 a[48:49], v18 offset:24576
  v_mfma_f32_16x16x32_bf16 v[84:87], a[4:7], a[100:103], v[84:87]
  ds_read_b64_tr_b16 a[50:51], v18 offset:25088
  buffer_load_dwordx4 a[196:199], v2, s[84:87], s88 offen offset:2048 sc1
  v_mfma_f32_16x16x32_bf16 v[88:91], a[4:7], a[104:107], v[88:91]
  ds_read_b64_tr_b16 a[52:53], v18 offset:27648
  v_mfma_f32_16x16x32_bf16 v[92:95], a[4:7], a[108:111], v[92:95]
  ds_read_b64_tr_b16 a[54:55], v18 offset:28160
  v_mfma_f32_16x16x32_bf16 v[96:99], a[8:11], a[96:99], v[96:99]
  ds_read_b64_tr_b16 a[56:57], v19 offset:24576
  v_mfma_f32_16x16x32_bf16 v[100:103], a[8:11], a[100:103], v[100:103]
  ds_read_b64_tr_b16 a[58:59], v19 offset:25088
  v_mfma_f32_16x16x32_bf16 v[104:107], a[8:11], a[104:107], v[104:107]
  ds_read_b64_tr_b16 a[60:61], v19 offset:27648
  buffer_load_dwordx4 a[200:203], v2, s[84:87], s88 offen offset:3072 sc1
  v_mfma_f32_16x16x32_bf16 v[108:111], a[8:11], a[108:111], v[108:111]
  ds_read_b64_tr_b16 a[62:63], v19 offset:28160
  v_mfma_f32_16x16x32_bf16 v[112:115], a[12:15], a[96:99], v[112:115]
  ds_read_b64_tr_b16 a[64:65], v20 offset:24576
  v_mfma_f32_16x16x32_bf16 v[116:119], a[12:15], a[100:103], v[116:119]
  ds_read_b64_tr_b16 a[66:67], v20 offset:25088
  v_mfma_f32_16x16x32_bf16 v[120:123], a[12:15], a[104:107], v[120:123]
  ds_read_b64_tr_b16 a[68:69], v20 offset:27648
  buffer_load_dwordx4 a[204:207], v3, s[84:87], s88 offen sc1
  v_mfma_f32_16x16x32_bf16 v[124:127], a[12:15], a[108:111], v[124:127]
  ds_read_b64_tr_b16 a[70:71], v20 offset:28160
  v_mfma_f32_16x16x32_bf16 v[128:131], a[16:19], a[96:99], v[128:131]
  ds_read_b64_tr_b16 a[72:73], v21 offset:24576
  v_mfma_f32_16x16x32_bf16 v[132:135], a[16:19], a[100:103], v[132:135]
  ds_read_b64_tr_b16 a[74:75], v21 offset:25088
  v_mfma_f32_16x16x32_bf16 v[136:139], a[16:19], a[104:107], v[136:139]
  ds_read_b64_tr_b16 a[76:77], v21 offset:27648
  s_add_u32 s88, s89, 184320
  v_mfma_f32_16x16x32_bf16 v[140:143], a[16:19], a[108:111], v[140:143]
  ds_read_b64_tr_b16 a[78:79], v21 offset:28160
  buffer_load_dwordx4 a[208:211], v2, s[84:87], s88 offen offset:0 sc1
  v_mfma_f32_16x16x32_bf16 v[144:147], a[20:23], a[96:99], v[144:147]
  ds_read_b64_tr_b16 a[80:81], v22 offset:24576
  v_mfma_f32_16x16x32_bf16 v[148:151], a[20:23], a[100:103], v[148:151]
  ds_read_b64_tr_b16 a[82:83], v22 offset:25088
  v_mfma_f32_16x16x32_bf16 v[152:155], a[20:23], a[104:107], v[152:155]
  ds_read_b64_tr_b16 a[84:85], v22 offset:27648
  v_mfma_f32_16x16x32_bf16 v[156:159], a[20:23], a[108:111], v[156:159]
  ds_read_b64_tr_b16 a[86:87], v22 offset:28160
  v_mfma_f32_16x16x32_bf16 v[160:163], a[24:27], a[96:99], v[160:163]
  buffer_load_dwordx4 a[212:215], v2, s[84:87], s88 offen offset:1024 sc1
  v_mfma_f32_16x16x32_bf16 v[164:167], a[24:27], a[100:103], v[164:167]
  v_mfma_f32_16x16x32_bf16 v[168:171], a[24:27], a[104:107], v[168:171]
  v_mfma_f32_16x16x32_bf16 v[172:175], a[24:27], a[108:111], v[172:175]
  v_mfma_f32_16x16x32_bf16 v[176:179], a[28:31], a[96:99], v[176:179]
  buffer_load_dwordx4 a[216:219], v2, s[84:87], s88 offen offset:2048 sc1
  v_mfma_f32_16x16x32_bf16 v[180:183], a[28:31], a[100:103], v[180:183]
  v_mfma_f32_16x16x32_bf16 v[184:187], a[28:31], a[104:107], v[184:187]
  v_mfma_f32_16x16x32_bf16 v[188:191], a[28:31], a[108:111], v[188:191]
  v_mfma_f32_16x16x32_bf16 v[192:195], a[32:35], a[96:99], v[192:195]
  v_mfma_f32_16x16x32_bf16 v[196:199], a[32:35], a[100:103], v[196:199]
  buffer_load_dwordx4 a[220:223], v2, s[84:87], s88 offen offset:3072 sc1
  v_mfma_f32_16x16x32_bf16 v[200:203], a[32:35], a[104:107], v[200:203]
  v_mfma_f32_16x16x32_bf16 v[204:207], a[32:35], a[108:111], v[204:207]
  v_mfma_f32_16x16x32_bf16 v[208:211], a[36:39], a[96:99], v[208:211]
  v_mfma_f32_16x16x32_bf16 v[212:215], a[36:39], a[100:103], v[212:215]
  v_mfma_f32_16x16x32_bf16 v[216:219], a[36:39], a[104:107], v[216:219]
  v_mfma_f32_16x16x32_bf16 v[220:223], a[36:39], a[108:111], v[220:223]
  s_waitcnt lgkmcnt(0)
  s_barrier
  v_mfma_f32_16x16x32_bf16 v[64:67], a[48:51], a[112:115], v[64:67]
  ds_read_b64_tr_b16 a[0:1], v23 offset:32768
  v_mfma_f32_16x16x32_bf16 v[68:71], a[48:51], a[116:119], v[68:71]
  ds_read_b64_tr_b16 a[2:3], v23 offset:32928
  buffer_load_dwordx4 a[224:227], v3, s[84:87], s88 offen sc1
  v_mfma_f32_16x16x32_bf16 v[72:75], a[48:51], a[120:123], v[72:75]
  ds_read_b64_tr_b16 a[4:5], v23 offset:32776
  v_mfma_f32_16x16x32_bf16 v[76:79], a[48:51], a[124:127], v[76:79]
  ds_read_b64_tr_b16 a[6:7], v23 offset:32936
  v_mfma_f32_16x16x32_bf16 v[80:83], a[52:55], a[112:115], v[80:83]
  ds_read_b64_tr_b16 a[8:9], v23 offset:32784
  s_add_u32 s88, s89, 204800
  v_mfma_f32_16x16x32_bf16 v[84:87], a[52:55], a[116:119], v[84:87]
  ds_read_b64_tr_b16 a[10:11], v23 offset:32944
  buffer_load_dwordx4 a[228:231], v2, s[84:87], s88 offen offset:0 sc1
  v_mfma_f32_16x16x32_bf16 v[88:91], a[52:55], a[120:123], v[88:91]
  ds_read_b64_tr_b16 a[12:13], v23 offset:32792
  v_mfma_f32_16x16x32_bf16 v[92:95], a[52:55], a[124:127], v[92:95]
  ds_read_b64_tr_b16 a[14:15], v23 offset:32952
  v_mfma_f32_16x16x32_bf16 v[96:99], a[56:59], a[112:115], v[96:99]
  ds_read_b64_tr_b16 a[16:17], v23 offset:32800
  v_mfma_f32_16x16x32_bf16 v[100:103], a[56:59], a[116:119], v[100:103]
  ds_read_b64_tr_b16 a[18:19], v23 offset:32960
  v_mfma_f32_16x16x32_bf16 v[104:107], a[56:59], a[120:123], v[104:107]
  ds_read_b64_tr_b16 a[20:21], v23 offset:33088
  buffer_load_dwordx4 a[232:235], v2, s[84:87], s88 offen offset:1024 sc1
  v_mfma_f32_16x16x32_bf16 v[108:111], a[56:59], a[124:127], v[108:111]
  ds_read_b64_tr_b16 a[22:23], v23 offset:33248
  v_mfma_f32_16x16x32_bf16 v[112:115], a[60:63], a[112:115], v[112:115]
  ds_read_b64_tr_b16 a[24:25], v23 offset:33096
  v_mfma_f32_16x16x32_bf16 v[116:119], a[60:63], a[116:119], v[116:119]
  ds_read_b64_tr_b16 a[26:27], v23 offset:33256
  v_mfma_f32_16x16x32_bf16 v[120:123], a[60:63], a[120:123], v[120:123]
  ds_read_b64_tr_b16 a[28:29], v23 offset:33104
  buffer_load_dwordx4 a[236:239], v2, s[84:87], s88 offen offset:2048 sc1
  v_mfma_f32_16x16x32_bf16 v[124:127], a[60:63], a[124:127], v[124:127]
  ds_read_b64_tr_b16 a[30:31], v23 offset:33264
  v_mfma_f32_16x16x32_bf16 v[128:131], a[64:67], a[112:115], v[128:131]
  ds_read_b64_tr_b16 a[32:33], v23 offset:33112
  v_mfma_f32_16x16x32_bf16 v[132:135], a[64:67], a[116:119], v[132:135]
  ds_read_b64_tr_b16 a[34:35], v23 offset:33272
  v_mfma_f32_16x16x32_bf16 v[136:139], a[64:67], a[120:123], v[136:139]
  ds_read_b64_tr_b16 a[36:37], v23 offset:33120
  v_mfma_f32_16x16x32_bf16 v[140:143], a[64:67], a[124:127], v[140:143]
  ds_read_b64_tr_b16 a[38:39], v23 offset:33280
  buffer_load_dwordx4 a[240:243], v2, s[84:87], s88 offen offset:3072 sc1
  v_mfma_f32_16x16x32_bf16 v[144:147], a[68:71], a[112:115], v[144:147]
  ds_read_b64_tr_b16 a[40:41], v23 offset:33408
  v_mfma_f32_16x16x32_bf16 v[148:151], a[68:71], a[116:119], v[148:151]
  ds_read_b64_tr_b16 a[42:43], v26 offset:32768
  v_mfma_f32_16x16x32_bf16 v[152:155], a[68:71], a[120:123], v[152:155]
  ds_read_b64_tr_b16 a[44:45], v23 offset:33416
  v_mfma_f32_16x16x32_bf16 v[156:159], a[68:71], a[124:127], v[156:159]
  ds_read_b64_tr_b16 a[46:47], v26 offset:32768
  v_mfma_f32_16x16x32_bf16 v[160:163], a[72:75], a[112:115], v[160:163]
  ds_read_b64_tr_b16 a[96:97], v23 offset:33424
  buffer_load_dwordx4 a[244:247], v3, s[84:87], s88 offen sc1
  v_mfma_f32_16x16x32_bf16 v[164:167], a[72:75], a[116:119], v[164:167]
  ds_read_b64_tr_b16 a[98:99], v26 offset:32768
  v_mfma_f32_16x16x32_bf16 v[168:171], a[72:75], a[120:123], v[168:171]
  ds_read_b64_tr_b16 a[100:101], v23 offset:33432
  v_mfma_f32_16x16x32_bf16 v[172:175], a[72:75], a[124:127], v[172:175]
  ds_read_b64_tr_b16 a[102:103], v26 offset:32768
  s_add_u32 s88, s89, 225280
  v_mfma_f32_16x16x32_bf16 v[176:179], a[76:79], a[112:115], v[176:179]
  ds_read_b64_tr_b16 a[104:105], v23 offset:33440
  buffer_load_dwordx4 a[248:251], v2, s[84:87], s88 offen offset:0 sc1
  v_mfma_f32_16x16x32_bf16 v[180:183], a[76:79], a[116:119], v[180:183]
  ds_read_b64_tr_b16 a[106:107], v26 offset:32768
  v_mfma_f32_16x16x32_bf16 v[184:187], a[76:79], a[120:123], v[184:187]
  v_mfma_f32_16x16x32_bf16 v[188:191], a[76:79], a[124:127], v[188:191]
  v_mfma_f32_16x16x32_bf16 v[192:195], a[80:83], a[112:115], v[192:195]
  v_mfma_f32_16x16x32_bf16 v[196:199], a[80:83], a[116:119], v[196:199]
  buffer_load_dwordx4 a[252:255], v2, s[84:87], s88 offen offset:1024 sc1
  v_mfma_f32_16x16x32_bf16 v[200:203], a[80:83], a[120:123], v[200:203]
  v_mfma_f32_16x16x32_bf16 v[204:207], a[80:83], a[124:127], v[204:207]
  v_mfma_f32_16x16x32_bf16 v[208:211], a[84:87], a[112:115], v[208:211]
  v_mfma_f32_16x16x32_bf16 v[212:215], a[84:87], a[116:119], v[212:215]
  v_mfma_f32_16x16x32_bf16 v[216:219], a[84:87], a[120:123], v[216:219]
  v_mfma_f32_16x16x32_bf16 v[220:223], a[84:87], a[124:127], v[220:223]
  v_cvt_pk_bf16_f32 v32, v64, v65
  v_cvt_pk_bf16_f32 v33, v66, v67
  v_cvt_pk_bf16_f32 v34, v96, v97
  v_cvt_pk_bf16_f32 v35, v98, v99
  v_cvt_pk_bf16_f32 v36, v128, v129
  v_cvt_pk_bf16_f32 v37, v130, v131
  v_cvt_pk_bf16_f32 v38, v160, v161
  v_cvt_pk_bf16_f32 v39, v162, v163
  v_cvt_pk_bf16_f32 v40, v192, v193
  v_cvt_pk_bf16_f32 v41, v194, v195
  s_waitcnt lgkmcnt(0)
  s_nop 0
  v_mfma_f32_16x16x32_bf16 v[64:67], a[0:3], v[32:35], 0
  v_cvt_pk_bf16_f32 v44, v68, v69
  v_cvt_pk_bf16_f32 v45, v70, v71
  v_mfma_f32_16x16x32_bf16 v[96:99], a[4:7], v[32:35], 0
  v_cvt_pk_bf16_f32 v46, v100, v101
  v_cvt_pk_bf16_f32 v47, v102, v103
  v_mfma_f32_16x16x32_bf16 v[128:131], a[8:11], v[32:35], 0
  v_cvt_pk_bf16_f32 v48, v132, v133
  v_cvt_pk_bf16_f32 v49, v134, v135
  v_mfma_f32_16x16x32_bf16 v[160:163], a[12:15], v[32:35], 0
  v_cvt_pk_bf16_f32 v50, v164, v165
  v_cvt_pk_bf16_f32 v51, v166, v167
  v_mfma_f32_16x16x32_bf16 v[192:195], a[16:19], v[32:35], 0
  v_cvt_pk_bf16_f32 v52, v196, v197
  v_cvt_pk_bf16_f32 v53, v198, v199
  v_mfma_f32_16x16x32_bf16 v[64:67], a[20:23], v[36:39], v[64:67]
  v_mfma_f32_16x16x32_bf16 v[96:99], a[24:27], v[36:39], v[96:99]
  v_mfma_f32_16x16x32_bf16 v[128:131], a[28:31], v[36:39], v[128:131]
  v_mfma_f32_16x16x32_bf16 v[160:163], a[32:35], v[36:39], v[160:163]
  v_mfma_f32_16x16x32_bf16 v[192:195], a[36:39], v[36:39], v[192:195]
  v_mfma_f32_16x16x32_bf16 v[64:67], a[40:43], v[40:43], v[64:67]
  v_mfma_f32_16x16x32_bf16 v[96:99], a[44:47], v[40:43], v[96:99]
  v_mfma_f32_16x16x32_bf16 v[128:131], a[96:99], v[40:43], v[128:131]
  v_mfma_f32_16x16x32_bf16 v[160:163], a[100:103], v[40:43], v[160:163]
  v_mfma_f32_16x16x32_bf16 v[192:195], a[104:107], v[40:43], v[192:195]
  v_cvt_pk_bf16_f32 v80, v80, v81
  v_cvt_pk_bf16_f32 v81, v82, v83
  v_cvt_pk_bf16_f32 v82, v112, v113
  v_cvt_pk_bf16_f32 v83, v114, v115
  v_cvt_pk_bf16_f32 v112, v144, v145
  v_cvt_pk_bf16_f32 v113, v146, v147
  v_cvt_pk_bf16_f32 v114, v176, v177
  v_cvt_pk_bf16_f32 v115, v178, v179
  v_cvt_pk_bf16_f32 v144, v208, v209
  v_cvt_pk_bf16_f32 v145, v210, v211
  v_mov_b32 v146, 0x3f80
  v_mov_b32_e64 v147, 0
  v_cvt_pk_bf16_f32 v84, v84, v85
  v_cvt_pk_bf16_f32 v85, v86, v87
  v_cvt_pk_bf16_f32 v86, v116, v117
  v_cvt_pk_bf16_f32 v87, v118, v119
  v_cvt_pk_bf16_f32 v116, v148, v149
  v_cvt_pk_bf16_f32 v117, v150, v151
  v_cvt_pk_bf16_f32 v118, v180, v181
  v_cvt_pk_bf16_f32 v119, v182, v183
  v_cvt_pk_bf16_f32 v148, v212, v213
  v_cvt_pk_bf16_f32 v149, v214, v215
  v_mov_b32 v150, 0x3f80
  v_mov_b32_e64 v151, 0
  v_max3_f32 v244, v64, v65, v66
  v_min3_f32 v246, v64, v65, v66
  v_max3_f32 v245, v67, v96, v97
  v_min3_f32 v247, v67, v96, v97
  v_max3_f32 v244, v244, v98, v99
  v_min3_f32 v246, v246, v98, v99
  v_max3_f32 v245, v245, v128, v129
  v_min3_f32 v247, v247, v128, v129
  v_max3_f32 v244, v244, v130, v131
  v_min3_f32 v246, v246, v130, v131
  v_max3_f32 v245, v245, v160, v161
  v_min3_f32 v247, v247, v160, v161
  v_max3_f32 v244, v244, v162, v163
  v_min3_f32 v246, v246, v162, v163
  v_max3_f32 v245, v245, v192, v193
  v_min3_f32 v247, v247, v192, v193
  v_max3_f32 v244, v244, v194, v195
  v_min3_f32 v246, v246, v194, v195
  v_max_f32 v244, v244, v245
  v_min_f32 v246, v246, v247
  v_mul_f32 v244, 0xbfb8aa3b, v244
  v_mul_f32 v246, 0x3fb8aa3b, v246
  v_pk_fma_f32 v[6:7], v[64:65], s[70:71], v[244:245] op_sel_hi:[1,1,0]
  v_pk_fma_f32 v[8:9], v[66:67], s[70:71], v[244:245] op_sel_hi:[1,1,0]
  v_pk_fma_f32 v[10:11], v[96:97], s[70:71], v[244:245] op_sel_hi:[1,1,0]
  v_pk_fma_f32 v[12:13], v[98:99], s[70:71], v[244:245] op_sel_hi:[1,1,0]
  v_pk_fma_f32 v[14:15], v[128:129], s[70:71], v[244:245] op_sel_hi:[1,1,0]
  v_pk_fma_f32 v[16:17], v[130:131], s[70:71], v[244:245] op_sel_hi:[1,1,0]
  v_pk_fma_f32 v[18:19], v[160:161], s[70:71], v[244:245] op_sel_hi:[1,1,0]
  v_pk_fma_f32 v[20:21], v[162:163], s[70:71], v[244:245] op_sel_hi:[1,1,0]
  v_pk_fma_f32 v[22:23], v[192:193], s[70:71], v[244:245] op_sel_hi:[1,1,0]
  v_pk_fma_f32 v[24:25], v[194:195], s[70:71], v[244:245] op_sel_hi:[1,1,0]
  v_pk_fma_f32 v[64:65], v[64:65], s[70:71], v[246:247] op_sel_hi:[1,1,0] neg_lo:[0,1,0] neg_hi:[0,1,0]
  v_pk_fma_f32 v[66:67], v[66:67], s[70:71], v[246:247] op_sel_hi:[1,1,0] neg_lo:[0,1,0] neg_hi:[0,1,0]
  v_pk_fma_f32 v[96:97], v[96:97], s[70:71], v[246:247] op_sel_hi:[1,1,0] neg_lo:[0,1,0] neg_hi:[0,1,0]
  v_pk_fma_f32 v[98:99], v[98:99], s[70:71], v[246:247] op_sel_hi:[1,1,0] neg_lo:[0,1,0] neg_hi:[0,1,0]
  v_pk_fma_f32 v[128:129], v[128:129], s[70:71], v[246:247] op_sel_hi:[1,1,0] neg_lo:[0,1,0] neg_hi:[0,1,0]
  v_pk_fma_f32 v[130:131], v[130:131], s[70:71], v[246:247] op_sel_hi:[1,1,0] neg_lo:[0,1,0] neg_hi:[0,1,0]
  v_pk_fma_f32 v[160:161], v[160:161], s[70:71], v[246:247] op_sel_hi:[1,1,0] neg_lo:[0,1,0] neg_hi:[0,1,0]
  v_pk_fma_f32 v[162:163], v[162:163], s[70:71], v[246:247] op_sel_hi:[1,1,0] neg_lo:[0,1,0] neg_hi:[0,1,0]
  v_pk_fma_f32 v[192:193], v[192:193], s[70:71], v[246:247] op_sel_hi:[1,1,0] neg_lo:[0,1,0] neg_hi:[0,1,0]
  v_pk_fma_f32 v[194:195], v[194:195], s[70:71], v[246:247] op_sel_hi:[1,1,0] neg_lo:[0,1,0] neg_hi:[0,1,0]
  v_mfma_f32_16x16x32_bf16 v[68:71], a[0:3], v[44:47], 0
  ds_write_b128 v28, v[80:83] offset:0
  v_exp_f32 v6, v6
  v_exp_f32 v7, v7
  v_mfma_f32_16x16x32_bf16 v[100:103], a[4:7], v[44:47], 0
  ds_write_b128 v28, v[112:115] offset:16
  v_exp_f32 v8, v8
  v_exp_f32 v9, v9
  v_mfma_f32_16x16x32_bf16 v[132:135], a[8:11], v[44:47], 0
  ds_write_b128 v28, v[144:147] offset:32
  v_exp_f32 v10, v10
  v_exp_f32 v11, v11
  v_mfma_f32_16x16x32_bf16 v[164:167], a[12:15], v[44:47], 0
  ds_write_b128 v28, v[84:87] offset:3584
  v_exp_f32 v12, v12
  v_exp_f32 v13, v13
  v_mfma_f32_16x16x32_bf16 v[196:199], a[16:19], v[44:47], 0
  ds_write_b128 v28, v[116:119] offset:3600
  v_exp_f32 v14, v14
  v_exp_f32 v15, v15
  v_mfma_f32_16x16x32_bf16 v[68:71], a[20:23], v[48:51], v[68:71]
  ds_write_b128 v28, v[148:151] offset:3616
  v_exp_f32 v16, v16
  v_exp_f32 v17, v17
  v_mfma_f32_16x16x32_bf16 v[100:103], a[24:27], v[48:51], v[100:103]
  v_exp_f32 v18, v18
  v_exp_f32 v19, v19
  v_mfma_f32_16x16x32_bf16 v[132:135], a[28:31], v[48:51], v[132:135]
  v_exp_f32 v20, v20
  v_exp_f32 v21, v21
  v_mfma_f32_16x16x32_bf16 v[164:167], a[32:35], v[48:51], v[164:167]
  v_exp_f32 v22, v22
  v_exp_f32 v23, v23
  v_mfma_f32_16x16x32_bf16 v[196:199], a[36:39], v[48:51], v[196:199]
  v_exp_f32 v24, v24
  v_exp_f32 v25, v25
  v_mfma_f32_16x16x32_bf16 v[68:71], a[40:43], v[52:55], v[68:71]
  v_exp_f32 v64, v64
  v_exp_f32 v65, v65
  v_mfma_f32_16x16x32_bf16 v[100:103], a[44:47], v[52:55], v[100:103]
  v_exp_f32 v66, v66
  v_exp_f32 v67, v67
  v_mfma_f32_16x16x32_bf16 v[132:135], a[96:99], v[52:55], v[132:135]
  v_exp_f32 v96, v96
  v_exp_f32 v97, v97
  v_mfma_f32_16x16x32_bf16 v[164:167], a[100:103], v[52:55], v[164:167]
  v_exp_f32 v98, v98
  v_exp_f32 v99, v99
  v_mfma_f32_16x16x32_bf16 v[196:199], a[104:107], v[52:55], v[196:199]
  v_exp_f32 v128, v128
  v_exp_f32 v129, v129
  v_exp_f32 v130, v130
  v_exp_f32 v131, v131
  v_exp_f32 v160, v160
  v_exp_f32 v161, v161
  v_exp_f32 v162, v162
  v_exp_f32 v163, v163
  v_exp_f32 v192, v192
  v_exp_f32 v193, v193
  v_exp_f32 v194, v194
  v_exp_f32 v195, v195
  v_pk_add_f32 v[248:249], v[6:7], v[8:9]
  v_pk_add_f32 v[244:245], v[10:11], v[12:13]
  v_pk_add_f32 v[250:251], v[64:65], v[66:67]
  v_pk_add_f32 v[246:247], v[96:97], v[98:99]
  v_pk_add_f32 v[248:249], v[248:249], v[14:15]
  v_pk_add_f32 v[244:245], v[244:245], v[16:17]
  v_pk_add_f32 v[250:251], v[250:251], v[128:129]
  v_pk_add_f32 v[246:247], v[246:247], v[130:131]
  v_pk_add_f32 v[248:249], v[248:249], v[18:19]
  v_pk_add_f32 v[244:245], v[244:245], v[20:21]
  v_pk_add_f32 v[250:251], v[250:251], v[160:161]
  v_pk_add_f32 v[246:247], v[246:247], v[162:163]
  v_pk_add_f32 v[248:249], v[248:249], v[22:23]
  v_pk_add_f32 v[244:245], v[244:245], v[24:25]
  v_pk_add_f32 v[250:251], v[250:251], v[192:193]
  v_pk_add_f32 v[246:247], v[246:247], v[194:195]
  v_pk_add_f32 v[248:249], v[248:249], v[244:245]
  v_pk_add_f32 v[250:251], v[250:251], v[246:247]
  v_add_f32 v248, v248, v249
  v_add_f32 v250, v250, v251
  v_rcp_f32 v248, v248
  v_rcp_f32 v250, v250
  v_pk_mul_f32 v[6:7], v[6:7], v[248:249] op_sel_hi:[1,0]
  v_pk_mul_f32 v[8:9], v[8:9], v[248:249] op_sel_hi:[1,0]
  v_pk_mul_f32 v[10:11], v[10:11], v[248:249] op_sel_hi:[1,0]
  v_pk_mul_f32 v[12:13], v[12:13], v[248:249] op_sel_hi:[1,0]
  v_pk_mul_f32 v[14:15], v[14:15], v[248:249] op_sel_hi:[1,0]
  v_pk_mul_f32 v[16:17], v[16:17], v[248:249] op_sel_hi:[1,0]
  v_pk_mul_f32 v[18:19], v[18:19], v[248:249] op_sel_hi:[1,0]
  v_pk_mul_f32 v[20:21], v[20:21], v[248:249] op_sel_hi:[1,0]
  v_pk_mul_f32 v[22:23], v[22:23], v[248:249] op_sel_hi:[1,0]
  v_pk_mul_f32 v[24:25], v[24:25], v[248:249] op_sel_hi:[1,0]
  v_pk_mul_f32 v[64:65], v[64:65], v[250:251] op_sel_hi:[1,0]
  v_pk_mul_f32 v[66:67], v[66:67], v[250:251] op_sel_hi:[1,0]
  v_pk_mul_f32 v[96:97], v[96:97], v[250:251] op_sel_hi:[1,0]
  v_pk_mul_f32 v[98:99], v[98:99], v[250:251] op_sel_hi:[1,0]
  v_pk_mul_f32 v[128:129], v[128:129], v[250:251] op_sel_hi:[1,0]
  v_pk_mul_f32 v[130:131], v[130:131], v[250:251] op_sel_hi:[1,0]
  v_pk_mul_f32 v[160:161], v[160:161], v[250:251] op_sel_hi:[1,0]
  v_pk_mul_f32 v[162:163], v[162:163], v[250:251] op_sel_hi:[1,0]
  v_pk_mul_f32 v[192:193], v[192:193], v[250:251] op_sel_hi:[1,0]
  v_pk_mul_f32 v[194:195], v[194:195], v[250:251] op_sel_hi:[1,0]
  v_cvt_pk_bf16_f32 v224, v6, v7
  v_cvt_pk_bf16_f32 v225, v8, v9
  v_cvt_pk_bf16_f32 v226, v10, v11
  v_cvt_pk_bf16_f32 v227, v12, v13
  v_cvt_pk_bf16_f32 v228, v14, v15
  v_cvt_pk_bf16_f32 v229, v16, v17
  v_cvt_pk_bf16_f32 v230, v18, v19
  v_cvt_pk_bf16_f32 v231, v20, v21
  v_cvt_pk_bf16_f32 v232, v22, v23
  v_cvt_pk_bf16_f32 v233, v24, v25
  v_cvt_pk_bf16_f32 v234, v64, v65
  v_cvt_pk_bf16_f32 v235, v66, v67
  v_cvt_pk_bf16_f32 v236, v96, v97
  v_cvt_pk_bf16_f32 v237, v98, v99
  v_cvt_pk_bf16_f32 v238, v128, v129
  v_cvt_pk_bf16_f32 v239, v130, v131
  v_cvt_pk_bf16_f32 v240, v160, v161
  v_cvt_pk_bf16_f32 v241, v162, v163
  v_cvt_pk_bf16_f32 v242, v192, v193
  v_cvt_pk_bf16_f32 v243, v194, v195
  ds_write_b128 v27, v[224:227] offset:0
  ds_write_b128 v27, v[228:231] offset:16
  ds_write_b128 v27, v[232:235] offset:32
  ds_write_b128 v27, v[236:239] offset:48
  ds_write_b128 v27, v[240:243] offset:64
  v_cvt_pk_bf16_f32 v32, v72, v73
  v_cvt_pk_bf16_f32 v33, v74, v75
  v_cvt_pk_bf16_f32 v34, v104, v105
  v_cvt_pk_bf16_f32 v35, v106, v107
  v_cvt_pk_bf16_f32 v36, v136, v137
  v_cvt_pk_bf16_f32 v37, v138, v139
  v_cvt_pk_bf16_f32 v38, v168, v169
  v_cvt_pk_bf16_f32 v39, v170, v171
  v_cvt_pk_bf16_f32 v40, v200, v201
  v_cvt_pk_bf16_f32 v41, v202, v203
  v_cvt_pk_bf16_f32 v88, v88, v89
  v_cvt_pk_bf16_f32 v89, v90, v91
  v_cvt_pk_bf16_f32 v90, v120, v121
  v_cvt_pk_bf16_f32 v91, v122, v123
  v_cvt_pk_bf16_f32 v120, v152, v153
  v_cvt_pk_bf16_f32 v121, v154, v155
  v_cvt_pk_bf16_f32 v122, v184, v185
  v_cvt_pk_bf16_f32 v123, v186, v187
  v_cvt_pk_bf16_f32 v152, v216, v217
  v_cvt_pk_bf16_f32 v153, v218, v219
  v_mov_b32 v154, 0x3f80
  v_mov_b32_e64 v155, 0
  v_cvt_pk_bf16_f32 v92, v92, v93
  v_cvt_pk_bf16_f32 v93, v94, v95
  v_cvt_pk_bf16_f32 v94, v124, v125
  v_cvt_pk_bf16_f32 v95, v126, v127
  v_cvt_pk_bf16_f32 v124, v156, v157
  v_cvt_pk_bf16_f32 v125, v158, v159
  v_cvt_pk_bf16_f32 v126, v188, v189
  v_cvt_pk_bf16_f32 v127, v190, v191
  v_cvt_pk_bf16_f32 v156, v220, v221
  v_cvt_pk_bf16_f32 v157, v222, v223
  v_mov_b32 v158, 0x3f80
  v_mov_b32_e64 v159, 0
  v_max3_f32 v244, v68, v69, v70
  v_min3_f32 v246, v68, v69, v70
  v_max3_f32 v245, v71, v100, v101
  v_min3_f32 v247, v71, v100, v101
  v_max3_f32 v244, v244, v102, v103
  v_min3_f32 v246, v246, v102, v103
  v_max3_f32 v245, v245, v132, v133
  v_min3_f32 v247, v247, v132, v133
  v_max3_f32 v244, v244, v134, v135
  v_min3_f32 v246, v246, v134, v135
  v_max3_f32 v245, v245, v164, v165
  v_min3_f32 v247, v247, v164, v165
  v_max3_f32 v244, v244, v166, v167
  v_min3_f32 v246, v246, v166, v167
  v_max3_f32 v245, v245, v196, v197
  v_min3_f32 v247, v247, v196, v197
  v_max3_f32 v244, v244, v198, v199
  v_min3_f32 v246, v246, v198, v199
  s_add_u32 s88, s89, 225280
  buffer_load_dwordx4 a[48:51], v2, s[84:87], s88 offen offset:2048 sc1
  v_max_f32 v244, v244, v245
  v_min_f32 v246, v246, v247
  v_mul_f32 v244, 0xbfb8aa3b, v244
  v_mul_f32 v246, 0x3fb8aa3b, v246
  v_pk_fma_f32 v[6:7], v[68:69], s[70:71], v[244:245] op_sel_hi:[1,1,0]
  v_pk_fma_f32 v[8:9], v[70:71], s[70:71], v[244:245] op_sel_hi:[1,1,0]
  v_pk_fma_f32 v[10:11], v[100:101], s[70:71], v[244:245] op_sel_hi:[1,1,0]
  v_pk_fma_f32 v[12:13], v[102:103], s[70:71], v[244:245] op_sel_hi:[1,1,0]
  v_pk_fma_f32 v[14:15], v[132:133], s[70:71], v[244:245] op_sel_hi:[1,1,0]
  v_pk_fma_f32 v[16:17], v[134:135], s[70:71], v[244:245] op_sel_hi:[1,1,0]
  v_pk_fma_f32 v[18:19], v[164:165], s[70:71], v[244:245] op_sel_hi:[1,1,0]
  v_pk_fma_f32 v[20:21], v[166:167], s[70:71], v[244:245] op_sel_hi:[1,1,0]
  v_pk_fma_f32 v[22:23], v[196:197], s[70:71], v[244:245] op_sel_hi:[1,1,0]
  v_pk_fma_f32 v[24:25], v[198:199], s[70:71], v[244:245] op_sel_hi:[1,1,0]
  buffer_load_dwordx4 a[52:55], v2, s[84:87], s88 offen offset:3072 sc1
  v_pk_fma_f32 v[68:69], v[68:69], s[70:71], v[246:247] op_sel_hi:[1,1,0] neg_lo:[0,1,0] neg_hi:[0,1,0]
  v_pk_fma_f32 v[70:71], v[70:71], s[70:71], v[246:247] op_sel_hi:[1,1,0] neg_lo:[0,1,0] neg_hi:[0,1,0]
  v_pk_fma_f32 v[100:101], v[100:101], s[70:71], v[246:247] op_sel_hi:[1,1,0] neg_lo:[0,1,0] neg_hi:[0,1,0]
  v_pk_fma_f32 v[102:103], v[102:103], s[70:71], v[246:247] op_sel_hi:[1,1,0] neg_lo:[0,1,0] neg_hi:[0,1,0]
  v_pk_fma_f32 v[132:133], v[132:133], s[70:71], v[246:247] op_sel_hi:[1,1,0] neg_lo:[0,1,0] neg_hi:[0,1,0]
  v_pk_fma_f32 v[134:135], v[134:135], s[70:71], v[246:247] op_sel_hi:[1,1,0] neg_lo:[0,1,0] neg_hi:[0,1,0]
  v_pk_fma_f32 v[164:165], v[164:165], s[70:71], v[246:247] op_sel_hi:[1,1,0] neg_lo:[0,1,0] neg_hi:[0,1,0]
  v_pk_fma_f32 v[166:167], v[166:167], s[70:71], v[246:247] op_sel_hi:[1,1,0] neg_lo:[0,1,0] neg_hi:[0,1,0]
  v_pk_fma_f32 v[196:197], v[196:197], s[70:71], v[246:247] op_sel_hi:[1,1,0] neg_lo:[0,1,0] neg_hi:[0,1,0]
  v_pk_fma_f32 v[198:199], v[198:199], s[70:71], v[246:247] op_sel_hi:[1,1,0] neg_lo:[0,1,0] neg_hi:[0,1,0]
  v_mfma_f32_16x16x32_bf16 v[72:75], a[0:3], v[32:35], 0
  ds_write_b128 v28, v[88:91] offset:7168
  v_exp_f32 v6, v6
  v_exp_f32 v7, v7
  v_mfma_f32_16x16x32_bf16 v[104:107], a[4:7], v[32:35], 0
  ds_write_b128 v28, v[120:123] offset:7184
  v_exp_f32 v8, v8
  v_exp_f32 v9, v9
  v_mfma_f32_16x16x32_bf16 v[136:139], a[8:11], v[32:35], 0
  ds_write_b128 v28, v[152:155] offset:7200
  v_exp_f32 v10, v10
  buffer_load_dwordx4 a[56:59], v3, s[84:87], s88 offen sc1
  v_exp_f32 v11, v11
  v_mfma_f32_16x16x32_bf16 v[168:171], a[12:15], v[32:35], 0
  ds_write_b128 v28, v[92:95] offset:10752
  v_exp_f32 v12, v12
  v_exp_f32 v13, v13
  v_mfma_f32_16x16x32_bf16 v[200:203], a[16:19], v[32:35], 0
  ds_write_b128 v28, v[124:127] offset:10768
  v_exp_f32 v14, v14
  v_exp_f32 v15, v15
  v_mfma_f32_16x16x32_bf16 v[72:75], a[20:23], v[36:39], v[72:75]
  ds_write_b128 v28, v[156:159] offset:10784
  v_exp_f32 v16, v16
  v_exp_f32 v17, v17
  v_mfma_f32_16x16x32_bf16 v[104:107], a[24:27], v[36:39], v[104:107]
  v_exp_f32 v18, v18
  v_exp_f32 v19, v19
  v_mfma_f32_16x16x32_bf16 v[136:139], a[28:31], v[36:39], v[136:139]
  v_exp_f32 v20, v20
  v_exp_f32 v21, v21
  v_mfma_f32_16x16x32_bf16 v[168:171], a[32:35], v[36:39], v[168:171]
  v_exp_f32_e64 v22, v22
  s_add_u32 s88, s89, 245760
  buffer_load_dwordx4 a[60:63], v2, s[84:87], s88 offen offset:0 sc1
  v_exp_f32 v23, v23
  v_mfma_f32_16x16x32_bf16 v[200:203], a[36:39], v[36:39], v[200:203]
  v_exp_f32 v24, v24
  v_exp_f32 v25, v25
  v_mfma_f32_16x16x32_bf16 v[72:75], a[40:43], v[40:43], v[72:75]
  v_exp_f32 v68, v68
  v_exp_f32 v69, v69
  v_mfma_f32_16x16x32_bf16 v[104:107], a[44:47], v[40:43], v[104:107]
  v_exp_f32 v70, v70
  v_exp_f32 v71, v71
  v_mfma_f32_16x16x32_bf16 v[136:139], a[96:99], v[40:43], v[136:139]
  v_exp_f32 v100, v100
  v_exp_f32 v101, v101
  v_mfma_f32_16x16x32_bf16 v[168:171], a[100:103], v[40:43], v[168:171]
  v_exp_f32 v102, v102
  v_exp_f32 v103, v103
  v_mfma_f32_16x16x32_bf16 v[200:203], a[104:107], v[40:43], v[200:203]
  v_exp_f32 v132, v132
  buffer_load_dwordx4 a[64:67], v2, s[84:87], s88 offen offset:1024 sc1
  v_exp_f32 v133, v133
  v_exp_f32 v134, v134
  v_exp_f32 v135, v135
  v_exp_f32 v164, v164
  v_exp_f32 v165, v165
  v_exp_f32 v166, v166
  v_exp_f32 v167, v167
  v_exp_f32 v196, v196
  v_exp_f32 v197, v197
  v_exp_f32 v198, v198
  v_exp_f32_e64 v199, v199
  v_pk_add_f32 v[248:249], v[6:7], v[8:9]
  v_pk_add_f32 v[244:245], v[10:11], v[12:13]
  v_pk_add_f32 v[250:251], v[68:69], v[70:71]
  v_pk_add_f32 v[246:247], v[100:101], v[102:103]
  v_pk_add_f32 v[248:249], v[248:249], v[14:15]
  v_pk_add_f32 v[244:245], v[244:245], v[16:17]
  v_pk_add_f32 v[250:251], v[250:251], v[132:133]
  v_pk_add_f32 v[246:247], v[246:247], v[134:135]
  v_pk_add_f32 v[248:249], v[248:249], v[18:19]
  v_pk_add_f32 v[244:245], v[244:245], v[20:21]
  v_pk_add_f32 v[250:251], v[250:251], v[164:165]
  v_pk_add_f32 v[246:247], v[246:247], v[166:167]
  v_pk_add_f32 v[248:249], v[248:249], v[22:23]
  v_pk_add_f32 v[244:245], v[244:245], v[24:25]
  v_pk_add_f32 v[250:251], v[250:251], v[196:197]
  v_pk_add_f32 v[246:247], v[246:247], v[198:199]
  v_pk_add_f32 v[248:249], v[248:249], v[244:245]
  v_pk_add_f32 v[250:251], v[250:251], v[246:247]
  buffer_load_dwordx4 a[68:71], v2, s[84:87], s88 offen offset:2048 sc1
  v_add_f32 v248, v248, v249
  v_add_f32 v250, v250, v251
  v_rcp_f32 v248, v248
  v_rcp_f32 v250, v250
  v_pk_mul_f32 v[6:7], v[6:7], v[248:249] op_sel_hi:[1,0]
  v_pk_mul_f32 v[8:9], v[8:9], v[248:249] op_sel_hi:[1,0]
  v_pk_mul_f32 v[10:11], v[10:11], v[248:249] op_sel_hi:[1,0]
  v_pk_mul_f32 v[12:13], v[12:13], v[248:249] op_sel_hi:[1,0]
  v_pk_mul_f32 v[14:15], v[14:15], v[248:249] op_sel_hi:[1,0]
  v_pk_mul_f32 v[16:17], v[16:17], v[248:249] op_sel_hi:[1,0]
  v_pk_mul_f32 v[18:19], v[18:19], v[248:249] op_sel_hi:[1,0]
  v_pk_mul_f32 v[20:21], v[20:21], v[248:249] op_sel_hi:[1,0]
  v_pk_mul_f32 v[22:23], v[22:23], v[248:249] op_sel_hi:[1,0]
  v_pk_mul_f32 v[24:25], v[24:25], v[248:249] op_sel_hi:[1,0]
  buffer_load_dwordx4 a[72:75], v2, s[84:87], s88 offen offset:3072 sc1
  v_pk_mul_f32 v[68:69], v[68:69], v[250:251] op_sel_hi:[1,0]
  v_pk_mul_f32 v[70:71], v[70:71], v[250:251] op_sel_hi:[1,0]
  v_pk_mul_f32 v[100:101], v[100:101], v[250:251] op_sel_hi:[1,0]
  v_pk_mul_f32 v[102:103], v[102:103], v[250:251] op_sel_hi:[1,0]
  v_pk_mul_f32 v[132:133], v[132:133], v[250:251] op_sel_hi:[1,0]
  v_pk_mul_f32 v[134:135], v[134:135], v[250:251] op_sel_hi:[1,0]
  v_pk_mul_f32 v[164:165], v[164:165], v[250:251] op_sel_hi:[1,0]
  v_pk_mul_f32 v[166:167], v[166:167], v[250:251] op_sel_hi:[1,0]
  v_pk_mul_f32 v[196:197], v[196:197], v[250:251] op_sel_hi:[1,0]
  v_pk_mul_f32 v[198:199], v[198:199], v[250:251] op_sel_hi:[1,0]
  v_cvt_pk_bf16_f32 v224, v6, v7
  v_cvt_pk_bf16_f32 v225, v8, v9
  v_cvt_pk_bf16_f32 v226, v10, v11
  v_cvt_pk_bf16_f32 v227, v12, v13
  v_cvt_pk_bf16_f32 v228, v14, v15
  v_cvt_pk_bf16_f32 v229, v16, v17
  v_cvt_pk_bf16_f32 v230, v18, v19
  v_cvt_pk_bf16_f32 v231, v20, v21
  v_cvt_pk_bf16_f32 v232, v22, v23
  v_cvt_pk_bf16_f32 v233, v24, v25
  buffer_load_dwordx4 a[76:79], v3, s[84:87], s88 offen sc1
  v_cvt_pk_bf16_f32 v234, v68, v69
  v_cvt_pk_bf16_f32 v235, v70, v71
  v_cvt_pk_bf16_f32 v236, v100, v101
  v_cvt_pk_bf16_f32 v237, v102, v103
  v_cvt_pk_bf16_f32 v238, v132, v133
  v_cvt_pk_bf16_f32 v239, v134, v135
  v_cvt_pk_bf16_f32 v240, v164, v165
  v_cvt_pk_bf16_f32 v241, v166, v167
  v_cvt_pk_bf16_f32 v242, v196, v197
  v_cvt_pk_bf16_f32 v243, v198, v199
  ds_write_b128 v27, v[224:227] offset:5632
  ds_write_b128 v27, v[228:231] offset:5648
  ds_write_b128 v27, v[232:235] offset:5664
  ds_write_b128 v27, v[236:239] offset:5680
  ds_write_b128 v27, v[240:243] offset:5696
  v_cvt_pk_bf16_f32 v44, v76, v77
  v_cvt_pk_bf16_f32 v45, v78, v79
  v_cvt_pk_bf16_f32 v46, v108, v109
  v_cvt_pk_bf16_f32 v47, v110, v111
  v_cvt_pk_bf16_f32 v48, v140, v141
  v_cvt_pk_bf16_f32 v49, v142, v143
  v_cvt_pk_bf16_f32 v50, v172, v173
  v_cvt_pk_bf16_f32 v51, v174, v175
  v_cvt_pk_bf16_f32 v52, v204, v205
  v_cvt_pk_bf16_f32 v53, v206, v207
  s_waitcnt lgkmcnt(5)
  s_barrier
  v_max3_f32 v244, v72, v73, v74
  v_min3_f32 v246, v72, v73, v74
  v_max3_f32 v245, v75, v104, v105
  v_min3_f32 v247, v75, v104, v105
  v_max3_f32 v244, v244, v106, v107
  v_min3_f32 v246, v246, v106, v107
  v_max3_f32 v245, v245, v136, v137
  v_min3_f32 v247, v247, v136, v137
  v_max3_f32 v244, v244, v138, v139
  v_min3_f32 v246, v246, v138, v139
  v_max3_f32 v245, v245, v168, v169
  v_min3_f32 v247, v247, v168, v169
  v_max3_f32 v244, v244, v170, v171
  v_min3_f32 v246, v246, v170, v171
  v_max3_f32 v245, v245, v200, v201
  v_min3_f32 v247, v247, v200, v201
  v_max3_f32 v244, v244, v202, v203
  v_min3_f32 v246, v246, v202, v203
  s_add_u32 s88, s89, 266240
  buffer_load_dwordx4 a[80:83], v2, s[84:87], s88 offen offset:0 sc1
  v_max_f32 v244, v244, v245
  v_min_f32 v246, v246, v247
  v_mul_f32 v244, 0xbfb8aa3b, v244
  v_mul_f32 v246, 0x3fb8aa3b, v246
  v_pk_fma_f32 v[6:7], v[72:73], s[70:71], v[244:245] op_sel_hi:[1,1,0]
  v_pk_fma_f32 v[8:9], v[74:75], s[70:71], v[244:245] op_sel_hi:[1,1,0]
  v_pk_fma_f32 v[10:11], v[104:105], s[70:71], v[244:245] op_sel_hi:[1,1,0]
  v_pk_fma_f32 v[12:13], v[106:107], s[70:71], v[244:245] op_sel_hi:[1,1,0]
  v_pk_fma_f32 v[14:15], v[136:137], s[70:71], v[244:245] op_sel_hi:[1,1,0]
  v_pk_fma_f32 v[16:17], v[138:139], s[70:71], v[244:245] op_sel_hi:[1,1,0]
  v_pk_fma_f32 v[18:19], v[168:169], s[70:71], v[244:245] op_sel_hi:[1,1,0]
  v_pk_fma_f32 v[20:21], v[170:171], s[70:71], v[244:245] op_sel_hi:[1,1,0]
  v_pk_fma_f32 v[22:23], v[200:201], s[70:71], v[244:245] op_sel_hi:[1,1,0]
  v_pk_fma_f32 v[24:25], v[202:203], s[70:71], v[244:245] op_sel_hi:[1,1,0]
  buffer_load_dwordx4 a[84:87], v2, s[84:87], s88 offen offset:1024 sc1
  v_pk_fma_f32 v[72:73], v[72:73], s[70:71], v[246:247] op_sel_hi:[1,1,0] neg_lo:[0,1,0] neg_hi:[0,1,0]
  v_pk_fma_f32 v[74:75], v[74:75], s[70:71], v[246:247] op_sel_hi:[1,1,0] neg_lo:[0,1,0] neg_hi:[0,1,0]
  v_pk_fma_f32 v[104:105], v[104:105], s[70:71], v[246:247] op_sel_hi:[1,1,0] neg_lo:[0,1,0] neg_hi:[0,1,0]
  v_pk_fma_f32 v[106:107], v[106:107], s[70:71], v[246:247] op_sel_hi:[1,1,0] neg_lo:[0,1,0] neg_hi:[0,1,0]
  v_pk_fma_f32 v[136:137], v[136:137], s[70:71], v[246:247] op_sel_hi:[1,1,0] neg_lo:[0,1,0] neg_hi:[0,1,0]
  v_pk_fma_f32 v[138:139], v[138:139], s[70:71], v[246:247] op_sel_hi:[1,1,0] neg_lo:[0,1,0] neg_hi:[0,1,0]
  v_pk_fma_f32 v[168:169], v[168:169], s[70:71], v[246:247] op_sel_hi:[1,1,0] neg_lo:[0,1,0] neg_hi:[0,1,0]
  v_pk_fma_f32 v[170:171], v[170:171], s[70:71], v[246:247] op_sel_hi:[1,1,0] neg_lo:[0,1,0] neg_hi:[0,1,0]
  v_pk_fma_f32 v[200:201], v[200:201], s[70:71], v[246:247] op_sel_hi:[1,1,0] neg_lo:[0,1,0] neg_hi:[0,1,0]
  v_pk_fma_f32 v[202:203], v[202:203], s[70:71], v[246:247] op_sel_hi:[1,1,0] neg_lo:[0,1,0] neg_hi:[0,1,0]
  v_mfma_f32_16x16x32_bf16 v[76:79], a[0:3], v[44:47], 0
  ds_read_b64_tr_b16 v[80:81], v30 offset:0
  v_exp_f32 v6, v6
  v_exp_f32 v7, v7
  v_mfma_f32_16x16x32_bf16 v[108:111], a[4:7], v[44:47], 0
  ds_read_b64_tr_b16 v[82:83], v30 offset:3584
  v_exp_f32 v8, v8
  v_exp_f32 v9, v9
  v_mfma_f32_16x16x32_bf16 v[140:143], a[8:11], v[44:47], 0
  ds_read_b64_tr_b16 v[84:85], v30 offset:32
  v_exp_f32 v10, v10
  buffer_load_dwordx4 a[88:91], v2, s[84:87], s88 offen offset:2048 sc1
  v_exp_f32 v11, v11
  v_mfma_f32_16x16x32_bf16 v[172:175], a[12:15], v[44:47], 0
  ds_read_b64_tr_b16 v[86:87], v30 offset:3616
  v_exp_f32 v12, v12
  v_exp_f32 v13, v13
  v_mfma_f32_16x16x32_bf16 v[204:207], a[16:19], v[44:47], 0
  ds_read_b64_tr_b16 v[88:89], v30 offset:7168
  v_exp_f32 v14, v14
  v_exp_f32 v15, v15
  v_mfma_f32_16x16x32_bf16 v[76:79], a[20:23], v[48:51], v[76:79]
  ds_read_b64_tr_b16 v[90:91], v30 offset:10752
  v_exp_f32 v16, v16
  v_exp_f32 v17, v17
  v_mfma_f32_16x16x32_bf16 v[108:111], a[24:27], v[48:51], v[108:111]
  ds_read_b64_tr_b16 v[92:93], v30 offset:7200
  v_exp_f32 v18, v18
  v_exp_f32 v19, v19
  v_mfma_f32_16x16x32_bf16 v[140:143], a[28:31], v[48:51], v[140:143]
  ds_read_b64_tr_b16 v[94:95], v30 offset:10784
  v_exp_f32 v20, v20
  v_exp_f32 v21, v21
  v_mfma_f32_16x16x32_bf16 v[172:175], a[32:35], v[48:51], v[172:175]
  ds_read_b64_tr_b16 v[112:113], v30 offset:14336
  v_exp_f32 v22, v22
  buffer_load_dwordx4 a[92:95], v2, s[84:87], s88 offen offset:3072 sc1
  v_exp_f32 v23, v23
  v_mfma_f32_16x16x32_bf16 v[204:207], a[36:39], v[48:51], v[204:207]
  ds_read_b64_tr_b16 v[114:115], v30 offset:17920
  v_exp_f32 v24, v24
  v_exp_f32 v25, v25
  v_mfma_f32_16x16x32_bf16 v[76:79], a[40:43], v[52:55], v[76:79]
  ds_read_b64_tr_b16 v[116:117], v30 offset:14368
  v_exp_f32 v72, v72
  v_exp_f32 v73, v73
  v_mfma_f32_16x16x32_bf16 v[108:111], a[44:47], v[52:55], v[108:111]
  ds_read_b64_tr_b16 v[118:119], v30 offset:17952
  v_exp_f32 v74, v74
  v_exp_f32 v75, v75
  v_mfma_f32_16x16x32_bf16 v[140:143], a[96:99], v[52:55], v[140:143]
  ds_read_b64_tr_b16 v[120:121], v30 offset:21504
  v_exp_f32 v104, v104
  v_exp_f32 v105, v105
  v_mfma_f32_16x16x32_bf16 v[172:175], a[100:103], v[52:55], v[172:175]
  ds_read_b64_tr_b16 v[122:123], v30 offset:25088
  v_exp_f32 v106, v106
  v_exp_f32 v107, v107
  v_mfma_f32_16x16x32_bf16 v[204:207], a[104:107], v[52:55], v[204:207]
  ds_read_b64_tr_b16 v[124:125], v30 offset:21536
  v_exp_f32 v136, v136
  buffer_load_dwordx4 a[108:111], v3, s[84:87], s88 offen sc1
  v_exp_f32 v137, v137
  ds_read_b64_tr_b16 v[126:127], v30 offset:25120
  v_exp_f32 v138, v138
  v_exp_f32 v139, v139
  v_exp_f32 v168, v168
  v_exp_f32 v169, v169
  v_exp_f32 v170, v170
  v_exp_f32 v171, v171
  v_exp_f32 v200, v200
  v_exp_f32 v201, v201
  v_exp_f32 v202, v202
  v_exp_f32 v203, v203
  v_pk_add_f32 v[248:249], v[6:7], v[8:9]
  v_pk_add_f32 v[244:245], v[10:11], v[12:13]
  v_pk_add_f32 v[250:251], v[72:73], v[74:75]
  v_pk_add_f32 v[246:247], v[104:105], v[106:107]
  v_pk_add_f32 v[248:249], v[248:249], v[14:15]
  v_pk_add_f32 v[244:245], v[244:245], v[16:17]
  v_pk_add_f32 v[250:251], v[250:251], v[136:137]
  v_pk_add_f32 v[246:247], v[246:247], v[138:139]
  v_pk_add_f32 v[248:249], v[248:249], v[18:19]
  v_pk_add_f32 v[244:245], v[244:245], v[20:21]
  v_pk_add_f32 v[250:251], v[250:251], v[168:169]
  v_pk_add_f32 v[246:247], v[246:247], v[170:171]
  v_pk_add_f32 v[248:249], v[248:249], v[22:23]
  v_pk_add_f32 v[244:245], v[244:245], v[24:25]
  v_pk_add_f32 v[250:251], v[250:251], v[200:201]
  v_pk_add_f32 v[246:247], v[246:247], v[202:203]
  v_pk_add_f32 v[248:249], v[248:249], v[244:245]
  v_pk_add_f32 v[250:251], v[250:251], v[246:247]
  s_add_u32 s88, s89, 286720
  buffer_load_dwordx4 a[112:115], v2, s[84:87], s88 offen offset:0 sc1
  v_add_f32 v248, v248, v249
  v_add_f32 v250, v250, v251
  v_rcp_f32 v248, v248
  v_rcp_f32 v250, v250
  v_pk_mul_f32 v[6:7], v[6:7], v[248:249] op_sel_hi:[1,0]
  v_pk_mul_f32 v[8:9], v[8:9], v[248:249] op_sel_hi:[1,0]
  v_pk_mul_f32 v[10:11], v[10:11], v[248:249] op_sel_hi:[1,0]
  v_pk_mul_f32 v[12:13], v[12:13], v[248:249] op_sel_hi:[1,0]
  v_pk_mul_f32 v[14:15], v[14:15], v[248:249] op_sel_hi:[1,0]
  v_pk_mul_f32 v[16:17], v[16:17], v[248:249] op_sel_hi:[1,0]
  v_pk_mul_f32 v[18:19], v[18:19], v[248:249] op_sel_hi:[1,0]
  v_pk_mul_f32 v[20:21], v[20:21], v[248:249] op_sel_hi:[1,0]
  v_pk_mul_f32 v[22:23], v[22:23], v[248:249] op_sel_hi:[1,0]
  v_pk_mul_f32 v[24:25], v[24:25], v[248:249] op_sel_hi:[1,0]
  buffer_load_dwordx4 a[116:119], v2, s[84:87], s88 offen offset:1024 sc1
  v_pk_mul_f32 v[72:73], v[72:73], v[250:251] op_sel_hi:[1,0]
  v_pk_mul_f32 v[74:75], v[74:75], v[250:251] op_sel_hi:[1,0]
  v_pk_mul_f32 v[104:105], v[104:105], v[250:251] op_sel_hi:[1,0]
  v_pk_mul_f32 v[106:107], v[106:107], v[250:251] op_sel_hi:[1,0]
  v_pk_mul_f32 v[136:137], v[136:137], v[250:251] op_sel_hi:[1,0]
  v_pk_mul_f32 v[138:139], v[138:139], v[250:251] op_sel_hi:[1,0]
  v_pk_mul_f32 v[168:169], v[168:169], v[250:251] op_sel_hi:[1,0]
  v_pk_mul_f32 v[170:171], v[170:171], v[250:251] op_sel_hi:[1,0]
  v_pk_mul_f32 v[200:201], v[200:201], v[250:251] op_sel_hi:[1,0]
  v_pk_mul_f32 v[202:203], v[202:203], v[250:251] op_sel_hi:[1,0]
  v_cvt_pk_bf16_f32 v224, v6, v7
  v_cvt_pk_bf16_f32 v225, v8, v9
  v_cvt_pk_bf16_f32 v226, v10, v11
  v_cvt_pk_bf16_f32 v227, v12, v13
  v_cvt_pk_bf16_f32 v228, v14, v15
  v_cvt_pk_bf16_f32 v229, v16, v17
  v_cvt_pk_bf16_f32 v230, v18, v19
  v_cvt_pk_bf16_f32 v231, v20, v21
  v_cvt_pk_bf16_f32 v232, v22, v23
  v_cvt_pk_bf16_f32 v233, v24, v25
  v_cvt_pk_bf16_f32 v234, v72, v73
  v_cvt_pk_bf16_f32 v235, v74, v75
  v_cvt_pk_bf16_f32 v236, v104, v105
  v_cvt_pk_bf16_f32 v237, v106, v107
  v_cvt_pk_bf16_f32 v238, v136, v137
  v_cvt_pk_bf16_f32 v239, v138, v139
  v_cvt_pk_bf16_f32 v240, v168, v169
  v_cvt_pk_bf16_f32 v241, v170, v171
  v_cvt_pk_bf16_f32 v242, v200, v201
  v_cvt_pk_bf16_f32 v243, v202, v203
  ds_write_b128 v27, v[224:227] offset:11264
  ds_write_b128 v27, v[228:231] offset:11280
  ds_write_b128 v27, v[232:235] offset:11296
  ds_write_b128 v27, v[236:239] offset:11312
  ds_write_b128 v27, v[240:243] offset:11328
  v_max3_f32 v244, v76, v77, v78
  v_min3_f32 v246, v76, v77, v78
  v_max3_f32 v245, v79, v108, v109
  v_min3_f32 v247, v79, v108, v109
  v_max3_f32 v244, v244, v110, v111
  v_min3_f32 v246, v246, v110, v111
  v_max3_f32 v245, v245, v140, v141
  v_min3_f32 v247, v247, v140, v141
  v_max3_f32 v244, v244, v142, v143
  v_min3_f32 v246, v246, v142, v143
  v_max3_f32 v245, v245, v172, v173
  v_min3_f32 v247, v247, v172, v173
  v_max3_f32 v244, v244, v174, v175
  v_min3_f32 v246, v246, v174, v175
  v_max3_f32 v245, v245, v204, v205
  v_min3_f32 v247, v247, v204, v205
  v_max3_f32 v244, v244, v206, v207
  v_min3_f32 v246, v246, v206, v207
  s_add_u32 s88, s89, 286720
  buffer_load_dwordx4 a[0:3], v2, s[84:87], s88 offen offset:2048 sc1
  v_max_f32 v244, v244, v245
  v_min_f32 v246, v246, v247
  v_mul_f32 v244, 0xbfb8aa3b, v244
  v_mul_f32 v246, 0x3fb8aa3b, v246
  v_pk_fma_f32 v[6:7], v[76:77], s[70:71], v[244:245] op_sel_hi:[1,1,0]
  v_pk_fma_f32 v[8:9], v[78:79], s[70:71], v[244:245] op_sel_hi:[1,1,0]
  v_pk_fma_f32 v[10:11], v[108:109], s[70:71], v[244:245] op_sel_hi:[1,1,0]
  v_pk_fma_f32 v[12:13], v[110:111], s[70:71], v[244:245] op_sel_hi:[1,1,0]
  v_pk_fma_f32 v[14:15], v[140:141], s[70:71], v[244:245] op_sel_hi:[1,1,0]
  v_pk_fma_f32 v[16:17], v[142:143], s[70:71], v[244:245] op_sel_hi:[1,1,0]
  v_pk_fma_f32 v[18:19], v[172:173], s[70:71], v[244:245] op_sel_hi:[1,1,0]
  v_pk_fma_f32 v[20:21], v[174:175], s[70:71], v[244:245] op_sel_hi:[1,1,0]
  v_pk_fma_f32 v[22:23], v[204:205], s[70:71], v[244:245] op_sel_hi:[1,1,0]
  v_pk_fma_f32 v[24:25], v[206:207], s[70:71], v[244:245] op_sel_hi:[1,1,0]
  buffer_load_dwordx4 a[4:7], v2, s[84:87], s88 offen offset:3072 sc1
  v_pk_fma_f32 v[76:77], v[76:77], s[70:71], v[246:247] op_sel_hi:[1,1,0] neg_lo:[0,1,0] neg_hi:[0,1,0]
  v_pk_fma_f32 v[78:79], v[78:79], s[70:71], v[246:247] op_sel_hi:[1,1,0] neg_lo:[0,1,0] neg_hi:[0,1,0]
  v_pk_fma_f32 v[108:109], v[108:109], s[70:71], v[246:247] op_sel_hi:[1,1,0] neg_lo:[0,1,0] neg_hi:[0,1,0]
  v_pk_fma_f32 v[110:111], v[110:111], s[70:71], v[246:247] op_sel_hi:[1,1,0] neg_lo:[0,1,0] neg_hi:[0,1,0]
  v_pk_fma_f32 v[140:141], v[140:141], s[70:71], v[246:247] op_sel_hi:[1,1,0] neg_lo:[0,1,0] neg_hi:[0,1,0]
  v_pk_fma_f32 v[142:143], v[142:143], s[70:71], v[246:247] op_sel_hi:[1,1,0] neg_lo:[0,1,0] neg_hi:[0,1,0]
  v_pk_fma_f32 v[172:173], v[172:173], s[70:71], v[246:247] op_sel_hi:[1,1,0] neg_lo:[0,1,0] neg_hi:[0,1,0]
  v_pk_fma_f32 v[174:175], v[174:175], s[70:71], v[246:247] op_sel_hi:[1,1,0] neg_lo:[0,1,0] neg_hi:[0,1,0]
  v_pk_fma_f32 v[204:205], v[204:205], s[70:71], v[246:247] op_sel_hi:[1,1,0] neg_lo:[0,1,0] neg_hi:[0,1,0]
  v_pk_fma_f32 v[206:207], v[206:207], s[70:71], v[246:247] op_sel_hi:[1,1,0] neg_lo:[0,1,0] neg_hi:[0,1,0]
  ds_read_b64_tr_b16 v[144:145], v30 offset:48
  v_exp_f32 v6, v6
  v_exp_f32 v7, v7
  ds_read_b64_tr_b16 v[146:147], v30 offset:3632
  v_exp_f32 v8, v8
  v_exp_f32 v9, v9
  ds_read_b64_tr_b16 v[148:149], v30 offset:80
  v_exp_f32 v10, v10
  buffer_load_dwordx4 a[8:11], v3, s[84:87], s88 offen sc1
  v_exp_f32 v11, v11
  ds_read_b64_tr_b16 v[150:151], v30 offset:3664
  v_exp_f32 v12, v12
  v_exp_f32 v13, v13
  ds_read_b64_tr_b16 v[152:153], v30 offset:7216
  v_exp_f32 v14, v14
  v_exp_f32 v15, v15
  ds_read_b64_tr_b16 v[154:155], v30 offset:10800
  v_exp_f32 v16, v16
  v_exp_f32 v17, v17
  ds_read_b64_tr_b16 v[156:157], v30 offset:7248
  v_exp_f32 v18, v18
  v_exp_f32 v19, v19
  ds_read_b64_tr_b16 v[158:159], v30 offset:10832
  v_exp_f32 v20, v20
  v_exp_f32 v21, v21
  ds_read_b64_tr_b16 v[176:177], v30 offset:14384
  v_exp_f32_e64 v22, v22
  s_add_u32 s88, s89, 307200
  buffer_load_dwordx4 a[12:15], v2, s[84:87], s88 offen offset:0 sc1
  v_exp_f32 v23, v23
  ds_read_b64_tr_b16 v[178:179], v30 offset:17968
  v_exp_f32 v24, v24
  v_exp_f32 v25, v25
  ds_read_b64_tr_b16 v[180:181], v30 offset:14416
  v_exp_f32 v76, v76
  v_exp_f32 v77, v77
  ds_read_b64_tr_b16 v[182:183], v30 offset:18000
  v_exp_f32 v78, v78
  v_exp_f32 v79, v79
  ds_read_b64_tr_b16 v[184:185], v30 offset:21552
  v_exp_f32 v108, v108
  v_exp_f32 v109, v109
  ds_read_b64_tr_b16 v[186:187], v30 offset:25136
  v_exp_f32 v110, v110
  v_exp_f32 v111, v111
  ds_read_b64_tr_b16 v[188:189], v30 offset:21584
  v_exp_f32 v140, v140
  buffer_load_dwordx4 a[16:19], v2, s[84:87], s88 offen offset:1024 sc1
  v_exp_f32 v141, v141
  ds_read_b64_tr_b16 v[190:191], v30 offset:25168
  v_exp_f32 v142, v142
  v_exp_f32 v143, v143
  v_exp_f32 v172, v172
  v_exp_f32 v173, v173
  v_exp_f32 v174, v174
  v_exp_f32 v175, v175
  v_exp_f32 v204, v204
  v_exp_f32 v205, v205
  v_exp_f32 v206, v206
  v_exp_f32_e64 v207, v207
  v_pk_add_f32 v[248:249], v[6:7], v[8:9]
  v_pk_add_f32 v[244:245], v[10:11], v[12:13]
  v_pk_add_f32 v[250:251], v[76:77], v[78:79]
  v_pk_add_f32 v[246:247], v[108:109], v[110:111]
  v_pk_add_f32 v[248:249], v[248:249], v[14:15]
  v_pk_add_f32 v[244:245], v[244:245], v[16:17]
  v_pk_add_f32 v[250:251], v[250:251], v[140:141]
  v_pk_add_f32 v[246:247], v[246:247], v[142:143]
  v_pk_add_f32 v[248:249], v[248:249], v[18:19]
  v_pk_add_f32 v[244:245], v[244:245], v[20:21]
  v_pk_add_f32 v[250:251], v[250:251], v[172:173]
  v_pk_add_f32 v[246:247], v[246:247], v[174:175]
  v_pk_add_f32 v[248:249], v[248:249], v[22:23]
  v_pk_add_f32 v[244:245], v[244:245], v[24:25]
  v_pk_add_f32 v[250:251], v[250:251], v[204:205]
  v_pk_add_f32 v[246:247], v[246:247], v[206:207]
  v_pk_add_f32 v[248:249], v[248:249], v[244:245]
  v_pk_add_f32 v[250:251], v[250:251], v[246:247]
  buffer_load_dwordx4 a[20:23], v2, s[84:87], s88 offen offset:2048 sc1
  v_add_f32 v248, v248, v249
  v_add_f32 v250, v250, v251
  v_rcp_f32 v248, v248
  v_rcp_f32 v250, v250
  v_pk_mul_f32 v[6:7], v[6:7], v[248:249] op_sel_hi:[1,0]
  v_pk_mul_f32 v[8:9], v[8:9], v[248:249] op_sel_hi:[1,0]
  v_pk_mul_f32 v[10:11], v[10:11], v[248:249] op_sel_hi:[1,0]
  v_pk_mul_f32 v[12:13], v[12:13], v[248:249] op_sel_hi:[1,0]
  v_pk_mul_f32 v[14:15], v[14:15], v[248:249] op_sel_hi:[1,0]
  v_pk_mul_f32 v[16:17], v[16:17], v[248:249] op_sel_hi:[1,0]
  v_pk_mul_f32 v[18:19], v[18:19], v[248:249] op_sel_hi:[1,0]
  v_pk_mul_f32 v[20:21], v[20:21], v[248:249] op_sel_hi:[1,0]
  v_pk_mul_f32 v[22:23], v[22:23], v[248:249] op_sel_hi:[1,0]
  v_pk_mul_f32 v[24:25], v[24:25], v[248:249] op_sel_hi:[1,0]
  buffer_load_dwordx4 a[24:27], v2, s[84:87], s88 offen offset:3072 sc1
  v_pk_mul_f32 v[76:77], v[76:77], v[250:251] op_sel_hi:[1,0]
  v_pk_mul_f32 v[78:79], v[78:79], v[250:251] op_sel_hi:[1,0]
  v_pk_mul_f32 v[108:109], v[108:109], v[250:251] op_sel_hi:[1,0]
  v_pk_mul_f32 v[110:111], v[110:111], v[250:251] op_sel_hi:[1,0]
  v_pk_mul_f32 v[140:141], v[140:141], v[250:251] op_sel_hi:[1,0]
  v_pk_mul_f32 v[142:143], v[142:143], v[250:251] op_sel_hi:[1,0]
  v_pk_mul_f32 v[172:173], v[172:173], v[250:251] op_sel_hi:[1,0]
  v_pk_mul_f32 v[174:175], v[174:175], v[250:251] op_sel_hi:[1,0]
  v_pk_mul_f32 v[204:205], v[204:205], v[250:251] op_sel_hi:[1,0]
  v_pk_mul_f32 v[206:207], v[206:207], v[250:251] op_sel_hi:[1,0]
  v_cvt_pk_bf16_f32 v224, v6, v7
  v_cvt_pk_bf16_f32 v225, v8, v9
  v_cvt_pk_bf16_f32 v226, v10, v11
  v_cvt_pk_bf16_f32 v227, v12, v13
  v_cvt_pk_bf16_f32 v228, v14, v15
  v_cvt_pk_bf16_f32 v229, v16, v17
  v_cvt_pk_bf16_f32 v230, v18, v19
  v_cvt_pk_bf16_f32 v231, v20, v21
  v_cvt_pk_bf16_f32 v232, v22, v23
  v_cvt_pk_bf16_f32 v233, v24, v25
  buffer_load_dwordx4 a[28:31], v3, s[84:87], s88 offen sc1
  v_cvt_pk_bf16_f32 v234, v76, v77
  v_cvt_pk_bf16_f32 v235, v78, v79
  v_cvt_pk_bf16_f32 v236, v108, v109
  v_cvt_pk_bf16_f32 v237, v110, v111
  v_cvt_pk_bf16_f32 v238, v140, v141
  v_cvt_pk_bf16_f32 v239, v142, v143
  v_cvt_pk_bf16_f32 v240, v172, v173
  v_cvt_pk_bf16_f32 v241, v174, v175
  v_cvt_pk_bf16_f32 v242, v204, v205
  v_cvt_pk_bf16_f32 v243, v206, v207
  ds_write_b128 v27, v[224:227] offset:16896
  ds_write_b128 v27, v[228:231] offset:16912
  ds_write_b128 v27, v[232:235] offset:16928
  ds_write_b128 v27, v[236:239] offset:16944
  ds_write_b128 v27, v[240:243] offset:16960
  s_waitcnt lgkmcnt(0)
  s_barrier
  ds_read_b64_tr_b16 v[64:65], v29 offset:0
  ds_read_b64_tr_b16 v[66:67], v29 offset:5632
  ds_read_b64_tr_b16 v[68:69], v29 offset:32
  ds_read_b64_tr_b16 v[70:71], v29 offset:5664
  ds_read_b64_tr_b16 v[72:73], v29 offset:64
  ds_read_b64_tr_b16 v[74:75], v29 offset:5696
  ds_read_b64_tr_b16 v[76:77], v29 offset:11264
  ds_read_b64_tr_b16 v[78:79], v29 offset:16896
  ds_read_b64_tr_b16 v[96:97], v29 offset:11296
  ds_read_b64_tr_b16 v[98:99], v29 offset:16928
  ds_read_b64_tr_b16 v[100:101], v29 offset:11328
  ds_read_b64_tr_b16 v[102:103], v29 offset:16960
  s_waitcnt lgkmcnt(6)
  s_nop 0
  v_mfma_f32_16x16x32_bf16 v[32:35], v[64:67], v[80:83], 0
  ds_read_b64_tr_b16 v[104:105], v29 offset:22528
  ds_read_b64_tr_b16 v[106:107], v29 offset:28160
  v_mfma_f32_16x16x32_bf16 v[36:39], v[64:67], v[84:87], 0
  ds_read_b64_tr_b16 v[108:109], v29 offset:22560
  ds_read_b64_tr_b16 v[110:111], v29 offset:28192
  v_mfma_f32_16x16x32_bf16 v[40:43], v[68:71], v[80:83], 0
  ds_read_b64_tr_b16 v[128:129], v29 offset:22592
  ds_read_b64_tr_b16 v[130:131], v29 offset:28224
  v_mfma_f32_16x16x32_bf16 v[44:47], v[68:71], v[84:87], 0
  s_add_u32 s88, s89, 327680
  buffer_load_dwordx4 a[32:35], v2, s[84:87], s88 offen offset:0 sc1
  v_mfma_f32_16x16x32_bf16 v[48:51], v[72:75], v[80:83], 0
  v_mfma_f32_16x16x32_bf16 v[52:55], v[72:75], v[84:87], 0
  s_waitcnt lgkmcnt(6)
  s_nop 0
  v_mfma_f32_16x16x32_bf16 v[32:35], v[76:79], v[88:91], v[32:35]
  ds_read_b64_tr_b16 v[132:133], v29 offset:33792
  ds_read_b64_tr_b16 v[134:135], v29 offset:39424
  v_mfma_f32_16x16x32_bf16 v[36:39], v[76:79], v[92:95], v[36:39]
  ds_read_b64_tr_b16 v[136:137], v29 offset:33824
  ds_read_b64_tr_b16 v[138:139], v29 offset:39456
  v_mfma_f32_16x16x32_bf16 v[40:43], v[96:99], v[88:91], v[40:43]
  ds_read_b64_tr_b16 v[140:141], v29 offset:33856
  ds_read_b64_tr_b16 v[142:143], v29 offset:39488
  v_mfma_f32_16x16x32_bf16 v[44:47], v[96:99], v[92:95], v[44:47]
  buffer_load_dwordx4 a[36:39], v2, s[84:87], s88 offen offset:1024 sc1
  v_mfma_f32_16x16x32_bf16 v[48:51], v[100:103], v[88:91], v[48:51]
  v_mfma_f32_16x16x32_bf16 v[52:55], v[100:103], v[92:95], v[52:55]
  s_waitcnt lgkmcnt(6)
  s_nop 0
  v_mfma_f32_16x16x32_bf16 v[32:35], v[104:107], v[112:115], v[32:35]
  ds_read_b64_tr_b16 v[160:161], v29 offset:80
  ds_read_b64_tr_b16 v[162:163], v29 offset:5712
  v_mfma_f32_16x16x32_bf16 v[36:39], v[104:107], v[116:119], v[36:39]
  ds_read_b64_tr_b16 v[164:165], v29 offset:112
  ds_read_b64_tr_b16 v[166:167], v29 offset:5744
  v_mfma_f32_16x16x32_bf16 v[40:43], v[108:111], v[112:115], v[40:43]
  ds_read_b64_tr_b16 v[168:169], v29 offset:144
  ds_read_b64_tr_b16 v[170:171], v29 offset:5776
  v_mfma_f32_16x16x32_bf16 v[44:47], v[108:111], v[116:119], v[44:47]
  buffer_load_dwordx4 a[40:43], v2, s[84:87], s88 offen offset:2048 sc1
  v_mfma_f32_16x16x32_bf16 v[48:51], v[128:131], v[112:115], v[48:51]
  v_mfma_f32_16x16x32_bf16 v[52:55], v[128:131], v[116:119], v[52:55]
  s_waitcnt lgkmcnt(6)
  s_nop 0
  v_mfma_f32_16x16x32_bf16 v[32:35], v[132:135], v[120:123], v[32:35]
  ds_read_b64_tr_b16 v[172:173], v29 offset:11344
  ds_read_b64_tr_b16 v[174:175], v29 offset:16976
  v_mfma_f32_16x16x32_bf16 v[36:39], v[132:135], v[124:127], v[36:39]
  ds_read_b64_tr_b16 v[192:193], v29 offset:11376
  ds_read_b64_tr_b16 v[194:195], v29 offset:17008
  v_mfma_f32_16x16x32_bf16 v[40:43], v[136:139], v[120:123], v[40:43]
  ds_read_b64_tr_b16 v[196:197], v29 offset:11408
  ds_read_b64_tr_b16 v[198:199], v29 offset:17040
  v_mfma_f32_16x16x32_bf16 v[44:47], v[136:139], v[124:127], v[44:47]
  buffer_load_dwordx4 a[44:47], v2, s[84:87], s88 offen offset:3072 sc1
  v_mfma_f32_16x16x32_bf16 v[48:51], v[140:143], v[120:123], v[48:51]
  v_mfma_f32_16x16x32_bf16 v[52:55], v[140:143], v[124:127], v[52:55]
  s_waitcnt lgkmcnt(6)
  s_nop 0
  v_mfma_f32_16x16x32_bf16 v[224:227], v[160:163], v[144:147], 0
  ds_read_b64_tr_b16 v[64:65], v29 offset:22608
  ds_read_b64_tr_b16 v[66:67], v29 offset:28240
  v_mfma_f32_16x16x32_bf16 v[228:231], v[160:163], v[148:151], 0
  ds_read_b64_tr_b16 v[68:69], v29 offset:22640
  ds_read_b64_tr_b16 v[70:71], v29 offset:28272
  v_mfma_f32_16x16x32_bf16 v[232:235], v[164:167], v[144:147], 0
  ds_read_b64_tr_b16 v[72:73], v29 offset:22672
  ds_read_b64_tr_b16 v[74:75], v29 offset:28304
  v_mfma_f32_16x16x32_bf16 v[236:239], v[164:167], v[148:151], 0
  v_mfma_f32_16x16x32_bf16 v[240:243], v[168:171], v[144:147], 0
  v_mfma_f32_16x16x32_bf16 v[244:247], v[168:171], v[148:151], 0
  s_waitcnt lgkmcnt(6)
  s_nop 0
  v_mfma_f32_16x16x32_bf16 v[224:227], v[172:175], v[152:155], v[224:227]
  ds_read_b64_tr_b16 v[76:77], v29 offset:33872
  ds_read_b64_tr_b16 v[78:79], v29 offset:39504
  v_mfma_f32_16x16x32_bf16 v[228:231], v[172:175], v[156:159], v[228:231]
  ds_read_b64_tr_b16 v[96:97], v29 offset:33904
  ds_read_b64_tr_b16 v[98:99], v29 offset:39536
  v_mfma_f32_16x16x32_bf16 v[232:235], v[192:195], v[152:155], v[232:235]
  ds_read_b64_tr_b16 v[100:101], v29 offset:33936
  ds_read_b64_tr_b16 v[102:103], v29 offset:39568
  v_mfma_f32_16x16x32_bf16 v[236:239], v[192:195], v[156:159], v[236:239]
  v_cvt_pk_bf16_f32 v32, v32, v33
  v_cvt_pk_bf16_f32 v33, v34, v35
  v_mfma_f32_16x16x32_bf16 v[240:243], v[196:199], v[152:155], v[240:243]
  ds_write_b64 v61, v[32:33] offset:0
  v_cvt_pk_bf16_f32 v36, v36, v37
  v_mfma_f32_16x16x32_bf16 v[244:247], v[196:199], v[156:159], v[244:247]
  v_cvt_pk_bf16_f32 v37, v38, v39
  s_mov_b64 exec, s[74:75]
  ds_write_b64 v61, v[36:37] offset:1280
  s_mov_b64 exec, -1
  s_waitcnt lgkmcnt(8)
  v_mfma_f32_16x16x32_bf16 v[224:227], v[64:67], v[176:179], v[224:227]
  v_cvt_pk_bf16_f32 v40, v40, v41
  v_cvt_pk_bf16_f32 v41, v42, v43
  v_mfma_f32_16x16x32_bf16 v[228:231], v[64:67], v[180:183], v[228:231]
  ds_write_b64 v61, v[40:41] offset:32
  v_cvt_pk_bf16_f32 v44, v44, v45
  v_mfma_f32_16x16x32_bf16 v[232:235], v[68:71], v[176:179], v[232:235]
  v_cvt_pk_bf16_f32 v45, v46, v47
  s_mov_b64 exec, s[74:75]
  ds_write_b64 v61, v[44:45] offset:1312
  s_mov_b64 exec, -1
  v_mfma_f32_16x16x32_bf16 v[236:239], v[68:71], v[180:183], v[236:239]
  v_mfma_f32_16x16x32_bf16 v[240:243], v[72:75], v[176:179], v[240:243]
  v_mfma_f32_16x16x32_bf16 v[244:247], v[72:75], v[180:183], v[244:247]
  s_waitcnt lgkmcnt(4)
  v_mfma_f32_16x16x32_bf16 v[224:227], v[76:79], v[184:187], v[224:227]
  v_cvt_pk_bf16_f32 v48, v48, v49
  v_cvt_pk_bf16_f32 v49, v50, v51
  v_mfma_f32_16x16x32_bf16 v[228:231], v[76:79], v[188:191], v[228:231]
  s_mov_b64 exec, s[72:73]
  ds_write_b64 v61, v[48:49] offset:64
  s_mov_b64 exec, -1
  v_cvt_pk_bf16_f32 v52, v52, v53
  v_mfma_f32_16x16x32_bf16 v[232:235], v[96:99], v[184:187], v[232:235]
  v_cvt_pk_bf16_f32 v53, v54, v55
  s_mov_b64 exec, s[76:77]
  ds_write_b64 v61, v[52:53] offset:1344
  s_mov_b64 exec, -1
  v_mfma_f32_16x16x32_bf16 v[236:239], v[96:99], v[188:191], v[236:239]
  v_mfma_f32_16x16x32_bf16 v[240:243], v[100:103], v[184:187], v[240:243]
  v_mfma_f32_16x16x32_bf16 v[244:247], v[100:103], v[188:191], v[244:247]
  v_cvt_pk_bf16_f32 v224, v224, v225
  v_cvt_pk_bf16_f32 v225, v226, v227
  ds_write_b64 v61, v[224:225] offset:1680
  v_cvt_pk_bf16_f32 v228, v228, v229
  v_cvt_pk_bf16_f32 v229, v230, v231
  s_mov_b64 exec, s[74:75]
  ds_write_b64 v61, v[228:229] offset:2960
  s_mov_b64 exec, -1
  v_cvt_pk_bf16_f32 v232, v232, v233
  v_cvt_pk_bf16_f32 v233, v234, v235
  ds_write_b64 v61, v[232:233] offset:1712
  v_cvt_pk_bf16_f32 v236, v236, v237
  v_cvt_pk_bf16_f32 v237, v238, v239
  s_mov_b64 exec, s[74:75]
  ds_write_b64 v61, v[236:237] offset:2992
  s_mov_b64 exec, -1
  v_cvt_pk_bf16_f32 v240, v240, v241
  v_cvt_pk_bf16_f32 v241, v242, v243
  s_mov_b64 exec, s[72:73]
  ds_write_b64 v61, v[240:241] offset:1744
  s_mov_b64 exec, -1
  v_cvt_pk_bf16_f32 v244, v244, v245
  v_cvt_pk_bf16_f32 v245, v246, v247
  s_mov_b64 exec, s[76:77]
  ds_write_b64 v61, v[244:245] offset:3024
  s_mov_b64 exec, -1
  s_waitcnt lgkmcnt(0)
  ds_read_b128 v[64:67], v62 offset:0
  ds_read_b128 v[68:71], v62 offset:1024
  ds_read_b128 v[72:75], v62 offset:2048
  ds_read_b128 v[76:79], v62 offset:3072
  s_waitcnt lgkmcnt(3)
  buffer_store_dwordx4 v[64:67], v2, s[52:55], s78 offen offset:0 sc1
  s_waitcnt lgkmcnt(2)
  buffer_store_dwordx4 v[68:71], v2, s[52:55], s78 offen offset:1024 sc1
  s_waitcnt lgkmcnt(1)
  buffer_store_dwordx4 v[72:75], v2, s[52:55], s78 offen offset:2048 sc1
  s_waitcnt lgkmcnt(0)
  buffer_store_dwordx4 v[76:79], v60, s[52:55], s78 offen offset:3072 sc1
  buffer_load_dwordx4 a[96:99], v3, s[84:87], s88 offen sc1
  s_add_u32 s88, s89, 348160
  buffer_load_dwordx4 a[100:103], v2, s[84:87], s88 offen offset:0 sc1
  buffer_load_dwordx4 a[104:107], v2, s[84:87], s88 offen offset:1024 sc1
  s_lshr_b32 s82, s37, 1
  s_mul_i32 s82, s82, 4352
  v_mov_b32 v4, s82
  s_cmp_lg_u32 s32, 0
  s_cbranch_scc1 Lp0_42
  global_load_dword v31, v4, s[90:91] sc1
  s_branch Lp1_43
Lp0_42:
  v_mov_b32 v4, 0
  global_load_dword v31, v4, s[8:9]
Lp1_43:
  v_and_b32 v24, 15, v0
  v_lshrrev_b32 v25, 4, v0
  s_mul_i32 s64, s37, 303104
  s_add_u32 s40, s30, s64
  s_addc_u32 s41, s31, 0
  s_and_b32 s41, s41, 0xffff
  s_mov_b32 s42, 0x4a000
  s_mov_b32 s43, 0x20000
  s_add_u32 s80, s32, 20
  s_lshl_b32 s80, s80, 12
  s_add_u32 s75, s32, 0
  s_and_b32 s75, s75, 3
  s_lshl_b32 s75, s75, 10
  v_add_u32 v26, s75, v2
  s_add_u32 s75, s32, 1
  s_and_b32 s75, s75, 3
  s_lshl_b32 s75, s75, 10
  v_add_u32 v27, s75, v2
  s_add_u32 s75, s32, 2
  s_and_b32 s75, s75, 3
  s_lshl_b32 s75, s75, 10
  v_add_u32 v28, s75, v2
  s_add_u32 s75, s32, 3
  s_and_b32 s75, s75, 3
  s_lshl_b32 s75, s75, 10
  v_add_u32 v29, s75, v2
  s_waitcnt vmcnt(0)
  s_cmp_lg_u32 s32, 0
  s_cbranch_scc1 Lpd_45
  v_cmp_gt_u32 vcc, 9, v31
  s_mov_b32 s95, 0x8000
  s_cmp_eq_u64 vcc, 0
  s_cbranch_scc1 Lpd_45
Lpoll_44:
  s_sleep 2
  global_load_dword v31, v4, s[90:91] sc1
  s_waitcnt vmcnt(0)
  v_cmp_gt_u32 vcc, 9, v31
  s_sub_u32 s95, s95, 1
  s_cmp_eq_u64 vcc, 0
  s_cbranch_scc1 Lpd_45
  s_cmp_lg_u32 s95, 0
  s_cbranch_scc1 Lpoll_44
Lpd_45:
  s_barrier
  buffer_load_dwordx4 v[196:199], v27, s[40:43], s80 offen sc1
  buffer_load_dwordx4 v[200:203], v28, s[40:43], s80 offen sc1
  buffer_load_dwordx4 v[204:207], v29, s[40:43], s80 offen sc1
  buffer_load_dwordx4 v[192:195], v26, s[40:43], s80 offen sc1
  s_add_u32 s80, s80, 16384
  buffer_load_dwordx4 v[212:215], v27, s[40:43], s80 offen sc1
  buffer_load_dwordx4 v[216:219], v28, s[40:43], s80 offen sc1
  buffer_load_dwordx4 v[220:223], v29, s[40:43], s80 offen sc1
  buffer_load_dwordx4 v[208:211], v26, s[40:43], s80 offen sc1
  s_add_u32 s80, s80, 16384
  buffer_load_dwordx4 v[228:231], v27, s[40:43], s80 offen sc1
  buffer_load_dwordx4 v[232:235], v28, s[40:43], s80 offen sc1
  buffer_load_dwordx4 v[236:239], v29, s[40:43], s80 offen sc1
  buffer_load_dwordx4 v[224:227], v26, s[40:43], s80 offen sc1
  s_add_u32 s80, s80, 16384
  buffer_load_dwordx4 v[244:247], v27, s[40:43], s80 offen sc1
  buffer_load_dwordx4 v[248:251], v28, s[40:43], s80 offen sc1
  buffer_load_dwordx4 v[252:255], v29, s[40:43], s80 offen sc1
  buffer_load_dwordx4 v[240:243], v26, s[40:43], s80 offen sc1
  s_add_u32 s80, s80, 16384
  buffer_load_dwordx4 v[148:151], v27, s[40:43], s80 offen sc1
  buffer_load_dwordx4 v[152:155], v28, s[40:43], s80 offen sc1
  buffer_load_dwordx4 v[156:159], v29, s[40:43], s80 offen sc1
  buffer_load_dwordx4 v[144:147], v26, s[40:43], s80 offen sc1
  s_add_u32 s80, s80, 16384
  buffer_load_dwordx4 v[164:167], v27, s[40:43], s80 offen sc1
  buffer_load_dwordx4 v[168:171], v28, s[40:43], s80 offen sc1
  buffer_load_dwordx4 v[172:175], v29, s[40:43], s80 offen sc1
  buffer_load_dwordx4 v[160:163], v26, s[40:43], s80 offen sc1
  s_add_u32 s80, s80, 16384
  buffer_load_dwordx4 v[180:183], v27, s[40:43], s80 offen sc1
  buffer_load_dwordx4 v[184:187], v28, s[40:43], s80 offen sc1
  buffer_load_dwordx4 v[188:191], v29, s[40:43], s80 offen sc1
  buffer_load_dwordx4 v[176:179], v26, s[40:43], s80 offen sc1
  s_add_u32 s80, s80, 16384
  s_add_u32 s48, s30, 0x1200000
  s_addc_u32 s49, s31, 0
  s_and_b32 s49, s49, 0xffff
  s_mov_b32 s50, 0x2000
  s_mov_b32 s51, 0x20000
  v_lshlrev_b32 v6, 2, v24
  s_add_u32 s75, s32, 1
  s_and_b32 s75, s75, 3
  s_waitcnt vmcnt(27)
  v_mfma_f32_16x16x32_bf16 v[84:87], a[128:131], v[196:199], 0
  s_mul_i32 s75, s75, 15360
  s_add_u32 s75, s75, 102400
  v_mfma_f32_16x16x32_bf16 v[88:91], a[132:135], v[196:199], 0
  s_add_u32 s88, s89, 348160
  buffer_load_dwordx4 v[32:35], v2, s[84:87], s88 offen offset:2048 sc1
  v_add_u32 v11, s75, v2
  s_add_u32 s75, s32, 2
  v_mfma_f32_16x16x32_bf16 v[92:95], a[136:139], v[196:199], 0
  s_and_b32 s75, s75, 3
  s_mul_i32 s75, s75, 15360
  v_mfma_f32_16x16x32_bf16 v[96:99], a[140:143], v[196:199], 0
  buffer_load_dwordx4 v[36:39], v2, s[84:87], s88 offen offset:3072 sc1
  s_add_u32 s75, s75, 107520
  v_add_u32 v12, s75, v2
  v_mfma_f32_16x16x32_bf16 v[100:103], a[144:147], v[196:199], 0
  s_add_u32 s75, s32, 3
  s_and_b32 s75, s75, 3
  s_waitcnt vmcnt(28)
  v_mfma_f32_16x16x32_bf16 v[104:107], a[128:131], v[200:203], 0
  s_mul_i32 s75, s75, 15360
  s_add_u32 s75, s75, 112640
  v_mfma_f32_16x16x32_bf16 v[108:111], a[132:135], v[200:203], 0
  buffer_load_dwordx4 v[40:43], v3, s[84:87], s88 offen sc1
  v_add_u32_e64 v13, s75, v2
  s_mul_i32 s75, s32, 15360
  v_mfma_f32_16x16x32_bf16 v[112:115], a[136:139], v[200:203], 0
  s_add_u32 s75, s75, 102400
  v_add_u32_e64 v8, s75, v2
  v_mfma_f32_16x16x32_bf16 v[116:119], a[140:143], v[200:203], 0
  s_add_u32 s88, s89, 368640
  buffer_load_dwordx4 v[44:47], v2, s[84:87], s88 offen offset:0 sc1
  v_add_u32 v9, 51200, v2
  s_mov_b32 s52, s26
  v_mfma_f32_16x16x32_bf16 v[120:123], a[144:147], v[200:203], 0
  s_and_b32 s53, s27, 0xffff
  s_mov_b32 s54, 0x280000
  s_waitcnt vmcnt(29)
  v_mfma_f32_16x16x32_bf16 v[124:127], a[128:131], v[204:207], 0
  s_mov_b32 s55, 0x20000
  s_lshl_b32 s81, s37, 6
  v_mfma_f32_16x16x32_bf16 v[128:131], a[132:135], v[204:207], 0
  buffer_load_dwordx4 v[48:51], v2, s[84:87], s88 offen offset:1024 sc1
  s_lshl_b32 s75, s32, 4
  s_add_u32 s81, s81, s75
  v_mfma_f32_16x16x32_bf16 v[132:135], a[136:139], v[204:207], 0
  s_lshl_b32 s74, s81, 2
  s_mul_i32 s81, s81, 1280
  v_mfma_f32_16x16x32_bf16 v[136:139], a[140:143], v[204:207], 0
  buffer_load_dwordx4 v[52:55], v2, s[84:87], s88 offen offset:2048 sc1
  s_mul_i32 s75, s38, 160
  s_add_u32 s81, s81, s75
  v_mfma_f32_16x16x32_bf16 v[140:143], a[144:147], v[204:207], 0
  v_mul_u32_u24 v16, 1280, v24
  v_lshl_add_u32 v16, v25, 3, v16
  s_waitcnt vmcnt(30)
  v_mfma_f32_16x16x32_bf16 v[64:67], a[128:131], v[192:195], 0
  s_lshr_b32 s82, s37, 1
  s_add_u32 s82, s82, 16
  v_mfma_f32_16x16x32_bf16 v[68:71], a[132:135], v[192:195], 0
  buffer_load_dwordx4 v[56:59], v2, s[84:87], s88 offen offset:3072 sc1
  s_mul_i32 s82, s82, 4352
  s_mov_b32 s73, 0
  v_mfma_f32_16x16x32_bf16 v[72:75], a[136:139], v[192:195], 0
  s_mul_i32 s75, s32, 15360
  s_add_u32 s75, s75, 102400
  v_mfma_f32_16x16x32_bf16 v[76:79], a[140:143], v[192:195], 0
  buffer_load_dwordx4 v[60:63], v3, s[84:87], s88 offen sc1
  v_mul_u32_u24 v17, 176, v24
  v_lshl_add_u32 v17, v25, 3, v17
  v_mfma_f32_16x16x32_bf16 v[80:83], a[144:147], v[192:195], 0
  v_add_u32 v17, s75, v17
  v_mov_b32 v30, 0x7fffffff
  s_waitcnt vmcnt(31)
  v_mfma_f32_16x16x32_bf16 v[84:87], a[148:151], v[212:215], v[84:87]
  v_add_u32 v14, 0, v0
  v_mul_u32_u24 v15, 205, v14
  v_mfma_f32_16x16x32_bf16 v[88:91], a[152:155], v[212:215], v[88:91]
  s_add_u32 s100, s89, 0
  s_add_u32 m0, s89, 0
  s_nop 0
  buffer_load_dwordx4 v2, s[84:87], s100 offen offset:0 sc1 lds
  v_lshrrev_b32 v15, 11, v15
  v_mul_u32_u24 v7, 10, v15
  v_mfma_f32_16x16x32_bf16 v[92:95], a[156:159], v[212:215], v[92:95]
  v_sub_u32 v14, v14, v7
  v_lshlrev_b32 v14, 4, v14
  v_mfma_f32_16x16x32_bf16 v[96:99], a[160:163], v[212:215], v[96:99]
  s_add_u32 m0, s89, 0
  s_nop 0
  buffer_load_dwordx4 v2, s[84:87], s100 offen offset:1024 sc1 lds
  v_mul_u32_u24 v7, 176, v15
  v_add3_u32 v18, v7, v14, s75
  v_mfma_f32_16x16x32_bf16 v[100:103], a[164:167], v[212:215], v[100:103]
  v_mul_u32_u24 v7, 1280, v15
  v_add_u32 v21, v7, v14
  s_waitcnt vmcnt(32)
  v_mfma_f32_16x16x32_bf16 v[104:107], a[148:151], v[216:219], v[104:107]
  v_add_u32 v14, 64, v0
  v_mul_u32_u24 v15, 205, v14
  v_mfma_f32_16x16x32_bf16 v[108:111], a[152:155], v[216:219], v[108:111]
  s_add_u32 m0, s89, 0
  s_nop 0
  buffer_load_dwordx4 v2, s[84:87], s100 offen offset:2048 sc1 lds
  v_lshrrev_b32 v15, 11, v15
  v_mul_u32_u24 v7, 10, v15
  v_mfma_f32_16x16x32_bf16 v[112:115], a[156:159], v[216:219], v[112:115]
  v_sub_u32 v14, v14, v7
  v_lshlrev_b32 v14, 4, v14
  v_mfma_f32_16x16x32_bf16 v[116:119], a[160:163], v[216:219], v[116:119]
  s_add_u32 m0, s89, 0
  s_nop 0
  buffer_load_dwordx4 v2, s[84:87], s100 offen offset:3072 sc1 lds
  v_mul_u32_u24 v7, 176, v15
  v_add3_u32 v19, v7, v14, s75
  v_mfma_f32_16x16x32_bf16 v[120:123], a[164:167], v[216:219], v[120:123]
  v_mul_u32_u24 v7, 1280, v15
  v_add_u32 v22, v7, v14
  s_waitcnt vmcnt(33)
  v_mfma_f32_16x16x32_bf16 v[124:127], a[148:151], v[220:223], v[124:127]
  v_add_u32 v14, 128, v0
  v_mul_u32_u24 v15, 205, v14
  v_mfma_f32_16x16x32_bf16 v[128:131], a[152:155], v[220:223], v[128:131]
  s_add_u32 m0, s89, 4096
  s_nop 0
  buffer_load_dwordx4 v3, s[84:87], s100 offen sc1 lds
  v_lshrrev_b32 v15, 11, v15
  v_mul_u32_u24 v7, 10, v15
  v_mfma_f32_16x16x32_bf16 v[132:135], a[156:159], v[220:223], v[132:135]
  v_sub_u32 v14, v14, v7
  v_lshlrev_b32_e64 v14, 4, v14
  v_mfma_f32_16x16x32_bf16 v[136:139], a[160:163], v[220:223], v[136:139]
  s_add_u32 s100, s89, 20480
  s_add_u32 m0, s89, 20480
  s_nop 0
  buffer_load_dwordx4 v2, s[84:87], s100 offen offset:0 sc1 lds
  v_mul_u32_u24 v7, 176, v15
  v_add3_u32 v20, v7, v14, s75
  v_mfma_f32_16x16x32_bf16 v[140:143], a[164:167], v[220:223], v[140:143]
  v_mul_u32_u24 v7, 1280, v15
  v_add_u32 v23, v7, v14
  s_waitcnt vmcnt(34)
  v_mfma_f32_16x16x32_bf16 v[64:67], a[148:151], v[208:211], v[64:67]
  v_cmp_gt_u32 vcc, 32, v0
  s_nop 1
  v_cndmask_b32 v23, v30, v23, vcc
  v_mfma_f32_16x16x32_bf16 v[68:71], a[152:155], v[208:211], v[68:71]
  s_add_u32 m0, s89, 20480
  s_nop 0
  buffer_load_dwordx4 v2, s[84:87], s100 offen offset:1024 sc1 lds
  v_mfma_f32_16x16x32_bf16 v[72:75], a[156:159], v[208:211], v[72:75]
  v_mfma_f32_16x16x32_bf16 v[76:79], a[160:163], v[208:211], v[76:79]
  s_add_u32 m0, s89, 20480
  s_nop 0
  buffer_load_dwordx4 v2, s[84:87], s100 offen offset:2048 sc1 lds
  v_mfma_f32_16x16x32_bf16 v[80:83], a[164:167], v[208:211], v[80:83]
  s_waitcnt vmcnt(35)
  v_mfma_f32_16x16x32_bf16 v[84:87], a[168:171], v[228:231], v[84:87]
  v_mfma_f32_16x16x32_bf16 v[88:91], a[172:175], v[228:231], v[88:91]
  s_add_u32 m0, s89, 20480
  s_nop 0
  buffer_load_dwordx4 v2, s[84:87], s100 offen offset:3072 sc1 lds
  v_mfma_f32_16x16x32_bf16 v[92:95], a[176:179], v[228:231], v[92:95]
  v_mfma_f32_16x16x32_bf16 v[96:99], a[180:183], v[228:231], v[96:99]
  s_add_u32 m0, s89, 24576
  s_nop 0
  buffer_load_dwordx4 v3, s[84:87], s100 offen sc1 lds
  v_mfma_f32_16x16x32_bf16 v[100:103], a[184:187], v[228:231], v[100:103]
  s_waitcnt vmcnt(36)
  v_mfma_f32_16x16x32_bf16 v[104:107], a[168:171], v[232:235], v[104:107]
  v_mfma_f32_16x16x32_bf16 v[108:111], a[172:175], v[232:235], v[108:111]
  s_add_u32 s100, s89, 40960
  s_add_u32 m0, s89, 40960
  s_nop 0
  buffer_load_dwordx4 v2, s[84:87], s100 offen offset:0 sc1 lds
  v_mfma_f32_16x16x32_bf16 v[112:115], a[176:179], v[232:235], v[112:115]
  v_mfma_f32_16x16x32_bf16 v[116:119], a[180:183], v[232:235], v[116:119]
  s_add_u32 m0, s89, 40960
  s_nop 0
  buffer_load_dwordx4 v2, s[84:87], s100 offen offset:1024 sc1 lds
  v_mfma_f32_16x16x32_bf16 v[120:123], a[184:187], v[232:235], v[120:123]
  s_waitcnt vmcnt(37)
  v_mfma_f32_16x16x32_bf16 v[124:127], a[168:171], v[236:239], v[124:127]
  v_mfma_f32_16x16x32_bf16 v[128:131], a[172:175], v[236:239], v[128:131]
  s_add_u32 m0, s89, 40960
  s_nop 0
  buffer_load_dwordx4 v2, s[84:87], s100 offen offset:2048 sc1 lds
  v_mfma_f32_16x16x32_bf16 v[132:135], a[176:179], v[236:239], v[132:135]
  v_mfma_f32_16x16x32_bf16 v[136:139], a[180:183], v[236:239], v[136:139]
  s_add_u32 m0, s89, 40960
  s_nop 0
  buffer_load_dwordx4 v2, s[84:87], s100 offen offset:3072 sc1 lds
  v_mfma_f32_16x16x32_bf16 v[140:143], a[184:187], v[236:239], v[140:143]
  s_waitcnt vmcnt(38)
  v_mfma_f32_16x16x32_bf16 v[64:67], a[168:171], v[224:227], v[64:67]
  v_mfma_f32_16x16x32_bf16 v[68:71], a[172:175], v[224:227], v[68:71]
  s_add_u32 m0, s89, 45056
  s_nop 0
  buffer_load_dwordx4 v3, s[84:87], s100 offen sc1 lds
  v_mfma_f32_16x16x32_bf16 v[72:75], a[176:179], v[224:227], v[72:75]
  v_mfma_f32_16x16x32_bf16 v[76:79], a[180:183], v[224:227], v[76:79]
  s_add_u32 s100, s89, 61440
  s_add_u32 m0, s89, 61440
  s_nop 0
  buffer_load_dwordx4 v2, s[84:87], s100 offen offset:0 sc1 lds
  v_mfma_f32_16x16x32_bf16 v[80:83], a[184:187], v[224:227], v[80:83]
  s_waitcnt vmcnt(39)
  v_mfma_f32_16x16x32_bf16 v[84:87], a[188:191], v[244:247], v[84:87]
  v_mfma_f32_16x16x32_bf16 v[88:91], a[192:195], v[244:247], v[88:91]
  s_add_u32 m0, s89, 61440
  s_nop 0
  buffer_load_dwordx4 v2, s[84:87], s100 offen offset:1024 sc1 lds
  v_mfma_f32_16x16x32_bf16 v[92:95], a[196:199], v[244:247], v[92:95]
  v_mfma_f32_16x16x32_bf16 v[96:99], a[200:203], v[244:247], v[96:99]
  s_add_u32 m0, s89, 61440
  s_nop 0
  buffer_load_dwordx4 v2, s[84:87], s100 offen offset:2048 sc1 lds
  v_mfma_f32_16x16x32_bf16 v[100:103], a[204:207], v[244:247], v[100:103]
  s_waitcnt vmcnt(40)
  v_mfma_f32_16x16x32_bf16 v[104:107], a[188:191], v[248:251], v[104:107]
  v_mfma_f32_16x16x32_bf16 v[108:111], a[192:195], v[248:251], v[108:111]
  s_add_u32 m0, s89, 61440
  s_nop 0
  buffer_load_dwordx4 v2, s[84:87], s100 offen offset:3072 sc1 lds
  v_mfma_f32_16x16x32_bf16 v[112:115], a[196:199], v[248:251], v[112:115]
  v_mfma_f32_16x16x32_bf16 v[116:119], a[200:203], v[248:251], v[116:119]
  s_add_u32 m0, s89, 65536
  s_nop 0
  buffer_load_dwordx4 v3, s[84:87], s100 offen sc1 lds
  v_mfma_f32_16x16x32_bf16 v[120:123], a[204:207], v[248:251], v[120:123]
  s_waitcnt vmcnt(41)
  v_mfma_f32_16x16x32_bf16 v[124:127], a[188:191], v[252:255], v[124:127]
  v_mfma_f32_16x16x32_bf16 v[128:131], a[192:195], v[252:255], v[128:131]
  s_add_u32 s100, s89, 81920
  s_add_u32 m0, s89, 81920
  s_nop 0
  buffer_load_dwordx4 v2, s[84:87], s100 offen offset:0 sc1 lds
  v_mfma_f32_16x16x32_bf16 v[132:135], a[196:199], v[252:255], v[132:135]
  v_mfma_f32_16x16x32_bf16 v[136:139], a[200:203], v[252:255], v[136:139]
  s_add_u32 m0, s89, 81920
  s_nop 0
  buffer_load_dwordx4 v2, s[84:87], s100 offen offset:1024 sc1 lds
  v_mfma_f32_16x16x32_bf16 v[140:143], a[204:207], v[252:255], v[140:143]
  s_waitcnt vmcnt(42)
  v_mfma_f32_16x16x32_bf16 v[64:67], a[188:191], v[240:243], v[64:67]
  v_mfma_f32_16x16x32_bf16 v[68:71], a[192:195], v[240:243], v[68:71]
  s_add_u32 m0, s89, 81920
  s_nop 0
  buffer_load_dwordx4 v2, s[84:87], s100 offen offset:2048 sc1 lds
  v_mfma_f32_16x16x32_bf16 v[72:75], a[196:199], v[240:243], v[72:75]
  v_mfma_f32_16x16x32_bf16 v[76:79], a[200:203], v[240:243], v[76:79]
  s_add_u32 m0, s89, 81920
  s_nop 0
  buffer_load_dwordx4 v2, s[84:87], s100 offen offset:3072 sc1 lds
  v_mfma_f32_16x16x32_bf16 v[80:83], a[204:207], v[240:243], v[80:83]
  s_waitcnt vmcnt(43)
  v_mfma_f32_16x16x32_bf16 v[84:87], a[208:211], v[148:151], v[84:87]
  v_mfma_f32_16x16x32_bf16 v[88:91], a[212:215], v[148:151], v[88:91]
  s_add_u32 m0, s89, 86016
  s_nop 0
  buffer_load_dwordx4 v3, s[84:87], s100 offen sc1 lds
  v_mfma_f32_16x16x32_bf16 v[92:95], a[216:219], v[148:151], v[92:95]
  v_mfma_f32_16x16x32_bf16 v[96:99], a[220:223], v[148:151], v[96:99]
  v_mfma_f32_16x16x32_bf16 v[100:103], a[224:227], v[148:151], v[100:103]
  buffer_load_dwordx4 v[148:151], v27, s[40:43], s80 offen sc1
  s_waitcnt vmcnt(44)
  v_mfma_f32_16x16x32_bf16 v[104:107], a[208:211], v[152:155], v[104:107]
  v_mfma_f32_16x16x32_bf16 v[108:111], a[212:215], v[152:155], v[108:111]
  v_mfma_f32_16x16x32_bf16 v[112:115], a[216:219], v[152:155], v[112:115]
  v_mfma_f32_16x16x32_bf16 v[116:119], a[220:223], v[152:155], v[116:119]
  v_mfma_f32_16x16x32_bf16 v[120:123], a[224:227], v[152:155], v[120:123]
  buffer_load_dwordx4 v[152:155], v28, s[40:43], s80 offen sc1
  s_waitcnt vmcnt(44)
  v_mfma_f32_16x16x32_bf16 v[124:127], a[208:211], v[156:159], v[124:127]
  v_mfma_f32_16x16x32_bf16 v[128:131], a[212:215], v[156:159], v[128:131]
  v_mfma_f32_16x16x32_bf16 v[132:135], a[216:219], v[156:159], v[132:135]
  v_mfma_f32_16x16x32_bf16 v[136:139], a[220:223], v[156:159], v[136:139]
  v_mfma_f32_16x16x32_bf16 v[140:143], a[224:227], v[156:159], v[140:143]
  buffer_load_dwordx4 v[156:159], v29, s[40:43], s80 offen sc1
  s_waitcnt vmcnt(44)
  v_mfma_f32_16x16x32_bf16 v[64:67], a[208:211], v[144:147], v[64:67]
  v_mfma_f32_16x16x32_bf16 v[68:71], a[212:215], v[144:147], v[68:71]
  v_mfma_f32_16x16x32_bf16 v[72:75], a[216:219], v[144:147], v[72:75]
  v_mfma_f32_16x16x32_bf16 v[76:79], a[220:223], v[144:147], v[76:79]
  v_mfma_f32_16x16x32_bf16 v[80:83], a[224:227], v[144:147], v[80:83]
  buffer_load_dwordx4 v[144:147], v26, s[40:43], s80 offen sc1
  s_add_u32 s80, s80, 16384
  s_waitcnt vmcnt(44)
  v_mfma_f32_16x16x32_bf16 v[84:87], a[228:231], v[164:167], v[84:87]
  v_mfma_f32_16x16x32_bf16 v[88:91], a[232:235], v[164:167], v[88:91]
  v_mfma_f32_16x16x32_bf16 v[92:95], a[236:239], v[164:167], v[92:95]
  v_mfma_f32_16x16x32_bf16 v[96:99], a[240:243], v[164:167], v[96:99]
  v_mfma_f32_16x16x32_bf16 v[100:103], a[244:247], v[164:167], v[100:103]
  buffer_load_dwordx4 v[164:167], v27, s[40:43], s80 offen sc1
  s_waitcnt vmcnt(44)
  v_mfma_f32_16x16x32_bf16 v[104:107], a[228:231], v[168:171], v[104:107]
  v_mfma_f32_16x16x32_bf16 v[108:111], a[232:235], v[168:171], v[108:111]
  v_mfma_f32_16x16x32_bf16 v[112:115], a[236:239], v[168:171], v[112:115]
  v_mfma_f32_16x16x32_bf16 v[116:119], a[240:243], v[168:171], v[116:119]
  v_mfma_f32_16x16x32_bf16 v[120:123], a[244:247], v[168:171], v[120:123]
  buffer_load_dwordx4 v[168:171], v28, s[40:43], s80 offen sc1
  s_waitcnt vmcnt(44)
  v_mfma_f32_16x16x32_bf16 v[124:127], a[228:231], v[172:175], v[124:127]
  v_mfma_f32_16x16x32_bf16 v[128:131], a[232:235], v[172:175], v[128:131]
  v_mfma_f32_16x16x32_bf16 v[132:135], a[236:239], v[172:175], v[132:135]
  v_mfma_f32_16x16x32_bf16 v[136:139], a[240:243], v[172:175], v[136:139]
  v_mfma_f32_16x16x32_bf16 v[140:143], a[244:247], v[172:175], v[140:143]
  buffer_load_dwordx4 v[172:175], v29, s[40:43], s80 offen sc1
  s_waitcnt vmcnt(44)
  v_mfma_f32_16x16x32_bf16 v[64:67], a[228:231], v[160:163], v[64:67]
  v_mfma_f32_16x16x32_bf16 v[68:71], a[232:235], v[160:163], v[68:71]
  v_mfma_f32_16x16x32_bf16 v[72:75], a[236:239], v[160:163], v[72:75]
  v_mfma_f32_16x16x32_bf16 v[76:79], a[240:243], v[160:163], v[76:79]
  v_mfma_f32_16x16x32_bf16 v[80:83], a[244:247], v[160:163], v[80:83]
  buffer_load_dwordx4 v[160:163], v26, s[40:43], s80 offen sc1
  s_add_u32 s80, s80, 16384
  s_waitcnt vmcnt(44)
  v_mfma_f32_16x16x32_bf16 v[84:87], a[248:251], v[180:183], v[84:87]
  v_mfma_f32_16x16x32_bf16 v[88:91], a[252:255], v[180:183], v[88:91]
  s_waitcnt vmcnt(8)
  s_barrier
  v_mfma_f32_16x16x32_bf16 v[92:95], a[48:51], v[180:183], v[92:95]
  ds_read_b128 a[128:131], v2 offset:0
  v_mfma_f32_16x16x32_bf16 v[96:99], a[52:55], v[180:183], v[96:99]
  ds_read_b128 a[132:135], v2 offset:1024
  v_mfma_f32_16x16x32_bf16 v[100:103], a[56:59], v[180:183], v[100:103]
  ds_read_b128 a[136:139], v2 offset:2048
  buffer_load_dwordx4 v[180:183], v27, s[40:43], s80 offen sc1
  v_mfma_f32_16x16x32_bf16 v[104:107], a[248:251], v[184:187], v[104:107]
  ds_read_b128 a[140:143], v2 offset:3072
  v_mfma_f32_16x16x32_bf16 v[108:111], a[252:255], v[184:187], v[108:111]
  ds_read_b128 a[144:147], v2 offset:4096
  v_mfma_f32_16x16x32_bf16 v[112:115], a[48:51], v[184:187], v[112:115]
  ds_read_b128 a[148:151], v2 offset:5120
  v_mfma_f32_16x16x32_bf16 v[116:119], a[52:55], v[184:187], v[116:119]
  ds_read_b128 a[152:155], v2 offset:6144
  v_mfma_f32_16x16x32_bf16 v[120:123], a[56:59], v[184:187], v[120:123]
  ds_read_b128 a[156:159], v2 offset:7168
  buffer_load_dwordx4 v[184:187], v28, s[40:43], s80 offen sc1
  v_mfma_f32_16x16x32_bf16 v[124:127], a[248:251], v[188:191], v[124:127]
  ds_read_b128 a[160:163], v2 offset:8192
  v_mfma_f32_16x16x32_bf16 v[128:131], a[252:255], v[188:191], v[128:131]
  ds_read_b128 a[164:167], v2 offset:9216
  v_mfma_f32_16x16x32_bf16 v[132:135], a[48:51], v[188:191], v[132:135]
  ds_read_b128 a[168:171], v2 offset:10240
  v_mfma_f32_16x16x32_bf16 v[136:139], a[52:55], v[188:191], v[136:139]
  ds_read_b128 a[172:175], v2 offset:11264
  v_mfma_f32_16x16x32_bf16 v[140:143], a[56:59], v[188:191], v[140:143]
  ds_read_b128 a[176:179], v2 offset:12288
  buffer_load_dwordx4 v[188:191], v29, s[40:43], s80 offen sc1
  v_mfma_f32_16x16x32_bf16 v[64:67], a[248:251], v[176:179], v[64:67]
  ds_read_b128 a[180:183], v2 offset:13312
  v_mfma_f32_16x16x32_bf16 v[68:71], a[252:255], v[176:179], v[68:71]
  ds_read_b128 a[184:187], v2 offset:14336
  v_mfma_f32_16x16x32_bf16 v[72:75], a[48:51], v[176:179], v[72:75]
  ds_read_b128 a[188:191], v2 offset:15360
  v_mfma_f32_16x16x32_bf16 v[76:79], a[52:55], v[176:179], v[76:79]
  ds_read_b128 a[192:195], v2 offset:16384
  v_mfma_f32_16x16x32_bf16 v[80:83], a[56:59], v[176:179], v[80:83]
  ds_read_b128 a[196:199], v2 offset:17408
  buffer_load_dwordx4 v[176:179], v26, s[40:43], s80 offen sc1
  s_add_u32 s80, s80, 16384
  s_waitcnt vmcnt(11)
  s_nop 0
  v_mfma_f32_16x16x32_bf16 v[84:87], a[60:63], v[148:151], v[84:87]
  ds_read_b128 a[200:203], v2 offset:18432
  v_mfma_f32_16x16x32_bf16 v[88:91], a[64:67], v[148:151], v[88:91]
  ds_read_b128 a[204:207], v2 offset:19456
  v_mfma_f32_16x16x32_bf16 v[92:95], a[68:71], v[148:151], v[92:95]
  ds_read_b128 a[208:211], v2 offset:20480
  v_mfma_f32_16x16x32_bf16 v[96:99], a[72:75], v[148:151], v[96:99]
  ds_read_b128 a[212:215], v2 offset:21504
  v_mfma_f32_16x16x32_bf16 v[100:103], a[76:79], v[148:151], v[100:103]
  ds_read_b128 a[216:219], v2 offset:22528
  buffer_load_dwordx4 v[148:151], v27, s[40:43], s80 offen sc1
  s_waitcnt vmcnt(11)
  s_nop 0
  v_mfma_f32_16x16x32_bf16 v[104:107], a[60:63], v[152:155], v[104:107]
  ds_read_b128 a[220:223], v2 offset:23552
  v_mfma_f32_16x16x32_bf16 v[108:111], a[64:67], v[152:155], v[108:111]
  ds_read_b128 a[224:227], v2 offset:24576
  v_mfma_f32_16x16x32_bf16 v[112:115], a[68:71], v[152:155], v[112:115]
  ds_read_b128 a[228:231], v2 offset:25600
  v_mfma_f32_16x16x32_bf16 v[116:119], a[72:75], v[152:155], v[116:119]
  ds_read_b128 a[232:235], v2 offset:26624
  v_mfma_f32_16x16x32_bf16 v[120:123], a[76:79], v[152:155], v[120:123]
  ds_read_b128 a[236:239], v2 offset:27648
  buffer_load_dwordx4 v[152:155], v28, s[40:43], s80 offen sc1
  s_waitcnt vmcnt(11)
  s_nop 0
  v_mfma_f32_16x16x32_bf16 v[124:127], a[60:63], v[156:159], v[124:127]
  ds_read_b128 a[240:243], v2 offset:28672
  v_mfma_f32_16x16x32_bf16 v[128:131], a[64:67], v[156:159], v[128:131]
  ds_read_b128 a[244:247], v2 offset:29696
  v_mfma_f32_16x16x32_bf16 v[132:135], a[68:71], v[156:159], v[132:135]
  ds_read_b128 a[248:251], v2 offset:30720
  v_mfma_f32_16x16x32_bf16 v[136:139], a[72:75], v[156:159], v[136:139]
  ds_read_b128 a[252:255], v2 offset:31744
  v_mfma_f32_16x16x32_bf16 v[140:143], a[76:79], v[156:159], v[140:143]
  ds_read_b128 a[48:51], v2 offset:32768
  buffer_load_dwordx4 v[156:159], v29, s[40:43], s80 offen sc1
  s_waitcnt vmcnt(11)
  v_mfma_f32_16x16x32_bf16 v[64:67], a[60:63], v[144:147], v[64:67]
  ds_read_b128 a[52:55], v2 offset:33792
  v_mfma_f32_16x16x32_bf16 v[68:71], a[64:67], v[144:147], v[68:71]
  ds_read_b128 a[56:59], v2 offset:34816
  v_mfma_f32_16x16x32_bf16 v[72:75], a[68:71], v[144:147], v[72:75]
  v_mfma_f32_16x16x32_bf16 v[76:79], a[72:75], v[144:147], v[76:79]
  v_mfma_f32_16x16x32_bf16 v[80:83], a[76:79], v[144:147], v[80:83]
  buffer_load_dwordx4 v[144:147], v26, s[40:43], s80 offen sc1
  s_add_u32 s80, s80, 16384
  s_waitcnt vmcnt(11)
  v_mfma_f32_16x16x32_bf16 v[84:87], a[80:83], v[164:167], v[84:87]
  ds_read_b128 a[60:63], v2 offset:35840
  v_mfma_f32_16x16x32_bf16 v[88:91], a[84:87], v[164:167], v[88:91]
  ds_read_b128 a[64:67], v2 offset:36864
  v_mfma_f32_16x16x32_bf16 v[92:95], a[88:91], v[164:167], v[92:95]
  ds_read_b128 a[68:71], v2 offset:37888
  v_mfma_f32_16x16x32_bf16 v[96:99], a[92:95], v[164:167], v[96:99]
  ds_read_b128 a[72:75], v2 offset:38912
  v_mfma_f32_16x16x32_bf16 v[100:103], a[108:111], v[164:167], v[100:103]
  ds_read_b128 a[76:79], v2 offset:39936
  buffer_load_dwordx4 v[164:167], v27, s[40:43], s80 offen sc1
  s_waitcnt vmcnt(11)
  v_mfma_f32_16x16x32_bf16 v[104:107], a[80:83], v[168:171], v[104:107]
  v_mfma_f32_16x16x32_bf16 v[108:111], a[84:87], v[168:171], v[108:111]
  v_mfma_f32_16x16x32_bf16 v[112:115], a[88:91], v[168:171], v[112:115]
  v_mfma_f32_16x16x32_bf16 v[116:119], a[92:95], v[168:171], v[116:119]
  v_mfma_f32_16x16x32_bf16 v[120:123], a[108:111], v[168:171], v[120:123]
  buffer_load_dwordx4 v[168:171], v28, s[40:43], s80 offen sc1
  s_waitcnt vmcnt(11)
  v_mfma_f32_16x16x32_bf16 v[124:127], a[80:83], v[172:175], v[124:127]
  v_mfma_f32_16x16x32_bf16 v[128:131], a[84:87], v[172:175], v[128:131]
  v_mfma_f32_16x16x32_bf16 v[132:135], a[88:91], v[172:175], v[132:135]
  v_mfma_f32_16x16x32_bf16 v[136:139], a[92:95], v[172:175], v[136:139]
  v_mfma_f32_16x16x32_bf16 v[140:143], a[108:111], v[172:175], v[140:143]
  buffer_load_dwordx4 v[172:175], v29, s[40:43], s80 offen sc1
  s_waitcnt vmcnt(11)
  v_mfma_f32_16x16x32_bf16 v[64:67], a[80:83], v[160:163], v[64:67]
  v_mfma_f32_16x16x32_bf16 v[68:71], a[84:87], v[160:163], v[68:71]
  v_mfma_f32_16x16x32_bf16 v[72:75], a[88:91], v[160:163], v[72:75]
  v_mfma_f32_16x16x32_bf16 v[76:79], a[92:95], v[160:163], v[76:79]
  v_mfma_f32_16x16x32_bf16 v[80:83], a[108:111], v[160:163], v[80:83]
  buffer_load_dwordx4 v[160:163], v26, s[40:43], s80 offen sc1
  s_add_u32 s80, s80, 16384
  s_waitcnt vmcnt(11)
  v_mfma_f32_16x16x32_bf16 v[84:87], a[112:115], v[180:183], v[84:87]
  ds_read_b128 a[80:83], v2 offset:40960
  v_mfma_f32_16x16x32_bf16 v[88:91], a[116:119], v[180:183], v[88:91]
  ds_read_b128 a[84:87], v2 offset:41984
  v_mfma_f32_16x16x32_bf16 v[92:95], a[0:3], v[180:183], v[92:95]
  ds_read_b128 a[88:91], v2 offset:43008
  v_mfma_f32_16x16x32_bf16 v[96:99], a[4:7], v[180:183], v[96:99]
  ds_read_b128 a[92:95], v2 offset:44032
  v_mfma_f32_16x16x32_bf16 v[100:103], a[8:11], v[180:183], v[100:103]
  ds_read_b128 a[108:111], v2 offset:45056
  buffer_load_dwordx4 v[180:183], v27, s[40:43], s80 offen sc1
  s_waitcnt vmcnt(11)
  v_mfma_f32_16x16x32_bf16 v[104:107], a[112:115], v[184:187], v[104:107]
  v_mfma_f32_16x16x32_bf16 v[108:111], a[116:119], v[184:187], v[108:111]
  v_mfma_f32_16x16x32_bf16 v[112:115], a[0:3], v[184:187], v[112:115]
  v_mfma_f32_16x16x32_bf16 v[116:119], a[4:7], v[184:187], v[116:119]
  v_mfma_f32_16x16x32_bf16 v[120:123], a[8:11], v[184:187], v[120:123]
  buffer_load_dwordx4 v[184:187], v28, s[40:43], s80 offen sc1
  s_waitcnt vmcnt(11)
  v_mfma_f32_16x16x32_bf16 v[124:127], a[112:115], v[188:191], v[124:127]
  v_mfma_f32_16x16x32_bf16 v[128:131], a[116:119], v[188:191], v[128:131]
  v_mfma_f32_16x16x32_bf16 v[132:135], a[0:3], v[188:191], v[132:135]
  v_mfma_f32_16x16x32_bf16 v[136:139], a[4:7], v[188:191], v[136:139]
  v_mfma_f32_16x16x32_bf16 v[140:143], a[8:11], v[188:191], v[140:143]
  buffer_load_dwordx4 v[188:191], v29, s[40:43], s80 offen sc1
  s_waitcnt vmcnt(11)
  v_mfma_f32_16x16x32_bf16 v[64:67], a[112:115], v[176:179], v[64:67]
  v_mfma_f32_16x16x32_bf16 v[68:71], a[116:119], v[176:179], v[68:71]
  v_mfma_f32_16x16x32_bf16 v[72:75], a[0:3], v[176:179], v[72:75]
  v_mfma_f32_16x16x32_bf16 v[76:79], a[4:7], v[176:179], v[76:79]
  v_mfma_f32_16x16x32_bf16 v[80:83], a[8:11], v[176:179], v[80:83]
  buffer_load_dwordx4 v[176:179], v26, s[40:43], s80 offen sc1
  s_add_u32 s80, s80, 16384
  s_waitcnt vmcnt(11)
  v_mfma_f32_16x16x32_bf16 v[84:87], a[12:15], v[148:151], v[84:87]
  ds_read_b128 a[112:115], v2 offset:46080
  v_mfma_f32_16x16x32_bf16 v[88:91], a[16:19], v[148:151], v[88:91]
  ds_read_b128 a[116:119], v2 offset:47104
  v_mfma_f32_16x16x32_bf16 v[92:95], a[20:23], v[148:151], v[92:95]
  ds_read_b128 a[0:3], v2 offset:48128
  v_mfma_f32_16x16x32_bf16 v[96:99], a[24:27], v[148:151], v[96:99]
  ds_read_b128 a[4:7], v2 offset:49152
  v_mfma_f32_16x16x32_bf16 v[100:103], a[28:31], v[148:151], v[100:103]
  ds_read_b128 a[8:11], v2 offset:50176
  buffer_load_dwordx4 v[148:151], v27, s[40:43], s80 offen sc1
  s_waitcnt vmcnt(11)
  v_mfma_f32_16x16x32_bf16 v[104:107], a[12:15], v[152:155], v[104:107]
  v_mfma_f32_16x16x32_bf16 v[108:111], a[16:19], v[152:155], v[108:111]
  v_mfma_f32_16x16x32_bf16 v[112:115], a[20:23], v[152:155], v[112:115]
  v_mfma_f32_16x16x32_bf16 v[116:119], a[24:27], v[152:155], v[116:119]
  v_mfma_f32_16x16x32_bf16 v[120:123], a[28:31], v[152:155], v[120:123]
  buffer_load_dwordx4 v[152:155], v28, s[40:43], s80 offen sc1
  s_waitcnt vmcnt(11)
  v_mfma_f32_16x16x32_bf16 v[124:127], a[12:15], v[156:159], v[124:127]
  v_mfma_f32_16x16x32_bf16 v[128:131], a[16:19], v[156:159], v[128:131]
  v_mfma_f32_16x16x32_bf16 v[132:135], a[20:23], v[156:159], v[132:135]
  v_mfma_f32_16x16x32_bf16 v[136:139], a[24:27], v[156:159], v[136:139]
  v_mfma_f32_16x16x32_bf16 v[140:143], a[28:31], v[156:159], v[140:143]
  buffer_load_dwordx4 v[156:159], v29, s[40:43], s80 offen sc1
  s_waitcnt vmcnt(11)
  v_mfma_f32_16x16x32_bf16 v[64:67], a[12:15], v[144:147], v[64:67]
  v_mfma_f32_16x16x32_bf16 v[68:71], a[16:19], v[144:147], v[68:71]
  v_mfma_f32_16x16x32_bf16 v[72:75], a[20:23], v[144:147], v[72:75]
  v_mov_b32 v4, s82
  s_cmp_lg_u32 s32, 0
  s_cbranch_scc1 Lp0_46
  global_load_dword v31, v4, s[90:91] sc1
  s_branch Lp1_47
Lp0_46:
  v_mov_b32 v4, 0
  global_load_dword v31, v4, s[8:9]
Lp1_47:
  v_mfma_f32_16x16x32_bf16 v[76:79], a[24:27], v[144:147], v[76:79]
  v_mfma_f32_16x16x32_bf16 v[80:83], a[28:31], v[144:147], v[80:83]
  buffer_load_dwordx4 v[144:147], v26, s[40:43], s80 offen sc1
  s_add_u32 s80, s80, 16384
  s_waitcnt vmcnt(12)
  s_nop 0
  v_mfma_f32_16x16x32_bf16 v[84:87], a[32:35], v[164:167], v[84:87]
  ds_read_b128 a[12:15], v9 offset:0
  v_mfma_f32_16x16x32_bf16 v[88:91], a[36:39], v[164:167], v[88:91]
  ds_read_b128 a[16:19], v9 offset:1024
  v_mfma_f32_16x16x32_bf16 v[92:95], a[40:43], v[164:167], v[92:95]
  ds_read_b128 a[20:23], v9 offset:2048
  v_mfma_f32_16x16x32_bf16 v[96:99], a[44:47], v[164:167], v[96:99]
  ds_read_b128 a[24:27], v9 offset:3072
  v_mfma_f32_16x16x32_bf16 v[100:103], a[96:99], v[164:167], v[100:103]
  ds_read_b128 a[28:31], v9 offset:4096
  s_waitcnt vmcnt(8)
  v_mfma_f32_16x16x32_bf16 v[84:87], a[100:103], v[180:183], v[84:87]
  v_mfma_f32_16x16x32_bf16 v[88:91], a[104:107], v[180:183], v[88:91]
  v_mfma_f32_16x16x32_bf16 v[92:95], v[32:35], v[180:183], v[92:95]
  v_mfma_f32_16x16x32_bf16 v[96:99], v[36:39], v[180:183], v[96:99]
  v_mfma_f32_16x16x32_bf16 v[100:103], v[40:43], v[180:183], v[100:103]
  s_waitcnt vmcnt(4)
  v_mfma_f32_16x16x32_bf16 v[84:87], v[44:47], v[148:151], v[84:87]
  v_mfma_f32_16x16x32_bf16 v[88:91], v[48:51], v[148:151], v[88:91]
  v_mfma_f32_16x16x32_bf16 v[92:95], v[52:55], v[148:151], v[92:95]
  v_mfma_f32_16x16x32_bf16 v[96:99], v[56:59], v[148:151], v[96:99]
  v_mfma_f32_16x16x32_bf16 v[100:103], v[60:63], v[148:151], v[100:103]
  v_mfma_f32_16x16x32_bf16 v[104:107], a[32:35], v[168:171], v[104:107]
  v_mfma_f32_16x16x32_bf16 v[108:111], a[36:39], v[168:171], v[108:111]
  v_mfma_f32_16x16x32_bf16 v[112:115], a[40:43], v[168:171], v[112:115]
  s_waitcnt vmcnt(1)
  s_cmp_lg_u32 s32, 0
  s_cbranch_scc1 Lpd_49
  v_cmp_gt_u32 vcc, 16, v31
  s_mov_b32 s95, 0x8000
  s_cmp_eq_u64 vcc, 0
  s_cbranch_scc1 Lpd_49
Lpoll_48:
  s_sleep 2
  global_load_dword v31, v4, s[90:91] sc1
  s_waitcnt vmcnt(0)
  v_cmp_gt_u32 vcc, 16, v31
  s_sub_u32 s95, s95, 1
  s_cmp_eq_u64 vcc, 0
  s_cbranch_scc1 Lpd_49
  s_cmp_lg_u32 s95, 0
  s_cbranch_scc1 Lpoll_48
Lpd_49:
  s_barrier
  s_nop 0
  buffer_load_dword v5, v6, s[48:51], s74 offen sc1
  buffer_load_dwordx4 v[192:195], v26, s[40:43], s73 offen sc1
  s_add_u32 s73, s73, 4096
  buffer_load_dwordx4 v[196:199], v26, s[40:43], s73 offen sc1
  s_add_u32 s73, s73, 4096
  buffer_load_dwordx4 v[200:203], v26, s[40:43], s73 offen sc1
  s_add_u32 s73, s73, 4096
  buffer_load_dwordx4 v[204:207], v26, s[40:43], s73 offen sc1
  s_add_u32 s73, s73, 4096
  buffer_load_dwordx4 v[208:211], v26, s[40:43], s73 offen sc1
  s_add_u32 s73, s73, 4096
  buffer_load_dwordx4 v[212:215], v26, s[40:43], s73 offen sc1
  v_mfma_f32_16x16x32_bf16 v[116:119], a[44:47], v[168:171], v[116:119]
  ds_write_b128 v11, v[84:87] offset:0
  s_add_u32 s73, s73, 4096
  buffer_load_dwordx4 v[216:219], v26, s[40:43], s73 offen sc1
  v_mfma_f32_16x16x32_bf16 v[120:123], a[96:99], v[168:171], v[120:123]
  ds_write_b128 v11, v[88:91] offset:1024
  v_mfma_f32_16x16x32_bf16 v[104:107], a[100:103], v[184:187], v[104:107]
  ds_write_b128 v11, v[92:95] offset:2048
  v_mfma_f32_16x16x32_bf16 v[108:111], a[104:107], v[184:187], v[108:111]
  ds_write_b128 v11, v[96:99] offset:3072
  s_add_u32 s73, s73, 4096
  buffer_load_dwordx4 v[220:223], v26, s[40:43], s73 offen sc1
  v_mfma_f32_16x16x32_bf16 v[112:115], v[32:35], v[184:187], v[112:115]
  ds_write_b128 v11, v[100:103] offset:4096
  v_mfma_f32_16x16x32_bf16 v[116:119], v[36:39], v[184:187], v[116:119]
  s_add_u32 s73, s73, 4096
  buffer_load_dwordx4 v[224:227], v26, s[40:43], s73 offen sc1
  v_mfma_f32_16x16x32_bf16 v[120:123], v[40:43], v[184:187], v[120:123]
  v_mfma_f32_16x16x32_bf16 v[104:107], v[44:47], v[152:155], v[104:107]
  v_mfma_f32_16x16x32_bf16 v[108:111], v[48:51], v[152:155], v[108:111]
  s_add_u32 s73, s73, 4096
  buffer_load_dwordx4 v[228:231], v26, s[40:43], s73 offen sc1
  v_mfma_f32_16x16x32_bf16 v[112:115], v[52:55], v[152:155], v[112:115]
  v_mfma_f32_16x16x32_bf16 v[116:119], v[56:59], v[152:155], v[116:119]
  s_add_u32 s73, s73, 4096
  buffer_load_dwordx4 v[232:235], v26, s[40:43], s73 offen sc1
  v_mfma_f32_16x16x32_bf16 v[120:123], v[60:63], v[152:155], v[120:123]
  v_mfma_f32_16x16x32_bf16 v[124:127], a[32:35], v[172:175], v[124:127]
  v_mfma_f32_16x16x32_bf16 v[128:131], a[36:39], v[172:175], v[128:131]
  s_add_u32 s73, s73, 4096
  buffer_load_dwordx4 v[236:239], v26, s[40:43], s73 offen sc1
  v_mfma_f32_16x16x32_bf16 v[132:135], a[40:43], v[172:175], v[132:135]
  v_mfma_f32_16x16x32_bf16 v[136:139], a[44:47], v[172:175], v[136:139]
  ds_write_b128 v12, v[104:107] offset:0
  s_add_u32 s73, s73, 4096
  buffer_load_dwordx4 v[240:243], v26, s[40:43], s73 offen sc1
  v_mfma_f32_16x16x32_bf16 v[140:143], a[96:99], v[172:175], v[140:143]
  ds_write_b128 v12, v[108:111] offset:1024
  v_mfma_f32_16x16x32_bf16 v[124:127], a[100:103], v[188:191], v[124:127]
  ds_write_b128 v12, v[112:115] offset:2048
  v_mfma_f32_16x16x32_bf16 v[128:131], a[104:107], v[188:191], v[128:131]
  ds_write_b128 v12, v[116:119] offset:3072
  s_add_u32 s73, s73, 4096
  buffer_load_dwordx4 v[244:247], v26, s[40:43], s73 offen sc1
  v_mfma_f32_16x16x32_bf16 v[132:135], v[32:35], v[188:191], v[132:135]
  ds_write_b128 v12, v[120:123] offset:4096
  v_mfma_f32_16x16x32_bf16 v[136:139], v[36:39], v[188:191], v[136:139]
  s_add_u32 s73, s73, 4096
  buffer_load_dwordx4 v[248:251], v26, s[40:43], s73 offen sc1
  v_mfma_f32_16x16x32_bf16 v[140:143], v[40:43], v[188:191], v[140:143]
  v_mfma_f32_16x16x32_bf16 v[124:127], v[44:47], v[156:159], v[124:127]
  v_mfma_f32_16x16x32_bf16 v[128:131], v[48:51], v[156:159], v[128:131]
  s_add_u32 s73, s73, 4096
  buffer_load_dwordx4 v[252:255], v26, s[40:43], s73 offen sc1
  v_mfma_f32_16x16x32_bf16 v[132:135], v[52:55], v[156:159], v[132:135]
  v_mfma_f32_16x16x32_bf16 v[136:139], v[56:59], v[156:159], v[136:139]
  v_mfma_f32_16x16x32_bf16 v[140:143], v[60:63], v[156:159], v[140:143]
  v_mfma_f32_16x16x32_bf16 v[64:67], a[32:35], v[160:163], v[64:67]
  v_mfma_f32_16x16x32_bf16 v[68:71], a[36:39], v[160:163], v[68:71]
  v_mfma_f32_16x16x32_bf16 v[72:75], a[40:43], v[160:163], v[72:75]
  v_mfma_f32_16x16x32_bf16 v[76:79], a[44:47], v[160:163], v[76:79]
  ds_write_b128 v13, v[124:127] offset:0
  v_mfma_f32_16x16x32_bf16 v[80:83], a[96:99], v[160:163], v[80:83]
  ds_write_b128 v13, v[128:131] offset:1024
  v_mfma_f32_16x16x32_bf16 v[64:67], a[100:103], v[176:179], v[64:67]
  ds_write_b128 v13, v[132:135] offset:2048
  v_mfma_f32_16x16x32_bf16 v[68:71], a[104:107], v[176:179], v[68:71]
  ds_write_b128 v13, v[136:139] offset:3072
  v_mfma_f32_16x16x32_bf16 v[72:75], v[32:35], v[176:179], v[72:75]
  ds_write_b128 v13, v[140:143] offset:4096
  v_mfma_f32_16x16x32_bf16 v[76:79], v[36:39], v[176:179], v[76:79]
  v_mfma_f32_16x16x32_bf16 v[80:83], v[40:43], v[176:179], v[80:83]
  s_waitcnt vmcnt(17)
  s_nop 0
  v_mfma_f32_16x16x32_bf16 v[64:67], v[44:47], v[144:147], v[64:67]
  v_mfma_f32_16x16x32_bf16 v[68:71], v[48:51], v[144:147], v[68:71]
  v_mfma_f32_16x16x32_bf16 v[72:75], v[52:55], v[144:147], v[72:75]
  v_mfma_f32_16x16x32_bf16 v[76:79], v[56:59], v[144:147], v[76:79]
  v_mfma_f32_16x16x32_bf16 v[80:83], v[60:63], v[144:147], v[80:83]
  s_add_u32 s73, s73, 4096
  buffer_load_dwordx4 v[148:151], v26, s[40:43], s73 offen sc1
  s_add_u32 s73, s73, 4096
  buffer_load_dwordx4 v[164:167], v26, s[40:43], s73 offen sc1
  s_add_u32 s73, s73, 4096
  buffer_load_dwordx4 v[180:183], v26, s[40:43], s73 offen sc1
  s_add_u32 s73, s73, 4096
  buffer_load_dwordx4 v[152:155], v26, s[40:43], s73 offen sc1
  s_waitcnt vmcnt(20)
  v_sub_f32 v10, 1.0, v5
  v_pk_mul_f32 v[64:65], v[64:65], v[10:11] op_sel_hi:[1,0]
  v_pk_mul_f32 v[66:67], v[66:67], v[10:11] op_sel_hi:[1,0]
  v_pk_mul_f32 v[68:69], v[68:69], v[10:11] op_sel_hi:[1,0]
  v_pk_mul_f32 v[70:71], v[70:71], v[10:11] op_sel_hi:[1,0]
  v_pk_mul_f32 v[72:73], v[72:73], v[10:11] op_sel_hi:[1,0]
  v_pk_mul_f32 v[74:75], v[74:75], v[10:11] op_sel_hi:[1,0]
  v_pk_mul_f32 v[76:77], v[76:77], v[10:11] op_sel_hi:[1,0]
  v_pk_mul_f32 v[78:79], v[78:79], v[10:11] op_sel_hi:[1,0]
  v_pk_mul_f32 v[80:81], v[80:81], v[10:11] op_sel_hi:[1,0]
  v_pk_mul_f32 v[82:83], v[82:83], v[10:11] op_sel_hi:[1,0]
  s_waitcnt lgkmcnt(0)
  s_barrier
  s_waitcnt vmcnt(19)
  s_nop 0
  v_mfma_f32_16x16x32_bf16 v[64:67], a[128:131], v[192:195], v[64:67]
  ds_read_b128 a[32:35], v9 offset:5120
  v_mfma_f32_16x16x32_bf16 v[68:71], a[132:135], v[192:195], v[68:71]
  ds_read_b128 a[36:39], v9 offset:6144
  v_mfma_f32_16x16x32_bf16 v[72:75], a[136:139], v[192:195], v[72:75]
  ds_read_b128 a[40:43], v9 offset:7168
  v_mfma_f32_16x16x32_bf16 v[76:79], a[140:143], v[192:195], v[76:79]
  ds_read_b128 a[44:47], v9 offset:8192
  v_mfma_f32_16x16x32_bf16 v[80:83], a[144:147], v[192:195], v[80:83]
  ds_read_b128 a[96:99], v9 offset:9216
  s_waitcnt vmcnt(18)
  s_nop 0
  v_mfma_f32_16x16x32_bf16 v[64:67], a[148:151], v[196:199], v[64:67]
  ds_read_b128 a[100:103], v9 offset:10240
  v_mfma_f32_16x16x32_bf16 v[68:71], a[152:155], v[196:199], v[68:71]
  ds_read_b128 a[104:107], v9 offset:11264
  v_mfma_f32_16x16x32_bf16 v[72:75], a[156:159], v[196:199], v[72:75]
  ds_read_b128 v[32:35], v9 offset:12288
  v_mfma_f32_16x16x32_bf16 v[76:79], a[160:163], v[196:199], v[76:79]
  ds_read_b128 v[36:39], v9 offset:13312
  v_mfma_f32_16x16x32_bf16 v[80:83], a[164:167], v[196:199], v[80:83]
  ds_read_b128 v[40:43], v9 offset:14336
  s_waitcnt vmcnt(17)
  s_nop 0
  v_mfma_f32_16x16x32_bf16 v[64:67], a[168:171], v[200:203], v[64:67]
  ds_read_b128 v[44:47], v9 offset:15360
  v_mfma_f32_16x16x32_bf16 v[68:71], a[172:175], v[200:203], v[68:71]
  ds_read_b128 v[48:51], v9 offset:16384
  v_mfma_f32_16x16x32_bf16 v[72:75], a[176:179], v[200:203], v[72:75]
  ds_read_b128 v[52:55], v9 offset:17408
  v_mfma_f32_16x16x32_bf16 v[76:79], a[180:183], v[200:203], v[76:79]
  ds_read_b128 v[56:59], v9 offset:18432
  v_mfma_f32_16x16x32_bf16 v[80:83], a[184:187], v[200:203], v[80:83]
  ds_read_b128 v[60:63], v9 offset:19456
  s_waitcnt vmcnt(16)
  s_nop 0
  v_mfma_f32_16x16x32_bf16 v[64:67], a[188:191], v[204:207], v[64:67]
  ds_read_b128 a[128:131], v9 offset:20480
  v_mfma_f32_16x16x32_bf16 v[68:71], a[192:195], v[204:207], v[68:71]
  ds_read_b128 a[132:135], v9 offset:21504
  v_mfma_f32_16x16x32_bf16 v[72:75], a[196:199], v[204:207], v[72:75]
  ds_read_b128 a[136:139], v9 offset:22528
  v_mfma_f32_16x16x32_bf16 v[76:79], a[200:203], v[204:207], v[76:79]
  ds_read_b128 a[140:143], v9 offset:23552
  v_mfma_f32_16x16x32_bf16 v[80:83], a[204:207], v[204:207], v[80:83]
  ds_read_b128 a[144:147], v9 offset:24576
  s_waitcnt vmcnt(15)
  s_nop 0
  v_mfma_f32_16x16x32_bf16 v[64:67], a[208:211], v[208:211], v[64:67]
  ds_read_b128 a[148:151], v9 offset:25600
  v_mfma_f32_16x16x32_bf16 v[68:71], a[212:215], v[208:211], v[68:71]
  ds_read_b128 a[152:155], v9 offset:26624
  v_mfma_f32_16x16x32_bf16 v[72:75], a[216:219], v[208:211], v[72:75]
  ds_read_b128 a[156:159], v9 offset:27648
  v_mfma_f32_16x16x32_bf16 v[76:79], a[220:223], v[208:211], v[76:79]
  ds_read_b128 a[160:163], v9 offset:28672
  v_mfma_f32_16x16x32_bf16 v[80:83], a[224:227], v[208:211], v[80:83]
  ds_read_b128 a[164:167], v9 offset:29696
  s_waitcnt vmcnt(14)
  s_nop 0
  v_mfma_f32_16x16x32_bf16 v[64:67], a[228:231], v[212:215], v[64:67]
  ds_read_b128 a[168:171], v9 offset:30720
  v_mfma_f32_16x16x32_bf16 v[68:71], a[232:235], v[212:215], v[68:71]
  ds_read_b128 a[172:175], v9 offset:31744
  v_mfma_f32_16x16x32_bf16 v[72:75], a[236:239], v[212:215], v[72:75]
  ds_read_b128 a[176:179], v9 offset:32768
  v_mfma_f32_16x16x32_bf16 v[76:79], a[240:243], v[212:215], v[76:79]
  ds_read_b128 a[180:183], v9 offset:33792
  v_mfma_f32_16x16x32_bf16 v[80:83], a[244:247], v[212:215], v[80:83]
  ds_read_b128 a[184:187], v9 offset:34816
  s_waitcnt vmcnt(13)
  s_nop 0
  v_mfma_f32_16x16x32_bf16 v[64:67], a[248:251], v[216:219], v[64:67]
  ds_read_b128 a[188:191], v9 offset:35840
  v_mfma_f32_16x16x32_bf16 v[68:71], a[252:255], v[216:219], v[68:71]
  ds_read_b128 a[192:195], v9 offset:36864
  v_mfma_f32_16x16x32_bf16 v[72:75], a[48:51], v[216:219], v[72:75]
  ds_read_b128 a[196:199], v9 offset:37888
  v_mfma_f32_16x16x32_bf16 v[76:79], a[52:55], v[216:219], v[76:79]
  ds_read_b128 a[200:203], v9 offset:38912
  v_mfma_f32_16x16x32_bf16 v[80:83], a[56:59], v[216:219], v[80:83]
  ds_read_b128 a[204:207], v9 offset:39936
  s_waitcnt vmcnt(12)
  s_nop 0
  v_mfma_f32_16x16x32_bf16 v[64:67], a[60:63], v[220:223], v[64:67]
  ds_read_b128 a[208:211], v9 offset:40960
  v_mfma_f32_16x16x32_bf16 v[68:71], a[64:67], v[220:223], v[68:71]
  ds_read_b128 a[212:215], v9 offset:41984
  v_mfma_f32_16x16x32_bf16 v[72:75], a[68:71], v[220:223], v[72:75]
  ds_read_b128 a[216:219], v9 offset:43008
  v_mfma_f32_16x16x32_bf16 v[76:79], a[72:75], v[220:223], v[76:79]
  ds_read_b128 a[220:223], v9 offset:44032
  v_mfma_f32_16x16x32_bf16 v[80:83], a[76:79], v[220:223], v[80:83]
  ds_read_b128 a[224:227], v9 offset:45056
  s_waitcnt vmcnt(11)
  s_nop 0
  v_mfma_f32_16x16x32_bf16 v[64:67], a[80:83], v[224:227], v[64:67]
  ds_read_b128 a[228:231], v9 offset:46080
  v_mfma_f32_16x16x32_bf16 v[68:71], a[84:87], v[224:227], v[68:71]
  ds_read_b128 a[232:235], v9 offset:47104
  v_mfma_f32_16x16x32_bf16 v[72:75], a[88:91], v[224:227], v[72:75]
  ds_read_b128 a[236:239], v9 offset:48128
  v_mfma_f32_16x16x32_bf16 v[76:79], a[92:95], v[224:227], v[76:79]
  ds_read_b128 a[240:243], v9 offset:49152
  v_mfma_f32_16x16x32_bf16 v[80:83], a[108:111], v[224:227], v[80:83]
  ds_read_b128 a[244:247], v9 offset:50176
  s_waitcnt vmcnt(10)
  s_nop 0
  v_mfma_f32_16x16x32_bf16 v[64:67], a[112:115], v[228:231], v[64:67]
  ds_read_b128 v[84:87], v8 offset:0
  v_mfma_f32_16x16x32_bf16 v[68:71], a[116:119], v[228:231], v[68:71]
  ds_read_b128 v[88:91], v8 offset:1024
  v_mfma_f32_16x16x32_bf16 v[72:75], a[0:3], v[228:231], v[72:75]
  ds_read_b128 v[92:95], v8 offset:2048
  v_mfma_f32_16x16x32_bf16 v[76:79], a[4:7], v[228:231], v[76:79]
  ds_read_b128 v[96:99], v8 offset:3072
  v_mfma_f32_16x16x32_bf16 v[80:83], a[8:11], v[228:231], v[80:83]
  ds_read_b128 v[100:103], v8 offset:4096
  s_waitcnt vmcnt(9)
  s_nop 0
  v_mfma_f32_16x16x32_bf16 v[64:67], a[12:15], v[232:235], v[64:67]
  ds_read_b128 v[104:107], v8 offset:5120
  v_mfma_f32_16x16x32_bf16 v[68:71], a[16:19], v[232:235], v[68:71]
  ds_read_b128 v[108:111], v8 offset:6144
  v_mfma_f32_16x16x32_bf16 v[72:75], a[20:23], v[232:235], v[72:75]
  ds_read_b128 v[112:115], v8 offset:7168
  v_mfma_f32_16x16x32_bf16 v[76:79], a[24:27], v[232:235], v[76:79]
  ds_read_b128 v[116:119], v8 offset:8192
  v_mfma_f32_16x16x32_bf16 v[80:83], a[28:31], v[232:235], v[80:83]
  ds_read_b128 v[120:123], v8 offset:9216
  s_waitcnt vmcnt(8) lgkmcnt(14)
  s_nop 0
  v_mfma_f32_16x16x32_bf16 v[64:67], a[32:35], v[236:239], v[64:67]
  ds_read_b128 v[124:127], v8 offset:10240
  v_mfma_f32_16x16x32_bf16 v[68:71], a[36:39], v[236:239], v[68:71]
  ds_read_b128 v[128:131], v8 offset:11264
  v_mfma_f32_16x16x32_bf16 v[72:75], a[40:43], v[236:239], v[72:75]
  ds_read_b128 v[132:135], v8 offset:12288
  v_mfma_f32_16x16x32_bf16 v[76:79], a[44:47], v[236:239], v[76:79]
  ds_read_b128 v[136:139], v8 offset:13312
  v_mfma_f32_16x16x32_bf16 v[80:83], a[96:99], v[236:239], v[80:83]
  ds_read_b128 v[140:143], v8 offset:14336
  s_waitcnt vmcnt(7)
  v_mfma_f32_16x16x32_bf16 v[64:67], a[100:103], v[240:243], v[64:67]
  v_mfma_f32_16x16x32_bf16 v[68:71], a[104:107], v[240:243], v[68:71]
  v_mfma_f32_16x16x32_bf16 v[72:75], v[32:35], v[240:243], v[72:75]
  v_mfma_f32_16x16x32_bf16 v[76:79], v[36:39], v[240:243], v[76:79]
  v_mfma_f32_16x16x32_bf16 v[80:83], v[40:43], v[240:243], v[80:83]
  s_waitcnt vmcnt(6)
  v_mfma_f32_16x16x32_bf16 v[64:67], v[44:47], v[244:247], v[64:67]
  v_mfma_f32_16x16x32_bf16 v[68:71], v[48:51], v[244:247], v[68:71]
  v_mfma_f32_16x16x32_bf16 v[72:75], v[52:55], v[244:247], v[72:75]
  v_mfma_f32_16x16x32_bf16 v[76:79], v[56:59], v[244:247], v[76:79]
  v_mfma_f32_16x16x32_bf16 v[80:83], v[60:63], v[244:247], v[80:83]
  s_waitcnt vmcnt(5)
  v_mfma_f32_16x16x32_bf16 v[64:67], a[128:131], v[248:251], v[64:67]
  v_mfma_f32_16x16x32_bf16 v[68:71], a[132:135], v[248:251], v[68:71]
  v_mfma_f32_16x16x32_bf16 v[72:75], a[136:139], v[248:251], v[72:75]
  v_mfma_f32_16x16x32_bf16 v[76:79], a[140:143], v[248:251], v[76:79]
  v_mfma_f32_16x16x32_bf16 v[80:83], a[144:147], v[248:251], v[80:83]
  s_waitcnt vmcnt(4)
  v_mfma_f32_16x16x32_bf16 v[64:67], a[148:151], v[252:255], v[64:67]
  v_mfma_f32_16x16x32_bf16 v[68:71], a[152:155], v[252:255], v[68:71]
  v_mfma_f32_16x16x32_bf16 v[72:75], a[156:159], v[252:255], v[72:75]
  v_mfma_f32_16x16x32_bf16 v[76:79], a[160:163], v[252:255], v[76:79]
  v_mfma_f32_16x16x32_bf16 v[80:83], a[164:167], v[252:255], v[80:83]
  s_waitcnt vmcnt(3)
  v_mfma_f32_16x16x32_bf16 v[64:67], a[168:171], v[148:151], v[64:67]
  v_mfma_f32_16x16x32_bf16 v[68:71], a[172:175], v[148:151], v[68:71]
  v_mfma_f32_16x16x32_bf16 v[72:75], a[176:179], v[148:151], v[72:75]
  v_mfma_f32_16x16x32_bf16 v[76:79], a[180:183], v[148:151], v[76:79]
  v_mfma_f32_16x16x32_bf16 v[80:83], a[184:187], v[148:151], v[80:83]
  s_waitcnt vmcnt(2)
  v_mfma_f32_16x16x32_bf16 v[64:67], a[188:191], v[164:167], v[64:67]
  v_mfma_f32_16x16x32_bf16 v[68:71], a[192:195], v[164:167], v[68:71]
  v_mfma_f32_16x16x32_bf16 v[72:75], a[196:199], v[164:167], v[72:75]
  v_mfma_f32_16x16x32_bf16 v[76:79], a[200:203], v[164:167], v[76:79]
  v_mfma_f32_16x16x32_bf16 v[80:83], a[204:207], v[164:167], v[80:83]
  s_waitcnt vmcnt(1)
  v_mfma_f32_16x16x32_bf16 v[64:67], a[208:211], v[180:183], v[64:67]
  v_mfma_f32_16x16x32_bf16 v[68:71], a[212:215], v[180:183], v[68:71]
  v_mfma_f32_16x16x32_bf16 v[72:75], a[216:219], v[180:183], v[72:75]
  v_mfma_f32_16x16x32_bf16 v[76:79], a[220:223], v[180:183], v[76:79]
  v_mfma_f32_16x16x32_bf16 v[80:83], a[224:227], v[180:183], v[80:83]
  s_waitcnt vmcnt(0) lgkmcnt(14)
  v_mfma_f32_16x16x32_bf16 v[64:67], a[228:231], v[152:155], v[64:67]
  v_mfma_f32_16x16x32_bf16 v[68:71], a[232:235], v[152:155], v[68:71]
  v_mfma_f32_16x16x32_bf16 v[72:75], a[236:239], v[152:155], v[72:75]
  v_mfma_f32_16x16x32_bf16 v[76:79], a[240:243], v[152:155], v[76:79]
  v_mfma_f32_16x16x32_bf16 v[80:83], a[244:247], v[152:155], v[80:83]
  s_waitcnt lgkmcnt(0)
  s_nop 0
  v_pk_add_f32 v[84:85], v[84:85], v[104:105]
  v_pk_add_f32 v[86:87], v[86:87], v[106:107]
  v_pk_add_f32 v[88:89], v[88:89], v[108:109]
  v_pk_add_f32 v[90:91], v[90:91], v[110:111]
  v_pk_add_f32 v[92:93], v[92:93], v[112:113]
  v_pk_add_f32 v[94:95], v[94:95], v[114:115]
  v_pk_add_f32 v[96:97], v[96:97], v[116:117]
  v_pk_add_f32 v[98:99], v[98:99], v[118:119]
  v_pk_add_f32 v[100:101], v[100:101], v[120:121]
  v_pk_add_f32 v[102:103], v[102:103], v[122:123]
  v_pk_add_f32 v[84:85], v[84:85], v[124:125]
  v_pk_add_f32 v[86:87], v[86:87], v[126:127]
  v_pk_add_f32 v[88:89], v[88:89], v[128:129]
  v_pk_add_f32 v[90:91], v[90:91], v[130:131]
  v_pk_add_f32 v[92:93], v[92:93], v[132:133]
  v_pk_add_f32 v[94:95], v[94:95], v[134:135]
  v_pk_add_f32 v[96:97], v[96:97], v[136:137]
  v_pk_add_f32 v[98:99], v[98:99], v[138:139]
  v_pk_add_f32 v[100:101], v[100:101], v[140:141]
  v_pk_add_f32 v[102:103], v[102:103], v[142:143]
  v_pk_fma_f32 v[64:65], v[84:85], v[10:11], v[64:65] op_sel_hi:[1,0,1]
  v_pk_fma_f32 v[66:67], v[86:87], v[10:11], v[66:67] op_sel_hi:[1,0,1]
  v_cvt_pk_bf16_f32 v104, v64, v65
  v_cvt_pk_bf16_f32 v105, v66, v67
  ds_write_b64 v17, v[104:105] offset:0
  v_pk_fma_f32 v[68:69], v[88:89], v[10:11], v[68:69] op_sel_hi:[1,0,1]
  v_pk_fma_f32 v[70:71], v[90:91], v[10:11], v[70:71] op_sel_hi:[1,0,1]
  v_cvt_pk_bf16_f32 v106, v68, v69
  v_cvt_pk_bf16_f32 v107, v70, v71
  ds_write_b64 v17, v[106:107] offset:32
  v_pk_fma_f32 v[72:73], v[92:93], v[10:11], v[72:73] op_sel_hi:[1,0,1]
  v_pk_fma_f32 v[74:75], v[94:95], v[10:11], v[74:75] op_sel_hi:[1,0,1]
  v_cvt_pk_bf16_f32 v108, v72, v73
  v_cvt_pk_bf16_f32 v109, v74, v75
  ds_write_b64 v17, v[108:109] offset:64
  v_pk_fma_f32 v[76:77], v[96:97], v[10:11], v[76:77] op_sel_hi:[1,0,1]
  v_pk_fma_f32 v[78:79], v[98:99], v[10:11], v[78:79] op_sel_hi:[1,0,1]
  v_cvt_pk_bf16_f32 v110, v76, v77
  v_cvt_pk_bf16_f32 v111, v78, v79
  ds_write_b64 v17, v[110:111] offset:96
  v_pk_fma_f32 v[80:81], v[100:101], v[10:11], v[80:81] op_sel_hi:[1,0,1]
  v_pk_fma_f32 v[82:83], v[102:103], v[10:11], v[82:83] op_sel_hi:[1,0,1]
  v_cvt_pk_bf16_f32 v112, v80, v81
  v_cvt_pk_bf16_f32 v113, v82, v83
  ds_write_b64 v17, v[112:113] offset:128
  ds_read_b128 v[64:67], v18
  ds_read_b128 v[68:71], v19
  ds_read_b128 v[72:75], v20
  s_waitcnt lgkmcnt(2)
  buffer_store_dwordx4 v[64:67], v21, s[52:55], s81 offen sc1
  s_waitcnt lgkmcnt(1)
  buffer_store_dwordx4 v[68:71], v22, s[52:55], s81 offen sc1
  s_waitcnt lgkmcnt(0)
  buffer_store_dwordx4 v[72:75], v23, s[52:55], s81 offen sc1
  s_endpgm
L_qa:
  s_mov_b32 s36, 13
  s_mul_i32 s75, s64, 6
  s_add_u32 s75, s75, s65
  s_sub_u32 s75, s75, 26
  s_lshr_b32 s79, s64, 1
  s_mul_i32 s35, s79, 12
  s_sub_u32 s35, s75, s35
  s_add_u32 s69, s75, 32
  s_mul_i32 s69, s69, 4352
  s_lshl_b32 s75, s75, 2
  s_add_u32 s75, s75, s32
  s_mul_i32 s76, s75, 205
  s_lshr_b32 s76, s76, 11
  s_mul_i32 s77, s76, 10
  s_sub_u32 s77, s75, s77
  s_cmp_ge_u32 s76, 19
  s_cselect_b32 s78, 0x4000000, 0
  s_mul_i32 s80, s76, 40960
  s_lshl_b32 s81, s77, 7
  s_add_u32 s80, s80, s81
  s_add_u32 s80, s80, s78
  v_lshrrev_b32 v24, 3, v0
  v_and_b32 v25, 7, v0
  v_and_b32 v26, 6, v24
  v_xor_b32 v26, v26, v25
  v_lshlrev_b32 v26, 4, v26
  v_mul_u32_u24 v32, 1280, v24
  v_add_u32 v32, v32, v26
  v_lshrrev_b32 v27, 2, v24
  v_and_b32_e64 v28, 3, v24
  v_lshl_add_u32 v27, v27, 3, v28
  v_mul_u32_u24 v36, 1280, v27
  v_add_u32_e64 v36, v36, v26
  v_add_u32 v33, 10240, v32
  v_add_u32 v37, 20480, v36
  v_add_u32 v34, 20480, v32
  v_add_u32 v38, 5120, v36
  v_add_u32 v35, 30720, v32
  v_add_u32 v39, 25600, v36
  s_lshl_b32 s82, s32, 14
  s_add_u32 s82, s82, 98304
  s_waitcnt lgkmcnt(0)
  s_mov_b32 s48, s22
  s_and_b32 s49, s23, 0xffff
  s_mov_b32 s50, 0x21c000
  s_mov_b32 s51, 0x20000
  s_mov_b32 s44, s14
  s_and_b32 s45, s15, 0xffff
  s_mov_b32 s46, 0xc8000
  s_mov_b32 s47, 0x20000
  s_add_u32 s81, s80, 737280
  s_add_u32 m0, s82, 0
  s_nop 0
  buffer_load_dwordx4 v32, s[48:51], s81 offen nt lds
  s_add_u32 m0, s82, 1024
  s_nop 0
  buffer_load_dwordx4 v33, s[48:51], s81 offen nt lds
  s_add_u32 m0, s82, 2048
  s_nop 0
  buffer_load_dwordx4 v34, s[48:51], s81 offen nt lds
  s_add_u32 m0, s82, 3072
  s_nop 0
  buffer_load_dwordx4 v35, s[48:51], s81 offen nt lds
  s_add_u32 s81, s80, 1515520
  s_add_u32 m0, s82, 4096
  s_nop 0
  buffer_load_dwordx4 v32, s[48:51], s81 offen nt lds
  s_add_u32 m0, s82, 5120
  s_nop 0
  buffer_load_dwordx4 v33, s[48:51], s81 offen nt lds
  s_add_u32 m0, s82, 6144
  s_nop 0
  buffer_load_dwordx4 v34, s[48:51], s81 offen nt lds
  s_add_u32 m0, s82, 7168
  s_nop 0
  buffer_load_dwordx4 v35, s[48:51], s81 offen nt lds
  s_add_u32 s81, s80, 0
  s_add_u32 m0, s82, 8192
  s_nop 0
  buffer_load_dwordx4 v36, s[44:47], s81 offen nt lds
  s_add_u32 m0, s82, 9216
  s_nop 0
  buffer_load_dwordx4 v37, s[44:47], s81 offen nt lds
  s_add_u32 m0, s82, 10240
  s_nop 0
  buffer_load_dwordx4 v38, s[44:47], s81 offen nt lds
  s_add_u32 m0, s82, 11264
  s_nop 0
  buffer_load_dwordx4 v39, s[44:47], s81 offen nt lds
  s_cmp_eq_u32 s76, 0
  s_cselect_b32 s96, s44, s48
  s_cselect_b32 s97, s45, s49
  s_cselect_b32 s98, s46, s50
  s_mov_b32 s99, 0x20000
  s_cselect_b64 vcc, -1, 0
  s_mov_b32 s72, 778240
  s_cselect_b32 s72, s72, 4294926336
  v_cndmask_b32 v40, v32, v36, vcc
  v_cndmask_b32 v41, v33, v37, vcc
  v_cndmask_b32 v42, v34, v38, vcc
  v_cndmask_b32 v43, v35, v39, vcc
  s_add_u32 s81, s80, s72
  s_add_u32 m0, s82, 12288
  s_nop 0
  buffer_load_dwordx4 v40, s[96:99], s81 offen nt lds
  s_add_u32 m0, s82, 13312
  s_nop 0
  buffer_load_dwordx4 v41, s[96:99], s81 offen nt lds
  s_add_u32 m0, s82, 14336
  s_nop 0
  buffer_load_dwordx4 v42, s[96:99], s81 offen nt lds
  s_add_u32 m0, s82, 15360
  s_nop 0
  buffer_load_dwordx4 v43, s[96:99], s81 offen nt lds
  s_mul_i32 s3, s75, 5120
  s_add_u32 s52, s30, 0xa00000
  s_addc_u32 s53, s31, 0
  s_and_b32 s53, s53, 0xffff
  s_mov_b32 s54, 0x2e4000
  s_mov_b32 s55, 0x20000
  s_and_b32 s65, s2, 7
  s_lshr_b32 s39, s2, 3
  s_lshl_b32 s37, s65, 2
  s_and_b32 s64, s39, 3
  s_add_u32 s37, s37, s64
  s_lshr_b32 s38, s39, 2
  s_lshr_b32 s83, s39, 1
  s_lshl_b32 s83, s83, 1
  s_and_b32 s39, s39, 1
  s_lshl_b32 s64, s65, 1
  s_add_u32 s39, s39, s64
  s_mul_i32 s64, s38, 378880
  s_add_u32 s84, s30, s64
  s_addc_u32 s85, s31, 0
  s_add_u32 s84, s84, 0xa00000
  s_addc_u32 s85, s85, 0
  s_and_b32 s85, s85, 0xffff
  s_mov_b32 s86, 0x5c800
  s_mov_b32 s87, 0x20000
  s_mul_i32 s89, s32, 5120
  s_add_u32 s90, s30, 0x1300000
  s_addc_u32 s91, s31, 0
  v_add_u32 v3, 4096, v2
  s_mov_b32 s70, 0x3fb8aa3b
  s_mov_b32 s71, 0x3fb8aa3b
  v_lshrrev_b32 v44, 2, v0
  v_bfe_u32 v45, v44, 1, 2
  v_and_b32 v46, 3, v0
  v_lshlrev_b32 v44, 7, v44
  v_lshl_add_u32 v44, v46, 3, v44
  v_add_u32 v44, s82, v44
  v_xor_b32 v46, 0, v45
  v_lshl_add_u32 v48, v46, 5, v44
  v_xor_b32 v46, 1, v45
  v_lshl_add_u32 v49, v46, 5, v44
  v_xor_b32 v46, 2, v45
  v_lshl_add_u32 v50, v46, 5, v44
  v_xor_b32 v46, 3, v45
  v_lshl_add_u32 v51, v46, 5, v44
  s_lshl_b32 s72, s77, 2
  s_add_u32 s72, s72, 0
  s_mul_i32 s73, s72, 205
  s_lshr_b32 s73, s73, 10
  s_mul_i32 s74, s73, 5
  s_sub_u32 s72, s72, s74
  s_mul_i32 s73, s73, 74
  s_add_u32 s73, s73, s76
  s_mul_i32 s73, s73, 5
  s_add_u32 s73, s73, s72
  s_lshl_b32 s73, s73, 10
  s_add_u32 s4, s73, s78
  s_lshl_b32 s72, s77, 2
  s_add_u32 s72, s72, 1
  s_mul_i32 s73, s72, 205
  s_lshr_b32 s73, s73, 10
  s_mul_i32 s74, s73, 5
  s_sub_u32 s72, s72, s74
  s_mul_i32 s73, s73, 74
  s_add_u32 s73, s73, s76
  s_mul_i32 s73, s73, 5
  s_add_u32 s73, s73, s72
  s_lshl_b32 s73, s73, 10
  s_add_u32 s5, s73, s78
  s_lshl_b32 s72, s77, 2
  s_add_u32 s72, s72, 2
  s_mul_i32 s73, s72, 205
  s_lshr_b32 s73, s73, 10
  s_mul_i32 s74, s73, 5
  s_sub_u32 s72, s72, s74
  s_mul_i32 s73, s73, 74
  s_add_u32 s73, s73, s76
  s_mul_i32 s73, s73, 5
  s_add_u32 s73, s73, s72
  s_lshl_b32 s73, s73, 10
  s_add_u32 s6, s73, s78
  s_lshl_b32 s72, s77, 2
  s_add_u32 s72, s72, 3
  s_mul_i32 s73, s72, 205
  s_lshr_b32 s73, s73, 10
  s_mul_i32 s74, s73, 5
  s_sub_u32 s72, s72, s74
  s_mul_i32 s73, s73, 74
  s_add_u32 s73, s73, s76
  s_mul_i32 s73, s73, 5
  s_add_u32 s73, s73, s72
  s_lshl_b32 s73, s73, 10
  s_add_u32 s7, s73, s78
  s_cmp_lt_u32 s76, 17
  s_cselect_b32 s100, 0, 0x4000000
  s_mov_b32 s60, 3840
  s_mul_i32 s65, s79, 320
  s_and_b32 s68, s65, 127
  s_sub_u32 s75, s65, s68
  s_add_u32 s76, s75, 122880
  s_sub_u32 s77, 2457600, s75
  s_sub_u32 s78, 2457600, s76
  s_add_u32 s44, s10, s75
  s_addc_u32 s45, s11, 0
  s_and_b32 s45, s45, 0xffff
  s_mov_b32 s46, s77
  s_mov_b32 s47, 0x20000
  s_add_u32 s48, s10, s76
  s_addc_u32 s49, s11, 0
  s_and_b32 s49, s49, 0xffff
  s_mov_b32 s50, s78
  s_mov_b32 s51, 0x20000
  v_lshrrev_b32 v28, 3, v0
  v_and_b32 v29, 7, v0
  v_bfe_u32 v26, v28, 1, 1
  s_lshl_b32 s64, s33, 1
  v_or_b32 v26, s64, v26
  v_lshlrev_b32 v26, 1, v26
  v_xor_b32 v26, v26, v29
  s_lshl_b32 s64, s32, 3
  v_add_u32 v27, s64, v28
  v_mul_lo_u32 v27, v27, s60
  v_lshl_add_u32 v5, v26, 4, v27
  s_lshl_b32 s64, s32, 5
  v_lshrrev_b32 v26, 1, v28
  v_xor_b32 v27, v26, v29
  v_add_u32 v26, s64, v28
  v_mul_u32_u24 v26, 1280, v26
  v_lshl_add_u32 v6, v27, 4, v26
  v_xor_b32_e64 v7, 64, v6
  v_add_u32 v7, 10240, v7
  v_add_u32 v8, 20480, v6
  v_add_u32 v9, 20480, v7
  s_mul_i32 s62, s32, 6144
  s_lshl_b32 s63, s32, 12
  s_add_u32 s63, s63, 98304
  s_mov_b32 s61, 0
  s_lshl_b32 s67, s60, 5
  s_mov_b32 s67, 245760
  s_mul_i32 s64, s32, 20480
  v_add_u32 v6, s64, v6
  v_add_u32 v7, s64, v7
  v_add_u32 v8, s64, v8
  v_add_u32_e64 v9, s64, v9
  s_add_u32 s63, s62, 73728
  s_mov_b32 s101, 40960
  s_mul_i32 s64, s35, 245760
  s_min_u32 s64, s64, 2621440
  s_sub_u32 s65, 2621440, s64
  s_add_u32 s40, s8, s64
  s_addc_u32 s41, s9, 0
  s_and_b32 s41, s41, 0xffff
  s_mov_b32 s42, s65
  s_mov_b32 s43, 0x20000
  s_lshl_b32 s64, s35, 2
  s_add_u32 s64, s64, s32
  s_mul_i32 s64, s64, 61440
  v_lshrrev_b32 v44, 2, v0
  v_mul_u32_u24 v44, 3840, v44
  v_and_b32 v45, 3, v0
  v_min_u32 v45, 2, v45
  v_lshl_add_u32 v44, v45, 7, v44
  buffer_load_dword v63, v44, s[44:47], s64 offen
  v_and_b32 v54, 15, v0
  v_lshrrev_b32 v55, 4, v0
  v_bfe_u32 v26, v54, 1, 3
  v_xor_b32 v26, v26, v55
  s_lshl_b32 s64, s33, 13
  s_add_u32 s64, s64, 98304
  v_lshlrev_b32 v27, 7, v54
  v_add_u32 v27, s64, v27
  v_lshl_add_u32 v10, v26, 4, v27
  v_xor_b32 v11, 64, v10
  v_bfe_u32 v26, v0, 2, 2
  v_and_b32 v27, 3, v0
  v_lshrrev_b32 v28, 1, v26
  v_and_b32 v29, 1, v55
  v_lshl_or_b32 v28, v29, 1, v28
  v_lshlrev_b32_e64 v28, 5, v28
  v_mul_u32_u24 v29, 6144, v55
  v_lshl_add_u32 v29, v26, 7, v29
  s_mul_i32 s64, s34, 160
  s_add_u32 s64, s64, s68
  v_mul_u32_u24 v27, 40, v27
  v_add_u32 v27, s64, v27
  v_add_u32 v30, 0, v27
  v_lshrrev_b32 v31, 7, v30
  v_and_b32 v30, 127, v30
  v_xor_b32 v30, v30, v28
  v_lshl_add_u32 v31, v31, 10, v29
  v_add_u32 v12, v30, v31
  v_add_u32 v18, 49152, v12
  v_add_u32 v30, 8, v27
  v_lshrrev_b32 v31, 7, v30
  v_and_b32 v30, 127, v30
  v_xor_b32 v30, v30, v28
  v_lshl_add_u32 v31, v31, 10, v29
  v_add_u32 v13, v30, v31
  v_add_u32 v19, 49152, v13
  v_add_u32 v30, 16, v27
  v_lshrrev_b32 v31, 7, v30
  v_and_b32 v30, 127, v30
  v_xor_b32 v30, v30, v28
  v_lshl_add_u32 v31, v31, 10, v29
  v_add_u32 v14, v30, v31
  v_add_u32 v20, 49152, v14
  v_add_u32 v30, 24, v27
  v_lshrrev_b32 v31, 7, v30
  v_and_b32 v30, 127, v30
  v_xor_b32 v30, v30, v28
  v_lshl_add_u32 v31, v31, 10, v29
  v_add_u32 v15, v30, v31
  v_add_u32 v21, 49152, v15
  v_add_u32 v30, 32, v27
  v_lshrrev_b32 v31, 7, v30
  v_and_b32 v30, 127, v30
  v_xor_b32 v30, v30, v28
  v_lshl_add_u32 v31, v31, 10, v29
  v_add_u32_e64 v16, v30, v31
  v_add_u32 v22, 49152, v16
  s_mul_i32 s64, s33, 4096
  s_sub_u32 s64, s64, 24576
  v_add_u32_e64 v10, s64, v10
  v_add_u32 v11, s64, v11
  s_waitcnt vmcnt(13)
  ds_read_b64_tr_b16 v[64:65], v48 offset:0
  ds_read_b64_tr_b16 v[66:67], v48 offset:2048
  ds_read_b64_tr_b16 v[68:69], v49 offset:0
  ds_read_b64_tr_b16 v[70:71], v49 offset:2048
  ds_read_b64_tr_b16 v[72:73], v50 offset:0
  ds_read_b64_tr_b16 v[74:75], v50 offset:2048
  ds_read_b64_tr_b16 v[76:77], v51 offset:0
  ds_read_b64_tr_b16 v[78:79], v51 offset:2048
  s_add_u32 s72, s4, 194560
  s_add_u32 s73, s5, 194560
  s_add_u32 s74, s6, 194560
  s_add_u32 s75, s7, 194560
  s_waitcnt lgkmcnt(0)
  buffer_store_dwordx4 v[64:67], v2, s[52:55], s72 offen sc1
  buffer_store_dwordx4 v[68:71], v2, s[52:55], s73 offen sc1
  buffer_store_dwordx4 v[72:75], v2, s[52:55], s74 offen sc1
  buffer_store_dwordx4 v[76:79], v2, s[52:55], s75 offen sc1
  s_waitcnt vmcnt(13)
  ds_read_b64_tr_b16 v[80:81], v48 offset:4096
  ds_read_b64_tr_b16 v[82:83], v48 offset:6144
  ds_read_b64_tr_b16 v[84:85], v49 offset:4096
  ds_read_b64_tr_b16 v[86:87], v49 offset:6144
  ds_read_b64_tr_b16 v[88:89], v50 offset:4096
  ds_read_b64_tr_b16 v[90:91], v50 offset:6144
  ds_read_b64_tr_b16 v[92:93], v51 offset:4096
  ds_read_b64_tr_b16 v[94:95], v51 offset:6144
  s_add_u32 s72, s4, 291840
  s_add_u32 s72, s72, s100
  s_add_u32 s73, s5, 291840
  s_add_u32 s73, s73, s100
  s_add_u32 s74, s6, 291840
  s_add_u32 s74, s74, s100
  s_add_u32 s75, s7, 291840
  s_add_u32 s75, s75, s100
  s_waitcnt lgkmcnt(0)
  buffer_store_dwordx4 v[80:83], v2, s[52:55], s72 offen sc1
  buffer_store_dwordx4 v[84:87], v2, s[52:55], s73 offen sc1
  buffer_store_dwordx4 v[88:91], v2, s[52:55], s74 offen sc1
  buffer_store_dwordx4 v[92:95], v2, s[52:55], s75 offen sc1
  s_waitcnt vmcnt(13)
  ds_read_b64_tr_b16 v[96:97], v48 offset:8192
  ds_read_b64_tr_b16 v[98:99], v48 offset:10240
  ds_read_b64_tr_b16 v[100:101], v49 offset:8192
  ds_read_b64_tr_b16 v[102:103], v49 offset:10240
  ds_read_b64_tr_b16 v[104:105], v50 offset:8192
  ds_read_b64_tr_b16 v[106:107], v50 offset:10240
  ds_read_b64_tr_b16 v[108:109], v51 offset:8192
  ds_read_b64_tr_b16 v[110:111], v51 offset:10240
  s_add_u32 s72, s4, 0
  s_add_u32 s73, s5, 0
  s_add_u32 s74, s6, 0
  s_add_u32 s75, s7, 0
  s_waitcnt lgkmcnt(0)
  buffer_store_dwordx4 v[96:99], v2, s[52:55], s72 offen sc1
  buffer_store_dwordx4 v[100:103], v2, s[52:55], s73 offen sc1
  buffer_store_dwordx4 v[104:107], v2, s[52:55], s74 offen sc1
  buffer_store_dwordx4 v[108:111], v2, s[52:55], s75 offen sc1
  s_waitcnt vmcnt(13)
  ds_read_b64_tr_b16 v[112:113], v48 offset:12288
  ds_read_b64_tr_b16 v[114:115], v48 offset:14336
  ds_read_b64_tr_b16 v[116:117], v49 offset:12288
  ds_read_b64_tr_b16 v[118:119], v49 offset:14336
  ds_read_b64_tr_b16 v[120:121], v50 offset:12288
  ds_read_b64_tr_b16 v[122:123], v50 offset:14336
  ds_read_b64_tr_b16 v[124:125], v51 offset:12288
  ds_read_b64_tr_b16 v[126:127], v51 offset:14336
  s_add_u32 s72, s4, 97280
  s_add_u32 s73, s5, 97280
  s_add_u32 s74, s6, 97280
  s_add_u32 s75, s7, 97280
  s_waitcnt lgkmcnt(0)
  buffer_store_dwordx4 v[112:115], v2, s[52:55], s72 offen sc1
  buffer_store_dwordx4 v[116:119], v2, s[52:55], s73 offen sc1
  buffer_store_dwordx4 v[120:123], v2, s[52:55], s74 offen sc1
  buffer_store_dwordx4 v[124:127], v2, s[52:55], s75 offen sc1
  s_add_u32 s96, s30, 0x1000000
  s_addc_u32 s97, s31, 0
  s_and_b32 s97, s97, 0xffff
  s_mov_b32 s98, 0xf0000
  s_mov_b32 s99, 0x20000
  v_mov_b32 v56, -1
  v_mov_b32 v57, -1
  v_mov_b32 v58, -1
  v_mov_b32 v59, -1
  buffer_store_dwordx4 v[56:59], v2, s[96:99], s3 offen offset:0 sc1
  buffer_store_dwordx4 v[56:59], v2, s[96:99], s3 offen offset:1024 sc1
  buffer_store_dwordx4 v[56:59], v2, s[96:99], s3 offen offset:2048 sc1
  buffer_store_dwordx4 v[56:59], v2, s[96:99], s3 offen offset:3072 sc1
  buffer_store_dwordx4 v[56:59], v3, s[96:99], s3 offen sc1
  s_cmp_eq_u32 s35, 11
  s_cbranch_scc1 L_spare
  s_add_u32 m0, s63, 0
  s_nop 0
  buffer_load_dwordx4 v6, s[40:43], 0 offen offset:0 lds
  s_add_u32 m0, s63, 1024
  s_nop 0
  buffer_load_dwordx4 v7, s[40:43], 0 offen offset:0 lds
  s_add_u32 m0, s63, 2048
  s_nop 0
  buffer_load_dwordx4 v8, s[40:43], 0 offen offset:0 lds
  s_add_u32 m0, s63, 3072
  s_nop 0
  buffer_load_dwordx4 v9, s[40:43], 0 offen offset:0 lds
  s_add_u32 m0, s63, 4096
  s_nop 0
  buffer_load_dwordx4 v6, s[40:43], s101 offen offset:0 lds
  s_add_u32 m0, s63, 5120
  s_nop 0
  buffer_load_dwordx4 v7, s[40:43], s101 offen offset:0 lds
  s_add_u32 m0, s62, 0
  s_nop 0
  buffer_load_dwordx4 v5, s[44:47], s61 offen offset:0 lds
  s_add_u32 m0, s62, 896
  s_nop 0
  buffer_load_dwordx4 v5, s[44:47], s61 offen offset:128 lds
  s_add_u32 m0, s62, 1792
  s_nop 0
  buffer_load_dwordx4 v5, s[44:47], s61 offen offset:256 lds
  s_add_u32 m0, s62, 3072
  s_nop 0
  buffer_load_dwordx4 v5, s[48:51], s61 offen offset:0 lds
  s_add_u32 m0, s62, 3968
  s_nop 0
  buffer_load_dwordx4 v5, s[48:51], s61 offen offset:128 lds
  s_add_u32 m0, s62, 4864
  s_nop 0
  buffer_load_dwordx4 v5, s[48:51], s61 offen offset:256 lds
  s_add_u32 s61, s61, s67
  s_add_u32 m0, s62, 24576
  s_nop 0
  buffer_load_dwordx4 v5, s[44:47], s61 offen offset:0 lds
  s_add_u32 m0, s62, 25472
  s_nop 0
  buffer_load_dwordx4 v5, s[44:47], s61 offen offset:128 lds
  s_add_u32 m0, s62, 26368
  s_nop 0
  buffer_load_dwordx4 v5, s[44:47], s61 offen offset:256 lds
  s_add_u32 m0, s62, 27648
  s_nop 0
  buffer_load_dwordx4 v5, s[48:51], s61 offen offset:0 lds
  s_add_u32 m0, s62, 28544
  s_nop 0
  buffer_load_dwordx4 v5, s[48:51], s61 offen offset:128 lds
  s_add_u32 m0, s62, 29440
  s_nop 0
  buffer_load_dwordx4 v5, s[48:51], s61 offen offset:256 lds
  s_add_u32 s61, s61, s67
  s_lshl_b32 s79, s79, 1
  s_add_u32 s79, s79, s34
  s_mul_i32 s80, s79, 3200
  s_add_u32 s56, s12, s80
  s_addc_u32 s57, s13, 0
  s_and_b32 s57, s57, 0xffff
  s_mov_b32 s58, 0xc80
  s_mov_b32 s59, 0x20000
  s_waitcnt vmcnt(18)
  s_barrier
  s_cmp_lg_u32 s32, 0
  s_cbranch_scc1 Lsg_50
  v_mov_b32 v4, 0
  v_mov_b32 v31, 1
  s_mov_b64 exec, 1
  global_atomic_add v4, v31, s[28:29] sc1
  s_mov_b64 exec, -1
Lsg_50:
  s_add_u32 m0, s63, 24448
  s_nop 0
  buffer_load_dwordx4 v6, s[40:43], 0 offen offset:128 lds
  s_add_u32 m0, s63, 25472
  s_nop 0
  buffer_load_dwordx4 v7, s[40:43], 0 offen offset:128 lds
  s_add_u32 m0, s63, 26496
  s_nop 0
  buffer_load_dwordx4 v8, s[40:43], 0 offen offset:128 lds
  s_add_u32 m0, s63, 27520
  s_nop 0
  buffer_load_dwordx4 v9, s[40:43], 0 offen offset:128 lds
  s_add_u32 m0, s63, 28544
  s_nop 0
  buffer_load_dwordx4 v6, s[40:43], s101 offen offset:128 lds
  s_add_u32 m0, s63, 29568
  s_nop 0
  buffer_load_dwordx4 v7, s[40:43], s101 offen offset:128 lds
  s_lshl_b32 s82, s32, 12
  s_add_u32 s82, s82, 147456
  s_mov_b32 m0, s82
  s_nop 0
  buffer_load_dwordx4 v2, s[56:59], 0 offen offset:0 lds
  s_mov_b32 m0, s82
  s_nop 0
  buffer_load_dwordx4 v2, s[56:59], 0 offen offset:1024 lds
  s_mov_b32 m0, s82
  s_nop 0
  buffer_load_dwordx4 v2, s[56:59], 0 offen offset:2048 lds
  s_mov_b32 m0, s82
  s_nop 0
  buffer_load_dwordx4 v2, s[56:59], 0 offen offset:3072 lds
  v_lshrrev_b32 v50, 4, v0
  v_and_b32 v51, 15, v0
  v_bfe_u32 v52, v0, 2, 2
  v_and_b32 v53, 3, v0
  v_mul_u32_u24 v48, 800, v50
  v_mad_u32_u24 v48, v52, 40, v48
  v_cmp_eq_u32 vcc, v50, v53
  v_mov_b32 v49, 3200
  s_nop 0
  v_cndmask_b32 v48, v49, v48, vcc
  v_add_u32 v23, s82, v48
  v_add_u32_e64 v26, s82, v49
  s_mov_b32 s64, 163840
  v_mul_lo_u32 v48, v50, s64
  v_lshl_add_u32 v27, v51, 4, v48
  s_mul_i32 s76, s35, 12
  s_mul_i32 s77, s33, 6
  s_add_u32 s76, s76, s77
  s_mul_i32 s75, s79, 655360
  s_mul_i32 s77, s76, 1280
  s_add_u32 s75, s75, s77
  s_add_u32 s52, s30, 0x1800000
  s_addc_u32 s53, s31, 0
  s_and_b32 s53, s53, 0xffff
  s_mov_b32 s54, 0x500000
  s_mov_b32 s55, 0x20000
  v_mov_b32 v42, 0
  v_mov_b32 v43, 0
  v_mov_b32 v54, 0
  v_mov_b32_e64 v55, 0
  s_waitcnt vmcnt(16)
  s_barrier
  ds_read_b128 a[80:83], v10 offset:0
  ds_read_b128 a[84:87], v11 offset:0
  ds_read_b128 a[88:91], v10 offset:2048
  ds_read_b128 a[92:95], v11 offset:2048
  ds_read_b128 a[96:99], v10 offset:4096
  ds_read_b128 a[100:103], v11 offset:4096
  ds_read_b128 a[104:107], v10 offset:6144
  ds_read_b128 a[108:111], v11 offset:6144
  ds_read_b128 a[112:115], v10 offset:8192
  ds_read_b128 a[116:119], v11 offset:8192
  ds_read_b128 a[120:123], v10 offset:10240
  ds_read_b128 a[124:127], v11 offset:10240
  ds_read_b64_tr_b16 a[0:1], v12 offset:0
  ds_read_b64_tr_b16 a[2:3], v12 offset:512
  ds_read_b64_tr_b16 a[4:5], v12 offset:3072
  ds_read_b64_tr_b16 a[6:7], v12 offset:3584
  ds_read_b64_tr_b16 a[8:9], v13 offset:0
  ds_read_b64_tr_b16 a[10:11], v13 offset:512
  ds_read_b64_tr_b16 a[12:13], v13 offset:3072
  ds_read_b64_tr_b16 a[14:15], v13 offset:3584
  ds_read_b64_tr_b16 a[16:17], v14 offset:0
  ds_read_b64_tr_b16 a[18:19], v14 offset:512
  ds_read_b64_tr_b16 a[20:21], v14 offset:3072
  ds_read_b64_tr_b16 a[22:23], v14 offset:3584
  ds_read_b64_tr_b16 a[24:25], v15 offset:0
  ds_read_b64_tr_b16 a[26:27], v15 offset:512
  ds_read_b64_tr_b16 a[28:29], v15 offset:3072
  ds_read_b64_tr_b16 a[30:31], v15 offset:3584
  ds_read_b64_tr_b16 a[32:33], v16 offset:0
  ds_read_b64_tr_b16 a[34:35], v16 offset:512
  ds_read_b64_tr_b16 a[36:37], v16 offset:3072
  ds_read_b64_tr_b16 a[38:39], v16 offset:3584
  s_add_u32 m0, s62, 49152
  s_nop 0
  buffer_load_dwordx4 v5, s[44:47], s61 offen offset:0 lds
  s_add_u32 m0, s62, 50048
  s_nop 0
  buffer_load_dwordx4 v5, s[44:47], s61 offen offset:128 lds
  s_add_u32 m0, s62, 50944
  s_nop 0
  buffer_load_dwordx4 v5, s[44:47], s61 offen offset:256 lds
  s_add_u32 m0, s62, 52224
  s_nop 0
  buffer_load_dwordx4 v5, s[48:51], s61 offen offset:0 lds
  s_add_u32 m0, s62, 53120
  s_nop 0
  buffer_load_dwordx4 v5, s[48:51], s61 offen offset:128 lds
  s_add_u32 m0, s62, 54016
  s_nop 0
  buffer_load_dwordx4 v5, s[48:51], s61 offen offset:256 lds
  s_add_u32 s61, s61, s67
  s_add_u32 m0, s63, 48896
  s_nop 0
  buffer_load_dwordx4 v6, s[40:43], 0 offen offset:256 lds
  s_add_u32 m0, s63, 49920
  s_nop 0
  buffer_load_dwordx4 v7, s[40:43], 0 offen offset:256 lds
  s_add_u32 m0, s63, 50944
  s_nop 0
  buffer_load_dwordx4 v8, s[40:43], 0 offen offset:256 lds
  s_add_u32 m0, s63, 51968
  s_nop 0
  buffer_load_dwordx4 v9, s[40:43], 0 offen offset:256 lds
  s_add_u32 m0, s63, 52992
  s_nop 0
  buffer_load_dwordx4 v6, s[40:43], s101 offen offset:256 lds
  s_add_u32 m0, s63, 54016
  s_nop 0
  buffer_load_dwordx4 v7, s[40:43], s101 offen offset:256 lds
  s_waitcnt vmcnt(16) lgkmcnt(0)
  s_barrier
  v_mfma_f32_16x16x32_bf16 v[64:67], a[0:3], a[80:83], 0
  ds_read_b128 a[128:131], v10 offset:24576
  s_add_u32 m0, s62, 0
  v_mfma_f32_16x16x32_bf16 v[64:67], a[4:7], a[84:87], v[64:67]
  ds_read_b128 a[132:135], v11 offset:24576
  buffer_load_dwordx4 v5, s[44:47], s61 offen offset:0 lds
  v_mfma_f32_16x16x32_bf16 v[68:71], a[0:3], a[88:91], 0
  ds_read_b128 a[136:139], v10 offset:26624
  v_mfma_f32_16x16x32_bf16 v[68:71], a[4:7], a[92:95], v[68:71]
  ds_read_b128 a[140:143], v11 offset:26624
  v_mfma_f32_16x16x32_bf16 v[72:75], a[0:3], a[96:99], 0
  ds_read_b128 a[144:147], v10 offset:28672
  s_add_u32 m0, s62, 896
  v_mfma_f32_16x16x32_bf16 v[72:75], a[4:7], a[100:103], v[72:75]
  ds_read_b128 a[148:151], v11 offset:28672
  buffer_load_dwordx4 v5, s[44:47], s61 offen offset:128 lds
  v_mfma_f32_16x16x32_bf16 v[76:79], a[0:3], a[104:107], 0
  ds_read_b128 a[152:155], v10 offset:30720
  v_mfma_f32_16x16x32_bf16 v[76:79], a[4:7], a[108:111], v[76:79]
  ds_read_b128 a[156:159], v11 offset:30720
  v_mfma_f32_16x16x32_bf16 v[80:83], a[0:3], a[112:115], 0
  ds_read_b128 a[160:163], v10 offset:32768
  v_mfma_f32_16x16x32_bf16 v[80:83], a[4:7], a[116:119], v[80:83]
  ds_read_b128 a[164:167], v11 offset:32768
  s_add_u32 m0, s62, 1792
  v_mfma_f32_16x16x32_bf16 v[84:87], a[0:3], a[120:123], 0
  ds_read_b128 a[168:171], v10 offset:34816
  buffer_load_dwordx4 v5, s[44:47], s61 offen offset:256 lds
  v_mfma_f32_16x16x32_bf16 v[84:87], a[4:7], a[124:127], v[84:87]
  ds_read_b128 a[172:175], v11 offset:34816
  v_mfma_f32_16x16x32_bf16 v[88:91], a[8:11], a[80:83], 0
  ds_read_b64_tr_b16 a[40:41], v12 offset:24576
  v_mfma_f32_16x16x32_bf16 v[88:91], a[12:15], a[84:87], v[88:91]
  ds_read_b64_tr_b16 a[42:43], v12 offset:25088
  v_mfma_f32_16x16x32_bf16 v[92:95], a[8:11], a[88:91], 0
  ds_read_b64_tr_b16 a[44:45], v12 offset:27648
  s_add_u32 m0, s62, 3072
  v_mfma_f32_16x16x32_bf16 v[92:95], a[12:15], a[92:95], v[92:95]
  ds_read_b64_tr_b16 a[46:47], v12 offset:28160
  buffer_load_dwordx4 v5, s[48:51], s61 offen offset:0 lds
  v_mfma_f32_16x16x32_bf16 v[96:99], a[8:11], a[96:99], 0
  ds_read_b64_tr_b16 a[48:49], v13 offset:24576
  v_mfma_f32_16x16x32_bf16 v[96:99], a[12:15], a[100:103], v[96:99]
  ds_read_b64_tr_b16 a[50:51], v13 offset:25088
  v_mfma_f32_16x16x32_bf16 v[100:103], a[8:11], a[104:107], 0
  ds_read_b64_tr_b16 a[52:53], v13 offset:27648
  v_mfma_f32_16x16x32_bf16 v[100:103], a[12:15], a[108:111], v[100:103]
  ds_read_b64_tr_b16 a[54:55], v13 offset:28160
  s_add_u32 m0, s62, 3968
  v_mfma_f32_16x16x32_bf16 v[104:107], a[8:11], a[112:115], 0
  ds_read_b64_tr_b16 a[56:57], v14 offset:24576
  buffer_load_dwordx4 v5, s[48:51], s61 offen offset:128 lds
  v_mfma_f32_16x16x32_bf16 v[104:107], a[12:15], a[116:119], v[104:107]
  ds_read_b64_tr_b16 a[58:59], v14 offset:25088
  v_mfma_f32_16x16x32_bf16 v[108:111], a[8:11], a[120:123], 0
  ds_read_b64_tr_b16 a[60:61], v14 offset:27648
  v_mfma_f32_16x16x32_bf16 v[108:111], a[12:15], a[124:127], v[108:111]
  ds_read_b64_tr_b16 a[62:63], v14 offset:28160
  s_add_u32 m0, s62, 4864
  v_mfma_f32_16x16x32_bf16 v[112:115], a[16:19], a[80:83], 0
  ds_read_b64_tr_b16 a[64:65], v15 offset:24576
  buffer_load_dwordx4 v5, s[48:51], s61 offen offset:256 lds
  s_add_u32 s61, s61, s67
  s_nop 0
  v_mfma_f32_16x16x32_bf16 v[112:115], a[20:23], a[84:87], v[112:115]
  ds_read_b64_tr_b16 a[66:67], v15 offset:25088
  v_mfma_f32_16x16x32_bf16 v[116:119], a[16:19], a[88:91], 0
  ds_read_b64_tr_b16 a[68:69], v15 offset:27648
  v_mfma_f32_16x16x32_bf16 v[116:119], a[20:23], a[92:95], v[116:119]
  ds_read_b64_tr_b16 a[70:71], v15 offset:28160
  v_mfma_f32_16x16x32_bf16 v[120:123], a[16:19], a[96:99], 0
  ds_read_b64_tr_b16 a[72:73], v16 offset:24576
  s_add_u32 m0, s63, -384
  v_mfma_f32_16x16x32_bf16 v[120:123], a[20:23], a[100:103], v[120:123]
  ds_read_b64_tr_b16 a[74:75], v16 offset:25088
  buffer_load_dwordx4 v6, s[40:43], 0 offen offset:384 lds
  v_mfma_f32_16x16x32_bf16 v[124:127], a[16:19], a[104:107], 0
  ds_read_b64_tr_b16 a[76:77], v16 offset:27648
  v_mfma_f32_16x16x32_bf16 v[124:127], a[20:23], a[108:111], v[124:127]
  ds_read_b64_tr_b16 a[78:79], v16 offset:28160
  v_mfma_f32_16x16x32_bf16 v[128:131], a[16:19], a[112:115], 0
  v_mfma_f32_16x16x32_bf16 v[128:131], a[20:23], a[116:119], v[128:131]
  s_add_u32 m0, s63, 640
  v_mfma_f32_16x16x32_bf16 v[132:135], a[16:19], a[120:123], 0
  buffer_load_dwordx4 v7, s[40:43], 0 offen offset:384 lds
  v_mfma_f32_16x16x32_bf16 v[132:135], a[20:23], a[124:127], v[132:135]
  v_mfma_f32_16x16x32_bf16 v[136:139], a[24:27], a[80:83], 0
  v_mfma_f32_16x16x32_bf16 v[136:139], a[28:31], a[84:87], v[136:139]
  v_mfma_f32_16x16x32_bf16 v[140:143], a[24:27], a[88:91], 0
  s_add_u32 m0, s63, 1664
  v_mfma_f32_16x16x32_bf16 v[140:143], a[28:31], a[92:95], v[140:143]
  buffer_load_dwordx4 v8, s[40:43], 0 offen offset:384 lds
  v_mfma_f32_16x16x32_bf16 v[144:147], a[24:27], a[96:99], 0
  v_mfma_f32_16x16x32_bf16 v[144:147], a[28:31], a[100:103], v[144:147]
  v_mfma_f32_16x16x32_bf16 v[148:151], a[24:27], a[104:107], 0
  s_add_u32 m0, s63, 2688
  v_mfma_f32_16x16x32_bf16 v[148:151], a[28:31], a[108:111], v[148:151]
  buffer_load_dwordx4 v9, s[40:43], 0 offen offset:384 lds
  v_mfma_f32_16x16x32_bf16 v[152:155], a[24:27], a[112:115], 0
  v_mfma_f32_16x16x32_bf16 v[152:155], a[28:31], a[116:119], v[152:155]
  v_mfma_f32_16x16x32_bf16 v[156:159], a[24:27], a[120:123], 0
  v_mfma_f32_16x16x32_bf16 v[156:159], a[28:31], a[124:127], v[156:159]
  s_add_u32 m0, s63, 3712
  v_mfma_f32_16x16x32_bf16 v[160:163], a[32:35], a[80:83], 0
  buffer_load_dwordx4 v6, s[40:43], s101 offen offset:384 lds
  v_mfma_f32_16x16x32_bf16 v[160:163], a[36:39], a[84:87], v[160:163]
  v_mfma_f32_16x16x32_bf16 v[164:167], a[32:35], a[88:91], 0
  v_mfma_f32_16x16x32_bf16 v[164:167], a[36:39], a[92:95], v[164:167]
  v_mfma_f32_16x16x32_bf16 v[168:171], a[32:35], a[96:99], 0
  s_add_u32 m0, s63, 4736
  v_mfma_f32_16x16x32_bf16 v[168:171], a[36:39], a[100:103], v[168:171]
  buffer_load_dwordx4 v7, s[40:43], s101 offen offset:384 lds
  v_mfma_f32_16x16x32_bf16 v[172:175], a[32:35], a[104:107], 0
  v_mfma_f32_16x16x32_bf16 v[172:175], a[36:39], a[108:111], v[172:175]
  v_mfma_f32_16x16x32_bf16 v[176:179], a[32:35], a[112:115], 0
  v_mfma_f32_16x16x32_bf16 v[176:179], a[36:39], a[116:119], v[176:179]
  v_mfma_f32_16x16x32_bf16 v[180:183], a[32:35], a[120:123], 0
  v_mfma_f32_16x16x32_bf16 v[180:183], a[36:39], a[124:127], v[180:183]
  s_waitcnt vmcnt(12) lgkmcnt(0)
  s_barrier
  v_mfma_f32_16x16x32_bf16 v[64:67], a[40:43], a[128:131], v[64:67]
  ds_read_b128 a[80:83], v10 offset:49152
  s_add_u32 m0, s62, 24576
  v_mfma_f32_16x16x32_bf16 v[64:67], a[44:47], a[132:135], v[64:67]
  ds_read_b128 a[84:87], v11 offset:49152
  buffer_load_dwordx4 v5, s[44:47], s61 offen offset:0 lds
  v_mfma_f32_16x16x32_bf16 v[68:71], a[40:43], a[136:139], v[68:71]
  ds_read_b128 a[88:91], v10 offset:51200
  v_mfma_f32_16x16x32_bf16 v[68:71], a[44:47], a[140:143], v[68:71]
  ds_read_b128 a[92:95], v11 offset:51200
  v_mfma_f32_16x16x32_bf16 v[72:75], a[40:43], a[144:147], v[72:75]
  ds_read_b128 a[96:99], v10 offset:53248
  s_add_u32 m0, s62, 25472
  v_mfma_f32_16x16x32_bf16 v[72:75], a[44:47], a[148:151], v[72:75]
  ds_read_b128 a[100:103], v11 offset:53248
  buffer_load_dwordx4 v5, s[44:47], s61 offen offset:128 lds
  v_mfma_f32_16x16x32_bf16 v[76:79], a[40:43], a[152:155], v[76:79]
  ds_read_b128 a[104:107], v10 offset:55296
  v_mfma_f32_16x16x32_bf16 v[76:79], a[44:47], a[156:159], v[76:79]
  ds_read_b128 a[108:111], v11 offset:55296
  v_mfma_f32_16x16x32_bf16 v[80:83], a[40:43], a[160:163], v[80:83]
  ds_read_b128 a[112:115], v10 offset:57344
  v_mfma_f32_16x16x32_bf16 v[80:83], a[44:47], a[164:167], v[80:83]
  ds_read_b128 a[116:119], v11 offset:57344
  s_add_u32 m0, s62, 26368
  v_mfma_f32_16x16x32_bf16 v[84:87], a[40:43], a[168:171], v[84:87]
  ds_read_b128 a[120:123], v10 offset:59392
  buffer_load_dwordx4 v5, s[44:47], s61 offen offset:256 lds
  v_mfma_f32_16x16x32_bf16 v[84:87], a[44:47], a[172:175], v[84:87]
  ds_read_b128 a[124:127], v11 offset:59392
  v_mfma_f32_16x16x32_bf16 v[88:91], a[48:51], a[128:131], v[88:91]
  ds_read_b64_tr_b16 a[0:1], v12 offset:49152
  v_mfma_f32_16x16x32_bf16 v[88:91], a[52:55], a[132:135], v[88:91]
  ds_read_b64_tr_b16 a[2:3], v12 offset:49664
  v_mfma_f32_16x16x32_bf16 v[92:95], a[48:51], a[136:139], v[92:95]
  ds_read_b64_tr_b16 a[4:5], v12 offset:52224
  s_add_u32 m0, s62, 27648
  v_mfma_f32_16x16x32_bf16 v[92:95], a[52:55], a[140:143], v[92:95]
  ds_read_b64_tr_b16 a[6:7], v12 offset:52736
  buffer_load_dwordx4 v5, s[48:51], s61 offen offset:0 lds
  v_mfma_f32_16x16x32_bf16 v[96:99], a[48:51], a[144:147], v[96:99]
  ds_read_b64_tr_b16 a[8:9], v13 offset:49152
  v_mfma_f32_16x16x32_bf16 v[96:99], a[52:55], a[148:151], v[96:99]
  ds_read_b64_tr_b16 a[10:11], v13 offset:49664
  v_mfma_f32_16x16x32_bf16 v[100:103], a[48:51], a[152:155], v[100:103]
  ds_read_b64_tr_b16 a[12:13], v13 offset:52224
  v_mfma_f32_16x16x32_bf16 v[100:103], a[52:55], a[156:159], v[100:103]
  ds_read_b64_tr_b16 a[14:15], v13 offset:52736
  s_add_u32 m0, s62, 28544
  v_mfma_f32_16x16x32_bf16 v[104:107], a[48:51], a[160:163], v[104:107]
  ds_read_b64_tr_b16 a[16:17], v14 offset:49152
  buffer_load_dwordx4 v5, s[48:51], s61 offen offset:128 lds
  v_mfma_f32_16x16x32_bf16 v[104:107], a[52:55], a[164:167], v[104:107]
  ds_read_b64_tr_b16 a[18:19], v14 offset:49664
  v_mfma_f32_16x16x32_bf16 v[108:111], a[48:51], a[168:171], v[108:111]
  ds_read_b64_tr_b16 a[20:21], v14 offset:52224
  v_mfma_f32_16x16x32_bf16 v[108:111], a[52:55], a[172:175], v[108:111]
  ds_read_b64_tr_b16 a[22:23], v14 offset:52736
  s_add_u32 m0, s62, 29440
  v_mfma_f32_16x16x32_bf16 v[112:115], a[56:59], a[128:131], v[112:115]
  ds_read_b64_tr_b16 a[24:25], v15 offset:49152
  buffer_load_dwordx4 v5, s[48:51], s61 offen offset:256 lds
  s_add_u32 s61, s61, s67
  s_nop 0
  v_mfma_f32_16x16x32_bf16 v[112:115], a[60:63], a[132:135], v[112:115]
  ds_read_b64_tr_b16 a[26:27], v15 offset:49664
  v_mfma_f32_16x16x32_bf16 v[116:119], a[56:59], a[136:139], v[116:119]
  ds_read_b64_tr_b16 a[28:29], v15 offset:52224
  v_mfma_f32_16x16x32_bf16 v[116:119], a[60:63], a[140:143], v[116:119]
  ds_read_b64_tr_b16 a[30:31], v15 offset:52736
  v_mfma_f32_16x16x32_bf16 v[120:123], a[56:59], a[144:147], v[120:123]
  ds_read_b64_tr_b16 a[32:33], v16 offset:49152
  s_add_u32 m0, s63, 24064
  v_mfma_f32_16x16x32_bf16 v[120:123], a[60:63], a[148:151], v[120:123]
  ds_read_b64_tr_b16 a[34:35], v16 offset:49664
  buffer_load_dwordx4 v6, s[40:43], 0 offen offset:512 lds
  v_mfma_f32_16x16x32_bf16 v[124:127], a[56:59], a[152:155], v[124:127]
  ds_read_b64_tr_b16 a[36:37], v16 offset:52224
  v_mfma_f32_16x16x32_bf16 v[124:127], a[60:63], a[156:159], v[124:127]
  ds_read_b64_tr_b16 a[38:39], v16 offset:52736
  v_mfma_f32_16x16x32_bf16 v[128:131], a[56:59], a[160:163], v[128:131]
  v_mfma_f32_16x16x32_bf16 v[128:131], a[60:63], a[164:167], v[128:131]
  s_add_u32 m0, s63, 25088
  v_mfma_f32_16x16x32_bf16 v[132:135], a[56:59], a[168:171], v[132:135]
  buffer_load_dwordx4 v7, s[40:43], 0 offen offset:512 lds
  v_mfma_f32_16x16x32_bf16 v[132:135], a[60:63], a[172:175], v[132:135]
  v_mfma_f32_16x16x32_bf16 v[136:139], a[64:67], a[128:131], v[136:139]
  v_mfma_f32_16x16x32_bf16 v[136:139], a[68:71], a[132:135], v[136:139]
  v_mfma_f32_16x16x32_bf16 v[140:143], a[64:67], a[136:139], v[140:143]
  s_add_u32 m0, s63, 26112
  v_mfma_f32_16x16x32_bf16 v[140:143], a[68:71], a[140:143], v[140:143]
  buffer_load_dwordx4 v8, s[40:43], 0 offen offset:512 lds
  v_mfma_f32_16x16x32_bf16 v[144:147], a[64:67], a[144:147], v[144:147]
  v_mfma_f32_16x16x32_bf16 v[144:147], a[68:71], a[148:151], v[144:147]
  v_mfma_f32_16x16x32_bf16 v[148:151], a[64:67], a[152:155], v[148:151]
  s_add_u32 m0, s63, 27136
  v_mfma_f32_16x16x32_bf16 v[148:151], a[68:71], a[156:159], v[148:151]
  buffer_load_dwordx4 v9, s[40:43], 0 offen offset:512 lds
  v_mfma_f32_16x16x32_bf16 v[152:155], a[64:67], a[160:163], v[152:155]
  v_mfma_f32_16x16x32_bf16 v[152:155], a[68:71], a[164:167], v[152:155]
  v_mfma_f32_16x16x32_bf16 v[156:159], a[64:67], a[168:171], v[156:159]
  v_mfma_f32_16x16x32_bf16 v[156:159], a[68:71], a[172:175], v[156:159]
  s_add_u32 m0, s63, 28160
  v_mfma_f32_16x16x32_bf16 v[160:163], a[72:75], a[128:131], v[160:163]
  buffer_load_dwordx4 v6, s[40:43], s101 offen offset:512 lds
  v_mfma_f32_16x16x32_bf16 v[160:163], a[76:79], a[132:135], v[160:163]
  v_mfma_f32_16x16x32_bf16 v[164:167], a[72:75], a[136:139], v[164:167]
  v_mfma_f32_16x16x32_bf16 v[164:167], a[76:79], a[140:143], v[164:167]
  v_mfma_f32_16x16x32_bf16 v[168:171], a[72:75], a[144:147], v[168:171]
  s_add_u32 m0, s63, 29184
  v_mfma_f32_16x16x32_bf16 v[168:171], a[76:79], a[148:151], v[168:171]
  buffer_load_dwordx4 v7, s[40:43], s101 offen offset:512 lds
  v_mfma_f32_16x16x32_bf16 v[172:175], a[72:75], a[152:155], v[172:175]
  v_mfma_f32_16x16x32_bf16 v[172:175], a[76:79], a[156:159], v[172:175]
  v_mfma_f32_16x16x32_bf16 v[176:179], a[72:75], a[160:163], v[176:179]
  v_mfma_f32_16x16x32_bf16 v[176:179], a[76:79], a[164:167], v[176:179]
  v_mfma_f32_16x16x32_bf16 v[180:183], a[72:75], a[168:171], v[180:183]
  v_mfma_f32_16x16x32_bf16 v[180:183], a[76:79], a[172:175], v[180:183]
  s_waitcnt vmcnt(12) lgkmcnt(0)
  s_barrier
  v_mfma_f32_16x16x32_bf16 v[64:67], a[0:3], a[80:83], v[64:67]
  ds_read_b128 a[128:131], v10 offset:0
  s_add_u32 m0, s62, 49152
  v_mfma_f32_16x16x32_bf16 v[64:67], a[4:7], a[84:87], v[64:67]
  ds_read_b128 a[132:135], v11 offset:0
  buffer_load_dwordx4 v5, s[44:47], s61 offen offset:0 lds
  v_mfma_f32_16x16x32_bf16 v[68:71], a[0:3], a[88:91], v[68:71]
  ds_read_b128 a[136:139], v10 offset:2048
  v_mfma_f32_16x16x32_bf16 v[68:71], a[4:7], a[92:95], v[68:71]
  ds_read_b128 a[140:143], v11 offset:2048
  v_mfma_f32_16x16x32_bf16 v[72:75], a[0:3], a[96:99], v[72:75]
  ds_read_b128 a[144:147], v10 offset:4096
  s_add_u32 m0, s62, 50048
  v_mfma_f32_16x16x32_bf16 v[72:75], a[4:7], a[100:103], v[72:75]
  ds_read_b128 a[148:151], v11 offset:4096
  buffer_load_dwordx4 v5, s[44:47], s61 offen offset:128 lds
  v_mfma_f32_16x16x32_bf16 v[76:79], a[0:3], a[104:107], v[76:79]
  ds_read_b128 a[152:155], v10 offset:6144
  v_mfma_f32_16x16x32_bf16 v[76:79], a[4:7], a[108:111], v[76:79]
  ds_read_b128 a[156:159], v11 offset:6144
  v_mfma_f32_16x16x32_bf16 v[80:83], a[0:3], a[112:115], v[80:83]
  ds_read_b128 a[160:163], v10 offset:8192
  v_mfma_f32_16x16x32_bf16 v[80:83], a[4:7], a[116:119], v[80:83]
  ds_read_b128 a[164:167], v11 offset:8192
  s_add_u32 m0, s62, 50944
  v_mfma_f32_16x16x32_bf16 v[84:87], a[0:3], a[120:123], v[84:87]
  ds_read_b128 a[168:171], v10 offset:10240
  buffer_load_dwordx4 v5, s[44:47], s61 offen offset:256 lds
  v_mfma_f32_16x16x32_bf16 v[84:87], a[4:7], a[124:127], v[84:87]
  ds_read_b128 a[172:175], v11 offset:10240
  v_mfma_f32_16x16x32_bf16 v[88:91], a[8:11], a[80:83], v[88:91]
  ds_read_b64_tr_b16 a[40:41], v12 offset:0
  v_mfma_f32_16x16x32_bf16 v[88:91], a[12:15], a[84:87], v[88:91]
  ds_read_b64_tr_b16 a[42:43], v12 offset:512
  v_mfma_f32_16x16x32_bf16 v[92:95], a[8:11], a[88:91], v[92:95]
  ds_read_b64_tr_b16 a[44:45], v12 offset:3072
  s_add_u32 m0, s62, 52224
  v_mfma_f32_16x16x32_bf16 v[92:95], a[12:15], a[92:95], v[92:95]
  ds_read_b64_tr_b16 a[46:47], v12 offset:3584
  buffer_load_dwordx4 v5, s[48:51], s61 offen offset:0 lds
  v_mfma_f32_16x16x32_bf16 v[96:99], a[8:11], a[96:99], v[96:99]
  ds_read_b64_tr_b16 a[48:49], v13 offset:0
  v_mfma_f32_16x16x32_bf16 v[96:99], a[12:15], a[100:103], v[96:99]
  ds_read_b64_tr_b16 a[50:51], v13 offset:512
  v_mfma_f32_16x16x32_bf16 v[100:103], a[8:11], a[104:107], v[100:103]
  ds_read_b64_tr_b16 a[52:53], v13 offset:3072
  v_mfma_f32_16x16x32_bf16 v[100:103], a[12:15], a[108:111], v[100:103]
  ds_read_b64_tr_b16 a[54:55], v13 offset:3584
  s_add_u32 m0, s62, 53120
  v_mfma_f32_16x16x32_bf16 v[104:107], a[8:11], a[112:115], v[104:107]
  ds_read_b64_tr_b16 a[56:57], v14 offset:0
  buffer_load_dwordx4 v5, s[48:51], s61 offen offset:128 lds
  v_mfma_f32_16x16x32_bf16 v[104:107], a[12:15], a[116:119], v[104:107]
  ds_read_b64_tr_b16 a[58:59], v14 offset:512
  v_mfma_f32_16x16x32_bf16 v[108:111], a[8:11], a[120:123], v[108:111]
  ds_read_b64_tr_b16 a[60:61], v14 offset:3072
  v_mfma_f32_16x16x32_bf16 v[108:111], a[12:15], a[124:127], v[108:111]
  ds_read_b64_tr_b16 a[62:63], v14 offset:3584
  s_add_u32 m0, s62, 54016
  v_mfma_f32_16x16x32_bf16 v[112:115], a[16:19], a[80:83], v[112:115]
  ds_read_b64_tr_b16 a[64:65], v15 offset:0
  buffer_load_dwordx4 v5, s[48:51], s61 offen offset:256 lds
  s_add_u32 s61, s61, s67
  s_nop 0
  v_mfma_f32_16x16x32_bf16 v[112:115], a[20:23], a[84:87], v[112:115]
  ds_read_b64_tr_b16 a[66:67], v15 offset:512
  v_mfma_f32_16x16x32_bf16 v[116:119], a[16:19], a[88:91], v[116:119]
  ds_read_b64_tr_b16 a[68:69], v15 offset:3072
  v_mfma_f32_16x16x32_bf16 v[116:119], a[20:23], a[92:95], v[116:119]
  ds_read_b64_tr_b16 a[70:71], v15 offset:3584
  v_mfma_f32_16x16x32_bf16 v[120:123], a[16:19], a[96:99], v[120:123]
  ds_read_b64_tr_b16 a[72:73], v16 offset:0
  s_add_u32 m0, s63, 48512
  v_mfma_f32_16x16x32_bf16 v[120:123], a[20:23], a[100:103], v[120:123]
  ds_read_b64_tr_b16 a[74:75], v16 offset:512
  buffer_load_dwordx4 v6, s[40:43], 0 offen offset:640 lds
  v_mfma_f32_16x16x32_bf16 v[124:127], a[16:19], a[104:107], v[124:127]
  ds_read_b64_tr_b16 a[76:77], v16 offset:3072
  v_mfma_f32_16x16x32_bf16 v[124:127], a[20:23], a[108:111], v[124:127]
  ds_read_b64_tr_b16 a[78:79], v16 offset:3584
  v_mfma_f32_16x16x32_bf16 v[128:131], a[16:19], a[112:115], v[128:131]
  v_mfma_f32_16x16x32_bf16 v[128:131], a[20:23], a[116:119], v[128:131]
  s_add_u32 m0, s63, 49536
  v_mfma_f32_16x16x32_bf16 v[132:135], a[16:19], a[120:123], v[132:135]
  buffer_load_dwordx4 v7, s[40:43], 0 offen offset:640 lds
  v_mfma_f32_16x16x32_bf16 v[132:135], a[20:23], a[124:127], v[132:135]
  v_mfma_f32_16x16x32_bf16 v[136:139], a[24:27], a[80:83], v[136:139]
  v_mfma_f32_16x16x32_bf16 v[136:139], a[28:31], a[84:87], v[136:139]
  v_mfma_f32_16x16x32_bf16 v[140:143], a[24:27], a[88:91], v[140:143]
  s_add_u32 m0, s63, 50560
  v_mfma_f32_16x16x32_bf16 v[140:143], a[28:31], a[92:95], v[140:143]
  buffer_load_dwordx4 v8, s[40:43], 0 offen offset:640 lds
  v_mfma_f32_16x16x32_bf16 v[144:147], a[24:27], a[96:99], v[144:147]
  v_mfma_f32_16x16x32_bf16 v[144:147], a[28:31], a[100:103], v[144:147]
  v_mfma_f32_16x16x32_bf16 v[148:151], a[24:27], a[104:107], v[148:151]
  s_add_u32 m0, s63, 51584
  v_mfma_f32_16x16x32_bf16 v[148:151], a[28:31], a[108:111], v[148:151]
  buffer_load_dwordx4 v9, s[40:43], 0 offen offset:640 lds
  v_mfma_f32_16x16x32_bf16 v[152:155], a[24:27], a[112:115], v[152:155]
  v_mfma_f32_16x16x32_bf16 v[152:155], a[28:31], a[116:119], v[152:155]
  v_mfma_f32_16x16x32_bf16 v[156:159], a[24:27], a[120:123], v[156:159]
  v_mfma_f32_16x16x32_bf16 v[156:159], a[28:31], a[124:127], v[156:159]
  s_add_u32 m0, s63, 52608
  v_mfma_f32_16x16x32_bf16 v[160:163], a[32:35], a[80:83], v[160:163]
  buffer_load_dwordx4 v6, s[40:43], s101 offen offset:640 lds
  v_mfma_f32_16x16x32_bf16 v[160:163], a[36:39], a[84:87], v[160:163]
  v_mfma_f32_16x16x32_bf16 v[164:167], a[32:35], a[88:91], v[164:167]
  v_mfma_f32_16x16x32_bf16 v[164:167], a[36:39], a[92:95], v[164:167]
  v_mfma_f32_16x16x32_bf16 v[168:171], a[32:35], a[96:99], v[168:171]
  s_add_u32 m0, s63, 53632
  v_mfma_f32_16x16x32_bf16 v[168:171], a[36:39], a[100:103], v[168:171]
  buffer_load_dwordx4 v7, s[40:43], s101 offen offset:640 lds
  v_mfma_f32_16x16x32_bf16 v[172:175], a[32:35], a[104:107], v[172:175]
  v_mfma_f32_16x16x32_bf16 v[172:175], a[36:39], a[108:111], v[172:175]
  v_mfma_f32_16x16x32_bf16 v[176:179], a[32:35], a[112:115], v[176:179]
  v_mfma_f32_16x16x32_bf16 v[176:179], a[36:39], a[116:119], v[176:179]
  v_mfma_f32_16x16x32_bf16 v[180:183], a[32:35], a[120:123], v[180:183]
  v_mfma_f32_16x16x32_bf16 v[180:183], a[36:39], a[124:127], v[180:183]
  s_waitcnt vmcnt(12) lgkmcnt(0)
  s_barrier
  v_mfma_f32_16x16x32_bf16 v[64:67], a[40:43], a[128:131], v[64:67]
  ds_read_b128 a[80:83], v10 offset:24576
  s_add_u32 m0, s62, 0
  s_nop 0
  v_mfma_f32_16x16x32_bf16 v[64:67], a[44:47], a[132:135], v[64:67]
  ds_read_b128 a[84:87], v11 offset:24576
  buffer_load_dwordx4 v5, s[44:47], s61 offen offset:0 lds
  v_mfma_f32_16x16x32_bf16 v[68:71], a[40:43], a[136:139], v[68:71]
  ds_read_b128 a[88:91], v10 offset:26624
  v_mfma_f32_16x16x32_bf16 v[68:71], a[44:47], a[140:143], v[68:71]
  ds_read_b128 a[92:95], v11 offset:26624
  v_mfma_f32_16x16x32_bf16 v[72:75], a[40:43], a[144:147], v[72:75]
  ds_read_b128 a[96:99], v10 offset:28672
  s_add_u32 m0, s62, 896
  v_mfma_f32_16x16x32_bf16 v[72:75], a[44:47], a[148:151], v[72:75]
  ds_read_b128 a[100:103], v11 offset:28672
  buffer_load_dwordx4 v5, s[44:47], s61 offen offset:128 lds
  v_mfma_f32_16x16x32_bf16 v[76:79], a[40:43], a[152:155], v[76:79]
  ds_read_b128 a[104:107], v10 offset:30720
  v_mfma_f32_16x16x32_bf16 v[76:79], a[44:47], a[156:159], v[76:79]
  ds_read_b128 a[108:111], v11 offset:30720
  v_mfma_f32_16x16x32_bf16 v[80:83], a[40:43], a[160:163], v[80:83]
  ds_read_b128 a[112:115], v10 offset:32768
  v_mfma_f32_16x16x32_bf16 v[80:83], a[44:47], a[164:167], v[80:83]
  ds_read_b128 a[116:119], v11 offset:32768
  s_add_u32 m0, s62, 1792
  v_mfma_f32_16x16x32_bf16 v[84:87], a[40:43], a[168:171], v[84:87]
  ds_read_b128 a[120:123], v10 offset:34816
  buffer_load_dwordx4 v5, s[44:47], s61 offen offset:256 lds
  v_mfma_f32_16x16x32_bf16 v[84:87], a[44:47], a[172:175], v[84:87]
  ds_read_b128 a[124:127], v11 offset:34816
  v_mfma_f32_16x16x32_bf16 v[88:91], a[48:51], a[128:131], v[88:91]
  ds_read_b64_tr_b16 a[0:1], v12 offset:24576
  v_mfma_f32_16x16x32_bf16 v[88:91], a[52:55], a[132:135], v[88:91]
  ds_read_b64_tr_b16 a[2:3], v12 offset:25088
  v_mfma_f32_16x16x32_bf16 v[92:95], a[48:51], a[136:139], v[92:95]
  ds_read_b64_tr_b16 a[4:5], v12 offset:27648
  s_add_u32 m0, s62, 3072
  v_mfma_f32_16x16x32_bf16 v[92:95], a[52:55], a[140:143], v[92:95]
  ds_read_b64_tr_b16 a[6:7], v12 offset:28160
  buffer_load_dwordx4 v5, s[48:51], s61 offen offset:0 lds
  v_mfma_f32_16x16x32_bf16 v[96:99], a[48:51], a[144:147], v[96:99]
  ds_read_b64_tr_b16 a[8:9], v13 offset:24576
  v_mfma_f32_16x16x32_bf16 v[96:99], a[52:55], a[148:151], v[96:99]
  ds_read_b64_tr_b16 a[10:11], v13 offset:25088
  v_mfma_f32_16x16x32_bf16 v[100:103], a[48:51], a[152:155], v[100:103]
  ds_read_b64_tr_b16 a[12:13], v13 offset:27648
  v_mfma_f32_16x16x32_bf16 v[100:103], a[52:55], a[156:159], v[100:103]
  ds_read_b64_tr_b16 a[14:15], v13 offset:28160
  s_add_u32 m0, s62, 3968
  v_mfma_f32_16x16x32_bf16 v[104:107], a[48:51], a[160:163], v[104:107]
  ds_read_b64_tr_b16 a[16:17], v14 offset:24576
  buffer_load_dwordx4 v5, s[48:51], s61 offen offset:128 lds
  v_mfma_f32_16x16x32_bf16 v[104:107], a[52:55], a[164:167], v[104:107]
  ds_read_b64_tr_b16 a[18:19], v14 offset:25088
  v_mfma_f32_16x16x32_bf16 v[108:111], a[48:51], a[168:171], v[108:111]
  ds_read_b64_tr_b16 a[20:21], v14 offset:27648
  v_mfma_f32_16x16x32_bf16 v[108:111], a[52:55], a[172:175], v[108:111]
  ds_read_b64_tr_b16 a[22:23], v14 offset:28160
  s_add_u32 m0, s62, 4864
  v_mfma_f32_16x16x32_bf16 v[112:115], a[56:59], a[128:131], v[112:115]
  ds_read_b64_tr_b16 a[24:25], v15 offset:24576
  buffer_load_dwordx4 v5, s[48:51], s61 offen offset:256 lds
  s_add_u32 s61, s61, s67
  s_nop 0
  v_mfma_f32_16x16x32_bf16 v[112:115], a[60:63], a[132:135], v[112:115]
  ds_read_b64_tr_b16 a[26:27], v15 offset:25088
  v_mfma_f32_16x16x32_bf16 v[116:119], a[56:59], a[136:139], v[116:119]
  ds_read_b64_tr_b16 a[28:29], v15 offset:27648
  v_mfma_f32_16x16x32_bf16 v[116:119], a[60:63], a[140:143], v[116:119]
  ds_read_b64_tr_b16 a[30:31], v15 offset:28160
  v_mfma_f32_16x16x32_bf16 v[120:123], a[56:59], a[144:147], v[120:123]
  ds_read_b64_tr_b16 a[32:33], v16 offset:24576
  s_add_u32 m0, s63, -768
  v_mfma_f32_16x16x32_bf16 v[120:123], a[60:63], a[148:151], v[120:123]
  ds_read_b64_tr_b16 a[34:35], v16 offset:25088
  buffer_load_dwordx4 v6, s[40:43], 0 offen offset:768 lds
  v_mfma_f32_16x16x32_bf16 v[124:127], a[56:59], a[152:155], v[124:127]
  ds_read_b64_tr_b16 a[36:37], v16 offset:27648
  v_mfma_f32_16x16x32_bf16 v[124:127], a[60:63], a[156:159], v[124:127]
  ds_read_b64_tr_b16 a[38:39], v16 offset:28160
  v_mfma_f32_16x16x32_bf16 v[128:131], a[56:59], a[160:163], v[128:131]
  v_mfma_f32_16x16x32_bf16 v[128:131], a[60:63], a[164:167], v[128:131]
  s_add_u32 m0, s63, 256
  v_mfma_f32_16x16x32_bf16 v[132:135], a[56:59], a[168:171], v[132:135]
  buffer_load_dwordx4 v7, s[40:43], 0 offen offset:768 lds
  v_mfma_f32_16x16x32_bf16 v[132:135], a[60:63], a[172:175], v[132:135]
  v_mfma_f32_16x16x32_bf16 v[136:139], a[64:67], a[128:131], v[136:139]
  v_mfma_f32_16x16x32_bf16 v[136:139], a[68:71], a[132:135], v[136:139]
  v_mfma_f32_16x16x32_bf16 v[140:143], a[64:67], a[136:139], v[140:143]
  s_add_u32 m0, s63, 1280
  v_mfma_f32_16x16x32_bf16 v[140:143], a[68:71], a[140:143], v[140:143]
  buffer_load_dwordx4 v8, s[40:43], 0 offen offset:768 lds
  v_mfma_f32_16x16x32_bf16 v[144:147], a[64:67], a[144:147], v[144:147]
  v_mfma_f32_16x16x32_bf16 v[144:147], a[68:71], a[148:151], v[144:147]
  v_mfma_f32_16x16x32_bf16 v[148:151], a[64:67], a[152:155], v[148:151]
  s_add_u32 m0, s63, 2304
  v_mfma_f32_16x16x32_bf16 v[148:151], a[68:71], a[156:159], v[148:151]
  buffer_load_dwordx4 v9, s[40:43], 0 offen offset:768 lds
  v_mfma_f32_16x16x32_bf16 v[152:155], a[64:67], a[160:163], v[152:155]
  v_mfma_f32_16x16x32_bf16 v[152:155], a[68:71], a[164:167], v[152:155]
  v_mfma_f32_16x16x32_bf16 v[156:159], a[64:67], a[168:171], v[156:159]
  v_mfma_f32_16x16x32_bf16 v[156:159], a[68:71], a[172:175], v[156:159]
  s_add_u32 m0, s63, 3328
  v_mfma_f32_16x16x32_bf16 v[160:163], a[72:75], a[128:131], v[160:163]
  buffer_load_dwordx4 v6, s[40:43], s101 offen offset:768 lds
  v_mfma_f32_16x16x32_bf16 v[160:163], a[76:79], a[132:135], v[160:163]
  v_mfma_f32_16x16x32_bf16 v[164:167], a[72:75], a[136:139], v[164:167]
  v_mfma_f32_16x16x32_bf16 v[164:167], a[76:79], a[140:143], v[164:167]
  v_mfma_f32_16x16x32_bf16 v[168:171], a[72:75], a[144:147], v[168:171]
  s_add_u32 m0, s63, 4352
  v_mfma_f32_16x16x32_bf16 v[168:171], a[76:79], a[148:151], v[168:171]
  buffer_load_dwordx4 v7, s[40:43], s101 offen offset:768 lds
  v_mfma_f32_16x16x32_bf16 v[172:175], a[72:75], a[152:155], v[172:175]
  v_mfma_f32_16x16x32_bf16 v[172:175], a[76:79], a[156:159], v[172:175]
  v_mfma_f32_16x16x32_bf16 v[176:179], a[72:75], a[160:163], v[176:179]
  v_mfma_f32_16x16x32_bf16 v[176:179], a[76:79], a[164:167], v[176:179]
  v_mfma_f32_16x16x32_bf16 v[180:183], a[72:75], a[168:171], v[180:183]
  v_mfma_f32_16x16x32_bf16 v[180:183], a[76:79], a[172:175], v[180:183]
  s_waitcnt vmcnt(12) lgkmcnt(0)
  s_barrier
  v_mfma_f32_16x16x32_bf16 v[64:67], a[0:3], a[80:83], v[64:67]
  ds_read_b128 a[128:131], v10 offset:49152
  s_add_u32 m0, s62, 24576
  v_mfma_f32_16x16x32_bf16 v[64:67], a[4:7], a[84:87], v[64:67]
  ds_read_b128 a[132:135], v11 offset:49152
  buffer_load_dwordx4 v5, s[44:47], s61 offen offset:0 lds
  v_mfma_f32_16x16x32_bf16 v[68:71], a[0:3], a[88:91], v[68:71]
  ds_read_b128 a[136:139], v10 offset:51200
  v_mfma_f32_16x16x32_bf16 v[68:71], a[4:7], a[92:95], v[68:71]
  ds_read_b128 a[140:143], v11 offset:51200
  v_mfma_f32_16x16x32_bf16 v[72:75], a[0:3], a[96:99], v[72:75]
  ds_read_b128 a[144:147], v10 offset:53248
  s_add_u32 m0, s62, 25472
  v_mfma_f32_16x16x32_bf16 v[72:75], a[4:7], a[100:103], v[72:75]
  ds_read_b128 a[148:151], v11 offset:53248
  buffer_load_dwordx4 v5, s[44:47], s61 offen offset:128 lds
  v_mfma_f32_16x16x32_bf16 v[76:79], a[0:3], a[104:107], v[76:79]
  ds_read_b128 a[152:155], v10 offset:55296
  v_mfma_f32_16x16x32_bf16 v[76:79], a[4:7], a[108:111], v[76:79]
  ds_read_b128 a[156:159], v11 offset:55296
  v_mfma_f32_16x16x32_bf16 v[80:83], a[0:3], a[112:115], v[80:83]
  ds_read_b128 a[160:163], v10 offset:57344
  v_mfma_f32_16x16x32_bf16 v[80:83], a[4:7], a[116:119], v[80:83]
  ds_read_b128 a[164:167], v11 offset:57344
  s_add_u32 m0, s62, 26368
  v_mfma_f32_16x16x32_bf16 v[84:87], a[0:3], a[120:123], v[84:87]
  ds_read_b128 a[168:171], v10 offset:59392
  buffer_load_dwordx4 v5, s[44:47], s61 offen offset:256 lds
  v_mfma_f32_16x16x32_bf16 v[84:87], a[4:7], a[124:127], v[84:87]
  ds_read_b128 a[172:175], v11 offset:59392
  v_mfma_f32_16x16x32_bf16 v[88:91], a[8:11], a[80:83], v[88:91]
  ds_read_b64_tr_b16 a[40:41], v12 offset:49152
  v_mfma_f32_16x16x32_bf16 v[88:91], a[12:15], a[84:87], v[88:91]
  ds_read_b64_tr_b16 a[42:43], v12 offset:49664
  v_mfma_f32_16x16x32_bf16 v[92:95], a[8:11], a[88:91], v[92:95]
  ds_read_b64_tr_b16 a[44:45], v12 offset:52224
  s_add_u32 m0, s62, 27648
  v_mfma_f32_16x16x32_bf16 v[92:95], a[12:15], a[92:95], v[92:95]
  ds_read_b64_tr_b16 a[46:47], v12 offset:52736
  buffer_load_dwordx4 v5, s[48:51], s61 offen offset:0 lds
  v_mfma_f32_16x16x32_bf16 v[96:99], a[8:11], a[96:99], v[96:99]
  ds_read_b64_tr_b16 a[48:49], v13 offset:49152
  v_mfma_f32_16x16x32_bf16 v[96:99], a[12:15], a[100:103], v[96:99]
  ds_read_b64_tr_b16 a[50:51], v13 offset:49664
  v_mfma_f32_16x16x32_bf16 v[100:103], a[8:11], a[104:107], v[100:103]
  ds_read_b64_tr_b16 a[52:53], v13 offset:52224
  v_mfma_f32_16x16x32_bf16 v[100:103], a[12:15], a[108:111], v[100:103]
  ds_read_b64_tr_b16 a[54:55], v13 offset:52736
  s_add_u32 m0, s62, 28544
  v_mfma_f32_16x16x32_bf16 v[104:107], a[8:11], a[112:115], v[104:107]
  ds_read_b64_tr_b16 a[56:57], v14 offset:49152
  buffer_load_dwordx4 v5, s[48:51], s61 offen offset:128 lds
  v_mfma_f32_16x16x32_bf16 v[104:107], a[12:15], a[116:119], v[104:107]
  ds_read_b64_tr_b16 a[58:59], v14 offset:49664
  v_mfma_f32_16x16x32_bf16 v[108:111], a[8:11], a[120:123], v[108:111]
  ds_read_b64_tr_b16 a[60:61], v14 offset:52224
  v_mfma_f32_16x16x32_bf16 v[108:111], a[12:15], a[124:127], v[108:111]
  ds_read_b64_tr_b16 a[62:63], v14 offset:52736
  s_add_u32 m0, s62, 29440
  v_mfma_f32_16x16x32_bf16 v[112:115], a[16:19], a[80:83], v[112:115]
  ds_read_b64_tr_b16 a[64:65], v15 offset:49152
  buffer_load_dwordx4 v5, s[48:51], s61 offen offset:256 lds
  s_add_u32 s61, s61, s67
  s_nop 0
  v_mfma_f32_16x16x32_bf16 v[112:115], a[20:23], a[84:87], v[112:115]
  ds_read_b64_tr_b16 a[66:67], v15 offset:49664
  v_mfma_f32_16x16x32_bf16 v[116:119], a[16:19], a[88:91], v[116:119]
  ds_read_b64_tr_b16 a[68:69], v15 offset:52224
  v_mfma_f32_16x16x32_bf16 v[116:119], a[20:23], a[92:95], v[116:119]
  ds_read_b64_tr_b16 a[70:71], v15 offset:52736
  v_mfma_f32_16x16x32_bf16 v[120:123], a[16:19], a[96:99], v[120:123]
  ds_read_b64_tr_b16 a[72:73], v16 offset:49152
  s_add_u32 m0, s63, 23680
  v_mfma_f32_16x16x32_bf16 v[120:123], a[20:23], a[100:103], v[120:123]
  ds_read_b64_tr_b16 a[74:75], v16 offset:49664
  buffer_load_dwordx4 v6, s[40:43], 0 offen offset:896 lds
  v_mfma_f32_16x16x32_bf16 v[124:127], a[16:19], a[104:107], v[124:127]
  ds_read_b64_tr_b16 a[76:77], v16 offset:52224
  v_mfma_f32_16x16x32_bf16 v[124:127], a[20:23], a[108:111], v[124:127]
  ds_read_b64_tr_b16 a[78:79], v16 offset:52736
  v_mfma_f32_16x16x32_bf16 v[128:131], a[16:19], a[112:115], v[128:131]
  v_mfma_f32_16x16x32_bf16 v[128:131], a[20:23], a[116:119], v[128:131]
  s_add_u32 m0, s63, 24704
  v_mfma_f32_16x16x32_bf16 v[132:135], a[16:19], a[120:123], v[132:135]
  buffer_load_dwordx4 v7, s[40:43], 0 offen offset:896 lds
  v_mfma_f32_16x16x32_bf16 v[132:135], a[20:23], a[124:127], v[132:135]
  v_mfma_f32_16x16x32_bf16 v[136:139], a[24:27], a[80:83], v[136:139]
  v_mfma_f32_16x16x32_bf16 v[136:139], a[28:31], a[84:87], v[136:139]
  v_mfma_f32_16x16x32_bf16 v[140:143], a[24:27], a[88:91], v[140:143]
  s_add_u32 m0, s63, 25728
  v_mfma_f32_16x16x32_bf16 v[140:143], a[28:31], a[92:95], v[140:143]
  buffer_load_dwordx4 v8, s[40:43], 0 offen offset:896 lds
  v_mfma_f32_16x16x32_bf16 v[144:147], a[24:27], a[96:99], v[144:147]
  v_mfma_f32_16x16x32_bf16 v[144:147], a[28:31], a[100:103], v[144:147]
  v_mfma_f32_16x16x32_bf16 v[148:151], a[24:27], a[104:107], v[148:151]
  s_add_u32 m0, s63, 26752
  v_mfma_f32_16x16x32_bf16 v[148:151], a[28:31], a[108:111], v[148:151]
  buffer_load_dwordx4 v9, s[40:43], 0 offen offset:896 lds
  v_mfma_f32_16x16x32_bf16 v[152:155], a[24:27], a[112:115], v[152:155]
  v_mfma_f32_16x16x32_bf16 v[152:155], a[28:31], a[116:119], v[152:155]
  v_mfma_f32_16x16x32_bf16 v[156:159], a[24:27], a[120:123], v[156:159]
  v_mfma_f32_16x16x32_bf16 v[156:159], a[28:31], a[124:127], v[156:159]
  s_add_u32 m0, s63, 27776
  v_mfma_f32_16x16x32_bf16 v[160:163], a[32:35], a[80:83], v[160:163]
  buffer_load_dwordx4 v6, s[40:43], s101 offen offset:896 lds
  v_mfma_f32_16x16x32_bf16 v[160:163], a[36:39], a[84:87], v[160:163]
  v_mfma_f32_16x16x32_bf16 v[164:167], a[32:35], a[88:91], v[164:167]
  v_mfma_f32_16x16x32_bf16 v[164:167], a[36:39], a[92:95], v[164:167]
  v_mfma_f32_16x16x32_bf16 v[168:171], a[32:35], a[96:99], v[168:171]
  s_add_u32 m0, s63, 28800
  v_mfma_f32_16x16x32_bf16 v[168:171], a[36:39], a[100:103], v[168:171]
  buffer_load_dwordx4 v7, s[40:43], s101 offen offset:896 lds
  v_mfma_f32_16x16x32_bf16 v[172:175], a[32:35], a[104:107], v[172:175]
  v_mfma_f32_16x16x32_bf16 v[172:175], a[36:39], a[108:111], v[172:175]
  v_mfma_f32_16x16x32_bf16 v[176:179], a[32:35], a[112:115], v[176:179]
  v_mfma_f32_16x16x32_bf16 v[176:179], a[36:39], a[116:119], v[176:179]
  v_mfma_f32_16x16x32_bf16 v[180:183], a[32:35], a[120:123], v[180:183]
  v_mfma_f32_16x16x32_bf16 v[180:183], a[36:39], a[124:127], v[180:183]
  s_waitcnt vmcnt(12) lgkmcnt(0)
  s_barrier
  v_mfma_f32_16x16x32_bf16 v[64:67], a[40:43], a[128:131], v[64:67]
  ds_read_b128 a[80:83], v10 offset:0
  s_add_u32 m0, s62, 49152
  v_mfma_f32_16x16x32_bf16 v[64:67], a[44:47], a[132:135], v[64:67]
  ds_read_b128 a[84:87], v11 offset:0
  buffer_load_dwordx4 v5, s[44:47], s61 offen offset:0 lds
  v_mfma_f32_16x16x32_bf16 v[68:71], a[40:43], a[136:139], v[68:71]
  ds_read_b128 a[88:91], v10 offset:2048
  v_mfma_f32_16x16x32_bf16 v[68:71], a[44:47], a[140:143], v[68:71]
  ds_read_b128 a[92:95], v11 offset:2048
  v_mfma_f32_16x16x32_bf16 v[72:75], a[40:43], a[144:147], v[72:75]
  ds_read_b128 a[96:99], v10 offset:4096
  s_add_u32 m0, s62, 50048
  v_mfma_f32_16x16x32_bf16 v[72:75], a[44:47], a[148:151], v[72:75]
  ds_read_b128 a[100:103], v11 offset:4096
  buffer_load_dwordx4 v5, s[44:47], s61 offen offset:128 lds
  v_mfma_f32_16x16x32_bf16 v[76:79], a[40:43], a[152:155], v[76:79]
  ds_read_b128 a[104:107], v10 offset:6144
  v_mfma_f32_16x16x32_bf16 v[76:79], a[44:47], a[156:159], v[76:79]
  ds_read_b128 a[108:111], v11 offset:6144
  v_mfma_f32_16x16x32_bf16 v[80:83], a[40:43], a[160:163], v[80:83]
  ds_read_b128 a[112:115], v10 offset:8192
  v_mfma_f32_16x16x32_bf16 v[80:83], a[44:47], a[164:167], v[80:83]
  ds_read_b128 a[116:119], v11 offset:8192
  s_add_u32 m0, s62, 50944
  v_mfma_f32_16x16x32_bf16 v[84:87], a[40:43], a[168:171], v[84:87]
  ds_read_b128 a[120:123], v10 offset:10240
  buffer_load_dwordx4 v5, s[44:47], s61 offen offset:256 lds
  v_mfma_f32_16x16x32_bf16 v[84:87], a[44:47], a[172:175], v[84:87]
  ds_read_b128 a[124:127], v11 offset:10240
  v_mfma_f32_16x16x32_bf16 v[88:91], a[48:51], a[128:131], v[88:91]
  ds_read_b64_tr_b16 a[0:1], v12 offset:0
  v_mfma_f32_16x16x32_bf16 v[88:91], a[52:55], a[132:135], v[88:91]
  ds_read_b64_tr_b16 a[2:3], v12 offset:512
  v_mfma_f32_16x16x32_bf16 v[92:95], a[48:51], a[136:139], v[92:95]
  ds_read_b64_tr_b16 a[4:5], v12 offset:3072
  s_add_u32 m0, s62, 52224
  v_mfma_f32_16x16x32_bf16 v[92:95], a[52:55], a[140:143], v[92:95]
  ds_read_b64_tr_b16 a[6:7], v12 offset:3584
  buffer_load_dwordx4 v5, s[48:51], s61 offen offset:0 lds
  v_mfma_f32_16x16x32_bf16 v[96:99], a[48:51], a[144:147], v[96:99]
  ds_read_b64_tr_b16 a[8:9], v13 offset:0
  v_mfma_f32_16x16x32_bf16 v[96:99], a[52:55], a[148:151], v[96:99]
  ds_read_b64_tr_b16 a[10:11], v13 offset:512
  v_mfma_f32_16x16x32_bf16 v[100:103], a[48:51], a[152:155], v[100:103]
  ds_read_b64_tr_b16 a[12:13], v13 offset:3072
  v_mfma_f32_16x16x32_bf16 v[100:103], a[52:55], a[156:159], v[100:103]
  ds_read_b64_tr_b16 a[14:15], v13 offset:3584
  s_add_u32 m0, s62, 53120
  v_mfma_f32_16x16x32_bf16 v[104:107], a[48:51], a[160:163], v[104:107]
  ds_read_b64_tr_b16 a[16:17], v14 offset:0
  buffer_load_dwordx4 v5, s[48:51], s61 offen offset:128 lds
  v_mfma_f32_16x16x32_bf16 v[104:107], a[52:55], a[164:167], v[104:107]
  ds_read_b64_tr_b16 a[18:19], v14 offset:512
  v_mfma_f32_16x16x32_bf16 v[108:111], a[48:51], a[168:171], v[108:111]
  ds_read_b64_tr_b16 a[20:21], v14 offset:3072
  v_mfma_f32_16x16x32_bf16 v[108:111], a[52:55], a[172:175], v[108:111]
  ds_read_b64_tr_b16 a[22:23], v14 offset:3584
  s_add_u32 m0, s62, 54016
  v_mfma_f32_16x16x32_bf16 v[112:115], a[56:59], a[128:131], v[112:115]
  ds_read_b64_tr_b16 a[24:25], v15 offset:0
  buffer_load_dwordx4 v5, s[48:51], s61 offen offset:256 lds
  s_add_u32 s61, s61, s67
  s_nop 0
  v_mfma_f32_16x16x32_bf16 v[112:115], a[60:63], a[132:135], v[112:115]
  ds_read_b64_tr_b16 a[26:27], v15 offset:512
  v_mfma_f32_16x16x32_bf16 v[116:119], a[56:59], a[136:139], v[116:119]
  ds_read_b64_tr_b16 a[28:29], v15 offset:3072
  v_mfma_f32_16x16x32_bf16 v[116:119], a[60:63], a[140:143], v[116:119]
  ds_read_b64_tr_b16 a[30:31], v15 offset:3584
  v_mfma_f32_16x16x32_bf16 v[120:123], a[56:59], a[144:147], v[120:123]
  ds_read_b64_tr_b16 a[32:33], v16 offset:0
  s_add_u32 m0, s63, 48128
  v_mfma_f32_16x16x32_bf16 v[120:123], a[60:63], a[148:151], v[120:123]
  ds_read_b64_tr_b16 a[34:35], v16 offset:512
  buffer_load_dwordx4 v6, s[40:43], 0 offen offset:1024 lds
  v_mfma_f32_16x16x32_bf16 v[124:127], a[56:59], a[152:155], v[124:127]
  ds_read_b64_tr_b16 a[36:37], v16 offset:3072
  v_mfma_f32_16x16x32_bf16 v[124:127], a[60:63], a[156:159], v[124:127]
  ds_read_b64_tr_b16 a[38:39], v16 offset:3584
  v_mfma_f32_16x16x32_bf16 v[128:131], a[56:59], a[160:163], v[128:131]
  v_mfma_f32_16x16x32_bf16 v[128:131], a[60:63], a[164:167], v[128:131]
  s_add_u32 m0, s63, 49152
  v_mfma_f32_16x16x32_bf16 v[132:135], a[56:59], a[168:171], v[132:135]
  buffer_load_dwordx4 v7, s[40:43], 0 offen offset:1024 lds
  v_mfma_f32_16x16x32_bf16 v[132:135], a[60:63], a[172:175], v[132:135]
  v_mfma_f32_16x16x32_bf16 v[136:139], a[64:67], a[128:131], v[136:139]
  v_mfma_f32_16x16x32_bf16 v[136:139], a[68:71], a[132:135], v[136:139]
  v_mfma_f32_16x16x32_bf16 v[140:143], a[64:67], a[136:139], v[140:143]
  s_add_u32 m0, s63, 50176
  v_mfma_f32_16x16x32_bf16 v[140:143], a[68:71], a[140:143], v[140:143]
  buffer_load_dwordx4 v8, s[40:43], 0 offen offset:1024 lds
  v_mfma_f32_16x16x32_bf16 v[144:147], a[64:67], a[144:147], v[144:147]
  v_mfma_f32_16x16x32_bf16 v[144:147], a[68:71], a[148:151], v[144:147]
  v_mfma_f32_16x16x32_bf16 v[148:151], a[64:67], a[152:155], v[148:151]
  s_add_u32 m0, s63, 51200
  v_mfma_f32_16x16x32_bf16 v[148:151], a[68:71], a[156:159], v[148:151]
  buffer_load_dwordx4 v9, s[40:43], 0 offen offset:1024 lds
  v_mfma_f32_16x16x32_bf16 v[152:155], a[64:67], a[160:163], v[152:155]
  v_mfma_f32_16x16x32_bf16 v[152:155], a[68:71], a[164:167], v[152:155]
  v_mfma_f32_16x16x32_bf16 v[156:159], a[64:67], a[168:171], v[156:159]
  v_mfma_f32_16x16x32_bf16 v[156:159], a[68:71], a[172:175], v[156:159]
  s_add_u32 m0, s63, 52224
  v_mfma_f32_16x16x32_bf16 v[160:163], a[72:75], a[128:131], v[160:163]
  buffer_load_dwordx4 v6, s[40:43], s101 offen offset:1024 lds
  v_mfma_f32_16x16x32_bf16 v[160:163], a[76:79], a[132:135], v[160:163]
  v_mfma_f32_16x16x32_bf16 v[164:167], a[72:75], a[136:139], v[164:167]
  v_mfma_f32_16x16x32_bf16 v[164:167], a[76:79], a[140:143], v[164:167]
  v_mfma_f32_16x16x32_bf16 v[168:171], a[72:75], a[144:147], v[168:171]
  s_add_u32 m0, s63, 53248
  v_mfma_f32_16x16x32_bf16 v[168:171], a[76:79], a[148:151], v[168:171]
  buffer_load_dwordx4 v7, s[40:43], s101 offen offset:1024 lds
  v_mfma_f32_16x16x32_bf16 v[172:175], a[72:75], a[152:155], v[172:175]
  v_mfma_f32_16x16x32_bf16 v[172:175], a[76:79], a[156:159], v[172:175]
  v_mfma_f32_16x16x32_bf16 v[176:179], a[72:75], a[160:163], v[176:179]
  v_mfma_f32_16x16x32_bf16 v[176:179], a[76:79], a[164:167], v[176:179]
  v_mfma_f32_16x16x32_bf16 v[180:183], a[72:75], a[168:171], v[180:183]
  v_mfma_f32_16x16x32_bf16 v[180:183], a[76:79], a[172:175], v[180:183]
  s_waitcnt vmcnt(12) lgkmcnt(0)
  s_barrier
  v_mfma_f32_16x16x32_bf16 v[64:67], a[0:3], a[80:83], v[64:67]
  ds_read_b128 a[128:131], v10 offset:24576
  s_add_u32 m0, s62, 0
  s_nop 0
  v_mfma_f32_16x16x32_bf16 v[64:67], a[4:7], a[84:87], v[64:67]
  ds_read_b128 a[132:135], v11 offset:24576
  buffer_load_dwordx4 v5, s[44:47], s61 offen offset:0 lds
  v_mfma_f32_16x16x32_bf16 v[68:71], a[0:3], a[88:91], v[68:71]
  ds_read_b128 a[136:139], v10 offset:26624
  v_mfma_f32_16x16x32_bf16 v[68:71], a[4:7], a[92:95], v[68:71]
  ds_read_b128 a[140:143], v11 offset:26624
  v_mfma_f32_16x16x32_bf16 v[72:75], a[0:3], a[96:99], v[72:75]
  ds_read_b128 a[144:147], v10 offset:28672
  s_add_u32 m0, s62, 896
  v_mfma_f32_16x16x32_bf16 v[72:75], a[4:7], a[100:103], v[72:75]
  ds_read_b128 a[148:151], v11 offset:28672
  buffer_load_dwordx4 v5, s[44:47], s61 offen offset:128 lds
  v_mfma_f32_16x16x32_bf16 v[76:79], a[0:3], a[104:107], v[76:79]
  ds_read_b128 a[152:155], v10 offset:30720
  v_mfma_f32_16x16x32_bf16 v[76:79], a[4:7], a[108:111], v[76:79]
  ds_read_b128 a[156:159], v11 offset:30720
  v_mfma_f32_16x16x32_bf16 v[80:83], a[0:3], a[112:115], v[80:83]
  ds_read_b128 a[160:163], v10 offset:32768
  v_mfma_f32_16x16x32_bf16 v[80:83], a[4:7], a[116:119], v[80:83]
  ds_read_b128 a[164:167], v11 offset:32768
  s_add_u32 m0, s62, 1792
  v_mfma_f32_16x16x32_bf16 v[84:87], a[0:3], a[120:123], v[84:87]
  ds_read_b128 a[168:171], v10 offset:34816
  buffer_load_dwordx4 v5, s[44:47], s61 offen offset:256 lds
  v_mfma_f32_16x16x32_bf16 v[84:87], a[4:7], a[124:127], v[84:87]
  ds_read_b128 a[172:175], v11 offset:34816
  v_mfma_f32_16x16x32_bf16 v[88:91], a[8:11], a[80:83], v[88:91]
  ds_read_b64_tr_b16 a[40:41], v12 offset:24576
  v_mfma_f32_16x16x32_bf16 v[88:91], a[12:15], a[84:87], v[88:91]
  ds_read_b64_tr_b16 a[42:43], v12 offset:25088
  v_mfma_f32_16x16x32_bf16 v[92:95], a[8:11], a[88:91], v[92:95]
  ds_read_b64_tr_b16 a[44:45], v12 offset:27648
  s_add_u32 m0, s62, 3072
  v_mfma_f32_16x16x32_bf16 v[92:95], a[12:15], a[92:95], v[92:95]
  ds_read_b64_tr_b16 a[46:47], v12 offset:28160
  buffer_load_dwordx4 v5, s[48:51], s61 offen offset:0 lds
  v_mfma_f32_16x16x32_bf16 v[96:99], a[8:11], a[96:99], v[96:99]
  ds_read_b64_tr_b16 a[48:49], v13 offset:24576
  v_mfma_f32_16x16x32_bf16 v[96:99], a[12:15], a[100:103], v[96:99]
  ds_read_b64_tr_b16 a[50:51], v13 offset:25088
  v_mfma_f32_16x16x32_bf16 v[100:103], a[8:11], a[104:107], v[100:103]
  ds_read_b64_tr_b16 a[52:53], v13 offset:27648
  v_mfma_f32_16x16x32_bf16 v[100:103], a[12:15], a[108:111], v[100:103]
  ds_read_b64_tr_b16 a[54:55], v13 offset:28160
  s_add_u32 m0, s62, 3968
  v_mfma_f32_16x16x32_bf16 v[104:107], a[8:11], a[112:115], v[104:107]
  ds_read_b64_tr_b16 a[56:57], v14 offset:24576
  buffer_load_dwordx4 v5, s[48:51], s61 offen offset:128 lds
  v_mfma_f32_16x16x32_bf16 v[104:107], a[12:15], a[116:119], v[104:107]
  ds_read_b64_tr_b16 a[58:59], v14 offset:25088
  v_mfma_f32_16x16x32_bf16 v[108:111], a[8:11], a[120:123], v[108:111]
  ds_read_b64_tr_b16 a[60:61], v14 offset:27648
  v_mfma_f32_16x16x32_bf16 v[108:111], a[12:15], a[124:127], v[108:111]
  ds_read_b64_tr_b16 a[62:63], v14 offset:28160
  s_add_u32 m0, s62, 4864
  v_mfma_f32_16x16x32_bf16 v[112:115], a[16:19], a[80:83], v[112:115]
  ds_read_b64_tr_b16 a[64:65], v15 offset:24576
  buffer_load_dwordx4 v5, s[48:51], s61 offen offset:256 lds
  s_add_u32 s61, s61, s67
  s_nop 0
  v_mfma_f32_16x16x32_bf16 v[112:115], a[20:23], a[84:87], v[112:115]
  ds_read_b64_tr_b16 a[66:67], v15 offset:25088
  v_mfma_f32_16x16x32_bf16 v[116:119], a[16:19], a[88:91], v[116:119]
  ds_read_b64_tr_b16 a[68:69], v15 offset:27648
  v_mfma_f32_16x16x32_bf16 v[116:119], a[20:23], a[92:95], v[116:119]
  ds_read_b64_tr_b16 a[70:71], v15 offset:28160
  v_mfma_f32_16x16x32_bf16 v[120:123], a[16:19], a[96:99], v[120:123]
  ds_read_b64_tr_b16 a[72:73], v16 offset:24576
  s_add_u32 m0, s63, -1152
  v_mfma_f32_16x16x32_bf16 v[120:123], a[20:23], a[100:103], v[120:123]
  ds_read_b64_tr_b16 a[74:75], v16 offset:25088
  buffer_load_dwordx4 v6, s[40:43], 0 offen offset:1152 lds
  v_mfma_f32_16x16x32_bf16 v[124:127], a[16:19], a[104:107], v[124:127]
  ds_read_b64_tr_b16 a[76:77], v16 offset:27648
  v_mfma_f32_16x16x32_bf16 v[124:127], a[20:23], a[108:111], v[124:127]
  ds_read_b64_tr_b16 a[78:79], v16 offset:28160
  v_mfma_f32_16x16x32_bf16 v[128:131], a[16:19], a[112:115], v[128:131]
  v_mfma_f32_16x16x32_bf16 v[128:131], a[20:23], a[116:119], v[128:131]
  s_add_u32 m0, s63, -128
  v_mfma_f32_16x16x32_bf16 v[132:135], a[16:19], a[120:123], v[132:135]
  buffer_load_dwordx4 v7, s[40:43], 0 offen offset:1152 lds
  v_mfma_f32_16x16x32_bf16 v[132:135], a[20:23], a[124:127], v[132:135]
  v_mfma_f32_16x16x32_bf16 v[136:139], a[24:27], a[80:83], v[136:139]
  v_mfma_f32_16x16x32_bf16 v[136:139], a[28:31], a[84:87], v[136:139]
  v_mfma_f32_16x16x32_bf16 v[140:143], a[24:27], a[88:91], v[140:143]
  s_add_u32 m0, s63, 896
  v_mfma_f32_16x16x32_bf16 v[140:143], a[28:31], a[92:95], v[140:143]
  buffer_load_dwordx4 v8, s[40:43], 0 offen offset:1152 lds
  v_mfma_f32_16x16x32_bf16 v[144:147], a[24:27], a[96:99], v[144:147]
  v_mfma_f32_16x16x32_bf16 v[144:147], a[28:31], a[100:103], v[144:147]
  v_mfma_f32_16x16x32_bf16 v[148:151], a[24:27], a[104:107], v[148:151]
  s_add_u32 m0, s63, 1920
  v_mfma_f32_16x16x32_bf16 v[148:151], a[28:31], a[108:111], v[148:151]
  buffer_load_dwordx4 v9, s[40:43], 0 offen offset:1152 lds
  v_mfma_f32_16x16x32_bf16 v[152:155], a[24:27], a[112:115], v[152:155]
  v_mfma_f32_16x16x32_bf16 v[152:155], a[28:31], a[116:119], v[152:155]
  v_mfma_f32_16x16x32_bf16 v[156:159], a[24:27], a[120:123], v[156:159]
  v_mfma_f32_16x16x32_bf16 v[156:159], a[28:31], a[124:127], v[156:159]
  s_add_u32 m0, s63, 2944
  v_mfma_f32_16x16x32_bf16 v[160:163], a[32:35], a[80:83], v[160:163]
  buffer_load_dwordx4 v6, s[40:43], s101 offen offset:1152 lds
  v_mfma_f32_16x16x32_bf16 v[160:163], a[36:39], a[84:87], v[160:163]
  v_mfma_f32_16x16x32_bf16 v[164:167], a[32:35], a[88:91], v[164:167]
  v_mfma_f32_16x16x32_bf16 v[164:167], a[36:39], a[92:95], v[164:167]
  v_mfma_f32_16x16x32_bf16 v[168:171], a[32:35], a[96:99], v[168:171]
  s_add_u32 m0, s63, 3968
  v_mfma_f32_16x16x32_bf16 v[168:171], a[36:39], a[100:103], v[168:171]
  buffer_load_dwordx4 v7, s[40:43], s101 offen offset:1152 lds
  v_mfma_f32_16x16x32_bf16 v[172:175], a[32:35], a[104:107], v[172:175]
  v_mfma_f32_16x16x32_bf16 v[172:175], a[36:39], a[108:111], v[172:175]
  v_mfma_f32_16x16x32_bf16 v[176:179], a[32:35], a[112:115], v[176:179]
  v_mfma_f32_16x16x32_bf16 v[176:179], a[36:39], a[116:119], v[176:179]
  v_mfma_f32_16x16x32_bf16 v[180:183], a[32:35], a[120:123], v[180:183]
  v_mfma_f32_16x16x32_bf16 v[180:183], a[36:39], a[124:127], v[180:183]
  s_waitcnt vmcnt(12) lgkmcnt(0)
  s_barrier
  v_mfma_f32_16x16x32_bf16 v[64:67], a[40:43], a[128:131], v[64:67]
  ds_read_b128 a[80:83], v10 offset:49152
  v_mfma_f32_16x16x32_bf16 v[64:67], a[44:47], a[132:135], v[64:67]
  ds_read_b128 a[84:87], v11 offset:49152
  v_mfma_f32_16x16x32_bf16 v[68:71], a[40:43], a[136:139], v[68:71]
  ds_read_b128 a[88:91], v10 offset:51200
  v_mfma_f32_16x16x32_bf16 v[68:71], a[44:47], a[140:143], v[68:71]
  ds_read_b128 a[92:95], v11 offset:51200
  v_mfma_f32_16x16x32_bf16 v[72:75], a[40:43], a[144:147], v[72:75]
  ds_read_b128 a[96:99], v10 offset:53248
  v_mfma_f32_16x16x32_bf16 v[72:75], a[44:47], a[148:151], v[72:75]
  ds_read_b128 a[100:103], v11 offset:53248
  v_mfma_f32_16x16x32_bf16 v[76:79], a[40:43], a[152:155], v[76:79]
  ds_read_b128 a[104:107], v10 offset:55296
  v_mfma_f32_16x16x32_bf16 v[76:79], a[44:47], a[156:159], v[76:79]
  ds_read_b128 a[108:111], v11 offset:55296
  v_mfma_f32_16x16x32_bf16 v[80:83], a[40:43], a[160:163], v[80:83]
  ds_read_b128 a[112:115], v10 offset:57344
  v_mfma_f32_16x16x32_bf16 v[80:83], a[44:47], a[164:167], v[80:83]
  ds_read_b128 a[116:119], v11 offset:57344
  v_mfma_f32_16x16x32_bf16 v[84:87], a[40:43], a[168:171], v[84:87]
  ds_read_b128 a[120:123], v10 offset:59392
  v_mfma_f32_16x16x32_bf16 v[84:87], a[44:47], a[172:175], v[84:87]
  ds_read_b128 a[124:127], v11 offset:59392
  v_mfma_f32_16x16x32_bf16 v[88:91], a[48:51], a[128:131], v[88:91]
  ds_read_b64_tr_b16 a[0:1], v12 offset:49152
  v_mfma_f32_16x16x32_bf16 v[88:91], a[52:55], a[132:135], v[88:91]
  ds_read_b64_tr_b16 a[2:3], v12 offset:49664
  v_mfma_f32_16x16x32_bf16 v[92:95], a[48:51], a[136:139], v[92:95]
  ds_read_b64_tr_b16 a[4:5], v12 offset:52224
  v_mfma_f32_16x16x32_bf16 v[92:95], a[52:55], a[140:143], v[92:95]
  ds_read_b64_tr_b16 a[6:7], v12 offset:52736
  v_mfma_f32_16x16x32_bf16 v[96:99], a[48:51], a[144:147], v[96:99]
  ds_read_b64_tr_b16 a[8:9], v13 offset:49152
  v_mfma_f32_16x16x32_bf16 v[96:99], a[52:55], a[148:151], v[96:99]
  ds_read_b64_tr_b16 a[10:11], v13 offset:49664
  v_mfma_f32_16x16x32_bf16 v[100:103], a[48:51], a[152:155], v[100:103]
  ds_read_b64_tr_b16 a[12:13], v13 offset:52224
  v_mfma_f32_16x16x32_bf16 v[100:103], a[52:55], a[156:159], v[100:103]
  ds_read_b64_tr_b16 a[14:15], v13 offset:52736
  v_mfma_f32_16x16x32_bf16 v[104:107], a[48:51], a[160:163], v[104:107]
  ds_read_b64_tr_b16 a[16:17], v14 offset:49152
  v_mfma_f32_16x16x32_bf16 v[104:107], a[52:55], a[164:167], v[104:107]
  ds_read_b64_tr_b16 a[18:19], v14 offset:49664
  v_mfma_f32_16x16x32_bf16 v[108:111], a[48:51], a[168:171], v[108:111]
  ds_read_b64_tr_b16 a[20:21], v14 offset:52224
  v_mfma_f32_16x16x32_bf16 v[108:111], a[52:55], a[172:175], v[108:111]
  ds_read_b64_tr_b16 a[22:23], v14 offset:52736
  v_mfma_f32_16x16x32_bf16 v[112:115], a[56:59], a[128:131], v[112:115]
  ds_read_b64_tr_b16 a[24:25], v15 offset:49152
  v_mfma_f32_16x16x32_bf16 v[112:115], a[60:63], a[132:135], v[112:115]
  ds_read_b64_tr_b16 a[26:27], v15 offset:49664
  v_mfma_f32_16x16x32_bf16 v[116:119], a[56:59], a[136:139], v[116:119]
  ds_read_b64_tr_b16 a[28:29], v15 offset:52224
  v_mfma_f32_16x16x32_bf16 v[116:119], a[60:63], a[140:143], v[116:119]
  ds_read_b64_tr_b16 a[30:31], v15 offset:52736
  v_mfma_f32_16x16x32_bf16 v[120:123], a[56:59], a[144:147], v[120:123]
  ds_read_b64_tr_b16 a[32:33], v16 offset:49152
  v_mfma_f32_16x16x32_bf16 v[120:123], a[60:63], a[148:151], v[120:123]
  ds_read_b64_tr_b16 a[34:35], v16 offset:49664
  v_mfma_f32_16x16x32_bf16 v[124:127], a[56:59], a[152:155], v[124:127]
  ds_read_b64_tr_b16 a[36:37], v16 offset:52224
  v_mfma_f32_16x16x32_bf16 v[124:127], a[60:63], a[156:159], v[124:127]
  ds_read_b64_tr_b16 a[38:39], v16 offset:52736
  v_mfma_f32_16x16x32_bf16 v[128:131], a[56:59], a[160:163], v[128:131]
  v_mfma_f32_16x16x32_bf16 v[128:131], a[60:63], a[164:167], v[128:131]
  v_mfma_f32_16x16x32_bf16 v[132:135], a[56:59], a[168:171], v[132:135]
  v_mfma_f32_16x16x32_bf16 v[132:135], a[60:63], a[172:175], v[132:135]
  v_mfma_f32_16x16x32_bf16 v[136:139], a[64:67], a[128:131], v[136:139]
  v_mfma_f32_16x16x32_bf16 v[136:139], a[68:71], a[132:135], v[136:139]
  v_mfma_f32_16x16x32_bf16 v[140:143], a[64:67], a[136:139], v[140:143]
  v_mfma_f32_16x16x32_bf16 v[140:143], a[68:71], a[140:143], v[140:143]
  v_mfma_f32_16x16x32_bf16 v[144:147], a[64:67], a[144:147], v[144:147]
  v_mfma_f32_16x16x32_bf16 v[144:147], a[68:71], a[148:151], v[144:147]
  v_mfma_f32_16x16x32_bf16 v[148:151], a[64:67], a[152:155], v[148:151]
  v_mfma_f32_16x16x32_bf16 v[148:151], a[68:71], a[156:159], v[148:151]
  v_mfma_f32_16x16x32_bf16 v[152:155], a[64:67], a[160:163], v[152:155]
  v_mfma_f32_16x16x32_bf16 v[152:155], a[68:71], a[164:167], v[152:155]
  v_mfma_f32_16x16x32_bf16 v[156:159], a[64:67], a[168:171], v[156:159]
  v_mfma_f32_16x16x32_bf16 v[156:159], a[68:71], a[172:175], v[156:159]
  v_mfma_f32_16x16x32_bf16 v[160:163], a[72:75], a[128:131], v[160:163]
  v_mfma_f32_16x16x32_bf16 v[160:163], a[76:79], a[132:135], v[160:163]
  v_mfma_f32_16x16x32_bf16 v[164:167], a[72:75], a[136:139], v[164:167]
  v_mfma_f32_16x16x32_bf16 v[164:167], a[76:79], a[140:143], v[164:167]
  v_mfma_f32_16x16x32_bf16 v[168:171], a[72:75], a[144:147], v[168:171]
  v_mfma_f32_16x16x32_bf16 v[168:171], a[76:79], a[148:151], v[168:171]
  v_mfma_f32_16x16x32_bf16 v[172:175], a[72:75], a[152:155], v[172:175]
  v_mfma_f32_16x16x32_bf16 v[172:175], a[76:79], a[156:159], v[172:175]
  v_mfma_f32_16x16x32_bf16 v[176:179], a[72:75], a[160:163], v[176:179]
  v_mfma_f32_16x16x32_bf16 v[176:179], a[76:79], a[164:167], v[176:179]
  v_mfma_f32_16x16x32_bf16 v[180:183], a[72:75], a[168:171], v[180:183]
  v_mfma_f32_16x16x32_bf16 v[180:183], a[76:79], a[172:175], v[180:183]
  v_mov_b32 v4, 0
  s_cmp_lg_u32 s32, 0
  s_cbranch_scc1 Lp0_51
  global_load_dword v31, v4, s[28:29] sc1
  s_branch Lp1_52
Lp0_51:
  v_mov_b32 v4, 0
  global_load_dword v31, v4, s[8:9]
Lp1_52:
  s_waitcnt vmcnt(1) lgkmcnt(0)
  s_barrier
  s_nop 0
  v_mfma_f32_16x16x32_bf16 v[64:67], a[0:3], a[80:83], v[64:67]
  ds_read_b128 a[128:131], v10 offset:0
  v_mfma_f32_16x16x32_bf16 v[64:67], a[4:7], a[84:87], v[64:67]
  ds_read_b128 a[132:135], v11 offset:0
  v_mfma_f32_16x16x32_bf16 v[68:71], a[0:3], a[88:91], v[68:71]
  ds_read_b128 a[136:139], v10 offset:2048
  v_mfma_f32_16x16x32_bf16 v[68:71], a[4:7], a[92:95], v[68:71]
  ds_read_b128 a[140:143], v11 offset:2048
  v_mfma_f32_16x16x32_bf16 v[72:75], a[0:3], a[96:99], v[72:75]
  ds_read_b128 a[144:147], v10 offset:4096
  v_mfma_f32_16x16x32_bf16 v[72:75], a[4:7], a[100:103], v[72:75]
  ds_read_b128 a[148:151], v11 offset:4096
  v_mfma_f32_16x16x32_bf16 v[76:79], a[0:3], a[104:107], v[76:79]
  ds_read_b128 a[152:155], v10 offset:6144
  v_mfma_f32_16x16x32_bf16 v[76:79], a[4:7], a[108:111], v[76:79]
  ds_read_b128 a[156:159], v11 offset:6144
  v_mfma_f32_16x16x32_bf16 v[80:83], a[0:3], a[112:115], v[80:83]
  ds_read_b128 a[160:163], v10 offset:8192
  v_mfma_f32_16x16x32_bf16 v[80:83], a[4:7], a[116:119], v[80:83]
  ds_read_b128 a[164:167], v11 offset:8192
  v_mfma_f32_16x16x32_bf16 v[84:87], a[0:3], a[120:123], v[84:87]
  ds_read_b128 a[168:171], v10 offset:10240
  v_mfma_f32_16x16x32_bf16 v[84:87], a[4:7], a[124:127], v[84:87]
  ds_read_b128 a[172:175], v11 offset:10240
  v_mfma_f32_16x16x32_bf16 v[88:91], a[8:11], a[80:83], v[88:91]
  ds_read_b64_tr_b16 a[40:41], v12 offset:0
  v_mfma_f32_16x16x32_bf16 v[88:91], a[12:15], a[84:87], v[88:91]
  ds_read_b64_tr_b16 a[42:43], v12 offset:512
  v_mfma_f32_16x16x32_bf16 v[92:95], a[8:11], a[88:91], v[92:95]
  ds_read_b64_tr_b16 a[44:45], v12 offset:3072
  v_mfma_f32_16x16x32_bf16 v[92:95], a[12:15], a[92:95], v[92:95]
  ds_read_b64_tr_b16 a[46:47], v12 offset:3584
  v_mfma_f32_16x16x32_bf16 v[96:99], a[8:11], a[96:99], v[96:99]
  ds_read_b64_tr_b16 a[48:49], v13 offset:0
  v_mfma_f32_16x16x32_bf16 v[96:99], a[12:15], a[100:103], v[96:99]
  ds_read_b64_tr_b16 a[50:51], v13 offset:512
  v_mfma_f32_16x16x32_bf16 v[100:103], a[8:11], a[104:107], v[100:103]
  ds_read_b64_tr_b16 a[52:53], v13 offset:3072
  v_mfma_f32_16x16x32_bf16 v[100:103], a[12:15], a[108:111], v[100:103]
  ds_read_b64_tr_b16 a[54:55], v13 offset:3584
  v_mfma_f32_16x16x32_bf16 v[104:107], a[8:11], a[112:115], v[104:107]
  ds_read_b64_tr_b16 a[56:57], v14 offset:0
  v_mfma_f32_16x16x32_bf16 v[104:107], a[12:15], a[116:119], v[104:107]
  ds_read_b64_tr_b16 a[58:59], v14 offset:512
  v_mfma_f32_16x16x32_bf16 v[108:111], a[8:11], a[120:123], v[108:111]
  ds_read_b64_tr_b16 a[60:61], v14 offset:3072
  v_mfma_f32_16x16x32_bf16 v[108:111], a[12:15], a[124:127], v[108:111]
  ds_read_b64_tr_b16 a[62:63], v14 offset:3584
  v_mfma_f32_16x16x32_bf16 v[112:115], a[16:19], a[80:83], v[112:115]
  ds_read_b64_tr_b16 a[64:65], v15 offset:0
  v_mfma_f32_16x16x32_bf16 v[112:115], a[20:23], a[84:87], v[112:115]
  ds_read_b64_tr_b16 a[66:67], v15 offset:512
  v_mfma_f32_16x16x32_bf16 v[116:119], a[16:19], a[88:91], v[116:119]
  ds_read_b64_tr_b16 a[68:69], v15 offset:3072
  v_mfma_f32_16x16x32_bf16 v[116:119], a[20:23], a[92:95], v[116:119]
  ds_read_b64_tr_b16 a[70:71], v15 offset:3584
  v_mfma_f32_16x16x32_bf16 v[120:123], a[16:19], a[96:99], v[120:123]
  ds_read_b64_tr_b16 a[72:73], v16 offset:0
  v_mfma_f32_16x16x32_bf16 v[120:123], a[20:23], a[100:103], v[120:123]
  ds_read_b64_tr_b16 a[74:75], v16 offset:512
  v_mfma_f32_16x16x32_bf16 v[124:127], a[16:19], a[104:107], v[124:127]
  ds_read_b64_tr_b16 a[76:77], v16 offset:3072
  v_mfma_f32_16x16x32_bf16 v[124:127], a[20:23], a[108:111], v[124:127]
  ds_read_b64_tr_b16 a[78:79], v16 offset:3584
  v_mfma_f32_16x16x32_bf16 v[128:131], a[16:19], a[112:115], v[128:131]
  v_mfma_f32_16x16x32_bf16 v[128:131], a[20:23], a[116:119], v[128:131]
  v_mfma_f32_16x16x32_bf16 v[132:135], a[16:19], a[120:123], v[132:135]
  v_mfma_f32_16x16x32_bf16 v[132:135], a[20:23], a[124:127], v[132:135]
  v_mfma_f32_16x16x32_bf16 v[136:139], a[24:27], a[80:83], v[136:139]
  v_mfma_f32_16x16x32_bf16 v[136:139], a[28:31], a[84:87], v[136:139]
  v_mfma_f32_16x16x32_bf16 v[140:143], a[24:27], a[88:91], v[140:143]
  v_mfma_f32_16x16x32_bf16 v[140:143], a[28:31], a[92:95], v[140:143]
  v_mfma_f32_16x16x32_bf16 v[144:147], a[24:27], a[96:99], v[144:147]
  v_mfma_f32_16x16x32_bf16 v[144:147], a[28:31], a[100:103], v[144:147]
  v_mfma_f32_16x16x32_bf16 v[148:151], a[24:27], a[104:107], v[148:151]
  v_mfma_f32_16x16x32_bf16 v[148:151], a[28:31], a[108:111], v[148:151]
  v_mfma_f32_16x16x32_bf16 v[152:155], a[24:27], a[112:115], v[152:155]
  v_mfma_f32_16x16x32_bf16 v[152:155], a[28:31], a[116:119], v[152:155]
  v_mfma_f32_16x16x32_bf16 v[156:159], a[24:27], a[120:123], v[156:159]
  v_mfma_f32_16x16x32_bf16 v[156:159], a[28:31], a[124:127], v[156:159]
  v_mfma_f32_16x16x32_bf16 v[160:163], a[32:35], a[80:83], v[160:163]
  v_mfma_f32_16x16x32_bf16 v[160:163], a[36:39], a[84:87], v[160:163]
  v_mfma_f32_16x16x32_bf16 v[164:167], a[32:35], a[88:91], v[164:167]
  v_mfma_f32_16x16x32_bf16 v[164:167], a[36:39], a[92:95], v[164:167]
  v_mfma_f32_16x16x32_bf16 v[168:171], a[32:35], a[96:99], v[168:171]
  v_mfma_f32_16x16x32_bf16 v[168:171], a[36:39], a[100:103], v[168:171]
  v_mfma_f32_16x16x32_bf16 v[172:175], a[32:35], a[104:107], v[172:175]
  v_mfma_f32_16x16x32_bf16 v[172:175], a[36:39], a[108:111], v[172:175]
  v_mfma_f32_16x16x32_bf16 v[176:179], a[32:35], a[112:115], v[176:179]
  v_mfma_f32_16x16x32_bf16 v[176:179], a[36:39], a[116:119], v[176:179]
  v_mfma_f32_16x16x32_bf16 v[180:183], a[32:35], a[120:123], v[180:183]
  v_mfma_f32_16x16x32_bf16 v[180:183], a[36:39], a[124:127], v[180:183]
  s_waitcnt lgkmcnt(0)
  s_waitcnt vmcnt(0)
  s_cmp_lg_u32 s32, 0
  s_cbranch_scc1 Lpd_54
  v_cmp_gt_u32 vcc, 48, v31
  s_mov_b32 s95, 0x8000
  s_cmp_eq_u64 vcc, 0
  s_cbranch_scc1 Lpd_54
Lpoll_53:
  s_sleep 8
  global_load_dword v31, v4, s[28:29] sc1
  s_waitcnt vmcnt(0)
  v_cmp_gt_u32 vcc, 48, v31
  s_sub_u32 s95, s95, 1
  s_cmp_eq_u64 vcc, 0
  s_cbranch_scc1 Lpd_54
  s_cmp_lg_u32 s95, 0
  s_cbranch_scc1 Lpoll_53
Lpd_54:
  s_barrier
  v_mfma_f32_16x16x32_bf16 v[64:67], a[40:43], a[128:131], v[64:67]
  ds_read_b64_tr_b16 a[176:177], v23 offset:0
  s_add_u32 s88, s89, 204800
  v_mfma_f32_16x16x32_bf16 v[64:67], a[44:47], a[132:135], v[64:67]
  ds_read_b64_tr_b16 a[178:179], v23 offset:160
  buffer_load_dwordx4 a[236:239], v2, s[84:87], s88 offen offset:2048 sc1
  v_mfma_f32_16x16x32_bf16 v[68:71], a[40:43], a[136:139], v[68:71]
  ds_read_b64_tr_b16 a[180:181], v23 offset:8
  v_mfma_f32_16x16x32_bf16 v[68:71], a[44:47], a[140:143], v[68:71]
  ds_read_b64_tr_b16 a[182:183], v23 offset:168
  v_mfma_f32_16x16x32_bf16 v[72:75], a[40:43], a[144:147], v[72:75]
  ds_read_b64_tr_b16 a[184:185], v23 offset:16
  v_mfma_f32_16x16x32_bf16 v[72:75], a[44:47], a[148:151], v[72:75]
  ds_read_b64_tr_b16 a[186:187], v23 offset:176
  v_mfma_f32_16x16x32_bf16 v[76:79], a[40:43], a[152:155], v[76:79]
  ds_read_b64_tr_b16 a[188:189], v23 offset:24
  v_mfma_f32_16x16x32_bf16 v[76:79], a[44:47], a[156:159], v[76:79]
  ds_read_b64_tr_b16 a[190:191], v23 offset:184
  v_mfma_f32_16x16x32_bf16 v[80:83], a[40:43], a[160:163], v[80:83]
  ds_read_b64_tr_b16 a[192:193], v23 offset:32
  v_mfma_f32_16x16x32_bf16 v[80:83], a[44:47], a[164:167], v[80:83]
  ds_read_b64_tr_b16 a[194:195], v23 offset:192
  v_mfma_f32_16x16x32_bf16 v[84:87], a[40:43], a[168:171], v[84:87]
  ds_read_b64_tr_b16 a[196:197], v23 offset:320
  v_mfma_f32_16x16x32_bf16 v[84:87], a[44:47], a[172:175], v[84:87]
  ds_read_b64_tr_b16 a[198:199], v23 offset:480
  v_mfma_f32_16x16x32_bf16 v[88:91], a[48:51], a[128:131], v[88:91]
  ds_read_b64_tr_b16 a[200:201], v23 offset:328
  buffer_load_dwordx4 a[240:243], v2, s[84:87], s88 offen offset:3072 sc1
  v_mfma_f32_16x16x32_bf16 v[88:91], a[52:55], a[132:135], v[88:91]
  ds_read_b64_tr_b16 a[202:203], v23 offset:488
  v_mfma_f32_16x16x32_bf16 v[92:95], a[48:51], a[136:139], v[92:95]
  ds_read_b64_tr_b16 a[204:205], v23 offset:336
  v_mfma_f32_16x16x32_bf16 v[92:95], a[52:55], a[140:143], v[92:95]
  ds_read_b64_tr_b16 a[206:207], v23 offset:496
  v_mfma_f32_16x16x32_bf16 v[96:99], a[48:51], a[144:147], v[96:99]
  ds_read_b64_tr_b16 a[208:209], v23 offset:344
  v_mfma_f32_16x16x32_bf16 v[96:99], a[52:55], a[148:151], v[96:99]
  ds_read_b64_tr_b16 a[210:211], v23 offset:504
  v_mfma_f32_16x16x32_bf16 v[100:103], a[48:51], a[152:155], v[100:103]
  ds_read_b64_tr_b16 a[212:213], v23 offset:352
  v_mfma_f32_16x16x32_bf16 v[100:103], a[52:55], a[156:159], v[100:103]
  ds_read_b64_tr_b16 a[214:215], v23 offset:512
  v_mfma_f32_16x16x32_bf16 v[104:107], a[48:51], a[160:163], v[104:107]
  ds_read_b64_tr_b16 a[216:217], v23 offset:640
  v_mfma_f32_16x16x32_bf16 v[104:107], a[52:55], a[164:167], v[104:107]
  ds_read_b64_tr_b16 a[218:219], v26
  v_mfma_f32_16x16x32_bf16 v[108:111], a[48:51], a[168:171], v[108:111]
  ds_read_b64_tr_b16 a[220:221], v23 offset:648
  v_mfma_f32_16x16x32_bf16 v[108:111], a[52:55], a[172:175], v[108:111]
  ds_read_b64_tr_b16 a[222:223], v26
  buffer_load_dwordx4 a[244:247], v3, s[84:87], s88 offen sc1
  v_mfma_f32_16x16x32_bf16 v[112:115], a[56:59], a[128:131], v[112:115]
  ds_read_b64_tr_b16 a[224:225], v23 offset:656
  v_mfma_f32_16x16x32_bf16 v[112:115], a[60:63], a[132:135], v[112:115]
  ds_read_b64_tr_b16 a[226:227], v26
  v_mfma_f32_16x16x32_bf16 v[116:119], a[56:59], a[136:139], v[116:119]
  ds_read_b64_tr_b16 a[228:229], v23 offset:664
  v_mfma_f32_16x16x32_bf16 v[116:119], a[60:63], a[140:143], v[116:119]
  ds_read_b64_tr_b16 a[230:231], v26
  v_mfma_f32_16x16x32_bf16 v[120:123], a[56:59], a[144:147], v[120:123]
  ds_read_b64_tr_b16 a[232:233], v23 offset:672
  v_mfma_f32_16x16x32_bf16 v[120:123], a[60:63], a[148:151], v[120:123]
  ds_read_b64_tr_b16 a[234:235], v26
  v_mfma_f32_16x16x32_bf16 v[124:127], a[56:59], a[152:155], v[124:127]
  v_mfma_f32_16x16x32_bf16 v[124:127], a[60:63], a[156:159], v[124:127]
  v_mfma_f32_16x16x32_bf16 v[128:131], a[56:59], a[160:163], v[128:131]
  v_mfma_f32_16x16x32_bf16 v[128:131], a[60:63], a[164:167], v[128:131]
  v_mfma_f32_16x16x32_bf16 v[132:135], a[56:59], a[168:171], v[132:135]
  s_add_u32 s88, s89, 225280
  v_mfma_f32_16x16x32_bf16 v[132:135], a[60:63], a[172:175], v[132:135]
  buffer_load_dwordx4 a[248:251], v2, s[84:87], s88 offen offset:0 sc1
  v_mfma_f32_16x16x32_bf16 v[136:139], a[64:67], a[128:131], v[136:139]
  v_mfma_f32_16x16x32_bf16 v[136:139], a[68:71], a[132:135], v[136:139]
  v_mfma_f32_16x16x32_bf16 v[140:143], a[64:67], a[136:139], v[140:143]
  v_mfma_f32_16x16x32_bf16 v[140:143], a[68:71], a[140:143], v[140:143]
  v_mfma_f32_16x16x32_bf16 v[144:147], a[64:67], a[144:147], v[144:147]
  v_mfma_f32_16x16x32_bf16 v[144:147], a[68:71], a[148:151], v[144:147]
  v_mfma_f32_16x16x32_bf16 v[148:151], a[64:67], a[152:155], v[148:151]
  v_mfma_f32_16x16x32_bf16 v[148:151], a[68:71], a[156:159], v[148:151]
  v_mfma_f32_16x16x32_bf16 v[152:155], a[64:67], a[160:163], v[152:155]
  v_mfma_f32_16x16x32_bf16 v[152:155], a[68:71], a[164:167], v[152:155]
  v_mfma_f32_16x16x32_bf16 v[156:159], a[64:67], a[168:171], v[156:159]
  buffer_load_dwordx4 a[252:255], v2, s[84:87], s88 offen offset:1024 sc1
  v_mfma_f32_16x16x32_bf16 v[156:159], a[68:71], a[172:175], v[156:159]
  v_mfma_f32_16x16x32_bf16 v[160:163], a[72:75], a[128:131], v[160:163]
  v_mfma_f32_16x16x32_bf16 v[160:163], a[76:79], a[132:135], v[160:163]
  v_mfma_f32_16x16x32_bf16 v[164:167], a[72:75], a[136:139], v[164:167]
  v_mfma_f32_16x16x32_bf16 v[164:167], a[76:79], a[140:143], v[164:167]
  v_mfma_f32_16x16x32_bf16 v[168:171], a[72:75], a[144:147], v[168:171]
  v_mfma_f32_16x16x32_bf16 v[168:171], a[76:79], a[148:151], v[168:171]
  v_mfma_f32_16x16x32_bf16 v[172:175], a[72:75], a[152:155], v[172:175]
  v_mfma_f32_16x16x32_bf16 v[172:175], a[76:79], a[156:159], v[172:175]
  v_mfma_f32_16x16x32_bf16 v[176:179], a[72:75], a[160:163], v[176:179]
  v_mfma_f32_16x16x32_bf16 v[176:179], a[76:79], a[164:167], v[176:179]
  v_mfma_f32_16x16x32_bf16 v[180:183], a[72:75], a[168:171], v[180:183]
  v_mfma_f32_16x16x32_bf16 v[180:183], a[76:79], a[172:175], v[180:183]
  v_cvt_pk_bf16_f32 v32, v64, v65
  v_cvt_pk_bf16_f32 v33, v66, v67
  v_cvt_pk_bf16_f32 v34, v88, v89
  v_cvt_pk_bf16_f32 v35, v90, v91
  v_cvt_pk_bf16_f32 v36, v112, v113
  v_cvt_pk_bf16_f32 v37, v114, v115
  v_cvt_pk_bf16_f32 v38, v136, v137
  v_cvt_pk_bf16_f32 v39, v138, v139
  v_cvt_pk_bf16_f32 v40, v160, v161
  v_cvt_pk_bf16_f32 v41, v162, v163
  s_waitcnt lgkmcnt(0)
  s_nop 0
  v_mfma_f32_16x16x32_bf16 v[64:67], a[176:179], v[32:35], 0
  v_cvt_pk_bf16_f32 v44, v68, v69
  v_cvt_pk_bf16_f32 v45, v70, v71
  v_mfma_f32_16x16x32_bf16 v[88:91], a[180:183], v[32:35], 0
  v_cvt_pk_bf16_f32 v46, v92, v93
  v_cvt_pk_bf16_f32 v47, v94, v95
  v_mfma_f32_16x16x32_bf16 v[112:115], a[184:187], v[32:35], 0
  v_cvt_pk_bf16_f32 v48, v116, v117
  v_cvt_pk_bf16_f32 v49, v118, v119
  v_mfma_f32_16x16x32_bf16 v[136:139], a[188:191], v[32:35], 0
  v_cvt_pk_bf16_f32 v50, v140, v141
  v_cvt_pk_bf16_f32 v51, v142, v143
  v_mfma_f32_16x16x32_bf16 v[160:163], a[192:195], v[32:35], 0
  v_cvt_pk_bf16_f32 v52, v164, v165
  v_cvt_pk_bf16_f32 v53, v166, v167
  v_mfma_f32_16x16x32_bf16 v[64:67], a[196:199], v[36:39], v[64:67]
  v_mfma_f32_16x16x32_bf16 v[88:91], a[200:203], v[36:39], v[88:91]
  v_mfma_f32_16x16x32_bf16 v[112:115], a[204:207], v[36:39], v[112:115]
  v_mfma_f32_16x16x32_bf16 v[136:139], a[208:211], v[36:39], v[136:139]
  v_mfma_f32_16x16x32_bf16 v[160:163], a[212:215], v[36:39], v[160:163]
  v_mfma_f32_16x16x32_bf16 v[64:67], a[216:219], v[40:43], v[64:67]
  v_mfma_f32_16x16x32_bf16 v[88:91], a[220:223], v[40:43], v[88:91]
  v_mfma_f32_16x16x32_bf16 v[112:115], a[224:227], v[40:43], v[112:115]
  v_mfma_f32_16x16x32_bf16 v[136:139], a[228:231], v[40:43], v[136:139]
  v_mfma_f32_16x16x32_bf16 v[160:163], a[232:235], v[40:43], v[160:163]
  s_nop 3
  s_nop 0
  v_max3_f32 v204, v64, v65, v66
  v_min3_f32 v206, v64, v65, v66
  v_max3_f32 v205, v67, v88, v89
  v_min3_f32 v207, v67, v88, v89
  v_max3_f32 v204, v204, v90, v91
  v_min3_f32 v206, v206, v90, v91
  v_max3_f32 v205, v205, v112, v113
  v_min3_f32 v207, v207, v112, v113
  v_max3_f32 v204, v204, v114, v115
  v_min3_f32 v206, v206, v114, v115
  v_max3_f32 v205, v205, v136, v137
  v_min3_f32 v207, v207, v136, v137
  v_max3_f32 v204, v204, v138, v139
  v_min3_f32 v206, v206, v138, v139
  v_max3_f32 v205, v205, v160, v161
  v_min3_f32 v207, v207, v160, v161
  v_max3_f32 v204, v204, v162, v163
  v_min3_f32 v206, v206, v162, v163
  s_add_u32 s88, s89, 102400
  buffer_load_dwordx4 a[128:131], v2, s[84:87], s88 offen offset:0 sc1
  v_max_f32 v204, v204, v205
  v_min_f32 v206, v206, v207
  v_mul_f32 v204, 0xbfb8aa3b, v204
  v_mul_f32 v206, 0x3fb8aa3b, v206
  v_pk_fma_f32 v[184:185], v[64:65], s[70:71], v[204:205] op_sel_hi:[1,1,0]
  v_pk_fma_f32 v[186:187], v[66:67], s[70:71], v[204:205] op_sel_hi:[1,1,0]
  v_pk_fma_f32 v[188:189], v[88:89], s[70:71], v[204:205] op_sel_hi:[1,1,0]
  v_pk_fma_f32 v[190:191], v[90:91], s[70:71], v[204:205] op_sel_hi:[1,1,0]
  v_pk_fma_f32 v[192:193], v[112:113], s[70:71], v[204:205] op_sel_hi:[1,1,0]
  v_pk_fma_f32 v[194:195], v[114:115], s[70:71], v[204:205] op_sel_hi:[1,1,0]
  v_pk_fma_f32 v[196:197], v[136:137], s[70:71], v[204:205] op_sel_hi:[1,1,0]
  v_pk_fma_f32 v[198:199], v[138:139], s[70:71], v[204:205] op_sel_hi:[1,1,0]
  v_pk_fma_f32 v[200:201], v[160:161], s[70:71], v[204:205] op_sel_hi:[1,1,0]
  v_pk_fma_f32 v[202:203], v[162:163], s[70:71], v[204:205] op_sel_hi:[1,1,0]
  buffer_load_dwordx4 a[132:135], v2, s[84:87], s88 offen offset:1024 sc1
  v_pk_fma_f32 v[64:65], v[64:65], s[70:71], v[206:207] op_sel_hi:[1,1,0] neg_lo:[0,1,0] neg_hi:[0,1,0]
  v_pk_fma_f32 v[66:67], v[66:67], s[70:71], v[206:207] op_sel_hi:[1,1,0] neg_lo:[0,1,0] neg_hi:[0,1,0]
  v_pk_fma_f32 v[88:89], v[88:89], s[70:71], v[206:207] op_sel_hi:[1,1,0] neg_lo:[0,1,0] neg_hi:[0,1,0]
  v_pk_fma_f32 v[90:91], v[90:91], s[70:71], v[206:207] op_sel_hi:[1,1,0] neg_lo:[0,1,0] neg_hi:[0,1,0]
  v_pk_fma_f32 v[112:113], v[112:113], s[70:71], v[206:207] op_sel_hi:[1,1,0] neg_lo:[0,1,0] neg_hi:[0,1,0]
  v_pk_fma_f32 v[114:115], v[114:115], s[70:71], v[206:207] op_sel_hi:[1,1,0] neg_lo:[0,1,0] neg_hi:[0,1,0]
  v_pk_fma_f32 v[136:137], v[136:137], s[70:71], v[206:207] op_sel_hi:[1,1,0] neg_lo:[0,1,0] neg_hi:[0,1,0]
  v_pk_fma_f32 v[138:139], v[138:139], s[70:71], v[206:207] op_sel_hi:[1,1,0] neg_lo:[0,1,0] neg_hi:[0,1,0]
  v_pk_fma_f32 v[160:161], v[160:161], s[70:71], v[206:207] op_sel_hi:[1,1,0] neg_lo:[0,1,0] neg_hi:[0,1,0]
  v_pk_fma_f32 v[162:163], v[162:163], s[70:71], v[206:207] op_sel_hi:[1,1,0] neg_lo:[0,1,0] neg_hi:[0,1,0]
  v_mfma_f32_16x16x32_bf16 v[68:71], a[176:179], v[44:47], 0
  v_exp_f32 v184, v184
  v_exp_f32 v185, v185
  v_mfma_f32_16x16x32_bf16 v[92:95], a[180:183], v[44:47], 0
  v_exp_f32 v186, v186
  v_exp_f32 v187, v187
  v_mfma_f32_16x16x32_bf16 v[116:119], a[184:187], v[44:47], 0
  v_exp_f32 v188, v188
  buffer_load_dwordx4 a[136:139], v2, s[84:87], s88 offen offset:2048 sc1
  v_exp_f32 v189, v189
  v_mfma_f32_16x16x32_bf16 v[140:143], a[188:191], v[44:47], 0
  v_exp_f32 v190, v190
  v_exp_f32 v191, v191
  v_mfma_f32_16x16x32_bf16 v[164:167], a[192:195], v[44:47], 0
  v_exp_f32 v192, v192
  v_exp_f32 v193, v193
  v_mfma_f32_16x16x32_bf16 v[68:71], a[196:199], v[48:51], v[68:71]
  v_exp_f32 v194, v194
  v_exp_f32 v195, v195
  v_mfma_f32_16x16x32_bf16 v[92:95], a[200:203], v[48:51], v[92:95]
  v_exp_f32 v196, v196
  v_exp_f32 v197, v197
  v_mfma_f32_16x16x32_bf16 v[116:119], a[204:207], v[48:51], v[116:119]
  v_exp_f32 v198, v198
  v_exp_f32 v199, v199
  v_mfma_f32_16x16x32_bf16 v[140:143], a[208:211], v[48:51], v[140:143]
  v_exp_f32 v200, v200
  buffer_load_dwordx4 a[140:143], v2, s[84:87], s88 offen offset:3072 sc1
  v_exp_f32 v201, v201
  v_mfma_f32_16x16x32_bf16 v[164:167], a[212:215], v[48:51], v[164:167]
  v_exp_f32 v202, v202
  v_exp_f32 v203, v203
  v_mfma_f32_16x16x32_bf16 v[68:71], a[216:219], v[52:55], v[68:71]
  v_exp_f32 v64, v64
  v_exp_f32 v65, v65
  v_mfma_f32_16x16x32_bf16 v[92:95], a[220:223], v[52:55], v[92:95]
  v_exp_f32 v66, v66
  v_exp_f32 v67, v67
  v_mfma_f32_16x16x32_bf16 v[116:119], a[224:227], v[52:55], v[116:119]
  v_exp_f32 v88, v88
  v_exp_f32 v89, v89
  v_mfma_f32_16x16x32_bf16 v[140:143], a[228:231], v[52:55], v[140:143]
  v_exp_f32 v90, v90
  v_exp_f32 v91, v91
  v_mfma_f32_16x16x32_bf16 v[164:167], a[232:235], v[52:55], v[164:167]
  v_exp_f32 v112, v112
  buffer_load_dwordx4 a[144:147], v3, s[84:87], s88 offen sc1
  v_exp_f32 v113, v113
  v_exp_f32 v114, v114
  v_exp_f32 v115, v115
  v_exp_f32 v136, v136
  v_exp_f32 v137, v137
  v_exp_f32 v138, v138
  v_exp_f32 v139, v139
  v_exp_f32 v160, v160
  v_exp_f32 v161, v161
  v_exp_f32 v162, v162
  v_exp_f32 v163, v163
  v_pk_add_f32 v[208:209], v[184:185], v[186:187]
  v_pk_add_f32 v[204:205], v[188:189], v[190:191]
  v_pk_add_f32 v[210:211], v[64:65], v[66:67]
  v_pk_add_f32 v[206:207], v[88:89], v[90:91]
  v_pk_add_f32 v[208:209], v[208:209], v[192:193]
  v_pk_add_f32 v[204:205], v[204:205], v[194:195]
  v_pk_add_f32 v[210:211], v[210:211], v[112:113]
  v_pk_add_f32 v[206:207], v[206:207], v[114:115]
  v_pk_add_f32 v[208:209], v[208:209], v[196:197]
  v_pk_add_f32 v[204:205], v[204:205], v[198:199]
  v_pk_add_f32 v[210:211], v[210:211], v[136:137]
  v_pk_add_f32 v[206:207], v[206:207], v[138:139]
  v_pk_add_f32 v[208:209], v[208:209], v[200:201]
  v_pk_add_f32 v[204:205], v[204:205], v[202:203]
  v_pk_add_f32 v[210:211], v[210:211], v[160:161]
  v_pk_add_f32 v[206:207], v[206:207], v[162:163]
  v_pk_add_f32 v[208:209], v[208:209], v[204:205]
  v_pk_add_f32 v[210:211], v[210:211], v[206:207]
  s_add_u32 s88, s89, 122880
  buffer_load_dwordx4 a[148:151], v2, s[84:87], s88 offen offset:0 sc1
  v_add_f32 v208, v208, v209
  v_add_f32 v210, v210, v211
  v_rcp_f32 v208, v208
  v_rcp_f32 v210, v210
  v_pk_mul_f32 v[184:185], v[184:185], v[208:209] op_sel_hi:[1,0]
  v_pk_mul_f32 v[186:187], v[186:187], v[208:209] op_sel_hi:[1,0]
  v_pk_mul_f32 v[188:189], v[188:189], v[208:209] op_sel_hi:[1,0]
  v_pk_mul_f32 v[190:191], v[190:191], v[208:209] op_sel_hi:[1,0]
  v_pk_mul_f32 v[192:193], v[192:193], v[208:209] op_sel_hi:[1,0]
  v_pk_mul_f32 v[194:195], v[194:195], v[208:209] op_sel_hi:[1,0]
  v_pk_mul_f32 v[196:197], v[196:197], v[208:209] op_sel_hi:[1,0]
  v_pk_mul_f32 v[198:199], v[198:199], v[208:209] op_sel_hi:[1,0]
  v_pk_mul_f32 v[200:201], v[200:201], v[208:209] op_sel_hi:[1,0]
  v_pk_mul_f32 v[202:203], v[202:203], v[208:209] op_sel_hi:[1,0]
  buffer_load_dwordx4 a[152:155], v2, s[84:87], s88 offen offset:1024 sc1
  v_pk_mul_f32 v[64:65], v[64:65], v[210:211] op_sel_hi:[1,0]
  v_pk_mul_f32 v[66:67], v[66:67], v[210:211] op_sel_hi:[1,0]
  v_pk_mul_f32 v[88:89], v[88:89], v[210:211] op_sel_hi:[1,0]
  v_pk_mul_f32 v[90:91], v[90:91], v[210:211] op_sel_hi:[1,0]
  v_pk_mul_f32 v[112:113], v[112:113], v[210:211] op_sel_hi:[1,0]
  v_pk_mul_f32 v[114:115], v[114:115], v[210:211] op_sel_hi:[1,0]
  v_pk_mul_f32 v[136:137], v[136:137], v[210:211] op_sel_hi:[1,0]
  v_pk_mul_f32 v[138:139], v[138:139], v[210:211] op_sel_hi:[1,0]
  v_pk_mul_f32 v[160:161], v[160:161], v[210:211] op_sel_hi:[1,0]
  v_pk_mul_f32 v[162:163], v[162:163], v[210:211] op_sel_hi:[1,0]
  buffer_load_dwordx4 a[156:159], v2, s[84:87], s88 offen offset:2048 sc1
  v_cvt_pk_bf16_f32 v163, v162, v163
  v_cvt_pk_bf16_f32 v162, v160, v161
  v_cvt_pk_bf16_f32 v161, v138, v139
  v_cvt_pk_bf16_f32 v160, v136, v137
  v_cvt_pk_bf16_f32 v139, v114, v115
  v_cvt_pk_bf16_f32 v138, v112, v113
  v_cvt_pk_bf16_f32 v137, v90, v91
  v_cvt_pk_bf16_f32 v136, v88, v89
  v_cvt_pk_bf16_f32 v115, v66, v67
  v_cvt_pk_bf16_f32 v114, v64, v65
  v_cvt_pk_bf16_f32 v64, v184, v185
  v_cvt_pk_bf16_f32 v65, v186, v187
  v_cvt_pk_bf16_f32 v66, v188, v189
  v_cvt_pk_bf16_f32 v67, v190, v191
  v_cvt_pk_bf16_f32 v88, v192, v193
  v_cvt_pk_bf16_f32 v89, v194, v195
  v_cvt_pk_bf16_f32 v90, v196, v197
  v_cvt_pk_bf16_f32 v91, v198, v199
  v_cvt_pk_bf16_f32 v112, v200, v201
  v_cvt_pk_bf16_f32 v113, v202, v203
  v_cvt_pk_bf16_f32 v32, v72, v73
  v_cvt_pk_bf16_f32 v33, v74, v75
  v_cvt_pk_bf16_f32 v34, v96, v97
  v_cvt_pk_bf16_f32 v35, v98, v99
  v_cvt_pk_bf16_f32 v36, v120, v121
  v_cvt_pk_bf16_f32 v37, v122, v123
  v_cvt_pk_bf16_f32 v38, v144, v145
  v_cvt_pk_bf16_f32 v39, v146, v147
  v_cvt_pk_bf16_f32 v40, v168, v169
  v_cvt_pk_bf16_f32 v41, v170, v171
  v_max3_f32 v204, v68, v69, v70
  v_min3_f32 v206, v68, v69, v70
  v_max3_f32 v205, v71, v92, v93
  v_min3_f32 v207, v71, v92, v93
  v_max3_f32 v204, v204, v94, v95
  v_min3_f32 v206, v206, v94, v95
  v_max3_f32 v205, v205, v116, v117
  v_min3_f32 v207, v207, v116, v117
  v_max3_f32 v204, v204, v118, v119
  v_min3_f32 v206, v206, v118, v119
  v_max3_f32 v205, v205, v140, v141
  v_min3_f32 v207, v207, v140, v141
  v_max3_f32 v204, v204, v142, v143
  v_min3_f32 v206, v206, v142, v143
  v_max3_f32 v205, v205, v164, v165
  v_min3_f32 v207, v207, v164, v165
  v_max3_f32 v204, v204, v166, v167
  v_min3_f32 v206, v206, v166, v167
  buffer_load_dwordx4 a[160:163], v2, s[84:87], s88 offen offset:3072 sc1
  v_max_f32 v204, v204, v205
  v_min_f32 v206, v206, v207
  v_mul_f32 v204, 0xbfb8aa3b, v204
  v_mul_f32 v206, 0x3fb8aa3b, v206
  v_pk_fma_f32 v[184:185], v[68:69], s[70:71], v[204:205] op_sel_hi:[1,1,0]
  v_pk_fma_f32 v[186:187], v[70:71], s[70:71], v[204:205] op_sel_hi:[1,1,0]
  v_pk_fma_f32 v[188:189], v[92:93], s[70:71], v[204:205] op_sel_hi:[1,1,0]
  v_pk_fma_f32 v[190:191], v[94:95], s[70:71], v[204:205] op_sel_hi:[1,1,0]
  v_pk_fma_f32 v[192:193], v[116:117], s[70:71], v[204:205] op_sel_hi:[1,1,0]
  v_pk_fma_f32 v[194:195], v[118:119], s[70:71], v[204:205] op_sel_hi:[1,1,0]
  v_pk_fma_f32 v[196:197], v[140:141], s[70:71], v[204:205] op_sel_hi:[1,1,0]
  v_pk_fma_f32 v[198:199], v[142:143], s[70:71], v[204:205] op_sel_hi:[1,1,0]
  v_pk_fma_f32 v[200:201], v[164:165], s[70:71], v[204:205] op_sel_hi:[1,1,0]
  v_pk_fma_f32 v[202:203], v[166:167], s[70:71], v[204:205] op_sel_hi:[1,1,0]
  buffer_load_dwordx4 a[164:167], v3, s[84:87], s88 offen sc1
  v_pk_fma_f32 v[68:69], v[68:69], s[70:71], v[206:207] op_sel_hi:[1,1,0] neg_lo:[0,1,0] neg_hi:[0,1,0]
  v_pk_fma_f32 v[70:71], v[70:71], s[70:71], v[206:207] op_sel_hi:[1,1,0] neg_lo:[0,1,0] neg_hi:[0,1,0]
  v_pk_fma_f32 v[92:93], v[92:93], s[70:71], v[206:207] op_sel_hi:[1,1,0] neg_lo:[0,1,0] neg_hi:[0,1,0]
  v_pk_fma_f32 v[94:95], v[94:95], s[70:71], v[206:207] op_sel_hi:[1,1,0] neg_lo:[0,1,0] neg_hi:[0,1,0]
  v_pk_fma_f32 v[116:117], v[116:117], s[70:71], v[206:207] op_sel_hi:[1,1,0] neg_lo:[0,1,0] neg_hi:[0,1,0]
  v_pk_fma_f32 v[118:119], v[118:119], s[70:71], v[206:207] op_sel_hi:[1,1,0] neg_lo:[0,1,0] neg_hi:[0,1,0]
  v_pk_fma_f32 v[140:141], v[140:141], s[70:71], v[206:207] op_sel_hi:[1,1,0] neg_lo:[0,1,0] neg_hi:[0,1,0]
  v_pk_fma_f32 v[142:143], v[142:143], s[70:71], v[206:207] op_sel_hi:[1,1,0] neg_lo:[0,1,0] neg_hi:[0,1,0]
  v_pk_fma_f32 v[164:165], v[164:165], s[70:71], v[206:207] op_sel_hi:[1,1,0] neg_lo:[0,1,0] neg_hi:[0,1,0]
  v_pk_fma_f32 v[166:167], v[166:167], s[70:71], v[206:207] op_sel_hi:[1,1,0] neg_lo:[0,1,0] neg_hi:[0,1,0]
  v_mfma_f32_16x16x32_bf16 v[72:75], a[176:179], v[32:35], 0
  s_add_u32 s77, s75, 0
  s_cmp_lt_u32 s76, 128
  s_cselect_b32 s77, s77, 0x4000000
  v_exp_f32 v184, v184
  v_exp_f32_e64 v185, v185
  v_mfma_f32_16x16x32_bf16 v[96:99], a[180:183], v[32:35], 0
  buffer_store_dwordx4 v[64:67], v27, s[52:55], s77 offen offset:0 sc1
  v_exp_f32 v186, v186
  v_exp_f32 v187, v187
  v_mfma_f32_16x16x32_bf16 v[120:123], a[184:187], v[32:35], 0
  buffer_store_dwordx4 v[88:91], v27, s[52:55], s77 offen offset:256 sc1
  v_exp_f32_e64 v188, v188
  s_add_u32 s88, s89, 143360
  buffer_load_dwordx4 a[168:171], v2, s[84:87], s88 offen offset:0 sc1
  v_exp_f32_e64 v189, v189
  v_mfma_f32_16x16x32_bf16 v[144:147], a[188:191], v[32:35], 0
  buffer_store_dwordx4 v[112:115], v27, s[52:55], s77 offen offset:512 sc1
  v_exp_f32 v190, v190
  v_exp_f32 v191, v191
  v_mfma_f32_16x16x32_bf16 v[168:171], a[192:195], v[32:35], 0
  buffer_store_dwordx4 v[136:139], v27, s[52:55], s77 offen offset:768 sc1
  v_exp_f32 v192, v192
  v_exp_f32 v193, v193
  v_mfma_f32_16x16x32_bf16 v[72:75], a[196:199], v[36:39], v[72:75]
  buffer_store_dwordx4 v[160:163], v27, s[52:55], s77 offen offset:1024 sc1
  v_exp_f32 v194, v194
  v_exp_f32 v195, v195
  v_mfma_f32_16x16x32_bf16 v[96:99], a[200:203], v[36:39], v[96:99]
  v_exp_f32 v196, v196
  v_exp_f32 v197, v197
  v_mfma_f32_16x16x32_bf16 v[120:123], a[204:207], v[36:39], v[120:123]
  v_exp_f32 v198, v198
  v_exp_f32 v199, v199
  v_mfma_f32_16x16x32_bf16 v[144:147], a[208:211], v[36:39], v[144:147]
  v_exp_f32 v200, v200
  buffer_load_dwordx4 a[172:175], v2, s[84:87], s88 offen offset:1024 sc1
  v_exp_f32 v201, v201
  v_mfma_f32_16x16x32_bf16 v[168:171], a[212:215], v[36:39], v[168:171]
  v_exp_f32 v202, v202
  v_exp_f32 v203, v203
  v_mfma_f32_16x16x32_bf16 v[72:75], a[216:219], v[40:43], v[72:75]
  v_exp_f32 v68, v68
  v_exp_f32 v69, v69
  v_mfma_f32_16x16x32_bf16 v[96:99], a[220:223], v[40:43], v[96:99]
  v_exp_f32 v70, v70
  v_exp_f32 v71, v71
  v_mfma_f32_16x16x32_bf16 v[120:123], a[224:227], v[40:43], v[120:123]
  v_exp_f32 v92, v92
  v_exp_f32 v93, v93
  v_mfma_f32_16x16x32_bf16 v[144:147], a[228:231], v[40:43], v[144:147]
  v_exp_f32 v94, v94
  v_exp_f32 v95, v95
  v_mfma_f32_16x16x32_bf16 v[168:171], a[232:235], v[40:43], v[168:171]
  v_exp_f32_e64 v116, v116
  s_add_u32 s88, s89, 225280
  buffer_load_dwordx4 a[48:51], v2, s[84:87], s88 offen offset:2048 sc1
  v_exp_f32 v117, v117
  v_exp_f32 v118, v118
  v_exp_f32 v119, v119
  v_exp_f32 v140, v140
  v_exp_f32 v141, v141
  v_exp_f32 v142, v142
  v_exp_f32 v143, v143
  v_exp_f32 v164, v164
  v_exp_f32 v165, v165
  v_exp_f32 v166, v166
  v_exp_f32_e64 v167, v167
  v_pk_add_f32 v[208:209], v[184:185], v[186:187]
  v_pk_add_f32 v[204:205], v[188:189], v[190:191]
  v_pk_add_f32 v[210:211], v[68:69], v[70:71]
  v_pk_add_f32 v[206:207], v[92:93], v[94:95]
  v_pk_add_f32 v[208:209], v[208:209], v[192:193]
  v_pk_add_f32 v[204:205], v[204:205], v[194:195]
  v_pk_add_f32 v[210:211], v[210:211], v[116:117]
  v_pk_add_f32 v[206:207], v[206:207], v[118:119]
  v_pk_add_f32 v[208:209], v[208:209], v[196:197]
  v_pk_add_f32 v[204:205], v[204:205], v[198:199]
  v_pk_add_f32 v[210:211], v[210:211], v[140:141]
  v_pk_add_f32 v[206:207], v[206:207], v[142:143]
  v_pk_add_f32 v[208:209], v[208:209], v[200:201]
  v_pk_add_f32 v[204:205], v[204:205], v[202:203]
  v_pk_add_f32 v[210:211], v[210:211], v[164:165]
  v_pk_add_f32 v[206:207], v[206:207], v[166:167]
  v_pk_add_f32 v[208:209], v[208:209], v[204:205]
  v_pk_add_f32 v[210:211], v[210:211], v[206:207]
  buffer_load_dwordx4 a[52:55], v2, s[84:87], s88 offen offset:3072 sc1
  v_add_f32 v208, v208, v209
  v_add_f32 v210, v210, v211
  v_rcp_f32 v208, v208
  v_rcp_f32 v210, v210
  v_pk_mul_f32 v[184:185], v[184:185], v[208:209] op_sel_hi:[1,0]
  v_pk_mul_f32 v[186:187], v[186:187], v[208:209] op_sel_hi:[1,0]
  v_pk_mul_f32 v[188:189], v[188:189], v[208:209] op_sel_hi:[1,0]
  v_pk_mul_f32 v[190:191], v[190:191], v[208:209] op_sel_hi:[1,0]
  v_pk_mul_f32 v[192:193], v[192:193], v[208:209] op_sel_hi:[1,0]
  v_pk_mul_f32 v[194:195], v[194:195], v[208:209] op_sel_hi:[1,0]
  v_pk_mul_f32 v[196:197], v[196:197], v[208:209] op_sel_hi:[1,0]
  v_pk_mul_f32 v[198:199], v[198:199], v[208:209] op_sel_hi:[1,0]
  v_pk_mul_f32 v[200:201], v[200:201], v[208:209] op_sel_hi:[1,0]
  v_pk_mul_f32 v[202:203], v[202:203], v[208:209] op_sel_hi:[1,0]
  buffer_load_dwordx4 a[56:59], v3, s[84:87], s88 offen sc1
  v_pk_mul_f32 v[68:69], v[68:69], v[210:211] op_sel_hi:[1,0]
  v_pk_mul_f32 v[70:71], v[70:71], v[210:211] op_sel_hi:[1,0]
  v_pk_mul_f32 v[92:93], v[92:93], v[210:211] op_sel_hi:[1,0]
  v_pk_mul_f32 v[94:95], v[94:95], v[210:211] op_sel_hi:[1,0]
  v_pk_mul_f32 v[116:117], v[116:117], v[210:211] op_sel_hi:[1,0]
  v_pk_mul_f32 v[118:119], v[118:119], v[210:211] op_sel_hi:[1,0]
  v_pk_mul_f32 v[140:141], v[140:141], v[210:211] op_sel_hi:[1,0]
  v_pk_mul_f32 v[142:143], v[142:143], v[210:211] op_sel_hi:[1,0]
  v_pk_mul_f32 v[164:165], v[164:165], v[210:211] op_sel_hi:[1,0]
  v_pk_mul_f32 v[166:167], v[166:167], v[210:211] op_sel_hi:[1,0]
  s_add_u32 s88, s89, 245760
  buffer_load_dwordx4 a[60:63], v2, s[84:87], s88 offen offset:0 sc1
  v_cvt_pk_bf16_f32 v167, v166, v167
  v_cvt_pk_bf16_f32 v166, v164, v165
  v_cvt_pk_bf16_f32 v165, v142, v143
  v_cvt_pk_bf16_f32 v164, v140, v141
  v_cvt_pk_bf16_f32 v143, v118, v119
  v_cvt_pk_bf16_f32 v142, v116, v117
  v_cvt_pk_bf16_f32 v141, v94, v95
  v_cvt_pk_bf16_f32 v140, v92, v93
  v_cvt_pk_bf16_f32 v119, v70, v71
  v_cvt_pk_bf16_f32 v118, v68, v69
  v_cvt_pk_bf16_f32 v68, v184, v185
  v_cvt_pk_bf16_f32 v69, v186, v187
  v_cvt_pk_bf16_f32 v70, v188, v189
  v_cvt_pk_bf16_f32 v71, v190, v191
  v_cvt_pk_bf16_f32 v92, v192, v193
  v_cvt_pk_bf16_f32 v93, v194, v195
  v_cvt_pk_bf16_f32 v94, v196, v197
  v_cvt_pk_bf16_f32 v95, v198, v199
  v_cvt_pk_bf16_f32 v116, v200, v201
  v_cvt_pk_bf16_f32 v117, v202, v203
  v_cvt_pk_bf16_f32 v44, v76, v77
  v_cvt_pk_bf16_f32 v45, v78, v79
  v_cvt_pk_bf16_f32 v46, v100, v101
  v_cvt_pk_bf16_f32 v47, v102, v103
  v_cvt_pk_bf16_f32 v48, v124, v125
  v_cvt_pk_bf16_f32 v49, v126, v127
  v_cvt_pk_bf16_f32 v50, v148, v149
  v_cvt_pk_bf16_f32 v51, v150, v151
  v_cvt_pk_bf16_f32 v52, v172, v173
  v_cvt_pk_bf16_f32 v53, v174, v175
  v_max3_f32 v204, v72, v73, v74
  v_min3_f32 v206, v72, v73, v74
  v_max3_f32 v205, v75, v96, v97
  v_min3_f32 v207, v75, v96, v97
  v_max3_f32 v204, v204, v98, v99
  v_min3_f32 v206, v206, v98, v99
  v_max3_f32 v205, v205, v120, v121
  v_min3_f32 v207, v207, v120, v121
  v_max3_f32 v204, v204, v122, v123
  v_min3_f32 v206, v206, v122, v123
  v_max3_f32 v205, v205, v144, v145
  v_min3_f32 v207, v207, v144, v145
  v_max3_f32 v204, v204, v146, v147
  v_min3_f32 v206, v206, v146, v147
  v_max3_f32 v205, v205, v168, v169
  v_min3_f32 v207, v207, v168, v169
  v_max3_f32 v204, v204, v170, v171
  v_min3_f32 v206, v206, v170, v171
  buffer_load_dwordx4 a[64:67], v2, s[84:87], s88 offen offset:1024 sc1
  v_max_f32 v204, v204, v205
  v_min_f32 v206, v206, v207
  v_mul_f32 v204, 0xbfb8aa3b, v204
  v_mul_f32 v206, 0x3fb8aa3b, v206
  v_pk_fma_f32 v[184:185], v[72:73], s[70:71], v[204:205] op_sel_hi:[1,1,0]
  v_pk_fma_f32 v[186:187], v[74:75], s[70:71], v[204:205] op_sel_hi:[1,1,0]
  v_pk_fma_f32 v[188:189], v[96:97], s[70:71], v[204:205] op_sel_hi:[1,1,0]
  v_pk_fma_f32 v[190:191], v[98:99], s[70:71], v[204:205] op_sel_hi:[1,1,0]
  v_pk_fma_f32 v[192:193], v[120:121], s[70:71], v[204:205] op_sel_hi:[1,1,0]
  v_pk_fma_f32 v[194:195], v[122:123], s[70:71], v[204:205] op_sel_hi:[1,1,0]
  v_pk_fma_f32 v[196:197], v[144:145], s[70:71], v[204:205] op_sel_hi:[1,1,0]
  v_pk_fma_f32 v[198:199], v[146:147], s[70:71], v[204:205] op_sel_hi:[1,1,0]
  v_pk_fma_f32 v[200:201], v[168:169], s[70:71], v[204:205] op_sel_hi:[1,1,0]
  v_pk_fma_f32 v[202:203], v[170:171], s[70:71], v[204:205] op_sel_hi:[1,1,0]
  buffer_load_dwordx4 a[68:71], v2, s[84:87], s88 offen offset:2048 sc1
  v_pk_fma_f32 v[72:73], v[72:73], s[70:71], v[206:207] op_sel_hi:[1,1,0] neg_lo:[0,1,0] neg_hi:[0,1,0]
  v_pk_fma_f32 v[74:75], v[74:75], s[70:71], v[206:207] op_sel_hi:[1,1,0] neg_lo:[0,1,0] neg_hi:[0,1,0]
  v_pk_fma_f32 v[96:97], v[96:97], s[70:71], v[206:207] op_sel_hi:[1,1,0] neg_lo:[0,1,0] neg_hi:[0,1,0]
  v_pk_fma_f32 v[98:99], v[98:99], s[70:71], v[206:207] op_sel_hi:[1,1,0] neg_lo:[0,1,0] neg_hi:[0,1,0]
  v_pk_fma_f32 v[120:121], v[120:121], s[70:71], v[206:207] op_sel_hi:[1,1,0] neg_lo:[0,1,0] neg_hi:[0,1,0]
  v_pk_fma_f32 v[122:123], v[122:123], s[70:71], v[206:207] op_sel_hi:[1,1,0] neg_lo:[0,1,0] neg_hi:[0,1,0]
  v_pk_fma_f32 v[144:145], v[144:145], s[70:71], v[206:207] op_sel_hi:[1,1,0] neg_lo:[0,1,0] neg_hi:[0,1,0]
  v_pk_fma_f32 v[146:147], v[146:147], s[70:71], v[206:207] op_sel_hi:[1,1,0] neg_lo:[0,1,0] neg_hi:[0,1,0]
  v_pk_fma_f32 v[168:169], v[168:169], s[70:71], v[206:207] op_sel_hi:[1,1,0] neg_lo:[0,1,0] neg_hi:[0,1,0]
  v_pk_fma_f32 v[170:171], v[170:171], s[70:71], v[206:207] op_sel_hi:[1,1,0] neg_lo:[0,1,0] neg_hi:[0,1,0]
  v_mfma_f32_16x16x32_bf16 v[76:79], a[176:179], v[44:47], 0
  s_add_u32 s77, s75, 1280
  s_cmp_lt_u32 s76, 127
  s_cselect_b32 s77, s77, 0x4000000
  v_exp_f32 v184, v184
  v_exp_f32 v185, v185
  v_mfma_f32_16x16x32_bf16 v[100:103], a[180:183], v[44:47], 0
  buffer_store_dwordx4 v[68:71], v27, s[52:55], s77 offen offset:0 sc1
  v_exp_f32 v186, v186
  v_exp_f32 v187, v187
  v_mfma_f32_16x16x32_bf16 v[124:127], a[184:187], v[44:47], 0
  buffer_store_dwordx4 v[92:95], v27, s[52:55], s77 offen offset:256 sc1
  v_exp_f32 v188, v188
  buffer_load_dwordx4 a[72:75], v2, s[84:87], s88 offen offset:3072 sc1
  v_exp_f32 v189, v189
  v_mfma_f32_16x16x32_bf16 v[148:151], a[188:191], v[44:47], 0
  buffer_store_dwordx4 v[116:119], v27, s[52:55], s77 offen offset:512 sc1
  v_exp_f32 v190, v190
  v_exp_f32 v191, v191
  v_mfma_f32_16x16x32_bf16 v[172:175], a[192:195], v[44:47], 0
  buffer_store_dwordx4 v[140:143], v27, s[52:55], s77 offen offset:768 sc1
  v_exp_f32 v192, v192
  v_exp_f32 v193, v193
  v_mfma_f32_16x16x32_bf16 v[76:79], a[196:199], v[48:51], v[76:79]
  buffer_store_dwordx4 v[164:167], v27, s[52:55], s77 offen offset:1024 sc1
  v_exp_f32 v194, v194
  v_exp_f32 v195, v195
  v_mfma_f32_16x16x32_bf16 v[100:103], a[200:203], v[48:51], v[100:103]
  v_exp_f32 v196, v196
  v_exp_f32 v197, v197
  v_mfma_f32_16x16x32_bf16 v[124:127], a[204:207], v[48:51], v[124:127]
  v_exp_f32 v198, v198
  v_exp_f32 v199, v199
  v_mfma_f32_16x16x32_bf16 v[148:151], a[208:211], v[48:51], v[148:151]
  v_exp_f32 v200, v200
  buffer_load_dwordx4 a[76:79], v3, s[84:87], s88 offen sc1
  v_exp_f32 v201, v201
  v_mfma_f32_16x16x32_bf16 v[172:175], a[212:215], v[48:51], v[172:175]
  v_exp_f32 v202, v202
  v_exp_f32 v203, v203
  v_mfma_f32_16x16x32_bf16 v[76:79], a[216:219], v[52:55], v[76:79]
  v_exp_f32 v72, v72
  v_exp_f32 v73, v73
  v_mfma_f32_16x16x32_bf16 v[100:103], a[220:223], v[52:55], v[100:103]
  v_exp_f32 v74, v74
  v_exp_f32 v75, v75
  v_mfma_f32_16x16x32_bf16 v[124:127], a[224:227], v[52:55], v[124:127]
  v_exp_f32 v96, v96
  v_exp_f32 v97, v97
  v_mfma_f32_16x16x32_bf16 v[148:151], a[228:231], v[52:55], v[148:151]
  v_exp_f32 v98, v98
  v_exp_f32 v99, v99
  v_mfma_f32_16x16x32_bf16 v[172:175], a[232:235], v[52:55], v[172:175]
  v_exp_f32_e64 v120, v120
  s_add_u32 s88, s89, 266240
  buffer_load_dwordx4 a[80:83], v2, s[84:87], s88 offen offset:0 sc1
  v_exp_f32 v121, v121
  v_exp_f32 v122, v122
  v_exp_f32 v123, v123
  v_exp_f32 v144, v144
  v_exp_f32 v145, v145
  v_exp_f32 v146, v146
  v_exp_f32 v147, v147
  v_exp_f32 v168, v168
  v_exp_f32 v169, v169
  v_exp_f32 v170, v170
  v_exp_f32_e64 v171, v171
  v_pk_add_f32 v[208:209], v[184:185], v[186:187]
  v_pk_add_f32 v[204:205], v[188:189], v[190:191]
  v_pk_add_f32 v[210:211], v[72:73], v[74:75]
  v_pk_add_f32 v[206:207], v[96:97], v[98:99]
  v_pk_add_f32 v[208:209], v[208:209], v[192:193]
  v_pk_add_f32 v[204:205], v[204:205], v[194:195]
  v_pk_add_f32 v[210:211], v[210:211], v[120:121]
  v_pk_add_f32 v[206:207], v[206:207], v[122:123]
  v_pk_add_f32 v[208:209], v[208:209], v[196:197]
  v_pk_add_f32 v[204:205], v[204:205], v[198:199]
  v_pk_add_f32 v[210:211], v[210:211], v[144:145]
  v_pk_add_f32 v[206:207], v[206:207], v[146:147]
  v_pk_add_f32 v[208:209], v[208:209], v[200:201]
  v_pk_add_f32 v[204:205], v[204:205], v[202:203]
  v_pk_add_f32 v[210:211], v[210:211], v[168:169]
  v_pk_add_f32 v[206:207], v[206:207], v[170:171]
  v_pk_add_f32 v[208:209], v[208:209], v[204:205]
  v_pk_add_f32 v[210:211], v[210:211], v[206:207]
  buffer_load_dwordx4 a[84:87], v2, s[84:87], s88 offen offset:1024 sc1
  v_add_f32 v208, v208, v209
  v_add_f32 v210, v210, v211
  v_rcp_f32 v208, v208
  v_rcp_f32 v210, v210
  v_pk_mul_f32 v[184:185], v[184:185], v[208:209] op_sel_hi:[1,0]
  v_pk_mul_f32 v[186:187], v[186:187], v[208:209] op_sel_hi:[1,0]
  v_pk_mul_f32 v[188:189], v[188:189], v[208:209] op_sel_hi:[1,0]
  v_pk_mul_f32 v[190:191], v[190:191], v[208:209] op_sel_hi:[1,0]
  v_pk_mul_f32 v[192:193], v[192:193], v[208:209] op_sel_hi:[1,0]
  v_pk_mul_f32 v[194:195], v[194:195], v[208:209] op_sel_hi:[1,0]
  v_pk_mul_f32 v[196:197], v[196:197], v[208:209] op_sel_hi:[1,0]
  v_pk_mul_f32 v[198:199], v[198:199], v[208:209] op_sel_hi:[1,0]
  v_pk_mul_f32 v[200:201], v[200:201], v[208:209] op_sel_hi:[1,0]
  v_pk_mul_f32 v[202:203], v[202:203], v[208:209] op_sel_hi:[1,0]
  buffer_load_dwordx4 a[88:91], v2, s[84:87], s88 offen offset:2048 sc1
  v_pk_mul_f32 v[72:73], v[72:73], v[210:211] op_sel_hi:[1,0]
  v_pk_mul_f32 v[74:75], v[74:75], v[210:211] op_sel_hi:[1,0]
  v_pk_mul_f32 v[96:97], v[96:97], v[210:211] op_sel_hi:[1,0]
  v_pk_mul_f32 v[98:99], v[98:99], v[210:211] op_sel_hi:[1,0]
  v_pk_mul_f32 v[120:121], v[120:121], v[210:211] op_sel_hi:[1,0]
  v_pk_mul_f32 v[122:123], v[122:123], v[210:211] op_sel_hi:[1,0]
  v_pk_mul_f32 v[144:145], v[144:145], v[210:211] op_sel_hi:[1,0]
  v_pk_mul_f32 v[146:147], v[146:147], v[210:211] op_sel_hi:[1,0]
  v_pk_mul_f32 v[168:169], v[168:169], v[210:211] op_sel_hi:[1,0]
  v_pk_mul_f32 v[170:171], v[170:171], v[210:211] op_sel_hi:[1,0]
  buffer_load_dwordx4 a[92:95], v2, s[84:87], s88 offen offset:3072 sc1
  v_cvt_pk_bf16_f32 v171, v170, v171
  v_cvt_pk_bf16_f32 v170, v168, v169
  v_cvt_pk_bf16_f32 v169, v146, v147
  v_cvt_pk_bf16_f32 v168, v144, v145
  v_cvt_pk_bf16_f32 v147, v122, v123
  v_cvt_pk_bf16_f32 v146, v120, v121
  v_cvt_pk_bf16_f32 v145, v98, v99
  v_cvt_pk_bf16_f32 v144, v96, v97
  v_cvt_pk_bf16_f32 v123, v74, v75
  v_cvt_pk_bf16_f32 v122, v72, v73
  v_cvt_pk_bf16_f32 v72, v184, v185
  v_cvt_pk_bf16_f32 v73, v186, v187
  v_cvt_pk_bf16_f32 v74, v188, v189
  v_cvt_pk_bf16_f32 v75, v190, v191
  v_cvt_pk_bf16_f32 v96, v192, v193
  v_cvt_pk_bf16_f32 v97, v194, v195
  v_cvt_pk_bf16_f32 v98, v196, v197
  v_cvt_pk_bf16_f32 v99, v198, v199
  v_cvt_pk_bf16_f32 v120, v200, v201
  v_cvt_pk_bf16_f32 v121, v202, v203
  v_cvt_pk_bf16_f32 v32, v80, v81
  v_cvt_pk_bf16_f32 v33, v82, v83
  v_cvt_pk_bf16_f32 v34, v104, v105
  v_cvt_pk_bf16_f32 v35, v106, v107
  v_cvt_pk_bf16_f32 v36, v128, v129
  v_cvt_pk_bf16_f32 v37, v130, v131
  v_cvt_pk_bf16_f32 v38, v152, v153
  v_cvt_pk_bf16_f32 v39, v154, v155
  v_cvt_pk_bf16_f32 v40, v176, v177
  v_cvt_pk_bf16_f32 v41, v178, v179
  v_max3_f32 v204, v76, v77, v78
  v_min3_f32 v206, v76, v77, v78
  v_max3_f32 v205, v79, v100, v101
  v_min3_f32 v207, v79, v100, v101
  v_max3_f32 v204, v204, v102, v103
  v_min3_f32 v206, v206, v102, v103
  v_max3_f32 v205, v205, v124, v125
  v_min3_f32 v207, v207, v124, v125
  v_max3_f32 v204, v204, v126, v127
  v_min3_f32 v206, v206, v126, v127
  v_max3_f32 v205, v205, v148, v149
  v_min3_f32 v207, v207, v148, v149
  v_max3_f32 v204, v204, v150, v151
  v_min3_f32 v206, v206, v150, v151
  v_max3_f32 v205, v205, v172, v173
  v_min3_f32 v207, v207, v172, v173
  v_max3_f32 v204, v204, v174, v175
  v_min3_f32 v206, v206, v174, v175
  buffer_load_dwordx4 a[108:111], v3, s[84:87], s88 offen sc1
  v_max_f32 v204, v204, v205
  v_min_f32 v206, v206, v207
  v_mul_f32 v204, 0xbfb8aa3b, v204
  v_mul_f32 v206, 0x3fb8aa3b, v206
  v_pk_fma_f32 v[184:185], v[76:77], s[70:71], v[204:205] op_sel_hi:[1,1,0]
  v_pk_fma_f32 v[186:187], v[78:79], s[70:71], v[204:205] op_sel_hi:[1,1,0]
  v_pk_fma_f32 v[188:189], v[100:101], s[70:71], v[204:205] op_sel_hi:[1,1,0]
  v_pk_fma_f32 v[190:191], v[102:103], s[70:71], v[204:205] op_sel_hi:[1,1,0]
  v_pk_fma_f32 v[192:193], v[124:125], s[70:71], v[204:205] op_sel_hi:[1,1,0]
  v_pk_fma_f32 v[194:195], v[126:127], s[70:71], v[204:205] op_sel_hi:[1,1,0]
  v_pk_fma_f32 v[196:197], v[148:149], s[70:71], v[204:205] op_sel_hi:[1,1,0]
  v_pk_fma_f32 v[198:199], v[150:151], s[70:71], v[204:205] op_sel_hi:[1,1,0]
  v_pk_fma_f32 v[200:201], v[172:173], s[70:71], v[204:205] op_sel_hi:[1,1,0]
  v_pk_fma_f32 v[202:203], v[174:175], s[70:71], v[204:205] op_sel_hi:[1,1,0]
  s_add_u32 s88, s89, 286720
  buffer_load_dwordx4 a[112:115], v2, s[84:87], s88 offen offset:0 sc1
  v_pk_fma_f32 v[76:77], v[76:77], s[70:71], v[206:207] op_sel_hi:[1,1,0] neg_lo:[0,1,0] neg_hi:[0,1,0]
  v_pk_fma_f32 v[78:79], v[78:79], s[70:71], v[206:207] op_sel_hi:[1,1,0] neg_lo:[0,1,0] neg_hi:[0,1,0]
  v_pk_fma_f32 v[100:101], v[100:101], s[70:71], v[206:207] op_sel_hi:[1,1,0] neg_lo:[0,1,0] neg_hi:[0,1,0]
  v_pk_fma_f32 v[102:103], v[102:103], s[70:71], v[206:207] op_sel_hi:[1,1,0] neg_lo:[0,1,0] neg_hi:[0,1,0]
  v_pk_fma_f32 v[124:125], v[124:125], s[70:71], v[206:207] op_sel_hi:[1,1,0] neg_lo:[0,1,0] neg_hi:[0,1,0]
  v_pk_fma_f32 v[126:127], v[126:127], s[70:71], v[206:207] op_sel_hi:[1,1,0] neg_lo:[0,1,0] neg_hi:[0,1,0]
  v_pk_fma_f32 v[148:149], v[148:149], s[70:71], v[206:207] op_sel_hi:[1,1,0] neg_lo:[0,1,0] neg_hi:[0,1,0]
  v_pk_fma_f32 v[150:151], v[150:151], s[70:71], v[206:207] op_sel_hi:[1,1,0] neg_lo:[0,1,0] neg_hi:[0,1,0]
  v_pk_fma_f32 v[172:173], v[172:173], s[70:71], v[206:207] op_sel_hi:[1,1,0] neg_lo:[0,1,0] neg_hi:[0,1,0]
  v_pk_fma_f32 v[174:175], v[174:175], s[70:71], v[206:207] op_sel_hi:[1,1,0] neg_lo:[0,1,0] neg_hi:[0,1,0]
  v_mfma_f32_16x16x32_bf16 v[80:83], a[176:179], v[32:35], 0
  s_add_u32 s77, s75, 2560
  s_cmp_lt_u32 s76, 126
  s_cselect_b32 s77, s77, 0x4000000
  v_exp_f32 v184, v184
  v_exp_f32 v185, v185
  v_mfma_f32_16x16x32_bf16 v[104:107], a[180:183], v[32:35], 0
  buffer_store_dwordx4 v[72:75], v27, s[52:55], s77 offen offset:0 sc1
  v_exp_f32 v186, v186
  v_exp_f32 v187, v187
  v_mfma_f32_16x16x32_bf16 v[128:131], a[184:187], v[32:35], 0
  buffer_store_dwordx4 v[96:99], v27, s[52:55], s77 offen offset:256 sc1
  v_exp_f32 v188, v188
  buffer_load_dwordx4 a[116:119], v2, s[84:87], s88 offen offset:1024 sc1
  v_exp_f32 v189, v189
  v_mfma_f32_16x16x32_bf16 v[152:155], a[188:191], v[32:35], 0
  buffer_store_dwordx4 v[120:123], v27, s[52:55], s77 offen offset:512 sc1
  v_exp_f32 v190, v190
  v_exp_f32 v191, v191
  v_mfma_f32_16x16x32_bf16 v[176:179], a[192:195], v[32:35], 0
  buffer_store_dwordx4 v[144:147], v27, s[52:55], s77 offen offset:768 sc1
  v_exp_f32 v192, v192
  v_exp_f32 v193, v193
  v_mfma_f32_16x16x32_bf16 v[80:83], a[196:199], v[36:39], v[80:83]
  buffer_store_dwordx4 v[168:171], v27, s[52:55], s77 offen offset:1024 sc1
  v_exp_f32 v194, v194
  v_exp_f32 v195, v195
  v_mfma_f32_16x16x32_bf16 v[104:107], a[200:203], v[36:39], v[104:107]
  v_exp_f32 v196, v196
  v_exp_f32 v197, v197
  v_mfma_f32_16x16x32_bf16 v[128:131], a[204:207], v[36:39], v[128:131]
  v_exp_f32 v198, v198
  v_exp_f32 v199, v199
  v_mfma_f32_16x16x32_bf16 v[152:155], a[208:211], v[36:39], v[152:155]
  v_exp_f32 v200, v200
  buffer_load_dwordx4 a[0:3], v2, s[84:87], s88 offen offset:2048 sc1
  v_exp_f32 v201, v201
  v_mfma_f32_16x16x32_bf16 v[176:179], a[212:215], v[36:39], v[176:179]
  v_exp_f32 v202, v202
  v_exp_f32 v203, v203
  v_mfma_f32_16x16x32_bf16 v[80:83], a[216:219], v[40:43], v[80:83]
  v_exp_f32 v76, v76
  v_exp_f32 v77, v77
  v_mfma_f32_16x16x32_bf16 v[104:107], a[220:223], v[40:43], v[104:107]
  v_exp_f32 v78, v78
  v_exp_f32 v79, v79
  v_mfma_f32_16x16x32_bf16 v[128:131], a[224:227], v[40:43], v[128:131]
  v_exp_f32 v100, v100
  v_exp_f32 v101, v101
  v_mfma_f32_16x16x32_bf16 v[152:155], a[228:231], v[40:43], v[152:155]
  v_exp_f32 v102, v102
  v_exp_f32 v103, v103
  v_mfma_f32_16x16x32_bf16 v[176:179], a[232:235], v[40:43], v[176:179]
  v_exp_f32 v124, v124
  buffer_load_dwordx4 a[4:7], v2, s[84:87], s88 offen offset:3072 sc1
  v_exp_f32 v125, v125
  v_exp_f32 v126, v126
  v_exp_f32 v127, v127
  v_exp_f32 v148, v148
  v_exp_f32 v149, v149
  v_exp_f32 v150, v150
  v_exp_f32 v151, v151
  v_exp_f32 v172, v172
  v_exp_f32 v173, v173
  v_exp_f32 v174, v174
  v_exp_f32 v175, v175
  v_pk_add_f32 v[208:209], v[184:185], v[186:187]
  v_pk_add_f32 v[204:205], v[188:189], v[190:191]
  v_pk_add_f32 v[210:211], v[76:77], v[78:79]
  v_pk_add_f32 v[206:207], v[100:101], v[102:103]
  v_pk_add_f32 v[208:209], v[208:209], v[192:193]
  v_pk_add_f32 v[204:205], v[204:205], v[194:195]
  v_pk_add_f32 v[210:211], v[210:211], v[124:125]
  v_pk_add_f32 v[206:207], v[206:207], v[126:127]
  v_pk_add_f32 v[208:209], v[208:209], v[196:197]
  v_pk_add_f32 v[204:205], v[204:205], v[198:199]
  v_pk_add_f32 v[210:211], v[210:211], v[148:149]
  v_pk_add_f32 v[206:207], v[206:207], v[150:151]
  v_pk_add_f32 v[208:209], v[208:209], v[200:201]
  v_pk_add_f32 v[204:205], v[204:205], v[202:203]
  v_pk_add_f32 v[210:211], v[210:211], v[172:173]
  v_pk_add_f32 v[206:207], v[206:207], v[174:175]
  v_pk_add_f32 v[208:209], v[208:209], v[204:205]
  v_pk_add_f32 v[210:211], v[210:211], v[206:207]
  buffer_load_dwordx4 a[8:11], v3, s[84:87], s88 offen sc1
  v_add_f32 v208, v208, v209
  v_add_f32 v210, v210, v211
  v_rcp_f32 v208, v208
  v_rcp_f32 v210, v210
  v_pk_mul_f32 v[184:185], v[184:185], v[208:209] op_sel_hi:[1,0]
  v_pk_mul_f32 v[186:187], v[186:187], v[208:209] op_sel_hi:[1,0]
  v_pk_mul_f32 v[188:189], v[188:189], v[208:209] op_sel_hi:[1,0]
  v_pk_mul_f32 v[190:191], v[190:191], v[208:209] op_sel_hi:[1,0]
  v_pk_mul_f32 v[192:193], v[192:193], v[208:209] op_sel_hi:[1,0]
  v_pk_mul_f32 v[194:195], v[194:195], v[208:209] op_sel_hi:[1,0]
  v_pk_mul_f32 v[196:197], v[196:197], v[208:209] op_sel_hi:[1,0]
  v_pk_mul_f32 v[198:199], v[198:199], v[208:209] op_sel_hi:[1,0]
  v_pk_mul_f32 v[200:201], v[200:201], v[208:209] op_sel_hi:[1,0]
  v_pk_mul_f32 v[202:203], v[202:203], v[208:209] op_sel_hi:[1,0]
  s_add_u32 s88, s89, 307200
  buffer_load_dwordx4 a[12:15], v2, s[84:87], s88 offen offset:0 sc1
  v_pk_mul_f32 v[76:77], v[76:77], v[210:211] op_sel_hi:[1,0]
  v_pk_mul_f32 v[78:79], v[78:79], v[210:211] op_sel_hi:[1,0]
  v_pk_mul_f32 v[100:101], v[100:101], v[210:211] op_sel_hi:[1,0]
  v_pk_mul_f32 v[102:103], v[102:103], v[210:211] op_sel_hi:[1,0]
  v_pk_mul_f32 v[124:125], v[124:125], v[210:211] op_sel_hi:[1,0]
  v_pk_mul_f32 v[126:127], v[126:127], v[210:211] op_sel_hi:[1,0]
  v_pk_mul_f32 v[148:149], v[148:149], v[210:211] op_sel_hi:[1,0]
  v_pk_mul_f32 v[150:151], v[150:151], v[210:211] op_sel_hi:[1,0]
  v_pk_mul_f32 v[172:173], v[172:173], v[210:211] op_sel_hi:[1,0]
  v_pk_mul_f32 v[174:175], v[174:175], v[210:211] op_sel_hi:[1,0]
  buffer_load_dwordx4 a[16:19], v2, s[84:87], s88 offen offset:1024 sc1
  v_cvt_pk_bf16_f32 v175, v174, v175
  v_cvt_pk_bf16_f32 v174, v172, v173
  v_cvt_pk_bf16_f32 v173, v150, v151
  v_cvt_pk_bf16_f32 v172, v148, v149
  v_cvt_pk_bf16_f32 v151, v126, v127
  v_cvt_pk_bf16_f32 v150, v124, v125
  v_cvt_pk_bf16_f32 v149, v102, v103
  v_cvt_pk_bf16_f32 v148, v100, v101
  v_cvt_pk_bf16_f32 v127, v78, v79
  v_cvt_pk_bf16_f32 v126, v76, v77
  v_cvt_pk_bf16_f32 v76, v184, v185
  v_cvt_pk_bf16_f32 v77, v186, v187
  v_cvt_pk_bf16_f32 v78, v188, v189
  v_cvt_pk_bf16_f32 v79, v190, v191
  v_cvt_pk_bf16_f32 v100, v192, v193
  v_cvt_pk_bf16_f32 v101, v194, v195
  v_cvt_pk_bf16_f32 v102, v196, v197
  v_cvt_pk_bf16_f32 v103, v198, v199
  v_cvt_pk_bf16_f32 v124, v200, v201
  v_cvt_pk_bf16_f32 v125, v202, v203
  v_cvt_pk_bf16_f32 v44, v84, v85
  v_cvt_pk_bf16_f32 v45, v86, v87
  v_cvt_pk_bf16_f32 v46, v108, v109
  v_cvt_pk_bf16_f32 v47, v110, v111
  v_cvt_pk_bf16_f32 v48, v132, v133
  v_cvt_pk_bf16_f32 v49, v134, v135
  v_cvt_pk_bf16_f32 v50, v156, v157
  v_cvt_pk_bf16_f32 v51, v158, v159
  v_cvt_pk_bf16_f32 v52, v180, v181
  v_cvt_pk_bf16_f32 v53, v182, v183
  v_max3_f32 v204, v80, v81, v82
  v_min3_f32 v206, v80, v81, v82
  v_max3_f32 v205, v83, v104, v105
  v_min3_f32 v207, v83, v104, v105
  v_max3_f32 v204, v204, v106, v107
  v_min3_f32 v206, v206, v106, v107
  v_max3_f32 v205, v205, v128, v129
  v_min3_f32 v207, v207, v128, v129
  v_max3_f32 v204, v204, v130, v131
  v_min3_f32 v206, v206, v130, v131
  v_max3_f32 v205, v205, v152, v153
  v_min3_f32 v207, v207, v152, v153
  v_max3_f32 v204, v204, v154, v155
  v_min3_f32 v206, v206, v154, v155
  v_max3_f32 v205, v205, v176, v177
  v_min3_f32 v207, v207, v176, v177
  v_max3_f32 v204, v204, v178, v179
  v_min3_f32 v206, v206, v178, v179
  buffer_load_dwordx4 a[20:23], v2, s[84:87], s88 offen offset:2048 sc1
  v_max_f32 v204, v204, v205
  v_min_f32 v206, v206, v207
  v_mul_f32 v204, 0xbfb8aa3b, v204
  v_mul_f32 v206, 0x3fb8aa3b, v206
  v_pk_fma_f32 v[184:185], v[80:81], s[70:71], v[204:205] op_sel_hi:[1,1,0]
  v_pk_fma_f32 v[186:187], v[82:83], s[70:71], v[204:205] op_sel_hi:[1,1,0]
  v_pk_fma_f32 v[188:189], v[104:105], s[70:71], v[204:205] op_sel_hi:[1,1,0]
  v_pk_fma_f32 v[190:191], v[106:107], s[70:71], v[204:205] op_sel_hi:[1,1,0]
  v_pk_fma_f32 v[192:193], v[128:129], s[70:71], v[204:205] op_sel_hi:[1,1,0]
  v_pk_fma_f32 v[194:195], v[130:131], s[70:71], v[204:205] op_sel_hi:[1,1,0]
  v_pk_fma_f32 v[196:197], v[152:153], s[70:71], v[204:205] op_sel_hi:[1,1,0]
  v_pk_fma_f32 v[198:199], v[154:155], s[70:71], v[204:205] op_sel_hi:[1,1,0]
  v_pk_fma_f32 v[200:201], v[176:177], s[70:71], v[204:205] op_sel_hi:[1,1,0]
  v_pk_fma_f32 v[202:203], v[178:179], s[70:71], v[204:205] op_sel_hi:[1,1,0]
  buffer_load_dwordx4 a[24:27], v2, s[84:87], s88 offen offset:3072 sc1
  v_pk_fma_f32 v[80:81], v[80:81], s[70:71], v[206:207] op_sel_hi:[1,1,0] neg_lo:[0,1,0] neg_hi:[0,1,0]
  v_pk_fma_f32 v[82:83], v[82:83], s[70:71], v[206:207] op_sel_hi:[1,1,0] neg_lo:[0,1,0] neg_hi:[0,1,0]
  v_pk_fma_f32 v[104:105], v[104:105], s[70:71], v[206:207] op_sel_hi:[1,1,0] neg_lo:[0,1,0] neg_hi:[0,1,0]
  v_pk_fma_f32 v[106:107], v[106:107], s[70:71], v[206:207] op_sel_hi:[1,1,0] neg_lo:[0,1,0] neg_hi:[0,1,0]
  v_pk_fma_f32 v[128:129], v[128:129], s[70:71], v[206:207] op_sel_hi:[1,1,0] neg_lo:[0,1,0] neg_hi:[0,1,0]
  v_pk_fma_f32 v[130:131], v[130:131], s[70:71], v[206:207] op_sel_hi:[1,1,0] neg_lo:[0,1,0] neg_hi:[0,1,0]
  v_pk_fma_f32 v[152:153], v[152:153], s[70:71], v[206:207] op_sel_hi:[1,1,0] neg_lo:[0,1,0] neg_hi:[0,1,0]
  v_pk_fma_f32 v[154:155], v[154:155], s[70:71], v[206:207] op_sel_hi:[1,1,0] neg_lo:[0,1,0] neg_hi:[0,1,0]
  v_pk_fma_f32 v[176:177], v[176:177], s[70:71], v[206:207] op_sel_hi:[1,1,0] neg_lo:[0,1,0] neg_hi:[0,1,0]
  v_pk_fma_f32 v[178:179], v[178:179], s[70:71], v[206:207] op_sel_hi:[1,1,0] neg_lo:[0,1,0] neg_hi:[0,1,0]
  v_mfma_f32_16x16x32_bf16 v[84:87], a[176:179], v[44:47], 0
  s_add_u32 s77, s75, 3840
  s_cmp_lt_u32 s76, 125
  s_cselect_b32 s77, s77, 0x4000000
  v_exp_f32 v184, v184
  v_exp_f32 v185, v185
  v_mfma_f32_16x16x32_bf16 v[108:111], a[180:183], v[44:47], 0
  buffer_store_dwordx4 v[76:79], v27, s[52:55], s77 offen offset:0 sc1
  v_exp_f32 v186, v186
  v_exp_f32 v187, v187
  v_mfma_f32_16x16x32_bf16 v[132:135], a[184:187], v[44:47], 0
  buffer_store_dwordx4 v[100:103], v27, s[52:55], s77 offen offset:256 sc1
  v_exp_f32 v188, v188
  buffer_load_dwordx4 a[28:31], v3, s[84:87], s88 offen sc1
  v_exp_f32 v189, v189
  v_mfma_f32_16x16x32_bf16 v[156:159], a[188:191], v[44:47], 0
  buffer_store_dwordx4 v[124:127], v27, s[52:55], s77 offen offset:512 sc1
  v_exp_f32 v190, v190
  v_exp_f32 v191, v191
  v_mfma_f32_16x16x32_bf16 v[180:183], a[192:195], v[44:47], 0
  buffer_store_dwordx4 v[148:151], v27, s[52:55], s77 offen offset:768 sc1
  v_exp_f32 v192, v192
  v_exp_f32 v193, v193
  v_mfma_f32_16x16x32_bf16 v[84:87], a[196:199], v[48:51], v[84:87]
  buffer_store_dwordx4 v[172:175], v27, s[52:55], s77 offen offset:1024 sc1
  v_exp_f32 v194, v194
  v_exp_f32 v195, v195
  v_mfma_f32_16x16x32_bf16 v[108:111], a[200:203], v[48:51], v[108:111]
  v_exp_f32 v196, v196
  v_exp_f32 v197, v197
  v_mfma_f32_16x16x32_bf16 v[132:135], a[204:207], v[48:51], v[132:135]
  v_exp_f32 v198, v198
  v_exp_f32 v199, v199
  v_mfma_f32_16x16x32_bf16 v[156:159], a[208:211], v[48:51], v[156:159]
  v_exp_f32_e64 v200, v200
  s_add_u32 s88, s89, 327680
  buffer_load_dwordx4 a[32:35], v2, s[84:87], s88 offen offset:0 sc1
  v_exp_f32 v201, v201
  v_mfma_f32_16x16x32_bf16 v[180:183], a[212:215], v[48:51], v[180:183]
  v_exp_f32 v202, v202
  v_exp_f32 v203, v203
  v_mfma_f32_16x16x32_bf16 v[84:87], a[216:219], v[52:55], v[84:87]
  v_exp_f32 v80, v80
  v_exp_f32 v81, v81
  v_mfma_f32_16x16x32_bf16 v[108:111], a[220:223], v[52:55], v[108:111]
  v_exp_f32 v82, v82
  v_exp_f32 v83, v83
  v_mfma_f32_16x16x32_bf16 v[132:135], a[224:227], v[52:55], v[132:135]
  v_exp_f32 v104, v104
  v_exp_f32 v105, v105
  v_mfma_f32_16x16x32_bf16 v[156:159], a[228:231], v[52:55], v[156:159]
  v_exp_f32 v106, v106
  v_exp_f32 v107, v107
  v_mfma_f32_16x16x32_bf16 v[180:183], a[232:235], v[52:55], v[180:183]
  v_exp_f32 v128, v128
  buffer_load_dwordx4 a[36:39], v2, s[84:87], s88 offen offset:1024 sc1
  v_exp_f32 v129, v129
  v_exp_f32 v130, v130
  v_exp_f32 v131, v131
  v_exp_f32 v152, v152
  v_exp_f32 v153, v153
  v_exp_f32 v154, v154
  v_exp_f32 v155, v155
  v_exp_f32 v176, v176
  v_exp_f32 v177, v177
  v_exp_f32 v178, v178
  v_exp_f32_e64 v179, v179
  v_pk_add_f32 v[208:209], v[184:185], v[186:187]
  v_pk_add_f32 v[204:205], v[188:189], v[190:191]
  v_pk_add_f32 v[210:211], v[80:81], v[82:83]
  v_pk_add_f32 v[206:207], v[104:105], v[106:107]
  v_pk_add_f32 v[208:209], v[208:209], v[192:193]
  v_pk_add_f32 v[204:205], v[204:205], v[194:195]
  v_pk_add_f32 v[210:211], v[210:211], v[128:129]
  v_pk_add_f32 v[206:207], v[206:207], v[130:131]
  v_pk_add_f32 v[208:209], v[208:209], v[196:197]
  v_pk_add_f32 v[204:205], v[204:205], v[198:199]
  v_pk_add_f32 v[210:211], v[210:211], v[152:153]
  v_pk_add_f32 v[206:207], v[206:207], v[154:155]
  v_pk_add_f32 v[208:209], v[208:209], v[200:201]
  v_pk_add_f32 v[204:205], v[204:205], v[202:203]
  v_pk_add_f32 v[210:211], v[210:211], v[176:177]
  v_pk_add_f32 v[206:207], v[206:207], v[178:179]
  v_pk_add_f32 v[208:209], v[208:209], v[204:205]
  v_pk_add_f32 v[210:211], v[210:211], v[206:207]
  buffer_load_dwordx4 a[40:43], v2, s[84:87], s88 offen offset:2048 sc1
  v_add_f32 v208, v208, v209
  v_add_f32 v210, v210, v211
  v_rcp_f32 v208, v208
  v_rcp_f32 v210, v210
  v_pk_mul_f32 v[184:185], v[184:185], v[208:209] op_sel_hi:[1,0]
  v_pk_mul_f32 v[186:187], v[186:187], v[208:209] op_sel_hi:[1,0]
  v_pk_mul_f32 v[188:189], v[188:189], v[208:209] op_sel_hi:[1,0]
  v_pk_mul_f32 v[190:191], v[190:191], v[208:209] op_sel_hi:[1,0]
  v_pk_mul_f32 v[192:193], v[192:193], v[208:209] op_sel_hi:[1,0]
  v_pk_mul_f32 v[194:195], v[194:195], v[208:209] op_sel_hi:[1,0]
  v_pk_mul_f32 v[196:197], v[196:197], v[208:209] op_sel_hi:[1,0]
  v_pk_mul_f32 v[198:199], v[198:199], v[208:209] op_sel_hi:[1,0]
  v_pk_mul_f32 v[200:201], v[200:201], v[208:209] op_sel_hi:[1,0]
  v_pk_mul_f32 v[202:203], v[202:203], v[208:209] op_sel_hi:[1,0]
  buffer_load_dwordx4 a[44:47], v2, s[84:87], s88 offen offset:3072 sc1
  v_pk_mul_f32 v[80:81], v[80:81], v[210:211] op_sel_hi:[1,0]
  v_pk_mul_f32 v[82:83], v[82:83], v[210:211] op_sel_hi:[1,0]
  v_pk_mul_f32 v[104:105], v[104:105], v[210:211] op_sel_hi:[1,0]
  v_pk_mul_f32 v[106:107], v[106:107], v[210:211] op_sel_hi:[1,0]
  v_pk_mul_f32 v[128:129], v[128:129], v[210:211] op_sel_hi:[1,0]
  v_pk_mul_f32 v[130:131], v[130:131], v[210:211] op_sel_hi:[1,0]
  v_pk_mul_f32 v[152:153], v[152:153], v[210:211] op_sel_hi:[1,0]
  v_pk_mul_f32 v[154:155], v[154:155], v[210:211] op_sel_hi:[1,0]
  v_pk_mul_f32 v[176:177], v[176:177], v[210:211] op_sel_hi:[1,0]
  v_pk_mul_f32 v[178:179], v[178:179], v[210:211] op_sel_hi:[1,0]
  buffer_load_dwordx4 a[96:99], v3, s[84:87], s88 offen sc1
  v_cvt_pk_bf16_f32 v179, v178, v179
  v_cvt_pk_bf16_f32 v178, v176, v177
  v_cvt_pk_bf16_f32 v177, v154, v155
  v_cvt_pk_bf16_f32 v176, v152, v153
  v_cvt_pk_bf16_f32 v155, v130, v131
  v_cvt_pk_bf16_f32 v154, v128, v129
  v_cvt_pk_bf16_f32 v153, v106, v107
  v_cvt_pk_bf16_f32 v152, v104, v105
  v_cvt_pk_bf16_f32 v131, v82, v83
  v_cvt_pk_bf16_f32 v130, v80, v81
  v_cvt_pk_bf16_f32 v80, v184, v185
  v_cvt_pk_bf16_f32 v81, v186, v187
  v_cvt_pk_bf16_f32 v82, v188, v189
  v_cvt_pk_bf16_f32 v83, v190, v191
  v_cvt_pk_bf16_f32 v104, v192, v193
  v_cvt_pk_bf16_f32 v105, v194, v195
  v_cvt_pk_bf16_f32 v106, v196, v197
  v_cvt_pk_bf16_f32 v107, v198, v199
  v_cvt_pk_bf16_f32 v128, v200, v201
  v_cvt_pk_bf16_f32 v129, v202, v203
  v_max3_f32 v204, v84, v85, v86
  v_min3_f32 v206, v84, v85, v86
  v_max3_f32 v205, v87, v108, v109
  v_min3_f32 v207, v87, v108, v109
  v_max3_f32 v204, v204, v110, v111
  v_min3_f32 v206, v206, v110, v111
  v_max3_f32 v205, v205, v132, v133
  v_min3_f32 v207, v207, v132, v133
  v_max3_f32 v204, v204, v134, v135
  v_min3_f32 v206, v206, v134, v135
  v_max3_f32 v205, v205, v156, v157
  v_min3_f32 v207, v207, v156, v157
  v_max3_f32 v204, v204, v158, v159
  v_min3_f32 v206, v206, v158, v159
  v_max3_f32 v205, v205, v180, v181
  v_min3_f32 v207, v207, v180, v181
  v_max3_f32 v204, v204, v182, v183
  v_min3_f32 v206, v206, v182, v183
  s_add_u32 s88, s89, 348160
  buffer_load_dwordx4 a[100:103], v2, s[84:87], s88 offen offset:0 sc1
  v_max_f32 v204, v204, v205
  v_min_f32 v206, v206, v207
  v_mul_f32 v204, 0xbfb8aa3b, v204
  v_mul_f32 v206, 0x3fb8aa3b, v206
  v_pk_fma_f32 v[184:185], v[84:85], s[70:71], v[204:205] op_sel_hi:[1,1,0]
  v_pk_fma_f32 v[186:187], v[86:87], s[70:71], v[204:205] op_sel_hi:[1,1,0]
  v_pk_fma_f32 v[188:189], v[108:109], s[70:71], v[204:205] op_sel_hi:[1,1,0]
  v_pk_fma_f32 v[190:191], v[110:111], s[70:71], v[204:205] op_sel_hi:[1,1,0]
  v_pk_fma_f32 v[192:193], v[132:133], s[70:71], v[204:205] op_sel_hi:[1,1,0]
  v_pk_fma_f32 v[194:195], v[134:135], s[70:71], v[204:205] op_sel_hi:[1,1,0]
  v_pk_fma_f32 v[196:197], v[156:157], s[70:71], v[204:205] op_sel_hi:[1,1,0]
  v_pk_fma_f32 v[198:199], v[158:159], s[70:71], v[204:205] op_sel_hi:[1,1,0]
  v_pk_fma_f32 v[200:201], v[180:181], s[70:71], v[204:205] op_sel_hi:[1,1,0]
  v_pk_fma_f32 v[202:203], v[182:183], s[70:71], v[204:205] op_sel_hi:[1,1,0]
  buffer_load_dwordx4 a[104:107], v2, s[84:87], s88 offen offset:1024 sc1
  v_pk_fma_f32 v[84:85], v[84:85], s[70:71], v[206:207] op_sel_hi:[1,1,0] neg_lo:[0,1,0] neg_hi:[0,1,0]
  v_pk_fma_f32 v[86:87], v[86:87], s[70:71], v[206:207] op_sel_hi:[1,1,0] neg_lo:[0,1,0] neg_hi:[0,1,0]
  v_pk_fma_f32 v[108:109], v[108:109], s[70:71], v[206:207] op_sel_hi:[1,1,0] neg_lo:[0,1,0] neg_hi:[0,1,0]
  v_pk_fma_f32 v[110:111], v[110:111], s[70:71], v[206:207] op_sel_hi:[1,1,0] neg_lo:[0,1,0] neg_hi:[0,1,0]
  v_pk_fma_f32 v[132:133], v[132:133], s[70:71], v[206:207] op_sel_hi:[1,1,0] neg_lo:[0,1,0] neg_hi:[0,1,0]
  v_pk_fma_f32 v[134:135], v[134:135], s[70:71], v[206:207] op_sel_hi:[1,1,0] neg_lo:[0,1,0] neg_hi:[0,1,0]
  v_pk_fma_f32 v[156:157], v[156:157], s[70:71], v[206:207] op_sel_hi:[1,1,0] neg_lo:[0,1,0] neg_hi:[0,1,0]
  v_pk_fma_f32 v[158:159], v[158:159], s[70:71], v[206:207] op_sel_hi:[1,1,0] neg_lo:[0,1,0] neg_hi:[0,1,0]
  v_pk_fma_f32 v[180:181], v[180:181], s[70:71], v[206:207] op_sel_hi:[1,1,0] neg_lo:[0,1,0] neg_hi:[0,1,0]
  v_pk_fma_f32 v[182:183], v[182:183], s[70:71], v[206:207] op_sel_hi:[1,1,0] neg_lo:[0,1,0] neg_hi:[0,1,0]
  s_add_u32 s77, s75, 5120
  s_cmp_lt_u32 s76, 124
  s_cselect_b32 s77, s77, 0x4000000
  v_exp_f32 v184, v184
  v_exp_f32 v185, v185
  buffer_store_dwordx4 v[80:83], v27, s[52:55], s77 offen offset:0 sc1
  v_exp_f32 v186, v186
  v_exp_f32 v187, v187
  buffer_store_dwordx4 v[104:107], v27, s[52:55], s77 offen offset:256 sc1
  v_exp_f32 v188, v188
  s_add_u32 s100, s89, 0
  s_add_u32 m0, s89, 0
  s_nop 0
  buffer_load_dwordx4 v2, s[84:87], s100 offen offset:0 sc1 lds
  v_exp_f32 v189, v189
  buffer_store_dwordx4 v[128:131], v27, s[52:55], s77 offen offset:512 sc1
  v_exp_f32 v190, v190
  v_exp_f32 v191, v191
  buffer_store_dwordx4 v[152:155], v27, s[52:55], s77 offen offset:768 sc1
  v_exp_f32 v192, v192
  v_exp_f32 v193, v193
  buffer_store_dwordx4 v[176:179], v27, s[52:55], s77 offen offset:1024 sc1
  v_exp_f32 v194, v194
  v_exp_f32 v195, v195
  v_exp_f32 v196, v196
  v_exp_f32 v197, v197
  v_exp_f32 v198, v198
  v_exp_f32 v199, v199
  v_exp_f32 v200, v200
  s_add_u32 m0, s89, 0
  s_nop 0
  buffer_load_dwordx4 v2, s[84:87], s100 offen offset:1024 sc1 lds
  v_exp_f32 v201, v201
  v_exp_f32 v202, v202
  v_exp_f32 v203, v203
  v_exp_f32 v84, v84
  v_exp_f32 v85, v85
  v_exp_f32 v86, v86
  v_exp_f32 v87, v87
  v_exp_f32 v108, v108
  v_exp_f32 v109, v109
  v_exp_f32 v110, v110
  v_exp_f32 v111, v111
  v_exp_f32 v132, v132
  s_add_u32 m0, s89, 0
  s_nop 0
  buffer_load_dwordx4 v2, s[84:87], s100 offen offset:2048 sc1 lds
  v_exp_f32 v133, v133
  v_exp_f32 v134, v134
  v_exp_f32 v135, v135
  v_exp_f32 v156, v156
  v_exp_f32 v157, v157
  v_exp_f32 v158, v158
  v_exp_f32 v159, v159
  v_exp_f32 v180, v180
  v_exp_f32 v181, v181
  v_exp_f32 v182, v182
  v_exp_f32_e64 v183, v183
  v_pk_add_f32 v[208:209], v[184:185], v[186:187]
  v_pk_add_f32 v[204:205], v[188:189], v[190:191]
  v_pk_add_f32 v[210:211], v[84:85], v[86:87]
  v_pk_add_f32 v[206:207], v[108:109], v[110:111]
  v_pk_add_f32 v[208:209], v[208:209], v[192:193]
  v_pk_add_f32 v[204:205], v[204:205], v[194:195]
  v_pk_add_f32 v[210:211], v[210:211], v[132:133]
  v_pk_add_f32 v[206:207], v[206:207], v[134:135]
  v_pk_add_f32 v[208:209], v[208:209], v[196:197]
  v_pk_add_f32 v[204:205], v[204:205], v[198:199]
  v_pk_add_f32 v[210:211], v[210:211], v[156:157]
  v_pk_add_f32 v[206:207], v[206:207], v[158:159]
  v_pk_add_f32 v[208:209], v[208:209], v[200:201]
  v_pk_add_f32 v[204:205], v[204:205], v[202:203]
  v_pk_add_f32 v[210:211], v[210:211], v[180:181]
  v_pk_add_f32 v[206:207], v[206:207], v[182:183]
  v_pk_add_f32 v[208:209], v[208:209], v[204:205]
  v_pk_add_f32 v[210:211], v[210:211], v[206:207]
  s_add_u32 m0, s89, 0
  s_nop 0
  buffer_load_dwordx4 v2, s[84:87], s100 offen offset:3072 sc1 lds
  v_add_f32 v208, v208, v209
  v_add_f32 v210, v210, v211
  v_rcp_f32 v208, v208
  v_rcp_f32 v210, v210
  v_pk_mul_f32 v[184:185], v[184:185], v[208:209] op_sel_hi:[1,0]
  v_pk_mul_f32 v[186:187], v[186:187], v[208:209] op_sel_hi:[1,0]
  v_pk_mul_f32 v[188:189], v[188:189], v[208:209] op_sel_hi:[1,0]
  v_pk_mul_f32 v[190:191], v[190:191], v[208:209] op_sel_hi:[1,0]
  v_pk_mul_f32 v[192:193], v[192:193], v[208:209] op_sel_hi:[1,0]
  v_pk_mul_f32 v[194:195], v[194:195], v[208:209] op_sel_hi:[1,0]
  v_pk_mul_f32 v[196:197], v[196:197], v[208:209] op_sel_hi:[1,0]
  v_pk_mul_f32 v[198:199], v[198:199], v[208:209] op_sel_hi:[1,0]
  v_pk_mul_f32 v[200:201], v[200:201], v[208:209] op_sel_hi:[1,0]
  v_pk_mul_f32 v[202:203], v[202:203], v[208:209] op_sel_hi:[1,0]
  s_add_u32 m0, s89, 4096
  s_nop 0
  s_nop 0
  buffer_load_dwordx4 v3, s[84:87], s100 offen sc1 lds
  v_pk_mul_f32 v[84:85], v[84:85], v[210:211] op_sel_hi:[1,0]
  v_pk_mul_f32 v[86:87], v[86:87], v[210:211] op_sel_hi:[1,0]
  v_pk_mul_f32 v[108:109], v[108:109], v[210:211] op_sel_hi:[1,0]
  v_pk_mul_f32 v[110:111], v[110:111], v[210:211] op_sel_hi:[1,0]
  v_pk_mul_f32 v[132:133], v[132:133], v[210:211] op_sel_hi:[1,0]
  v_pk_mul_f32 v[134:135], v[134:135], v[210:211] op_sel_hi:[1,0]
  v_pk_mul_f32 v[156:157], v[156:157], v[210:211] op_sel_hi:[1,0]
  v_pk_mul_f32 v[158:159], v[158:159], v[210:211] op_sel_hi:[1,0]
  v_pk_mul_f32 v[180:181], v[180:181], v[210:211] op_sel_hi:[1,0]
  v_pk_mul_f32 v[182:183], v[182:183], v[210:211] op_sel_hi:[1,0]
  v_cvt_pk_bf16_f32 v183, v182, v183
  v_cvt_pk_bf16_f32 v182, v180, v181
  v_cvt_pk_bf16_f32 v181, v158, v159
  v_cvt_pk_bf16_f32 v180, v156, v157
  v_cvt_pk_bf16_f32 v159, v134, v135
  v_cvt_pk_bf16_f32 v158, v132, v133
  v_cvt_pk_bf16_f32 v157, v110, v111
  v_cvt_pk_bf16_f32 v156, v108, v109
  v_cvt_pk_bf16_f32 v135, v86, v87
  v_cvt_pk_bf16_f32 v134, v84, v85
  v_cvt_pk_bf16_f32 v84, v184, v185
  v_cvt_pk_bf16_f32 v85, v186, v187
  v_cvt_pk_bf16_f32 v86, v188, v189
  v_cvt_pk_bf16_f32 v87, v190, v191
  v_cvt_pk_bf16_f32 v108, v192, v193
  v_cvt_pk_bf16_f32 v109, v194, v195
  v_cvt_pk_bf16_f32 v110, v196, v197
  v_cvt_pk_bf16_f32 v111, v198, v199
  v_cvt_pk_bf16_f32 v132, v200, v201
  v_cvt_pk_bf16_f32 v133, v202, v203
  s_add_u32 s77, s75, 6400
  s_cmp_lt_u32 s76, 123
  s_cselect_b32 s77, s77, 0x4000000
  buffer_store_dwordx4 v[84:87], v27, s[52:55], s77 offen offset:0 sc1
  buffer_store_dwordx4 v[108:111], v27, s[52:55], s77 offen offset:256 sc1
  buffer_store_dwordx4 v[132:135], v27, s[52:55], s77 offen offset:512 sc1
  buffer_store_dwordx4 v[156:159], v27, s[52:55], s77 offen offset:768 sc1
  buffer_store_dwordx4 v[180:183], v27, s[52:55], s77 offen offset:1024 sc1
  s_add_u32 s88, s89, 143360
  buffer_load_dwordx4 a[176:179], v2, s[84:87], s88 offen offset:2048 sc1
  buffer_load_dwordx4 a[180:183], v2, s[84:87], s88 offen offset:3072 sc1
  buffer_load_dwordx4 a[184:187], v3, s[84:87], s88 offen sc1
  s_add_u32 s88, s89, 163840
  buffer_load_dwordx4 a[188:191], v2, s[84:87], s88 offen offset:0 sc1
  buffer_load_dwordx4 a[192:195], v2, s[84:87], s88 offen offset:1024 sc1
  buffer_load_dwordx4 a[196:199], v2, s[84:87], s88 offen offset:2048 sc1
  s_waitcnt vmcnt(6)
  s_barrier
  s_cmp_lg_u32 s32, 0
  s_cbranch_scc1 Lsg_55
  v_mov_b32 v4, s69
  v_mov_b32 v31, 1
  s_mov_b64 exec, 1
  global_atomic_add v4, v31, s[90:91] sc1
  s_mov_b64 exec, -1
Lsg_55:
  s_branch L_qtail
L_spare:
  s_cmp_eq_u32 s79, 0
  s_cselect_b32 s64, 417792, 0
  s_add_u32 s96, s30, 0x1300000
  s_addc_u32 s97, s31, 0
  s_and_b32 s97, s97, 0xffff
  s_mov_b32 s98, s64
  s_mov_b32 s99, 0x20000
  v_mov_b32 v56, 0
  v_mov_b32 v57, 0
  v_mov_b32 v58, 0
  v_mov_b32 v59, 0
  s_mul_i32 s64, s32, 104448
  v_mul_u32_u24 v60, 4352, v24
  v_lshl_add_u32 v60, v25, 4, v60
  buffer_store_dwordx4 v[56:59], v60, s[96:99], s64 offen sc1
  s_add_u32 s64, s64, 34816
  buffer_store_dwordx4 v[56:59], v60, s[96:99], s64 offen sc1
  s_add_u32 s64, s64, 34816
  buffer_store_dwordx4 v[56:59], v60, s[96:99], s64 offen sc1
  s_add_u32 s64, s64, 34816
  s_lshl_b32 s72, s79, 2
  s_add_u32 s72, s72, s32
  s_mov_b32 s40, s8
  s_and_b32 s41, s9, 0xffff
  s_mov_b32 s42, 0x280000
  s_mov_b32 s43, 0x20000
  s_mov_b32 s56, s24
  s_and_b32 s57, s25, 0xffff
  s_mov_b32 s58, 0x500
  s_mov_b32 s59, 0x20000
  s_add_u32 s44, s30, 0x1200000
  s_addc_u32 s45, s31, 0
  s_and_b32 s45, s45, 0xffff
  s_mov_b32 s46, 0x2000
  s_mov_b32 s47, 0x20000
  v_and_b32 v24, 15, v0
  v_lshrrev_b32 v25, 4, v0
  v_lshlrev_b32 v26, 4, v24
  buffer_load_dwordx4 v[32:35], v26, s[56:59], 0 offen offset:0
  buffer_load_dwordx4 v[36:39], v26, s[56:59], 0 offen offset:256
  buffer_load_dwordx4 v[40:43], v26, s[56:59], 0 offen offset:512
  buffer_load_dwordx4 v[44:47], v26, s[56:59], 0 offen offset:768
  buffer_load_dwordx4 v[48:51], v26, s[56:59], 0 offen offset:1024
  s_waitcnt vmcnt(5)
  s_barrier
  s_cmp_lg_u32 s32, 0
  s_cbranch_scc1 Lsg_56
  v_mov_b32 v4, 0
  v_mov_b32 v31, 1
  s_mov_b64 exec, 1
  global_atomic_add v4, v31, s[28:29] sc1
  s_mov_b64 exec, -1
Lsg_56:
  v_lshlrev_b32 v27, 3, v25
  v_mul_u32_u24 v27, 1280, v27
  v_add_u32 v27, v27, v26
  v_lshl_add_u32 v28, v25, 3, v24
  v_lshlrev_b32 v28, 2, v28
  v_mov_b32 v30, 0x7fffffff
  v_cmp_gt_u32 vcc, 8, v24
  s_nop 1
  v_cndmask_b32 v28, v30, v28, vcc
  s_mul_i32 s74, s72, 163840
  s_lshl_b32 s75, s72, 9
  s_nop 0
  buffer_load_dwordx4 v[64:67], v27, s[40:43], s74 offen offset:0
  buffer_load_dwordx4 v[68:71], v27, s[40:43], s74 offen offset:256
  buffer_load_dwordx4 v[72:75], v27, s[40:43], s74 offen offset:512
  buffer_load_dwordx4 v[76:79], v27, s[40:43], s74 offen offset:768
  buffer_load_dwordx4 v[80:83], v27, s[40:43], s74 offen offset:1024
  s_add_u32 s74, s74, 1280
  buffer_load_dwordx4 v[84:87], v27, s[40:43], s74 offen offset:0
  buffer_load_dwordx4 v[88:91], v27, s[40:43], s74 offen offset:256
  buffer_load_dwordx4 v[92:95], v27, s[40:43], s74 offen offset:512
  buffer_load_dwordx4 v[96:99], v27, s[40:43], s74 offen offset:768
  buffer_load_dwordx4 v[100:103], v27, s[40:43], s74 offen offset:1024
  s_add_u32 s74, s74, 1280
  buffer_load_dwordx4 v[104:107], v27, s[40:43], s74 offen offset:0
  buffer_load_dwordx4 v[108:111], v27, s[40:43], s74 offen offset:256
  buffer_load_dwordx4 v[112:115], v27, s[40:43], s74 offen offset:512
  buffer_load_dwordx4 v[116:119], v27, s[40:43], s74 offen offset:768
  buffer_load_dwordx4 v[120:123], v27, s[40:43], s74 offen offset:1024
  s_add_u32 s74, s74, 1280
  s_mov_b32 s76, 0
L_gate:
  s_waitcnt vmcnt(10)
  buffer_load_dwordx4 v[124:127], v27, s[40:43], s74 offen offset:0
  buffer_load_dwordx4 v[128:131], v27, s[40:43], s74 offen offset:256
  buffer_load_dwordx4 v[132:135], v27, s[40:43], s74 offen offset:512
  buffer_load_dwordx4 v[136:139], v27, s[40:43], s74 offen offset:768
  buffer_load_dwordx4 v[140:143], v27, s[40:43], s74 offen offset:1024
  s_add_u32 s74, s74, 1280
  v_mov_b32 v30, 0
  v_dot2c_f32_bf16 v30, v64, v32
  v_dot2c_f32_bf16 v30, v65, v33
  v_dot2c_f32_bf16 v30, v66, v34
  v_dot2c_f32_bf16 v30, v67, v35
  v_dot2c_f32_bf16 v30, v68, v36
  v_dot2c_f32_bf16 v30, v69, v37
  v_dot2c_f32_bf16 v30, v70, v38
  v_dot2c_f32_bf16 v30, v71, v39
  v_dot2c_f32_bf16 v30, v72, v40
  v_dot2c_f32_bf16 v30, v73, v41
  v_dot2c_f32_bf16 v30, v74, v42
  v_dot2c_f32_bf16 v30, v75, v43
  v_dot2c_f32_bf16 v30, v76, v44
  v_dot2c_f32_bf16 v30, v77, v45
  v_dot2c_f32_bf16 v30, v78, v46
  v_dot2c_f32_bf16 v30, v79, v47
  v_dot2c_f32_bf16 v30, v80, v48
  v_dot2c_f32_bf16 v30, v81, v49
  v_dot2c_f32_bf16 v30, v82, v50
  v_dot2c_f32_bf16 v30, v83, v51
  s_nop 3
  v_add_f32_dpp v30, v30, v30 row_ror:8 row_mask:0xf bank_mask:0xf
  s_nop 1
  v_add_f32_dpp v30, v30, v30 row_ror:4 row_mask:0xf bank_mask:0xf
  s_nop 1
  v_add_f32_dpp v30, v30, v30 row_ror:2 row_mask:0xf bank_mask:0xf
  s_nop 1
  v_add_f32_dpp v30, v30, v30 row_ror:1 row_mask:0xf bank_mask:0xf
  v_cmp_eq_u32 vcc, 0, v24
  s_nop 1
  v_cndmask_b32 v29, v29, v30, vcc
  s_waitcnt vmcnt(10)
  buffer_load_dwordx4 v[144:147], v27, s[40:43], s74 offen offset:0
  buffer_load_dwordx4 v[148:151], v27, s[40:43], s74 offen offset:256
  buffer_load_dwordx4 v[152:155], v27, s[40:43], s74 offen offset:512
  buffer_load_dwordx4 v[156:159], v27, s[40:43], s74 offen offset:768
  buffer_load_dwordx4 v[160:163], v27, s[40:43], s74 offen offset:1024
  s_add_u32 s74, s74, 1280
  v_mov_b32 v30, 0
  v_dot2c_f32_bf16 v30, v84, v32
  v_dot2c_f32_bf16 v30, v85, v33
  v_dot2c_f32_bf16 v30, v86, v34
  v_dot2c_f32_bf16 v30, v87, v35
  v_dot2c_f32_bf16 v30, v88, v36
  v_dot2c_f32_bf16 v30, v89, v37
  v_dot2c_f32_bf16 v30, v90, v38
  v_dot2c_f32_bf16 v30, v91, v39
  v_dot2c_f32_bf16 v30, v92, v40
  v_dot2c_f32_bf16 v30, v93, v41
  v_dot2c_f32_bf16 v30, v94, v42
  v_dot2c_f32_bf16 v30, v95, v43
  v_dot2c_f32_bf16 v30, v96, v44
  v_dot2c_f32_bf16 v30, v97, v45
  v_dot2c_f32_bf16 v30, v98, v46
  v_dot2c_f32_bf16 v30, v99, v47
  v_dot2c_f32_bf16 v30, v100, v48
  v_dot2c_f32_bf16 v30, v101, v49
  v_dot2c_f32_bf16 v30, v102, v50
  v_dot2c_f32_bf16 v30, v103, v51
  s_nop 3
  v_add_f32_dpp v30, v30, v30 row_ror:8 row_mask:0xf bank_mask:0xf
  s_nop 1
  v_add_f32_dpp v30, v30, v30 row_ror:4 row_mask:0xf bank_mask:0xf
  s_nop 1
  v_add_f32_dpp v30, v30, v30 row_ror:2 row_mask:0xf bank_mask:0xf
  s_nop 1
  v_add_f32_dpp v30, v30, v30 row_ror:1 row_mask:0xf bank_mask:0xf
  v_cmp_eq_u32 vcc, 1, v24
  s_nop 1
  v_cndmask_b32 v29, v29, v30, vcc
  s_waitcnt vmcnt(10)
  buffer_load_dwordx4 v[164:167], v27, s[40:43], s74 offen offset:0
  buffer_load_dwordx4 v[168:171], v27, s[40:43], s74 offen offset:256
  buffer_load_dwordx4 v[172:175], v27, s[40:43], s74 offen offset:512
  buffer_load_dwordx4 v[176:179], v27, s[40:43], s74 offen offset:768
  buffer_load_dwordx4 v[180:183], v27, s[40:43], s74 offen offset:1024
  s_add_u32 s74, s74, 1280
  v_mov_b32 v30, 0
  v_dot2c_f32_bf16 v30, v104, v32
  v_dot2c_f32_bf16 v30, v105, v33
  v_dot2c_f32_bf16 v30, v106, v34
  v_dot2c_f32_bf16 v30, v107, v35
  v_dot2c_f32_bf16 v30, v108, v36
  v_dot2c_f32_bf16 v30, v109, v37
  v_dot2c_f32_bf16 v30, v110, v38
  v_dot2c_f32_bf16 v30, v111, v39
  v_dot2c_f32_bf16 v30, v112, v40
  v_dot2c_f32_bf16 v30, v113, v41
  v_dot2c_f32_bf16 v30, v114, v42
  v_dot2c_f32_bf16 v30, v115, v43
  v_dot2c_f32_bf16 v30, v116, v44
  v_dot2c_f32_bf16 v30, v117, v45
  v_dot2c_f32_bf16 v30, v118, v46
  v_dot2c_f32_bf16 v30, v119, v47
  v_dot2c_f32_bf16 v30, v120, v48
  v_dot2c_f32_bf16 v30, v121, v49
  v_dot2c_f32_bf16 v30, v122, v50
  v_dot2c_f32_bf16 v30, v123, v51
  s_nop 3
  v_add_f32_dpp v30, v30, v30 row_ror:8 row_mask:0xf bank_mask:0xf
  s_nop 1
  v_add_f32_dpp v30, v30, v30 row_ror:4 row_mask:0xf bank_mask:0xf
  s_nop 1
  v_add_f32_dpp v30, v30, v30 row_ror:2 row_mask:0xf bank_mask:0xf
  s_nop 1
  v_add_f32_dpp v30, v30, v30 row_ror:1 row_mask:0xf bank_mask:0xf
  v_cmp_eq_u32 vcc, 2, v24
  s_nop 1
  v_cndmask_b32 v29, v29, v30, vcc
  s_waitcnt vmcnt(10)
  buffer_load_dwordx4 v[184:187], v27, s[40:43], s74 offen offset:0
  buffer_load_dwordx4 v[188:191], v27, s[40:43], s74 offen offset:256
  buffer_load_dwordx4 v[192:195], v27, s[40:43], s74 offen offset:512
  buffer_load_dwordx4 v[196:199], v27, s[40:43], s74 offen offset:768
  buffer_load_dwordx4 v[200:203], v27, s[40:43], s74 offen offset:1024
  s_add_u32 s74, s74, 1280
  v_mov_b32 v30, 0
  v_dot2c_f32_bf16 v30, v124, v32
  v_dot2c_f32_bf16 v30, v125, v33
  v_dot2c_f32_bf16 v30, v126, v34
  v_dot2c_f32_bf16 v30, v127, v35
  v_dot2c_f32_bf16 v30, v128, v36
  v_dot2c_f32_bf16 v30, v129, v37
  v_dot2c_f32_bf16 v30, v130, v38
  v_dot2c_f32_bf16 v30, v131, v39
  v_dot2c_f32_bf16 v30, v132, v40
  v_dot2c_f32_bf16 v30, v133, v41
  v_dot2c_f32_bf16 v30, v134, v42
  v_dot2c_f32_bf16 v30, v135, v43
  v_dot2c_f32_bf16 v30, v136, v44
  v_dot2c_f32_bf16 v30, v137, v45
  v_dot2c_f32_bf16 v30, v138, v46
  v_dot2c_f32_bf16 v30, v139, v47
  v_dot2c_f32_bf16 v30, v140, v48
  v_dot2c_f32_bf16 v30, v141, v49
  v_dot2c_f32_bf16 v30, v142, v50
  v_dot2c_f32_bf16 v30, v143, v51
  s_nop 3
  v_add_f32_dpp v30, v30, v30 row_ror:8 row_mask:0xf bank_mask:0xf
  s_nop 1
  v_add_f32_dpp v30, v30, v30 row_ror:4 row_mask:0xf bank_mask:0xf
  s_nop 1
  v_add_f32_dpp v30, v30, v30 row_ror:2 row_mask:0xf bank_mask:0xf
  s_nop 1
  v_add_f32_dpp v30, v30, v30 row_ror:1 row_mask:0xf bank_mask:0xf
  v_cmp_eq_u32 vcc, 3, v24
  s_nop 1
  v_cndmask_b32 v29, v29, v30, vcc
  s_waitcnt vmcnt(10)
  buffer_load_dwordx4 v[204:207], v27, s[40:43], s74 offen offset:0
  buffer_load_dwordx4 v[208:211], v27, s[40:43], s74 offen offset:256
  buffer_load_dwordx4 v[212:215], v27, s[40:43], s74 offen offset:512
  buffer_load_dwordx4 v[216:219], v27, s[40:43], s74 offen offset:768
  buffer_load_dwordx4 v[220:223], v27, s[40:43], s74 offen offset:1024
  s_add_u32 s74, s74, 32000
  v_mov_b32 v30, 0
  v_dot2c_f32_bf16 v30, v144, v32
  v_dot2c_f32_bf16 v30, v145, v33
  v_dot2c_f32_bf16 v30, v146, v34
  v_dot2c_f32_bf16 v30, v147, v35
  v_dot2c_f32_bf16 v30, v148, v36
  v_dot2c_f32_bf16 v30, v149, v37
  v_dot2c_f32_bf16 v30, v150, v38
  v_dot2c_f32_bf16 v30, v151, v39
  v_dot2c_f32_bf16 v30, v152, v40
  v_dot2c_f32_bf16 v30, v153, v41
  v_dot2c_f32_bf16 v30, v154, v42
  v_dot2c_f32_bf16 v30, v155, v43
  v_dot2c_f32_bf16 v30, v156, v44
  v_dot2c_f32_bf16 v30, v157, v45
  v_dot2c_f32_bf16 v30, v158, v46
  v_dot2c_f32_bf16 v30, v159, v47
  v_dot2c_f32_bf16 v30, v160, v48
  v_dot2c_f32_bf16 v30, v161, v49
  v_dot2c_f32_bf16 v30, v162, v50
  v_dot2c_f32_bf16 v30, v163, v51
  s_nop 3
  v_add_f32_dpp v30, v30, v30 row_ror:8 row_mask:0xf bank_mask:0xf
  s_nop 1
  v_add_f32_dpp v30, v30, v30 row_ror:4 row_mask:0xf bank_mask:0xf
  s_nop 1
  v_add_f32_dpp v30, v30, v30 row_ror:2 row_mask:0xf bank_mask:0xf
  s_nop 1
  v_add_f32_dpp v30, v30, v30 row_ror:1 row_mask:0xf bank_mask:0xf
  v_cmp_eq_u32 vcc, 4, v24
  s_nop 1
  v_cndmask_b32 v29, v29, v30, vcc
  s_waitcnt vmcnt(10)
  buffer_load_dwordx4 v[64:67], v27, s[40:43], s74 offen offset:0
  buffer_load_dwordx4 v[68:71], v27, s[40:43], s74 offen offset:256
  buffer_load_dwordx4 v[72:75], v27, s[40:43], s74 offen offset:512
  buffer_load_dwordx4 v[76:79], v27, s[40:43], s74 offen offset:768
  buffer_load_dwordx4 v[80:83], v27, s[40:43], s74 offen offset:1024
  s_add_u32 s74, s74, 1280
  v_mov_b32 v30, 0
  v_dot2c_f32_bf16 v30, v164, v32
  v_dot2c_f32_bf16 v30, v165, v33
  v_dot2c_f32_bf16 v30, v166, v34
  v_dot2c_f32_bf16 v30, v167, v35
  v_dot2c_f32_bf16 v30, v168, v36
  v_dot2c_f32_bf16 v30, v169, v37
  v_dot2c_f32_bf16 v30, v170, v38
  v_dot2c_f32_bf16 v30, v171, v39
  v_dot2c_f32_bf16 v30, v172, v40
  v_dot2c_f32_bf16 v30, v173, v41
  v_dot2c_f32_bf16 v30, v174, v42
  v_dot2c_f32_bf16 v30, v175, v43
  v_dot2c_f32_bf16 v30, v176, v44
  v_dot2c_f32_bf16 v30, v177, v45
  v_dot2c_f32_bf16 v30, v178, v46
  v_dot2c_f32_bf16 v30, v179, v47
  v_dot2c_f32_bf16 v30, v180, v48
  v_dot2c_f32_bf16 v30, v181, v49
  v_dot2c_f32_bf16 v30, v182, v50
  v_dot2c_f32_bf16 v30, v183, v51
  s_nop 3
  v_add_f32_dpp v30, v30, v30 row_ror:8 row_mask:0xf bank_mask:0xf
  s_nop 1
  v_add_f32_dpp v30, v30, v30 row_ror:4 row_mask:0xf bank_mask:0xf
  s_nop 1
  v_add_f32_dpp v30, v30, v30 row_ror:2 row_mask:0xf bank_mask:0xf
  s_nop 1
  v_add_f32_dpp v30, v30, v30 row_ror:1 row_mask:0xf bank_mask:0xf
  v_cmp_eq_u32 vcc, 5, v24
  s_nop 1
  v_cndmask_b32 v29, v29, v30, vcc
  s_waitcnt vmcnt(10)
  buffer_load_dwordx4 v[84:87], v27, s[40:43], s74 offen offset:0
  buffer_load_dwordx4 v[88:91], v27, s[40:43], s74 offen offset:256
  buffer_load_dwordx4 v[92:95], v27, s[40:43], s74 offen offset:512
  buffer_load_dwordx4 v[96:99], v27, s[40:43], s74 offen offset:768
  buffer_load_dwordx4 v[100:103], v27, s[40:43], s74 offen offset:1024
  s_add_u32 s74, s74, 1280
  v_mov_b32 v30, 0
  v_dot2c_f32_bf16 v30, v184, v32
  v_dot2c_f32_bf16 v30, v185, v33
  v_dot2c_f32_bf16 v30, v186, v34
  v_dot2c_f32_bf16 v30, v187, v35
  v_dot2c_f32_bf16 v30, v188, v36
  v_dot2c_f32_bf16 v30, v189, v37
  v_dot2c_f32_bf16 v30, v190, v38
  v_dot2c_f32_bf16 v30, v191, v39
  v_dot2c_f32_bf16 v30, v192, v40
  v_dot2c_f32_bf16 v30, v193, v41
  v_dot2c_f32_bf16 v30, v194, v42
  v_dot2c_f32_bf16 v30, v195, v43
  v_dot2c_f32_bf16 v30, v196, v44
  v_dot2c_f32_bf16 v30, v197, v45
  v_dot2c_f32_bf16 v30, v198, v46
  v_dot2c_f32_bf16 v30, v199, v47
  v_dot2c_f32_bf16 v30, v200, v48
  v_dot2c_f32_bf16 v30, v201, v49
  v_dot2c_f32_bf16 v30, v202, v50
  v_dot2c_f32_bf16 v30, v203, v51
  s_nop 3
  v_add_f32_dpp v30, v30, v30 row_ror:8 row_mask:0xf bank_mask:0xf
  s_nop 1
  v_add_f32_dpp v30, v30, v30 row_ror:4 row_mask:0xf bank_mask:0xf
  s_nop 1
  v_add_f32_dpp v30, v30, v30 row_ror:2 row_mask:0xf bank_mask:0xf
  s_nop 1
  v_add_f32_dpp v30, v30, v30 row_ror:1 row_mask:0xf bank_mask:0xf
  v_cmp_eq_u32 vcc, 6, v24
  s_nop 1
  v_cndmask_b32 v29, v29, v30, vcc
  s_waitcnt vmcnt(10)
  buffer_load_dwordx4 v[104:107], v27, s[40:43], s74 offen offset:0
  buffer_load_dwordx4 v[108:111], v27, s[40:43], s74 offen offset:256
  buffer_load_dwordx4 v[112:115], v27, s[40:43], s74 offen offset:512
  buffer_load_dwordx4 v[116:119], v27, s[40:43], s74 offen offset:768
  buffer_load_dwordx4 v[120:123], v27, s[40:43], s74 offen offset:1024
  s_add_u32 s74, s74, 1280
  v_mov_b32 v30, 0
  v_dot2c_f32_bf16 v30, v204, v32
  v_dot2c_f32_bf16 v30, v205, v33
  v_dot2c_f32_bf16 v30, v206, v34
  v_dot2c_f32_bf16 v30, v207, v35
  v_dot2c_f32_bf16 v30, v208, v36
  v_dot2c_f32_bf16 v30, v209, v37
  v_dot2c_f32_bf16 v30, v210, v38
  v_dot2c_f32_bf16 v30, v211, v39
  v_dot2c_f32_bf16 v30, v212, v40
  v_dot2c_f32_bf16 v30, v213, v41
  v_dot2c_f32_bf16 v30, v214, v42
  v_dot2c_f32_bf16 v30, v215, v43
  v_dot2c_f32_bf16 v30, v216, v44
  v_dot2c_f32_bf16 v30, v217, v45
  v_dot2c_f32_bf16 v30, v218, v46
  v_dot2c_f32_bf16 v30, v219, v47
  v_dot2c_f32_bf16 v30, v220, v48
  v_dot2c_f32_bf16 v30, v221, v49
  v_dot2c_f32_bf16 v30, v222, v50
  v_dot2c_f32_bf16 v30, v223, v51
  s_nop 3
  v_add_f32_dpp v30, v30, v30 row_ror:8 row_mask:0xf bank_mask:0xf
  s_nop 1
  v_add_f32_dpp v30, v30, v30 row_ror:4 row_mask:0xf bank_mask:0xf
  s_nop 1
  v_add_f32_dpp v30, v30, v30 row_ror:2 row_mask:0xf bank_mask:0xf
  s_nop 1
  v_add_f32_dpp v30, v30, v30 row_ror:1 row_mask:0xf bank_mask:0xf
  v_cmp_eq_u32 vcc, 7, v24
  s_nop 1
  v_cndmask_b32 v29, v29, v30, vcc
  v_mul_f32 v31, 0xbfb8aa3b, v29
  v_exp_f32 v31, v31
  s_nop 0
  v_add_f32 v31, 1.0, v31
  v_rcp_f32 v31, v31
  s_nop 0
  buffer_store_dword v31, v28, s[44:47], s75 offen sc1
  s_add_u32 s75, s75, 128
  s_add_u32 s76, s76, 1
  s_cmp_lt_u32 s76, 4
  s_cbranch_scc1 L_gate
  s_waitcnt vmcnt(0)
  s_barrier
  s_cmp_lg_u32 s32, 0
  s_cbranch_scc1 Lsg_57
  v_mov_b32 v4, 128
  v_mov_b32 v31, 1
  s_mov_b64 exec, 1
  global_atomic_add v4, v31, s[28:29] sc1
  s_mov_b64 exec, -1
Lsg_57:
  v_mov_b32 v4, 0
  s_cmp_lg_u32 s32, 0
  s_cbranch_scc1 Lp0_58
  global_load_dword v31, v4, s[28:29] sc1
  s_branch Lp1_59
Lp0_58:
  v_mov_b32 v4, 0
  global_load_dword v31, v4, s[8:9]
Lp1_59:
  s_waitcnt vmcnt(0)
  s_cmp_lg_u32 s32, 0
  s_cbranch_scc1 Lpd_61
  v_cmp_gt_u32 vcc, 48, v31
  s_mov_b32 s95, 0x8000
  s_cmp_eq_u64 vcc, 0
  s_cbranch_scc1 Lpd_61
Lpoll_60:
  s_sleep 16
  global_load_dword v31, v4, s[28:29] sc1
  s_waitcnt vmcnt(0)
  v_cmp_gt_u32 vcc, 48, v31
  s_sub_u32 s95, s95, 1
  s_cmp_eq_u64 vcc, 0
  s_cbranch_scc1 Lpd_61
  s_cmp_lg_u32 s95, 0
  s_cbranch_scc1 Lpoll_60
Lpd_61:
  s_barrier
  s_add_u32 s88, s89, 102400
  buffer_load_dwordx4 a[128:131], v2, s[84:87], s88 offen offset:0 sc1
  buffer_load_dwordx4 a[132:135], v2, s[84:87], s88 offen offset:1024 sc1
  buffer_load_dwordx4 a[136:139], v2, s[84:87], s88 offen offset:2048 sc1
  buffer_load_dwordx4 a[140:143], v2, s[84:87], s88 offen offset:3072 sc1
  buffer_load_dwordx4 a[144:147], v3, s[84:87], s88 offen sc1
  s_add_u32 s88, s89, 122880
  buffer_load_dwordx4 a[148:151], v2, s[84:87], s88 offen offset:0 sc1
  buffer_load_dwordx4 a[152:155], v2, s[84:87], s88 offen offset:1024 sc1
  buffer_load_dwordx4 a[156:159], v2, s[84:87], s88 offen offset:2048 sc1
  buffer_load_dwordx4 a[160:163], v2, s[84:87], s88 offen offset:3072 sc1
  buffer_load_dwordx4 a[164:167], v3, s[84:87], s88 offen sc1
  s_add_u32 s88, s89, 143360
  buffer_load_dwordx4 a[168:171], v2, s[84:87], s88 offen offset:0 sc1
  buffer_load_dwordx4 a[172:175], v2, s[84:87], s88 offen offset:1024 sc1
  buffer_load_dwordx4 a[176:179], v2, s[84:87], s88 offen offset:2048 sc1
  buffer_load_dwordx4 a[180:183], v2, s[84:87], s88 offen offset:3072 sc1
  buffer_load_dwordx4 a[184:187], v3, s[84:87], s88 offen sc1
  s_add_u32 s88, s89, 163840
  buffer_load_dwordx4 a[188:191], v2, s[84:87], s88 offen offset:0 sc1
  buffer_load_dwordx4 a[192:195], v2, s[84:87], s88 offen offset:1024 sc1
  buffer_load_dwordx4 a[196:199], v2, s[84:87], s88 offen offset:2048 sc1
  s_add_u32 s88, s89, 204800
  buffer_load_dwordx4 a[236:239], v2, s[84:87], s88 offen offset:2048 sc1
  buffer_load_dwordx4 a[240:243], v2, s[84:87], s88 offen offset:3072 sc1
  buffer_load_dwordx4 a[244:247], v3, s[84:87], s88 offen sc1
  s_add_u32 s88, s89, 225280
  buffer_load_dwordx4 a[248:251], v2, s[84:87], s88 offen offset:0 sc1
  buffer_load_dwordx4 a[252:255], v2, s[84:87], s88 offen offset:1024 sc1
  buffer_load_dwordx4 a[48:51], v2, s[84:87], s88 offen offset:2048 sc1
  buffer_load_dwordx4 a[52:55], v2, s[84:87], s88 offen offset:3072 sc1
  buffer_load_dwordx4 a[56:59], v3, s[84:87], s88 offen sc1
  s_add_u32 s88, s89, 245760
  buffer_load_dwordx4 a[60:63], v2, s[84:87], s88 offen offset:0 sc1
  buffer_load_dwordx4 a[64:67], v2, s[84:87], s88 offen offset:1024 sc1
  buffer_load_dwordx4 a[68:71], v2, s[84:87], s88 offen offset:2048 sc1
  buffer_load_dwordx4 a[72:75], v2, s[84:87], s88 offen offset:3072 sc1
  buffer_load_dwordx4 a[76:79], v3, s[84:87], s88 offen sc1
  s_add_u32 s88, s89, 266240
  buffer_load_dwordx4 a[80:83], v2, s[84:87], s88 offen offset:0 sc1
  buffer_load_dwordx4 a[84:87], v2, s[84:87], s88 offen offset:1024 sc1
  buffer_load_dwordx4 a[88:91], v2, s[84:87], s88 offen offset:2048 sc1
  buffer_load_dwordx4 a[92:95], v2, s[84:87], s88 offen offset:3072 sc1
  buffer_load_dwordx4 a[108:111], v3, s[84:87], s88 offen sc1
  s_add_u32 s88, s89, 286720
  buffer_load_dwordx4 a[112:115], v2, s[84:87], s88 offen offset:0 sc1
  buffer_load_dwordx4 a[116:119], v2, s[84:87], s88 offen offset:1024 sc1
  buffer_load_dwordx4 a[0:3], v2, s[84:87], s88 offen offset:2048 sc1
  buffer_load_dwordx4 a[4:7], v2, s[84:87], s88 offen offset:3072 sc1
  buffer_load_dwordx4 a[8:11], v3, s[84:87], s88 offen sc1
  s_add_u32 s88, s89, 307200
  buffer_load_dwordx4 a[12:15], v2, s[84:87], s88 offen offset:0 sc1
  buffer_load_dwordx4 a[16:19], v2, s[84:87], s88 offen offset:1024 sc1
  buffer_load_dwordx4 a[20:23], v2, s[84:87], s88 offen offset:2048 sc1
  buffer_load_dwordx4 a[24:27], v2, s[84:87], s88 offen offset:3072 sc1
  buffer_load_dwordx4 a[28:31], v3, s[84:87], s88 offen sc1
  s_add_u32 s88, s89, 327680
  buffer_load_dwordx4 a[32:35], v2, s[84:87], s88 offen offset:0 sc1
  buffer_load_dwordx4 a[36:39], v2, s[84:87], s88 offen offset:1024 sc1
  buffer_load_dwordx4 a[40:43], v2, s[84:87], s88 offen offset:2048 sc1
  buffer_load_dwordx4 a[44:47], v2, s[84:87], s88 offen offset:3072 sc1
  buffer_load_dwordx4 a[96:99], v3, s[84:87], s88 offen sc1
  s_add_u32 s88, s89, 348160
  buffer_load_dwordx4 a[100:103], v2, s[84:87], s88 offen offset:0 sc1
  buffer_load_dwordx4 a[104:107], v2, s[84:87], s88 offen offset:1024 sc1
  s_add_u32 s100, s89, 0
  s_add_u32 m0, s89, 0
  s_nop 0
  buffer_load_dwordx4 v2, s[84:87], s100 offen offset:0 sc1 lds
  s_add_u32 m0, s89, 0
  s_nop 0
  buffer_load_dwordx4 v2, s[84:87], s100 offen offset:1024 sc1 lds
  s_add_u32 m0, s89, 0
  s_nop 0
  buffer_load_dwordx4 v2, s[84:87], s100 offen offset:2048 sc1 lds
  s_add_u32 m0, s89, 0
  s_nop 0
  buffer_load_dwordx4 v2, s[84:87], s100 offen offset:3072 sc1 lds
  s_add_u32 m0, s89, 4096
  s_nop 0
  buffer_load_dwordx4 v3, s[84:87], s100 offen sc1 lds
L_qtail:
  s_lshr_b32 s82, s37, 1
  s_mul_i32 s82, s82, 4352
  v_mov_b32 v4, s82
  s_cmp_lg_u32 s32, 0
  s_cbranch_scc1 Lp0_62
  global_load_dword v31, v4, s[90:91] sc1
  s_branch Lp1_63
Lp0_62:
  v_mov_b32 v4, 0
  global_load_dword v31, v4, s[8:9]
Lp1_63:
  v_and_b32 v24, 15, v0
  v_lshrrev_b32 v25, 4, v0
  s_mul_i32 s64, s37, 303104
  s_add_u32 s40, s30, s64
  s_addc_u32 s41, s31, 0
  s_and_b32 s41, s41, 0xffff
  s_mov_b32 s42, 0x4a000
  s_mov_b32 s43, 0x20000
  s_add_u32 s80, s32, 20
  s_lshl_b32 s80, s80, 12
  s_add_u32 s75, s32, 0
  s_and_b32 s75, s75, 3
  s_lshl_b32 s75, s75, 10
  v_add_u32 v26, s75, v2
  s_add_u32 s75, s32, 1
  s_and_b32 s75, s75, 3
  s_lshl_b32 s75, s75, 10
  v_add_u32 v27, s75, v2
  s_add_u32 s75, s32, 2
  s_and_b32 s75, s75, 3
  s_lshl_b32 s75, s75, 10
  v_add_u32 v28, s75, v2
  s_add_u32 s75, s32, 3
  s_and_b32 s75, s75, 3
  s_lshl_b32 s75, s75, 10
  v_add_u32 v29, s75, v2
  s_waitcnt vmcnt(0)
  s_cmp_lg_u32 s32, 0
  s_cbranch_scc1 Lpd_65
  v_cmp_gt_u32 vcc, 9, v31
  s_mov_b32 s95, 0x8000
  s_cmp_eq_u64 vcc, 0
  s_cbranch_scc1 Lpd_65
Lpoll_64:
  s_sleep 2
  global_load_dword v31, v4, s[90:91] sc1
  s_waitcnt vmcnt(0)
  v_cmp_gt_u32 vcc, 9, v31
  s_sub_u32 s95, s95, 1
  s_cmp_eq_u64 vcc, 0
  s_cbranch_scc1 Lpd_65
  s_cmp_lg_u32 s95, 0
  s_cbranch_scc1 Lpoll_64
Lpd_65:
  s_barrier
  s_nop 0
  buffer_load_dwordx4 v[196:199], v27, s[40:43], s80 offen sc1
  buffer_load_dwordx4 v[200:203], v28, s[40:43], s80 offen sc1
  buffer_load_dwordx4 v[204:207], v29, s[40:43], s80 offen sc1
  buffer_load_dwordx4 v[192:195], v26, s[40:43], s80 offen sc1
  s_add_u32 s80, s80, 16384
  buffer_load_dwordx4 v[212:215], v27, s[40:43], s80 offen sc1
  buffer_load_dwordx4 v[216:219], v28, s[40:43], s80 offen sc1
  buffer_load_dwordx4 v[220:223], v29, s[40:43], s80 offen sc1
  buffer_load_dwordx4 v[208:211], v26, s[40:43], s80 offen sc1
  s_add_u32 s80, s80, 16384
  buffer_load_dwordx4 v[228:231], v27, s[40:43], s80 offen sc1
  buffer_load_dwordx4 v[232:235], v28, s[40:43], s80 offen sc1
  buffer_load_dwordx4 v[236:239], v29, s[40:43], s80 offen sc1
  buffer_load_dwordx4 v[224:227], v26, s[40:43], s80 offen sc1
  s_add_u32 s80, s80, 16384
  buffer_load_dwordx4 v[244:247], v27, s[40:43], s80 offen sc1
  buffer_load_dwordx4 v[248:251], v28, s[40:43], s80 offen sc1
  buffer_load_dwordx4 v[252:255], v29, s[40:43], s80 offen sc1
  buffer_load_dwordx4 v[240:243], v26, s[40:43], s80 offen sc1
  s_add_u32 s80, s80, 16384
  buffer_load_dwordx4 v[148:151], v27, s[40:43], s80 offen sc1
  buffer_load_dwordx4 v[152:155], v28, s[40:43], s80 offen sc1
  buffer_load_dwordx4 v[156:159], v29, s[40:43], s80 offen sc1
  buffer_load_dwordx4 v[144:147], v26, s[40:43], s80 offen sc1
  s_add_u32 s80, s80, 16384
  buffer_load_dwordx4 v[164:167], v27, s[40:43], s80 offen sc1
  buffer_load_dwordx4 v[168:171], v28, s[40:43], s80 offen sc1
  buffer_load_dwordx4 v[172:175], v29, s[40:43], s80 offen sc1
  buffer_load_dwordx4 v[160:163], v26, s[40:43], s80 offen sc1
  s_add_u32 s80, s80, 16384
  buffer_load_dwordx4 v[180:183], v27, s[40:43], s80 offen sc1
  buffer_load_dwordx4 v[184:187], v28, s[40:43], s80 offen sc1
  buffer_load_dwordx4 v[188:191], v29, s[40:43], s80 offen sc1
  buffer_load_dwordx4 v[176:179], v26, s[40:43], s80 offen sc1
  s_add_u32 s80, s80, 16384
  s_add_u32 s48, s30, 0x1200000
  s_addc_u32 s49, s31, 0
  s_and_b32 s49, s49, 0xffff
  s_mov_b32 s50, 0x2000
  s_mov_b32 s51, 0x20000
  v_lshlrev_b32 v6, 2, v24
  s_add_u32 s75, s32, 1
  s_and_b32 s75, s75, 3
  s_waitcnt vmcnt(27)
  v_mfma_f32_16x16x32_bf16 v[84:87], a[128:131], v[196:199], 0
  s_mul_i32 s75, s75, 15360
  s_add_u32 s75, s75, 102400
  v_mfma_f32_16x16x32_bf16 v[88:91], a[132:135], v[196:199], 0
  s_add_u32 s88, s89, 163840
  buffer_load_dwordx4 a[200:203], v2, s[84:87], s88 offen offset:3072 sc1
  v_add_u32 v11, s75, v2
  s_add_u32 s75, s32, 2
  v_mfma_f32_16x16x32_bf16 v[92:95], a[136:139], v[196:199], 0
  s_and_b32 s75, s75, 3
  s_mul_i32 s75, s75, 15360
  v_mfma_f32_16x16x32_bf16 v[96:99], a[140:143], v[196:199], 0
  buffer_load_dwordx4 a[204:207], v3, s[84:87], s88 offen sc1
  s_add_u32 s75, s75, 107520
  v_add_u32 v12, s75, v2
  v_mfma_f32_16x16x32_bf16 v[100:103], a[144:147], v[196:199], 0
  s_add_u32 s75, s32, 3
  s_and_b32 s75, s75, 3
  s_waitcnt vmcnt(28)
  v_mfma_f32_16x16x32_bf16 v[104:107], a[128:131], v[200:203], 0
  s_mul_i32 s75, s75, 15360
  s_add_u32 s75, s75, 112640
  v_mfma_f32_16x16x32_bf16 v[108:111], a[132:135], v[200:203], 0
  s_add_u32 s88, s89, 184320
  buffer_load_dwordx4 a[208:211], v2, s[84:87], s88 offen offset:0 sc1
  v_add_u32_e64 v13, s75, v2
  s_mul_i32 s75, s32, 15360
  v_mfma_f32_16x16x32_bf16 v[112:115], a[136:139], v[200:203], 0
  s_add_u32 s75, s75, 102400
  v_add_u32_e64 v8, s75, v2
  v_mfma_f32_16x16x32_bf16 v[116:119], a[140:143], v[200:203], 0
  buffer_load_dwordx4 a[212:215], v2, s[84:87], s88 offen offset:1024 sc1
  v_add_u32 v9, 51200, v2
  s_mov_b32 s52, s26
  v_mfma_f32_16x16x32_bf16 v[120:123], a[144:147], v[200:203], 0
  s_and_b32 s53, s27, 0xffff
  s_mov_b32 s54, 0x280000
  s_waitcnt vmcnt(29)
  v_mfma_f32_16x16x32_bf16 v[124:127], a[128:131], v[204:207], 0
  s_mov_b32 s55, 0x20000
  s_lshl_b32 s81, s37, 6
  v_mfma_f32_16x16x32_bf16 v[128:131], a[132:135], v[204:207], 0
  buffer_load_dwordx4 a[216:219], v2, s[84:87], s88 offen offset:2048 sc1
  s_lshl_b32 s75, s32, 4
  s_add_u32 s81, s81, s75
  v_mfma_f32_16x16x32_bf16 v[132:135], a[136:139], v[204:207], 0
  s_lshl_b32 s74, s81, 2
  s_mul_i32 s81, s81, 1280
  v_mfma_f32_16x16x32_bf16 v[136:139], a[140:143], v[204:207], 0
  buffer_load_dwordx4 a[220:223], v2, s[84:87], s88 offen offset:3072 sc1
  s_mul_i32 s75, s38, 160
  s_add_u32 s81, s81, s75
  v_mfma_f32_16x16x32_bf16 v[140:143], a[144:147], v[204:207], 0
  v_mul_u32_u24 v16, 1280, v24
  v_lshl_add_u32 v16, v25, 3, v16
  s_waitcnt vmcnt(30)
  v_mfma_f32_16x16x32_bf16 v[64:67], a[128:131], v[192:195], 0
  s_lshr_b32 s82, s37, 1
  s_add_u32 s82, s82, 16
  v_mfma_f32_16x16x32_bf16 v[68:71], a[132:135], v[192:195], 0
  buffer_load_dwordx4 a[224:227], v3, s[84:87], s88 offen sc1
  s_mul_i32 s82, s82, 4352
  s_mov_b32 s73, 0
  v_mfma_f32_16x16x32_bf16 v[72:75], a[136:139], v[192:195], 0
  s_mul_i32 s75, s32, 15360
  s_add_u32 s75, s75, 102400
  v_mfma_f32_16x16x32_bf16 v[76:79], a[140:143], v[192:195], 0
  s_add_u32 s88, s89, 204800
  buffer_load_dwordx4 a[228:231], v2, s[84:87], s88 offen offset:0 sc1
  v_mul_u32_u24 v17, 176, v24
  v_lshl_add_u32 v17, v25, 3, v17
  v_mfma_f32_16x16x32_bf16 v[80:83], a[144:147], v[192:195], 0
  v_add_u32 v17, s75, v17
  v_mov_b32 v30, 0x7fffffff
  s_waitcnt vmcnt(31)
  v_mfma_f32_16x16x32_bf16 v[84:87], a[148:151], v[212:215], v[84:87]
  v_add_u32 v14, 0, v0
  v_mul_u32_u24 v15, 205, v14
  v_mfma_f32_16x16x32_bf16 v[88:91], a[152:155], v[212:215], v[88:91]
  buffer_load_dwordx4 a[232:235], v2, s[84:87], s88 offen offset:1024 sc1
  v_lshrrev_b32 v15, 11, v15
  v_mul_u32_u24 v7, 10, v15
  v_mfma_f32_16x16x32_bf16 v[92:95], a[156:159], v[212:215], v[92:95]
  v_sub_u32 v14, v14, v7
  v_lshlrev_b32 v14, 4, v14
  v_mfma_f32_16x16x32_bf16 v[96:99], a[160:163], v[212:215], v[96:99]
  s_add_u32 s88, s89, 348160
  buffer_load_dwordx4 v[32:35], v2, s[84:87], s88 offen offset:2048 sc1
  v_mul_u32_u24 v7, 176, v15
  v_add3_u32 v18, v7, v14, s75
  v_mfma_f32_16x16x32_bf16 v[100:103], a[164:167], v[212:215], v[100:103]
  v_mul_u32_u24 v7, 1280, v15
  v_add_u32 v21, v7, v14
  s_waitcnt vmcnt(32)
  v_mfma_f32_16x16x32_bf16 v[104:107], a[148:151], v[216:219], v[104:107]
  v_add_u32_e64 v14, 64, v0
  v_mul_u32_u24 v15, 205, v14
  v_mfma_f32_16x16x32_bf16 v[108:111], a[152:155], v[216:219], v[108:111]
  buffer_load_dwordx4 v[36:39], v2, s[84:87], s88 offen offset:3072 sc1
  v_lshrrev_b32 v15, 11, v15
  v_mul_u32_u24 v7, 10, v15
  v_mfma_f32_16x16x32_bf16 v[112:115], a[156:159], v[216:219], v[112:115]
  v_sub_u32 v14, v14, v7
  v_lshlrev_b32 v14, 4, v14
  v_mfma_f32_16x16x32_bf16 v[116:119], a[160:163], v[216:219], v[116:119]
  buffer_load_dwordx4 v[40:43], v3, s[84:87], s88 offen sc1
  v_mul_u32_u24 v7, 176, v15
  v_add3_u32 v19, v7, v14, s75
  v_mfma_f32_16x16x32_bf16 v[120:123], a[164:167], v[216:219], v[120:123]
  v_mul_u32_u24 v7, 1280, v15
  v_add_u32 v22, v7, v14
  s_waitcnt vmcnt(33)
  v_mfma_f32_16x16x32_bf16 v[124:127], a[148:151], v[220:223], v[124:127]
  v_add_u32 v14, 128, v0
  v_mul_u32_u24 v15, 205, v14
  v_mfma_f32_16x16x32_bf16 v[128:131], a[152:155], v[220:223], v[128:131]
  s_add_u32 s88, s89, 368640
  buffer_load_dwordx4 v[44:47], v2, s[84:87], s88 offen offset:0 sc1
  v_lshrrev_b32 v15, 11, v15
  v_mul_u32_u24 v7, 10, v15
  v_mfma_f32_16x16x32_bf16 v[132:135], a[156:159], v[220:223], v[132:135]
  v_sub_u32 v14, v14, v7
  v_lshlrev_b32 v14, 4, v14
  v_mfma_f32_16x16x32_bf16 v[136:139], a[160:163], v[220:223], v[136:139]
  buffer_load_dwordx4 v[48:51], v2, s[84:87], s88 offen offset:1024 sc1
  v_mul_u32_u24 v7, 176, v15
  v_add3_u32 v20, v7, v14, s75
  v_mfma_f32_16x16x32_bf16 v[140:143], a[164:167], v[220:223], v[140:143]
  v_mul_u32_u24 v7, 1280, v15
  v_add_u32 v23, v7, v14
  s_waitcnt vmcnt(34)
  v_mfma_f32_16x16x32_bf16 v[64:67], a[148:151], v[208:211], v[64:67]
  v_cmp_gt_u32 vcc, 32, v0
  s_nop 1
  v_cndmask_b32 v23, v30, v23, vcc
  v_mfma_f32_16x16x32_bf16 v[68:71], a[152:155], v[208:211], v[68:71]
  buffer_load_dwordx4 v[52:55], v2, s[84:87], s88 offen offset:2048 sc1
  v_mfma_f32_16x16x32_bf16 v[72:75], a[156:159], v[208:211], v[72:75]
  v_mfma_f32_16x16x32_bf16 v[76:79], a[160:163], v[208:211], v[76:79]
  buffer_load_dwordx4 v[56:59], v2, s[84:87], s88 offen offset:3072 sc1
  v_mfma_f32_16x16x32_bf16 v[80:83], a[164:167], v[208:211], v[80:83]
  s_waitcnt vmcnt(35)
  v_mfma_f32_16x16x32_bf16 v[84:87], a[168:171], v[228:231], v[84:87]
  v_mfma_f32_16x16x32_bf16 v[88:91], a[172:175], v[228:231], v[88:91]
  buffer_load_dwordx4 v[60:63], v3, s[84:87], s88 offen sc1
  v_mfma_f32_16x16x32_bf16 v[92:95], a[176:179], v[228:231], v[92:95]
  v_mfma_f32_16x16x32_bf16 v[96:99], a[180:183], v[228:231], v[96:99]
  s_add_u32 s100, s89, 20480
  s_add_u32 m0, s89, 20480
  s_nop 0
  buffer_load_dwordx4 v2, s[84:87], s100 offen offset:0 sc1 lds
  v_mfma_f32_16x16x32_bf16 v[100:103], a[184:187], v[228:231], v[100:103]
  s_waitcnt vmcnt(36)
  v_mfma_f32_16x16x32_bf16 v[104:107], a[168:171], v[232:235], v[104:107]
  v_mfma_f32_16x16x32_bf16 v[108:111], a[172:175], v[232:235], v[108:111]
  s_add_u32 m0, s89, 20480
  s_nop 0
  buffer_load_dwordx4 v2, s[84:87], s100 offen offset:1024 sc1 lds
  v_mfma_f32_16x16x32_bf16 v[112:115], a[176:179], v[232:235], v[112:115]
  v_mfma_f32_16x16x32_bf16 v[116:119], a[180:183], v[232:235], v[116:119]
  s_add_u32 m0, s89, 20480
  s_nop 0
  buffer_load_dwordx4 v2, s[84:87], s100 offen offset:2048 sc1 lds
  v_mfma_f32_16x16x32_bf16 v[120:123], a[184:187], v[232:235], v[120:123]
  s_waitcnt vmcnt(37)
  v_mfma_f32_16x16x32_bf16 v[124:127], a[168:171], v[236:239], v[124:127]
  v_mfma_f32_16x16x32_bf16 v[128:131], a[172:175], v[236:239], v[128:131]
  s_add_u32 m0, s89, 20480
  s_nop 0
  buffer_load_dwordx4 v2, s[84:87], s100 offen offset:3072 sc1 lds
  v_mfma_f32_16x16x32_bf16 v[132:135], a[176:179], v[236:239], v[132:135]
  v_mfma_f32_16x16x32_bf16 v[136:139], a[180:183], v[236:239], v[136:139]
  s_add_u32 m0, s89, 24576
  s_nop 0
  buffer_load_dwordx4 v3, s[84:87], s100 offen sc1 lds
  v_mfma_f32_16x16x32_bf16 v[140:143], a[184:187], v[236:239], v[140:143]
  s_waitcnt vmcnt(38)
  v_mfma_f32_16x16x32_bf16 v[64:67], a[168:171], v[224:227], v[64:67]
  v_mfma_f32_16x16x32_bf16 v[68:71], a[172:175], v[224:227], v[68:71]
  s_add_u32 s100, s89, 40960
  s_add_u32 m0, s89, 40960
  s_nop 0
  buffer_load_dwordx4 v2, s[84:87], s100 offen offset:0 sc1 lds
  v_mfma_f32_16x16x32_bf16 v[72:75], a[176:179], v[224:227], v[72:75]
  v_mfma_f32_16x16x32_bf16 v[76:79], a[180:183], v[224:227], v[76:79]
  s_add_u32 m0, s89, 40960
  s_nop 0
  buffer_load_dwordx4 v2, s[84:87], s100 offen offset:1024 sc1 lds
  v_mfma_f32_16x16x32_bf16 v[80:83], a[184:187], v[224:227], v[80:83]
  s_waitcnt vmcnt(22)
  v_mfma_f32_16x16x32_bf16 v[84:87], a[188:191], v[244:247], v[84:87]
  v_mfma_f32_16x16x32_bf16 v[88:91], a[192:195], v[244:247], v[88:91]
  s_add_u32 m0, s89, 40960
  s_nop 0
  buffer_load_dwordx4 v2, s[84:87], s100 offen offset:2048 sc1 lds
  v_mfma_f32_16x16x32_bf16 v[92:95], a[196:199], v[244:247], v[92:95]
  v_mfma_f32_16x16x32_bf16 v[96:99], a[200:203], v[244:247], v[96:99]
  s_add_u32 m0, s89, 40960
  s_nop 0
  buffer_load_dwordx4 v2, s[84:87], s100 offen offset:3072 sc1 lds
  v_mfma_f32_16x16x32_bf16 v[100:103], a[204:207], v[244:247], v[100:103]
  v_mfma_f32_16x16x32_bf16 v[104:107], a[188:191], v[248:251], v[104:107]
  v_mfma_f32_16x16x32_bf16 v[108:111], a[192:195], v[248:251], v[108:111]
  s_add_u32 m0, s89, 45056
  s_nop 0
  buffer_load_dwordx4 v3, s[84:87], s100 offen sc1 lds
  v_mfma_f32_16x16x32_bf16 v[112:115], a[196:199], v[248:251], v[112:115]
  v_mfma_f32_16x16x32_bf16 v[116:119], a[200:203], v[248:251], v[116:119]
  s_add_u32 s100, s89, 61440
  s_add_u32 m0, s89, 61440
  s_nop 0
  buffer_load_dwordx4 v2, s[84:87], s100 offen offset:0 sc1 lds
  v_mfma_f32_16x16x32_bf16 v[120:123], a[204:207], v[248:251], v[120:123]
  v_mfma_f32_16x16x32_bf16 v[124:127], a[188:191], v[252:255], v[124:127]
  v_mfma_f32_16x16x32_bf16 v[128:131], a[192:195], v[252:255], v[128:131]
  s_add_u32 m0, s89, 61440
  s_nop 0
  buffer_load_dwordx4 v2, s[84:87], s100 offen offset:1024 sc1 lds
  v_mfma_f32_16x16x32_bf16 v[132:135], a[196:199], v[252:255], v[132:135]
  v_mfma_f32_16x16x32_bf16 v[136:139], a[200:203], v[252:255], v[136:139]
  s_add_u32 m0, s89, 61440
  s_nop 0
  buffer_load_dwordx4 v2, s[84:87], s100 offen offset:2048 sc1 lds
  v_mfma_f32_16x16x32_bf16 v[140:143], a[204:207], v[252:255], v[140:143]
  v_mfma_f32_16x16x32_bf16 v[64:67], a[188:191], v[240:243], v[64:67]
  v_mfma_f32_16x16x32_bf16 v[68:71], a[192:195], v[240:243], v[68:71]
  s_add_u32 m0, s89, 61440
  s_nop 0
  buffer_load_dwordx4 v2, s[84:87], s100 offen offset:3072 sc1 lds
  v_mfma_f32_16x16x32_bf16 v[72:75], a[196:199], v[240:243], v[72:75]
  v_mfma_f32_16x16x32_bf16 v[76:79], a[200:203], v[240:243], v[76:79]
  s_add_u32 m0, s89, 65536
  s_nop 0
  buffer_load_dwordx4 v3, s[84:87], s100 offen sc1 lds
  v_mfma_f32_16x16x32_bf16 v[80:83], a[204:207], v[240:243], v[80:83]
  s_waitcnt vmcnt(25)
  v_mfma_f32_16x16x32_bf16 v[84:87], a[208:211], v[148:151], v[84:87]
  v_mfma_f32_16x16x32_bf16 v[88:91], a[212:215], v[148:151], v[88:91]
  s_add_u32 s100, s89, 81920
  s_add_u32 m0, s89, 81920
  s_nop 0
  buffer_load_dwordx4 v2, s[84:87], s100 offen offset:0 sc1 lds
  v_mfma_f32_16x16x32_bf16 v[92:95], a[216:219], v[148:151], v[92:95]
  v_mfma_f32_16x16x32_bf16 v[96:99], a[220:223], v[148:151], v[96:99]
  s_add_u32 m0, s89, 81920
  s_nop 0
  buffer_load_dwordx4 v2, s[84:87], s100 offen offset:1024 sc1 lds
  v_mfma_f32_16x16x32_bf16 v[100:103], a[224:227], v[148:151], v[100:103]
  buffer_load_dwordx4 v[148:151], v27, s[40:43], s80 offen sc1
  v_mfma_f32_16x16x32_bf16 v[104:107], a[208:211], v[152:155], v[104:107]
  v_mfma_f32_16x16x32_bf16 v[108:111], a[212:215], v[152:155], v[108:111]
  s_add_u32 m0, s89, 81920
  s_nop 0
  buffer_load_dwordx4 v2, s[84:87], s100 offen offset:2048 sc1 lds
  v_mfma_f32_16x16x32_bf16 v[112:115], a[216:219], v[152:155], v[112:115]
  v_mfma_f32_16x16x32_bf16 v[116:119], a[220:223], v[152:155], v[116:119]
  s_add_u32 m0, s89, 81920
  s_nop 0
  buffer_load_dwordx4 v2, s[84:87], s100 offen offset:3072 sc1 lds
  v_mfma_f32_16x16x32_bf16 v[120:123], a[224:227], v[152:155], v[120:123]
  buffer_load_dwordx4 v[152:155], v28, s[40:43], s80 offen sc1
  v_mfma_f32_16x16x32_bf16 v[124:127], a[208:211], v[156:159], v[124:127]
  v_mfma_f32_16x16x32_bf16 v[128:131], a[212:215], v[156:159], v[128:131]
  s_add_u32 m0, s89, 86016
  s_nop 0
  s_nop 0
  buffer_load_dwordx4 v3, s[84:87], s100 offen sc1 lds
  v_mfma_f32_16x16x32_bf16 v[132:135], a[216:219], v[156:159], v[132:135]
  v_mfma_f32_16x16x32_bf16 v[136:139], a[220:223], v[156:159], v[136:139]
  v_mfma_f32_16x16x32_bf16 v[140:143], a[224:227], v[156:159], v[140:143]
  buffer_load_dwordx4 v[156:159], v29, s[40:43], s80 offen sc1
  v_mfma_f32_16x16x32_bf16 v[64:67], a[208:211], v[144:147], v[64:67]
  v_mfma_f32_16x16x32_bf16 v[68:71], a[212:215], v[144:147], v[68:71]
  v_mfma_f32_16x16x32_bf16 v[72:75], a[216:219], v[144:147], v[72:75]
  v_mfma_f32_16x16x32_bf16 v[76:79], a[220:223], v[144:147], v[76:79]
  v_mfma_f32_16x16x32_bf16 v[80:83], a[224:227], v[144:147], v[80:83]
  buffer_load_dwordx4 v[144:147], v26, s[40:43], s80 offen sc1
  s_add_u32 s80, s80, 16384
  s_waitcnt vmcnt(32)
  s_nop 0
  v_mfma_f32_16x16x32_bf16 v[84:87], a[228:231], v[164:167], v[84:87]
  v_mfma_f32_16x16x32_bf16 v[88:91], a[232:235], v[164:167], v[88:91]
  v_mfma_f32_16x16x32_bf16 v[92:95], a[236:239], v[164:167], v[92:95]
  v_mfma_f32_16x16x32_bf16 v[96:99], a[240:243], v[164:167], v[96:99]
  v_mfma_f32_16x16x32_bf16 v[100:103], a[244:247], v[164:167], v[100:103]
  buffer_load_dwordx4 v[164:167], v27, s[40:43], s80 offen sc1
  v_mfma_f32_16x16x32_bf16 v[104:107], a[228:231], v[168:171], v[104:107]
  v_mfma_f32_16x16x32_bf16 v[108:111], a[232:235], v[168:171], v[108:111]
  v_mfma_f32_16x16x32_bf16 v[112:115], a[236:239], v[168:171], v[112:115]
  v_mfma_f32_16x16x32_bf16 v[116:119], a[240:243], v[168:171], v[116:119]
  v_mfma_f32_16x16x32_bf16 v[120:123], a[244:247], v[168:171], v[120:123]
  buffer_load_dwordx4 v[168:171], v28, s[40:43], s80 offen sc1
  v_mfma_f32_16x16x32_bf16 v[124:127], a[228:231], v[172:175], v[124:127]
  v_mfma_f32_16x16x32_bf16 v[128:131], a[232:235], v[172:175], v[128:131]
  v_mfma_f32_16x16x32_bf16 v[132:135], a[236:239], v[172:175], v[132:135]
  v_mfma_f32_16x16x32_bf16 v[136:139], a[240:243], v[172:175], v[136:139]
  v_mfma_f32_16x16x32_bf16 v[140:143], a[244:247], v[172:175], v[140:143]
  buffer_load_dwordx4 v[172:175], v29, s[40:43], s80 offen sc1
  v_mfma_f32_16x16x32_bf16 v[64:67], a[228:231], v[160:163], v[64:67]
  v_mfma_f32_16x16x32_bf16 v[68:71], a[232:235], v[160:163], v[68:71]
  v_mfma_f32_16x16x32_bf16 v[72:75], a[236:239], v[160:163], v[72:75]
  v_mfma_f32_16x16x32_bf16 v[76:79], a[240:243], v[160:163], v[76:79]
  v_mfma_f32_16x16x32_bf16 v[80:83], a[244:247], v[160:163], v[80:83]
  buffer_load_dwordx4 v[160:163], v26, s[40:43], s80 offen sc1
  s_add_u32 s80, s80, 16384
  v_mfma_f32_16x16x32_bf16 v[84:87], a[248:251], v[180:183], v[84:87]
  v_mfma_f32_16x16x32_bf16 v[88:91], a[252:255], v[180:183], v[88:91]
  v_mfma_f32_16x16x32_bf16 v[92:95], a[48:51], v[180:183], v[92:95]
  v_mfma_f32_16x16x32_bf16 v[96:99], a[52:55], v[180:183], v[96:99]
  v_mfma_f32_16x16x32_bf16 v[100:103], a[56:59], v[180:183], v[100:103]
  buffer_load_dwordx4 v[180:183], v27, s[40:43], s80 offen sc1
  v_mfma_f32_16x16x32_bf16 v[104:107], a[248:251], v[184:187], v[104:107]
  v_mfma_f32_16x16x32_bf16 v[108:111], a[252:255], v[184:187], v[108:111]
  v_mfma_f32_16x16x32_bf16 v[112:115], a[48:51], v[184:187], v[112:115]
  v_mfma_f32_16x16x32_bf16 v[116:119], a[52:55], v[184:187], v[116:119]
  v_mfma_f32_16x16x32_bf16 v[120:123], a[56:59], v[184:187], v[120:123]
  buffer_load_dwordx4 v[184:187], v28, s[40:43], s80 offen sc1
  v_mfma_f32_16x16x32_bf16 v[124:127], a[248:251], v[188:191], v[124:127]
  v_mfma_f32_16x16x32_bf16 v[128:131], a[252:255], v[188:191], v[128:131]
  s_waitcnt vmcnt(8)
  s_barrier
  v_mfma_f32_16x16x32_bf16 v[132:135], a[48:51], v[188:191], v[132:135]
  ds_read_b128 a[128:131], v2 offset:0
  v_mfma_f32_16x16x32_bf16 v[136:139], a[52:55], v[188:191], v[136:139]
  ds_read_b128 a[132:135], v2 offset:1024
  v_mfma_f32_16x16x32_bf16 v[140:143], a[56:59], v[188:191], v[140:143]
  ds_read_b128 a[136:139], v2 offset:2048
  buffer_load_dwordx4 v[188:191], v29, s[40:43], s80 offen sc1
  v_mfma_f32_16x16x32_bf16 v[64:67], a[248:251], v[176:179], v[64:67]
  ds_read_b128 a[140:143], v2 offset:3072
  v_mfma_f32_16x16x32_bf16 v[68:71], a[252:255], v[176:179], v[68:71]
  ds_read_b128 a[144:147], v2 offset:4096
  v_mfma_f32_16x16x32_bf16 v[72:75], a[48:51], v[176:179], v[72:75]
  ds_read_b128 a[148:151], v2 offset:5120
  v_mfma_f32_16x16x32_bf16 v[76:79], a[52:55], v[176:179], v[76:79]
  ds_read_b128 a[152:155], v2 offset:6144
  v_mfma_f32_16x16x32_bf16 v[80:83], a[56:59], v[176:179], v[80:83]
  ds_read_b128 a[156:159], v2 offset:7168
  buffer_load_dwordx4 v[176:179], v26, s[40:43], s80 offen sc1
  s_add_u32 s80, s80, 16384
  v_mfma_f32_16x16x32_bf16 v[84:87], a[60:63], v[148:151], v[84:87]
  ds_read_b128 a[160:163], v2 offset:8192
  v_mfma_f32_16x16x32_bf16 v[88:91], a[64:67], v[148:151], v[88:91]
  ds_read_b128 a[164:167], v2 offset:9216
  v_mfma_f32_16x16x32_bf16 v[92:95], a[68:71], v[148:151], v[92:95]
  ds_read_b128 a[168:171], v2 offset:10240
  v_mfma_f32_16x16x32_bf16 v[96:99], a[72:75], v[148:151], v[96:99]
  ds_read_b128 a[172:175], v2 offset:11264
  v_mfma_f32_16x16x32_bf16 v[100:103], a[76:79], v[148:151], v[100:103]
  ds_read_b128 a[176:179], v2 offset:12288
  buffer_load_dwordx4 v[148:151], v27, s[40:43], s80 offen sc1
  v_mfma_f32_16x16x32_bf16 v[104:107], a[60:63], v[152:155], v[104:107]
  ds_read_b128 a[180:183], v2 offset:13312
  v_mfma_f32_16x16x32_bf16 v[108:111], a[64:67], v[152:155], v[108:111]
  ds_read_b128 a[184:187], v2 offset:14336
  v_mfma_f32_16x16x32_bf16 v[112:115], a[68:71], v[152:155], v[112:115]
  ds_read_b128 a[188:191], v2 offset:15360
  v_mfma_f32_16x16x32_bf16 v[116:119], a[72:75], v[152:155], v[116:119]
  ds_read_b128 a[192:195], v2 offset:16384
  v_mfma_f32_16x16x32_bf16 v[120:123], a[76:79], v[152:155], v[120:123]
  ds_read_b128 a[196:199], v2 offset:17408
  buffer_load_dwordx4 v[152:155], v28, s[40:43], s80 offen sc1
  s_waitcnt vmcnt(11)
  s_nop 0
  v_mfma_f32_16x16x32_bf16 v[124:127], a[60:63], v[156:159], v[124:127]
  ds_read_b128 a[200:203], v2 offset:18432
  v_mfma_f32_16x16x32_bf16 v[128:131], a[64:67], v[156:159], v[128:131]
  ds_read_b128 a[204:207], v2 offset:19456
  v_mfma_f32_16x16x32_bf16 v[132:135], a[68:71], v[156:159], v[132:135]
  ds_read_b128 a[208:211], v2 offset:20480
  v_mfma_f32_16x16x32_bf16 v[136:139], a[72:75], v[156:159], v[136:139]
  ds_read_b128 a[212:215], v2 offset:21504
  v_mfma_f32_16x16x32_bf16 v[140:143], a[76:79], v[156:159], v[140:143]
  ds_read_b128 a[216:219], v2 offset:22528
  buffer_load_dwordx4 v[156:159], v29, s[40:43], s80 offen sc1
  s_waitcnt vmcnt(11)
  s_nop 0
  v_mfma_f32_16x16x32_bf16 v[64:67], a[60:63], v[144:147], v[64:67]
  ds_read_b128 a[220:223], v2 offset:23552
  v_mfma_f32_16x16x32_bf16 v[68:71], a[64:67], v[144:147], v[68:71]
  ds_read_b128 a[224:227], v2 offset:24576
  v_mfma_f32_16x16x32_bf16 v[72:75], a[68:71], v[144:147], v[72:75]
  ds_read_b128 a[228:231], v2 offset:25600
  v_mfma_f32_16x16x32_bf16 v[76:79], a[72:75], v[144:147], v[76:79]
  ds_read_b128 a[232:235], v2 offset:26624
  v_mfma_f32_16x16x32_bf16 v[80:83], a[76:79], v[144:147], v[80:83]
  ds_read_b128 a[236:239], v2 offset:27648
  buffer_load_dwordx4 v[144:147], v26, s[40:43], s80 offen sc1
  s_add_u32 s80, s80, 16384
  s_waitcnt vmcnt(11)
  s_nop 0
  v_mfma_f32_16x16x32_bf16 v[84:87], a[80:83], v[164:167], v[84:87]
  ds_read_b128 a[240:243], v2 offset:28672
  v_mfma_f32_16x16x32_bf16 v[88:91], a[84:87], v[164:167], v[88:91]
  ds_read_b128 a[244:247], v2 offset:29696
  v_mfma_f32_16x16x32_bf16 v[92:95], a[88:91], v[164:167], v[92:95]
  ds_read_b128 a[248:251], v2 offset:30720
  v_mfma_f32_16x16x32_bf16 v[96:99], a[92:95], v[164:167], v[96:99]
  ds_read_b128 a[252:255], v2 offset:31744
  v_mfma_f32_16x16x32_bf16 v[100:103], a[108:111], v[164:167], v[100:103]
  ds_read_b128 a[48:51], v2 offset:32768
  buffer_load_dwordx4 v[164:167], v27, s[40:43], s80 offen sc1
  s_waitcnt vmcnt(11)
  s_nop 0
  v_mfma_f32_16x16x32_bf16 v[104:107], a[80:83], v[168:171], v[104:107]
  ds_read_b128 a[52:55], v2 offset:33792
  v_mfma_f32_16x16x32_bf16 v[108:111], a[84:87], v[168:171], v[108:111]
  ds_read_b128 a[56:59], v2 offset:34816
  v_mfma_f32_16x16x32_bf16 v[112:115], a[88:91], v[168:171], v[112:115]
  ds_read_b128 a[60:63], v2 offset:35840
  v_mfma_f32_16x16x32_bf16 v[116:119], a[92:95], v[168:171], v[116:119]
  ds_read_b128 a[64:67], v2 offset:36864
  v_mfma_f32_16x16x32_bf16 v[120:123], a[108:111], v[168:171], v[120:123]
  ds_read_b128 a[68:71], v2 offset:37888
  buffer_load_dwordx4 v[168:171], v28, s[40:43], s80 offen sc1
  s_waitcnt vmcnt(11)
  v_mfma_f32_16x16x32_bf16 v[124:127], a[80:83], v[172:175], v[124:127]
  ds_read_b128 a[72:75], v2 offset:38912
  v_mfma_f32_16x16x32_bf16 v[128:131], a[84:87], v[172:175], v[128:131]
  ds_read_b128 a[76:79], v2 offset:39936
  v_mfma_f32_16x16x32_bf16 v[132:135], a[88:91], v[172:175], v[132:135]
  v_mfma_f32_16x16x32_bf16 v[136:139], a[92:95], v[172:175], v[136:139]
  v_mfma_f32_16x16x32_bf16 v[140:143], a[108:111], v[172:175], v[140:143]
  buffer_load_dwordx4 v[172:175], v29, s[40:43], s80 offen sc1
  s_waitcnt vmcnt(11)
  v_mfma_f32_16x16x32_bf16 v[64:67], a[80:83], v[160:163], v[64:67]
  v_mfma_f32_16x16x32_bf16 v[68:71], a[84:87], v[160:163], v[68:71]
  v_mfma_f32_16x16x32_bf16 v[72:75], a[88:91], v[160:163], v[72:75]
  v_mfma_f32_16x16x32_bf16 v[76:79], a[92:95], v[160:163], v[76:79]
  v_mfma_f32_16x16x32_bf16 v[80:83], a[108:111], v[160:163], v[80:83]
  buffer_load_dwordx4 v[160:163], v26, s[40:43], s80 offen sc1
  s_add_u32 s80, s80, 16384
  s_waitcnt vmcnt(11)
  s_nop 0
  v_mfma_f32_16x16x32_bf16 v[84:87], a[112:115], v[180:183], v[84:87]
  ds_read_b128 a[80:83], v2 offset:40960
  v_mfma_f32_16x16x32_bf16 v[88:91], a[116:119], v[180:183], v[88:91]
  ds_read_b128 a[84:87], v2 offset:41984
  v_mfma_f32_16x16x32_bf16 v[92:95], a[0:3], v[180:183], v[92:95]
  ds_read_b128 a[88:91], v2 offset:43008
  v_mfma_f32_16x16x32_bf16 v[96:99], a[4:7], v[180:183], v[96:99]
  ds_read_b128 a[92:95], v2 offset:44032
  v_mfma_f32_16x16x32_bf16 v[100:103], a[8:11], v[180:183], v[100:103]
  ds_read_b128 a[108:111], v2 offset:45056
  buffer_load_dwordx4 v[180:183], v27, s[40:43], s80 offen sc1
  s_waitcnt vmcnt(11)
  v_mfma_f32_16x16x32_bf16 v[104:107], a[112:115], v[184:187], v[104:107]
  v_mfma_f32_16x16x32_bf16 v[108:111], a[116:119], v[184:187], v[108:111]
  v_mfma_f32_16x16x32_bf16 v[112:115], a[0:3], v[184:187], v[112:115]
  v_mfma_f32_16x16x32_bf16 v[116:119], a[4:7], v[184:187], v[116:119]
  v_mfma_f32_16x16x32_bf16 v[120:123], a[8:11], v[184:187], v[120:123]
  buffer_load_dwordx4 v[184:187], v28, s[40:43], s80 offen sc1
  s_waitcnt vmcnt(11)
  v_mfma_f32_16x16x32_bf16 v[124:127], a[112:115], v[188:191], v[124:127]
  v_mfma_f32_16x16x32_bf16 v[128:131], a[116:119], v[188:191], v[128:131]
  v_mfma_f32_16x16x32_bf16 v[132:135], a[0:3], v[188:191], v[132:135]
  v_mfma_f32_16x16x32_bf16 v[136:139], a[4:7], v[188:191], v[136:139]
  v_mfma_f32_16x16x32_bf16 v[140:143], a[8:11], v[188:191], v[140:143]
  buffer_load_dwordx4 v[188:191], v29, s[40:43], s80 offen sc1
  s_waitcnt vmcnt(11)
  v_mfma_f32_16x16x32_bf16 v[64:67], a[112:115], v[176:179], v[64:67]
  v_mfma_f32_16x16x32_bf16 v[68:71], a[116:119], v[176:179], v[68:71]
  v_mfma_f32_16x16x32_bf16 v[72:75], a[0:3], v[176:179], v[72:75]
  v_mfma_f32_16x16x32_bf16 v[76:79], a[4:7], v[176:179], v[76:79]
  v_mfma_f32_16x16x32_bf16 v[80:83], a[8:11], v[176:179], v[80:83]
  buffer_load_dwordx4 v[176:179], v26, s[40:43], s80 offen sc1
  s_add_u32 s80, s80, 16384
  s_waitcnt vmcnt(11)
  v_mfma_f32_16x16x32_bf16 v[84:87], a[12:15], v[148:151], v[84:87]
  ds_read_b128 a[112:115], v2 offset:46080
  v_mfma_f32_16x16x32_bf16 v[88:91], a[16:19], v[148:151], v[88:91]
  ds_read_b128 a[116:119], v2 offset:47104
  v_mfma_f32_16x16x32_bf16 v[92:95], a[20:23], v[148:151], v[92:95]
  ds_read_b128 a[0:3], v2 offset:48128
  v_mfma_f32_16x16x32_bf16 v[96:99], a[24:27], v[148:151], v[96:99]
  ds_read_b128 a[4:7], v2 offset:49152
  v_mfma_f32_16x16x32_bf16 v[100:103], a[28:31], v[148:151], v[100:103]
  ds_read_b128 a[8:11], v2 offset:50176
  buffer_load_dwordx4 v[148:151], v27, s[40:43], s80 offen sc1
  s_waitcnt vmcnt(11)
  v_mfma_f32_16x16x32_bf16 v[104:107], a[12:15], v[152:155], v[104:107]
  v_mfma_f32_16x16x32_bf16 v[108:111], a[16:19], v[152:155], v[108:111]
  v_mfma_f32_16x16x32_bf16 v[112:115], a[20:23], v[152:155], v[112:115]
  v_mfma_f32_16x16x32_bf16 v[116:119], a[24:27], v[152:155], v[116:119]
  v_mfma_f32_16x16x32_bf16 v[120:123], a[28:31], v[152:155], v[120:123]
  buffer_load_dwordx4 v[152:155], v28, s[40:43], s80 offen sc1
  s_waitcnt vmcnt(11)
  v_mfma_f32_16x16x32_bf16 v[124:127], a[12:15], v[156:159], v[124:127]
  v_mfma_f32_16x16x32_bf16 v[128:131], a[16:19], v[156:159], v[128:131]
  v_mfma_f32_16x16x32_bf16 v[132:135], a[20:23], v[156:159], v[132:135]
  v_mfma_f32_16x16x32_bf16 v[136:139], a[24:27], v[156:159], v[136:139]
  v_mfma_f32_16x16x32_bf16 v[140:143], a[28:31], v[156:159], v[140:143]
  buffer_load_dwordx4 v[156:159], v29, s[40:43], s80 offen sc1
  s_waitcnt vmcnt(11)
  v_mfma_f32_16x16x32_bf16 v[64:67], a[12:15], v[144:147], v[64:67]
  v_mfma_f32_16x16x32_bf16 v[68:71], a[16:19], v[144:147], v[68:71]
  v_mfma_f32_16x16x32_bf16 v[72:75], a[20:23], v[144:147], v[72:75]
  v_mov_b32 v4, s82
  s_cmp_lg_u32 s32, 0
  s_cbranch_scc1 Lp0_66
  global_load_dword v31, v4, s[90:91] sc1
  s_branch Lp1_67
Lp0_66:
  v_mov_b32 v4, 0
  global_load_dword v31, v4, s[8:9]
Lp1_67:
  v_mfma_f32_16x16x32_bf16 v[76:79], a[24:27], v[144:147], v[76:79]
  v_mfma_f32_16x16x32_bf16 v[80:83], a[28:31], v[144:147], v[80:83]
  buffer_load_dwordx4 v[144:147], v26, s[40:43], s80 offen sc1
  s_add_u32 s80, s80, 16384
  s_waitcnt vmcnt(12)
  s_nop 0
  v_mfma_f32_16x16x32_bf16 v[84:87], a[32:35], v[164:167], v[84:87]
  ds_read_b128 a[12:15], v9 offset:0
  v_mfma_f32_16x16x32_bf16 v[88:91], a[36:39], v[164:167], v[88:91]
  ds_read_b128 a[16:19], v9 offset:1024
  v_mfma_f32_16x16x32_bf16 v[92:95], a[40:43], v[164:167], v[92:95]
  ds_read_b128 a[20:23], v9 offset:2048
  v_mfma_f32_16x16x32_bf16 v[96:99], a[44:47], v[164:167], v[96:99]
  ds_read_b128 a[24:27], v9 offset:3072
  v_mfma_f32_16x16x32_bf16 v[100:103], a[96:99], v[164:167], v[100:103]
  ds_read_b128 a[28:31], v9 offset:4096
  s_waitcnt vmcnt(8)
  v_mfma_f32_16x16x32_bf16 v[84:87], a[100:103], v[180:183], v[84:87]
  v_mfma_f32_16x16x32_bf16 v[88:91], a[104:107], v[180:183], v[88:91]
  v_mfma_f32_16x16x32_bf16 v[92:95], v[32:35], v[180:183], v[92:95]
  v_mfma_f32_16x16x32_bf16 v[96:99], v[36:39], v[180:183], v[96:99]
  v_mfma_f32_16x16x32_bf16 v[100:103], v[40:43], v[180:183], v[100:103]
  s_waitcnt vmcnt(4)
  v_mfma_f32_16x16x32_bf16 v[84:87], v[44:47], v[148:151], v[84:87]
  v_mfma_f32_16x16x32_bf16 v[88:91], v[48:51], v[148:151], v[88:91]
  v_mfma_f32_16x16x32_bf16 v[92:95], v[52:55], v[148:151], v[92:95]
  v_mfma_f32_16x16x32_bf16 v[96:99], v[56:59], v[148:151], v[96:99]
  v_mfma_f32_16x16x32_bf16 v[100:103], v[60:63], v[148:151], v[100:103]
  v_mfma_f32_16x16x32_bf16 v[104:107], a[32:35], v[168:171], v[104:107]
  v_mfma_f32_16x16x32_bf16 v[108:111], a[36:39], v[168:171], v[108:111]
  v_mfma_f32_16x16x32_bf16 v[112:115], a[40:43], v[168:171], v[112:115]
  s_waitcnt vmcnt(1)
  s_cmp_lg_u32 s32, 0
  s_cbranch_scc1 Lpd_69
  v_cmp_gt_u32 vcc, 16, v31
  s_mov_b32 s95, 0x8000
  s_cmp_eq_u64 vcc, 0
  s_cbranch_scc1 Lpd_69
Lpoll_68:
  s_sleep 2
  global_load_dword v31, v4, s[90:91] sc1
  s_waitcnt vmcnt(0)
  v_cmp_gt_u32 vcc, 16, v31
  s_sub_u32 s95, s95, 1
  s_cmp_eq_u64 vcc, 0
  s_cbranch_scc1 Lpd_69
  s_cmp_lg_u32 s95, 0
  s_cbranch_scc1 Lpoll_68
Lpd_69:
  s_barrier
  s_nop 0
  buffer_load_dword v5, v6, s[48:51], s74 offen sc1
  buffer_load_dwordx4 v[192:195], v26, s[40:43], s73 offen sc1
  s_add_u32 s73, s73, 4096
  buffer_load_dwordx4 v[196:199], v26, s[40:43], s73 offen sc1
  s_add_u32 s73, s73, 4096
  buffer_load_dwordx4 v[200:203], v26, s[40:43], s73 offen sc1
  s_add_u32 s73, s73, 4096
  buffer_load_dwordx4 v[204:207], v26, s[40:43], s73 offen sc1
  s_add_u32 s73, s73, 4096
  buffer_load_dwordx4 v[208:211], v26, s[40:43], s73 offen sc1
  s_add_u32 s73, s73, 4096
  buffer_load_dwordx4 v[212:215], v26, s[40:43], s73 offen sc1
  v_mfma_f32_16x16x32_bf16 v[116:119], a[44:47], v[168:171], v[116:119]
  ds_write_b128 v11, v[84:87] offset:0
  s_add_u32 s73, s73, 4096
  buffer_load_dwordx4 v[216:219], v26, s[40:43], s73 offen sc1
  v_mfma_f32_16x16x32_bf16 v[120:123], a[96:99], v[168:171], v[120:123]
  ds_write_b128 v11, v[88:91] offset:1024
  v_mfma_f32_16x16x32_bf16 v[104:107], a[100:103], v[184:187], v[104:107]
  ds_write_b128 v11, v[92:95] offset:2048
  v_mfma_f32_16x16x32_bf16 v[108:111], a[104:107], v[184:187], v[108:111]
  ds_write_b128 v11, v[96:99] offset:3072
  s_add_u32 s73, s73, 4096
  buffer_load_dwordx4 v[220:223], v26, s[40:43], s73 offen sc1
  v_mfma_f32_16x16x32_bf16 v[112:115], v[32:35], v[184:187], v[112:115]
  ds_write_b128 v11, v[100:103] offset:4096
  v_mfma_f32_16x16x32_bf16 v[116:119], v[36:39], v[184:187], v[116:119]
  s_add_u32 s73, s73, 4096
  buffer_load_dwordx4 v[224:227], v26, s[40:43], s73 offen sc1
  v_mfma_f32_16x16x32_bf16 v[120:123], v[40:43], v[184:187], v[120:123]
  v_mfma_f32_16x16x32_bf16 v[104:107], v[44:47], v[152:155], v[104:107]
  v_mfma_f32_16x16x32_bf16 v[108:111], v[48:51], v[152:155], v[108:111]
  s_add_u32 s73, s73, 4096
  buffer_load_dwordx4 v[228:231], v26, s[40:43], s73 offen sc1
  v_mfma_f32_16x16x32_bf16 v[112:115], v[52:55], v[152:155], v[112:115]
  v_mfma_f32_16x16x32_bf16 v[116:119], v[56:59], v[152:155], v[116:119]
  s_add_u32 s73, s73, 4096
  buffer_load_dwordx4 v[232:235], v26, s[40:43], s73 offen sc1
  v_mfma_f32_16x16x32_bf16 v[120:123], v[60:63], v[152:155], v[120:123]
  v_mfma_f32_16x16x32_bf16 v[124:127], a[32:35], v[172:175], v[124:127]
  v_mfma_f32_16x16x32_bf16 v[128:131], a[36:39], v[172:175], v[128:131]
  s_add_u32 s73, s73, 4096
  buffer_load_dwordx4 v[236:239], v26, s[40:43], s73 offen sc1
  v_mfma_f32_16x16x32_bf16 v[132:135], a[40:43], v[172:175], v[132:135]
  v_mfma_f32_16x16x32_bf16 v[136:139], a[44:47], v[172:175], v[136:139]
  ds_write_b128 v12, v[104:107] offset:0
  s_add_u32 s73, s73, 4096
  buffer_load_dwordx4 v[240:243], v26, s[40:43], s73 offen sc1
  v_mfma_f32_16x16x32_bf16 v[140:143], a[96:99], v[172:175], v[140:143]
  ds_write_b128 v12, v[108:111] offset:1024
  v_mfma_f32_16x16x32_bf16 v[124:127], a[100:103], v[188:191], v[124:127]
  ds_write_b128 v12, v[112:115] offset:2048
  v_mfma_f32_16x16x32_bf16 v[128:131], a[104:107], v[188:191], v[128:131]
  ds_write_b128 v12, v[116:119] offset:3072
  s_add_u32 s73, s73, 4096
  buffer_load_dwordx4 v[244:247], v26, s[40:43], s73 offen sc1
  v_mfma_f32_16x16x32_bf16 v[132:135], v[32:35], v[188:191], v[132:135]
  ds_write_b128 v12, v[120:123] offset:4096
  v_mfma_f32_16x16x32_bf16 v[136:139], v[36:39], v[188:191], v[136:139]
  s_add_u32 s73, s73, 4096
  buffer_load_dwordx4 v[248:251], v26, s[40:43], s73 offen sc1
  v_mfma_f32_16x16x32_bf16 v[140:143], v[40:43], v[188:191], v[140:143]
  v_mfma_f32_16x16x32_bf16 v[124:127], v[44:47], v[156:159], v[124:127]
  v_mfma_f32_16x16x32_bf16 v[128:131], v[48:51], v[156:159], v[128:131]
  s_add_u32 s73, s73, 4096
  buffer_load_dwordx4 v[252:255], v26, s[40:43], s73 offen sc1
  v_mfma_f32_16x16x32_bf16 v[132:135], v[52:55], v[156:159], v[132:135]
  v_mfma_f32_16x16x32_bf16 v[136:139], v[56:59], v[156:159], v[136:139]
  v_mfma_f32_16x16x32_bf16 v[140:143], v[60:63], v[156:159], v[140:143]
  v_mfma_f32_16x16x32_bf16 v[64:67], a[32:35], v[160:163], v[64:67]
  v_mfma_f32_16x16x32_bf16 v[68:71], a[36:39], v[160:163], v[68:71]
  v_mfma_f32_16x16x32_bf16 v[72:75], a[40:43], v[160:163], v[72:75]
  v_mfma_f32_16x16x32_bf16 v[76:79], a[44:47], v[160:163], v[76:79]
  ds_write_b128 v13, v[124:127] offset:0
  v_mfma_f32_16x16x32_bf16 v[80:83], a[96:99], v[160:163], v[80:83]
  ds_write_b128 v13, v[128:131] offset:1024
  v_mfma_f32_16x16x32_bf16 v[64:67], a[100:103], v[176:179], v[64:67]
  ds_write_b128 v13, v[132:135] offset:2048
  v_mfma_f32_16x16x32_bf16 v[68:71], a[104:107], v[176:179], v[68:71]
  ds_write_b128 v13, v[136:139] offset:3072
  v_mfma_f32_16x16x32_bf16 v[72:75], v[32:35], v[176:179], v[72:75]
  ds_write_b128 v13, v[140:143] offset:4096
  v_mfma_f32_16x16x32_bf16 v[76:79], v[36:39], v[176:179], v[76:79]
  v_mfma_f32_16x16x32_bf16 v[80:83], v[40:43], v[176:179], v[80:83]
  s_waitcnt vmcnt(17)
  s_nop 0
  v_mfma_f32_16x16x32_bf16 v[64:67], v[44:47], v[144:147], v[64:67]
  v_mfma_f32_16x16x32_bf16 v[68:71], v[48:51], v[144:147], v[68:71]
  v_mfma_f32_16x16x32_bf16 v[72:75], v[52:55], v[144:147], v[72:75]
  v_mfma_f32_16x16x32_bf16 v[76:79], v[56:59], v[144:147], v[76:79]
  v_mfma_f32_16x16x32_bf16 v[80:83], v[60:63], v[144:147], v[80:83]
  s_add_u32 s73, s73, 4096
  buffer_load_dwordx4 v[148:151], v26, s[40:43], s73 offen sc1
  s_add_u32 s73, s73, 4096
  buffer_load_dwordx4 v[164:167], v26, s[40:43], s73 offen sc1
  s_add_u32 s73, s73, 4096
  buffer_load_dwordx4 v[180:183], v26, s[40:43], s73 offen sc1
  s_add_u32 s73, s73, 4096
  buffer_load_dwordx4 v[152:155], v26, s[40:43], s73 offen sc1
  s_waitcnt vmcnt(20)
  v_sub_f32 v10, 1.0, v5
  v_pk_mul_f32 v[64:65], v[64:65], v[10:11] op_sel_hi:[1,0]
  v_pk_mul_f32 v[66:67], v[66:67], v[10:11] op_sel_hi:[1,0]
  v_pk_mul_f32 v[68:69], v[68:69], v[10:11] op_sel_hi:[1,0]
  v_pk_mul_f32 v[70:71], v[70:71], v[10:11] op_sel_hi:[1,0]
  v_pk_mul_f32 v[72:73], v[72:73], v[10:11] op_sel_hi:[1,0]
  v_pk_mul_f32 v[74:75], v[74:75], v[10:11] op_sel_hi:[1,0]
  v_pk_mul_f32 v[76:77], v[76:77], v[10:11] op_sel_hi:[1,0]
  v_pk_mul_f32 v[78:79], v[78:79], v[10:11] op_sel_hi:[1,0]
  v_pk_mul_f32 v[80:81], v[80:81], v[10:11] op_sel_hi:[1,0]
  v_pk_mul_f32 v[82:83], v[82:83], v[10:11] op_sel_hi:[1,0]
  s_waitcnt lgkmcnt(0)
  s_barrier
  s_waitcnt vmcnt(19)
  s_nop 0
  v_mfma_f32_16x16x32_bf16 v[64:67], a[128:131], v[192:195], v[64:67]
  ds_read_b128 a[32:35], v9 offset:5120
  v_mfma_f32_16x16x32_bf16 v[68:71], a[132:135], v[192:195], v[68:71]
  ds_read_b128 a[36:39], v9 offset:6144
  v_mfma_f32_16x16x32_bf16 v[72:75], a[136:139], v[192:195], v[72:75]
  ds_read_b128 a[40:43], v9 offset:7168
  v_mfma_f32_16x16x32_bf16 v[76:79], a[140:143], v[192:195], v[76:79]
  ds_read_b128 a[44:47], v9 offset:8192
  v_mfma_f32_16x16x32_bf16 v[80:83], a[144:147], v[192:195], v[80:83]
  ds_read_b128 a[96:99], v9 offset:9216
  s_waitcnt vmcnt(18)
  s_nop 0
  v_mfma_f32_16x16x32_bf16 v[64:67], a[148:151], v[196:199], v[64:67]
  ds_read_b128 a[100:103], v9 offset:10240
  v_mfma_f32_16x16x32_bf16 v[68:71], a[152:155], v[196:199], v[68:71]
  ds_read_b128 a[104:107], v9 offset:11264
  v_mfma_f32_16x16x32_bf16 v[72:75], a[156:159], v[196:199], v[72:75]
  ds_read_b128 v[32:35], v9 offset:12288
  v_mfma_f32_16x16x32_bf16 v[76:79], a[160:163], v[196:199], v[76:79]
  ds_read_b128 v[36:39], v9 offset:13312
  v_mfma_f32_16x16x32_bf16 v[80:83], a[164:167], v[196:199], v[80:83]
  ds_read_b128 v[40:43], v9 offset:14336
  s_waitcnt vmcnt(17)
  s_nop 0
  v_mfma_f32_16x16x32_bf16 v[64:67], a[168:171], v[200:203], v[64:67]
  ds_read_b128 v[44:47], v9 offset:15360
  v_mfma_f32_16x16x32_bf16 v[68:71], a[172:175], v[200:203], v[68:71]
  ds_read_b128 v[48:51], v9 offset:16384
  v_mfma_f32_16x16x32_bf16 v[72:75], a[176:179], v[200:203], v[72:75]
  ds_read_b128 v[52:55], v9 offset:17408
  v_mfma_f32_16x16x32_bf16 v[76:79], a[180:183], v[200:203], v[76:79]
  ds_read_b128 v[56:59], v9 offset:18432
  v_mfma_f32_16x16x32_bf16 v[80:83], a[184:187], v[200:203], v[80:83]
  ds_read_b128 v[60:63], v9 offset:19456
  s_waitcnt vmcnt(16)
  s_nop 0
  v_mfma_f32_16x16x32_bf16 v[64:67], a[188:191], v[204:207], v[64:67]
  ds_read_b128 a[128:131], v9 offset:20480
  v_mfma_f32_16x16x32_bf16 v[68:71], a[192:195], v[204:207], v[68:71]
  ds_read_b128 a[132:135], v9 offset:21504
  v_mfma_f32_16x16x32_bf16 v[72:75], a[196:199], v[204:207], v[72:75]
  ds_read_b128 a[136:139], v9 offset:22528
  v_mfma_f32_16x16x32_bf16 v[76:79], a[200:203], v[204:207], v[76:79]
  ds_read_b128 a[140:143], v9 offset:23552
  v_mfma_f32_16x16x32_bf16 v[80:83], a[204:207], v[204:207], v[80:83]
  ds_read_b128 a[144:147], v9 offset:24576
  s_waitcnt vmcnt(15)
  s_nop 0
  v_mfma_f32_16x16x32_bf16 v[64:67], a[208:211], v[208:211], v[64:67]
  ds_read_b128 a[148:151], v9 offset:25600
  v_mfma_f32_16x16x32_bf16 v[68:71], a[212:215], v[208:211], v[68:71]
  ds_read_b128 a[152:155], v9 offset:26624
  v_mfma_f32_16x16x32_bf16 v[72:75], a[216:219], v[208:211], v[72:75]
  ds_read_b128 a[156:159], v9 offset:27648
  v_mfma_f32_16x16x32_bf16 v[76:79], a[220:223], v[208:211], v[76:79]
  ds_read_b128 a[160:163], v9 offset:28672
  v_mfma_f32_16x16x32_bf16 v[80:83], a[224:227], v[208:211], v[80:83]
  ds_read_b128 a[164:167], v9 offset:29696
  s_waitcnt vmcnt(14)
  s_nop 0
  v_mfma_f32_16x16x32_bf16 v[64:67], a[228:231], v[212:215], v[64:67]
  ds_read_b128 a[168:171], v9 offset:30720
  v_mfma_f32_16x16x32_bf16 v[68:71], a[232:235], v[212:215], v[68:71]
  ds_read_b128 a[172:175], v9 offset:31744
  v_mfma_f32_16x16x32_bf16 v[72:75], a[236:239], v[212:215], v[72:75]
  ds_read_b128 a[176:179], v9 offset:32768
  v_mfma_f32_16x16x32_bf16 v[76:79], a[240:243], v[212:215], v[76:79]
  ds_read_b128 a[180:183], v9 offset:33792
  v_mfma_f32_16x16x32_bf16 v[80:83], a[244:247], v[212:215], v[80:83]
  ds_read_b128 a[184:187], v9 offset:34816
  s_waitcnt vmcnt(13)
  s_nop 0
  v_mfma_f32_16x16x32_bf16 v[64:67], a[248:251], v[216:219], v[64:67]
  ds_read_b128 a[188:191], v9 offset:35840
  v_mfma_f32_16x16x32_bf16 v[68:71], a[252:255], v[216:219], v[68:71]
  ds_read_b128 a[192:195], v9 offset:36864
  v_mfma_f32_16x16x32_bf16 v[72:75], a[48:51], v[216:219], v[72:75]
  ds_read_b128 a[196:199], v9 offset:37888
  v_mfma_f32_16x16x32_bf16 v[76:79], a[52:55], v[216:219], v[76:79]
  ds_read_b128 a[200:203], v9 offset:38912
  v_mfma_f32_16x16x32_bf16 v[80:83], a[56:59], v[216:219], v[80:83]
  ds_read_b128 a[204:207], v9 offset:39936
  s_waitcnt vmcnt(12)
  s_nop 0
  v_mfma_f32_16x16x32_bf16 v[64:67], a[60:63], v[220:223], v[64:67]
  ds_read_b128 a[208:211], v9 offset:40960
  v_mfma_f32_16x16x32_bf16 v[68:71], a[64:67], v[220:223], v[68:71]
  ds_read_b128 a[212:215], v9 offset:41984
  v_mfma_f32_16x16x32_bf16 v[72:75], a[68:71], v[220:223], v[72:75]
  ds_read_b128 a[216:219], v9 offset:43008
  v_mfma_f32_16x16x32_bf16 v[76:79], a[72:75], v[220:223], v[76:79]
  ds_read_b128 a[220:223], v9 offset:44032
  v_mfma_f32_16x16x32_bf16 v[80:83], a[76:79], v[220:223], v[80:83]
  ds_read_b128 a[224:227], v9 offset:45056
  s_waitcnt vmcnt(11)
  s_nop 0
  v_mfma_f32_16x16x32_bf16 v[64:67], a[80:83], v[224:227], v[64:67]
  ds_read_b128 a[228:231], v9 offset:46080
  v_mfma_f32_16x16x32_bf16 v[68:71], a[84:87], v[224:227], v[68:71]
  ds_read_b128 a[232:235], v9 offset:47104
  v_mfma_f32_16x16x32_bf16 v[72:75], a[88:91], v[224:227], v[72:75]
  ds_read_b128 a[236:239], v9 offset:48128
  v_mfma_f32_16x16x32_bf16 v[76:79], a[92:95], v[224:227], v[76:79]
  ds_read_b128 a[240:243], v9 offset:49152
  v_mfma_f32_16x16x32_bf16 v[80:83], a[108:111], v[224:227], v[80:83]
  ds_read_b128 a[244:247], v9 offset:50176
  s_waitcnt vmcnt(10)
  s_nop 0
  v_mfma_f32_16x16x32_bf16 v[64:67], a[112:115], v[228:231], v[64:67]
  ds_read_b128 v[84:87], v8 offset:0
  v_mfma_f32_16x16x32_bf16 v[68:71], a[116:119], v[228:231], v[68:71]
  ds_read_b128 v[88:91], v8 offset:1024
  v_mfma_f32_16x16x32_bf16 v[72:75], a[0:3], v[228:231], v[72:75]
  ds_read_b128 v[92:95], v8 offset:2048
  v_mfma_f32_16x16x32_bf16 v[76:79], a[4:7], v[228:231], v[76:79]
  ds_read_b128 v[96:99], v8 offset:3072
  v_mfma_f32_16x16x32_bf16 v[80:83], a[8:11], v[228:231], v[80:83]
  ds_read_b128 v[100:103], v8 offset:4096
  s_waitcnt vmcnt(9)
  s_nop 0
  v_mfma_f32_16x16x32_bf16 v[64:67], a[12:15], v[232:235], v[64:67]
  ds_read_b128 v[104:107], v8 offset:5120
  v_mfma_f32_16x16x32_bf16 v[68:71], a[16:19], v[232:235], v[68:71]
  ds_read_b128 v[108:111], v8 offset:6144
  v_mfma_f32_16x16x32_bf16 v[72:75], a[20:23], v[232:235], v[72:75]
  ds_read_b128 v[112:115], v8 offset:7168
  v_mfma_f32_16x16x32_bf16 v[76:79], a[24:27], v[232:235], v[76:79]
  ds_read_b128 v[116:119], v8 offset:8192
  v_mfma_f32_16x16x32_bf16 v[80:83], a[28:31], v[232:235], v[80:83]
  ds_read_b128 v[120:123], v8 offset:9216
  s_waitcnt vmcnt(8) lgkmcnt(14)
  s_nop 0
  v_mfma_f32_16x16x32_bf16 v[64:67], a[32:35], v[236:239], v[64:67]
  ds_read_b128 v[124:127], v8 offset:10240
  v_mfma_f32_16x16x32_bf16 v[68:71], a[36:39], v[236:239], v[68:71]
  ds_read_b128 v[128:131], v8 offset:11264
  v_mfma_f32_16x16x32_bf16 v[72:75], a[40:43], v[236:239], v[72:75]
  ds_read_b128 v[132:135], v8 offset:12288
  v_mfma_f32_16x16x32_bf16 v[76:79], a[44:47], v[236:239], v[76:79]
  ds_read_b128 v[136:139], v8 offset:13312
  v_mfma_f32_16x16x32_bf16 v[80:83], a[96:99], v[236:239], v[80:83]
  ds_read_b128 v[140:143], v8 offset:14336
  s_waitcnt vmcnt(7)
  v_mfma_f32_16x16x32_bf16 v[64:67], a[100:103], v[240:243], v[64:67]
  v_mfma_f32_16x16x32_bf16 v[68:71], a[104:107], v[240:243], v[68:71]
  v_mfma_f32_16x16x32_bf16 v[72:75], v[32:35], v[240:243], v[72:75]
  v_mfma_f32_16x16x32_bf16 v[76:79], v[36:39], v[240:243], v[76:79]
  v_mfma_f32_16x16x32_bf16 v[80:83], v[40:43], v[240:243], v[80:83]
  s_waitcnt vmcnt(6)
  v_mfma_f32_16x16x32_bf16 v[64:67], v[44:47], v[244:247], v[64:67]
  v_mfma_f32_16x16x32_bf16 v[68:71], v[48:51], v[244:247], v[68:71]
  v_mfma_f32_16x16x32_bf16 v[72:75], v[52:55], v[244:247], v[72:75]
  v_mfma_f32_16x16x32_bf16 v[76:79], v[56:59], v[244:247], v[76:79]
  v_mfma_f32_16x16x32_bf16 v[80:83], v[60:63], v[244:247], v[80:83]
  s_waitcnt vmcnt(5)
  v_mfma_f32_16x16x32_bf16 v[64:67], a[128:131], v[248:251], v[64:67]
  v_mfma_f32_16x16x32_bf16 v[68:71], a[132:135], v[248:251], v[68:71]
  v_mfma_f32_16x16x32_bf16 v[72:75], a[136:139], v[248:251], v[72:75]
  v_mfma_f32_16x16x32_bf16 v[76:79], a[140:143], v[248:251], v[76:79]
  v_mfma_f32_16x16x32_bf16 v[80:83], a[144:147], v[248:251], v[80:83]
  s_waitcnt vmcnt(4)
  v_mfma_f32_16x16x32_bf16 v[64:67], a[148:151], v[252:255], v[64:67]
  v_mfma_f32_16x16x32_bf16 v[68:71], a[152:155], v[252:255], v[68:71]
  v_mfma_f32_16x16x32_bf16 v[72:75], a[156:159], v[252:255], v[72:75]
  v_mfma_f32_16x16x32_bf16 v[76:79], a[160:163], v[252:255], v[76:79]
  v_mfma_f32_16x16x32_bf16 v[80:83], a[164:167], v[252:255], v[80:83]
  s_waitcnt vmcnt(3)
  v_mfma_f32_16x16x32_bf16 v[64:67], a[168:171], v[148:151], v[64:67]
  v_mfma_f32_16x16x32_bf16 v[68:71], a[172:175], v[148:151], v[68:71]
  v_mfma_f32_16x16x32_bf16 v[72:75], a[176:179], v[148:151], v[72:75]
  v_mfma_f32_16x16x32_bf16 v[76:79], a[180:183], v[148:151], v[76:79]
  v_mfma_f32_16x16x32_bf16 v[80:83], a[184:187], v[148:151], v[80:83]
  s_waitcnt vmcnt(2)
  v_mfma_f32_16x16x32_bf16 v[64:67], a[188:191], v[164:167], v[64:67]
  v_mfma_f32_16x16x32_bf16 v[68:71], a[192:195], v[164:167], v[68:71]
  v_mfma_f32_16x16x32_bf16 v[72:75], a[196:199], v[164:167], v[72:75]
  v_mfma_f32_16x16x32_bf16 v[76:79], a[200:203], v[164:167], v[76:79]
  v_mfma_f32_16x16x32_bf16 v[80:83], a[204:207], v[164:167], v[80:83]
  s_waitcnt vmcnt(1)
  v_mfma_f32_16x16x32_bf16 v[64:67], a[208:211], v[180:183], v[64:67]
  v_mfma_f32_16x16x32_bf16 v[68:71], a[212:215], v[180:183], v[68:71]
  v_mfma_f32_16x16x32_bf16 v[72:75], a[216:219], v[180:183], v[72:75]
  v_mfma_f32_16x16x32_bf16 v[76:79], a[220:223], v[180:183], v[76:79]
  v_mfma_f32_16x16x32_bf16 v[80:83], a[224:227], v[180:183], v[80:83]
  s_waitcnt vmcnt(0) lgkmcnt(14)
  v_mfma_f32_16x16x32_bf16 v[64:67], a[228:231], v[152:155], v[64:67]
  v_mfma_f32_16x16x32_bf16 v[68:71], a[232:235], v[152:155], v[68:71]
  v_mfma_f32_16x16x32_bf16 v[72:75], a[236:239], v[152:155], v[72:75]
  v_mfma_f32_16x16x32_bf16 v[76:79], a[240:243], v[152:155], v[76:79]
  v_mfma_f32_16x16x32_bf16 v[80:83], a[244:247], v[152:155], v[80:83]
  s_waitcnt lgkmcnt(0)
  s_nop 0
  v_pk_add_f32 v[84:85], v[84:85], v[104:105]
  v_pk_add_f32 v[86:87], v[86:87], v[106:107]
  v_pk_add_f32 v[88:89], v[88:89], v[108:109]
  v_pk_add_f32 v[90:91], v[90:91], v[110:111]
  v_pk_add_f32 v[92:93], v[92:93], v[112:113]
  v_pk_add_f32 v[94:95], v[94:95], v[114:115]
  v_pk_add_f32 v[96:97], v[96:97], v[116:117]
  v_pk_add_f32 v[98:99], v[98:99], v[118:119]
  v_pk_add_f32 v[100:101], v[100:101], v[120:121]
  v_pk_add_f32 v[102:103], v[102:103], v[122:123]
  v_pk_add_f32 v[84:85], v[84:85], v[124:125]
  v_pk_add_f32 v[86:87], v[86:87], v[126:127]
  v_pk_add_f32 v[88:89], v[88:89], v[128:129]
  v_pk_add_f32 v[90:91], v[90:91], v[130:131]
  v_pk_add_f32 v[92:93], v[92:93], v[132:133]
  v_pk_add_f32 v[94:95], v[94:95], v[134:135]
  v_pk_add_f32 v[96:97], v[96:97], v[136:137]
  v_pk_add_f32 v[98:99], v[98:99], v[138:139]
  v_pk_add_f32 v[100:101], v[100:101], v[140:141]
  v_pk_add_f32 v[102:103], v[102:103], v[142:143]
  v_pk_fma_f32 v[64:65], v[84:85], v[10:11], v[64:65] op_sel_hi:[1,0,1]
  v_pk_fma_f32 v[66:67], v[86:87], v[10:11], v[66:67] op_sel_hi:[1,0,1]
  v_cvt_pk_bf16_f32 v104, v64, v65
  v_cvt_pk_bf16_f32 v105, v66, v67
  ds_write_b64 v17, v[104:105] offset:0
  v_pk_fma_f32 v[68:69], v[88:89], v[10:11], v[68:69] op_sel_hi:[1,0,1]
  v_pk_fma_f32 v[70:71], v[90:91], v[10:11], v[70:71] op_sel_hi:[1,0,1]
  v_cvt_pk_bf16_f32 v106, v68, v69
  v_cvt_pk_bf16_f32 v107, v70, v71
  ds_write_b64 v17, v[106:107] offset:32
  v_pk_fma_f32 v[72:73], v[92:93], v[10:11], v[72:73] op_sel_hi:[1,0,1]
  v_pk_fma_f32 v[74:75], v[94:95], v[10:11], v[74:75] op_sel_hi:[1,0,1]
  v_cvt_pk_bf16_f32 v108, v72, v73
  v_cvt_pk_bf16_f32 v109, v74, v75
  ds_write_b64 v17, v[108:109] offset:64
  v_pk_fma_f32 v[76:77], v[96:97], v[10:11], v[76:77] op_sel_hi:[1,0,1]
  v_pk_fma_f32 v[78:79], v[98:99], v[10:11], v[78:79] op_sel_hi:[1,0,1]
  v_cvt_pk_bf16_f32 v110, v76, v77
  v_cvt_pk_bf16_f32 v111, v78, v79
  ds_write_b64 v17, v[110:111] offset:96
  v_pk_fma_f32 v[80:81], v[100:101], v[10:11], v[80:81] op_sel_hi:[1,0,1]
  v_pk_fma_f32 v[82:83], v[102:103], v[10:11], v[82:83] op_sel_hi:[1,0,1]
  v_cvt_pk_bf16_f32 v112, v80, v81
  v_cvt_pk_bf16_f32 v113, v82, v83
  ds_write_b64 v17, v[112:113] offset:128
  ds_read_b128 v[64:67], v18
  ds_read_b128 v[68:71], v19
  ds_read_b128 v[72:75], v20
  s_waitcnt lgkmcnt(2)
  buffer_store_dwordx4 v[64:67], v21, s[52:55], s81 offen sc1
  s_waitcnt lgkmcnt(1)
  buffer_store_dwordx4 v[68:71], v22, s[52:55], s81 offen sc1
  s_waitcnt lgkmcnt(0)
  buffer_store_dwordx4 v[72:75], v23, s[52:55], s81 offen sc1
  s_endpgm
L_end:
  s_endpgm
.section .rodata,"a"
.p2align 6
.amdhsa_kernel gated_mix__linear_kernel_hedgehog__swiglu_ffn__prompt_kernel
  .amdhsa_next_free_vgpr 512
  .amdhsa_next_free_sgpr 102
  .amdhsa_accum_offset 256
  .amdhsa_group_segment_fixed_size 0
  .amdhsa_kernarg_size 96
  .amdhsa_user_sgpr_count 2
  .amdhsa_user_sgpr_kernarg_segment_ptr 1
  .amdhsa_system_sgpr_workgroup_id_x 1
.end_amdhsa_kernel
```
